```python
import torch

def _softmax(x, axis=-1):
    return torch.softmax(x, dim=axis)
def _gelu(x):
    return torch.nn.functional.gelu(x, approximate="tanh")
def _silu(x):
    return torch.nn.functional.silu(x)
def _sigmoid(x):
    return torch.sigmoid(x)
def _layernorm(x, axis=-1, eps=1e-5):
    m = x.mean(dim=axis, keepdim=True)
    v = x.var(dim=axis, keepdim=True, unbiased=False)
    return (x - m) / torch.sqrt(v + eps)
def _scatter_add(tgt, idx, src, axis=0):
    return tgt.clone().index_add_(axis, idx, src)
def _segment_sum(src, seg, n):
    out = torch.zeros((n,) + src.shape[1:], dtype=src.dtype)
    return out.index_add_(0, seg, src)
def _pad(x, pw):
    flat = tuple(v for pair in reversed(pw) for v in pair)
    return torch.nn.functional.pad(x, flat)

kernel_name = 'recurrent_scan__mha_block_cached__mixer_channel_mlp__prompt'

def setup_inputs():

    _w = (lambda a: (lambda t: t.to(torch.bfloat16) if t.is_floating_point() else t)(torch.as_tensor(a)))
    def _A_setup():
        B, Sq, D = 1, 2048, 512
        H, Sk, Dh = 32, 2048, 128
        return {
            "x": _w((lambda *s: torch.randn(*s, dtype=torch.bfloat16) * 0.05)(B, Sq, D)),
            "k_cache": _w((lambda *s: torch.randn(*s, dtype=torch.bfloat16) * 1.6)(B, H, Sk, Dh)),
            "v_cache": _w((lambda *s: torch.randn(*s, dtype=torch.bfloat16) * 0.8)(B, H, Sk, Dh)),
            "wq": _w((lambda *s: torch.randn(*s, dtype=torch.bfloat16) * 1.6)(D, H * Dh) * (D ** -0.5)),
            "wo": _w((lambda *s: torch.randn(*s, dtype=torch.bfloat16) * 0.8)(H * Dh, D) * ((H * Dh) ** -0.5)),
        }
    _A_in = _A_setup()

    def _B_setup():
        B, S, D, F = 1, 2048, 512, 1792
        return {
            "x": _w((lambda *s: torch.randn(*s, dtype=torch.bfloat16) * 0.05)(B, S, D)),
            "w1": _w((lambda *s: torch.randn(*s, dtype=torch.bfloat16) * 1.6)(D, F) * (D ** -0.5)),
            "b1": _w((lambda *s: torch.randn(*s, dtype=torch.bfloat16) * 0.8)(F)),
            "w2": _w((lambda *s: torch.randn(*s, dtype=torch.bfloat16) * 0.2)(F, D) * (F ** -0.5)),
            "b2": _w((lambda *s: torch.randn(*s, dtype=torch.bfloat16) * 0.2)(D)),
        }
    _B_in = _B_setup()

    return {
        "A_x": _A_in["x"],
        "A_k_cache": _A_in["k_cache"],
        "A_v_cache": _A_in["v_cache"],
        "A_wq": _A_in["wq"],
        "A_wo": _A_in["wo"],
        "B_x": _B_in["x"],
        "B_w1": _B_in["w1"],
        "B_b1": _B_in["b1"],
        "B_w2": _B_in["w2"],
        "B_b2": _B_in["b2"],
    }

def reference(A_x, A_k_cache, A_v_cache, A_wq, A_wo, B_x, B_w1, B_b1, B_w2, B_b2):
    def _A_ref(x, k_cache, v_cache, wq, wo):
        B, Sq, D = x.shape
        H, Dh = 32, 128
        q = (lambda x, *d: x.permute(*d))((x @ wq).reshape(B, Sq, H, Dh), 0, 2, 1, 3)
        scores = torch.einsum("bhqd,bhkd->bhqk", q, k_cache) * (Dh ** -0.5)
        p = _softmax(scores, axis=-1)
        o = torch.einsum("bhqk,bhkd->bhqd", p, v_cache)
        return (lambda x, *d: x.permute(*d))(o, 0, 2, 1, 3).reshape(B, Sq, H * Dh) @ wo

    def _B_ref(x, w1, b1, w2, b2):
        y = _layernorm(x, axis=-1)
        h = _gelu(torch.einsum("bsd,df->bsf", y, w1) + b1)
        return torch.einsum("bsf,fd->bsd", h, w2) + b2

    x = A_x
    xn = _layernorm(x, axis=-1)
    s = _A_ref(xn, A_k_cache, A_v_cache, A_wq, A_wo)
    g = _silu(_B_ref(xn, B_w1, B_b1, B_w2, B_b2))
    return x + s * g
```

```asm
; @launch grid=(256,1,1) block=(256,1,1) lds=163840
.amdgcn_target "amdgcn-amd-amdhsa--gfx950"
.text
.globl recurrent_scan__mha_block_cached__mixer_channel_mlp__prompt_kernel
.p2align 12
.p2align 8
.type recurrent_scan__mha_block_cached__mixer_channel_mlp__prompt_kernel,@function
recurrent_scan__mha_block_cached__mixer_channel_mlp__prompt_kernel:
    s_cmp_ge_u32 s2, 256
    s_cbranch_scc1 L_end
    s_load_dwordx16 s[52:67], s[0:1], 0
    s_load_dwordx8 s[68:75], s[0:1], 64
    s_load_dwordx2 s[12:13], s[0:1], 96
    v_lshrrev_b32 v239, 6, v0
    v_and_b32 v236, 63, v0
    s_and_b32 s39, s2, 7
    v_readfirstlane_b32 s33, v239
    s_lshr_b32 s34, s2, 3
    s_and_b32 s49, s34, 3
    s_lshl_b32 s32, s39, 2
    s_add_u32 s32, s32, s49
    s_lshr_b32 s34, s34, 2
    v_lshrrev_b32 v237, 4, v236
    v_and_b32 v238, 15, v236
    v_lshlrev_b32 v206, 4, v236
    s_getpc_b64 s[50:51]
L_pc0:
    s_lshl_b32 s47, s49, 2
    s_add_u32 s47, s47, s33
    s_mul_i32 s47, s47, 4608
    v_min_u32 v241, 35, v236
    v_lshl_add_u32 v241, v241, 7, s47
    v_min_u32 v241, L_codeend-L_pc0-4, v241
    global_load_dword a57, v241, s[50:51]
    v_lshlrev_b32 v241, 2, v237
    v_xor_b32 v241, v241, v238
    v_lshlrev_b32 v241, 4, v241
    v_lshl_add_u32 v241, v237, 13, v241
    s_lshl_b32 s47, s33, 17
    v_add_u32 v220, s47, v241
    v_add_u32 v221, 31744, v220
    v_add_u32 v222, 63488, v220
    v_add_u32 v223, 95232, v220
    v_lshrrev_b32 v239, 3, v236
    v_and_b32 v240, 7, v236
    v_and_b32 v241, 2, v239
    v_xor_b32 v241, v241, v240
    v_lshlrev_b32 v241, 4, v241
    v_mul_u32_u24 v242, 3584, v239
    s_mul_i32 s47, s33, 57344
    v_add_u32 v242, s47, v242
    v_add_u32 v224, v242, v241
    v_xor_b32 v241, 64, v241
    v_add_u32 v242, 27648, v242
    v_add_u32 v225, v242, v241
    v_lshrrev_b32 v241, 1, v239
    v_xor_b32 v241, v241, v240
    v_lshlrev_b32 v241, 4, v241
    v_lshl_add_u32 v241, v239, 10, v241
    s_lshl_b32 s47, s33, 16
    v_add_u32 v212, s47, v241
    v_xor_b32_e64 v242, 64, v212
    v_add_u32 v213, 7168, v242
    v_add_u32 v214, 14336, v212
    v_add_u32 v215, 21504, v242
    v_add_u32 v216, 32768, v212
    v_add_u32 v217, 39936, v242
    v_add_u32 v218, 47104, v212
    v_add_u32 v219, 54272, v242
    s_lshl_b32 s47, s33, 13
    s_add_u32 s41, s47, 0
    s_lshl_b32 s47, s33, 12
    s_add_u32 s42, s47, 65536
    s_add_u32 s35, s47, 0
    s_add_u32 s36, s47, 65536
    s_lshl_b32 s47, s33, 11
    s_add_u32 s43, s47, 81920
    s_mov_b32 s44, 0
    s_mov_b32 s45, 0
    s_mov_b32 s46, 0
    s_mov_b32 s40, 0
    s_mov_b32 s18, 262144
    s_mov_b32 s19, 0x20000
    s_mov_b32 s23, 0x20000
    s_mov_b32 s27, 0x20000
    s_lshl_b32 s47, s32, 8
    s_sub_u32 s22, 4194304, s47
    s_lshl_b32 s48, s32, 7
    s_sub_u32 s26, 1835008, s48
    s_cmp_lt_u32 s32, 28
    s_cselect_b32 s26, s26, 0
    s_waitcnt lgkmcnt(0)
    s_add_u32 s20, s58, s47
    s_addc_u32 s21, s59, 0
    s_add_u32 s24, s64, s48
    s_addc_u32 s25, s65, 0
    s_lshl_b32 s47, s34, 18
    s_add_u32 s16, s52, s47
    s_addc_u32 s17, s53, 0
    s_add_u32 m0, s42, 0
    s_nop 0
    buffer_load_dwordx4 v220, s[20:23], s45 offen offset:0 lds
    v_and_b32 v247, 512, v206
    v_add_u32 v247, v247, v206
    v_lshrrev_b32 v239, 1, v238
    v_xor_b32 v239, v239, v237
    v_lshlrev_b32 v239, 4, v239
    v_lshl_add_u32 v239, v238, 7, v239
    v_add_u32 v226, s41, v239
    v_xor_b32 v227, 64, v226
    v_lshrrev_b32 v239, 2, v238
    buffer_load_dwordx4 v221, s[20:23], s45 offen offset:1024 lds
    v_and_b32 v240, 3, v236
    v_lshl_add_u32 v241, v237, 3, v239
    v_lshl_add_u32 v242, v239, 2, v240
    v_lshlrev_b32 v242, 4, v242
    v_lshl_add_u32 v242, v241, 8, v242
    v_add_u32 v242, 65536, v242
    s_lshl_b32 s47, s33, 6
    v_xor_b32 v228, s47, v242
    v_xor_b32 v229, 64, v228
    buffer_load_dwordx4 v222, s[20:23], s45 offen offset:2048 lds
    v_xor_b32 v230, 128, v228
    v_xor_b32 v231, 192, v228
    v_lshrrev_b32 v242, 1, v239
    v_and_b32 v243, 1, v237
    v_lshl_add_u32 v242, v243, 1, v242
    v_lshlrev_b32 v242, 5, v242
    v_lshl_add_u32 v242, v240, 3, v242
    v_lshl_add_u32 v242, v241, 7, v242
    v_add_u32 v242, 81920, v242
    buffer_load_dwordx4 v223, s[20:23], s45 offen offset:3072 lds
    s_and_b32 s47, s33, 2
    s_lshl_b32 s47, s47, 5
    v_xor_b32 v232, s47, v242
    v_xor_b32 v233, 32, v232
    v_xor_b32 v234, 64, v232
    v_xor_b32 v235, 96, v232
    s_lshl_b32 s47, s33, 2
    s_lshl_b32 s48, s33, 12
    s_add_u32 m0, s43, 0
    s_add_u32 s45, s45, 524288
    v_add_u32 v242, s47, v237
    buffer_load_dwordx4 v224, s[24:27], s46 offen offset:0 lds
    v_xor_b32 v242, v242, v238
    v_lshlrev_b32 v242, 4, v242
    v_lshl_add_u32 v242, v237, 8, v242
    v_add_u32 v204, s48, v242
    s_and_b32 s47, s33, 1
    s_lshl_b32 s47, s47, 1
    v_lshlrev_b32 v242, 2, v237
    v_or_b32 v242, s47, v242
    v_xor_b32 v242, v242, v238
    buffer_load_dwordx4 v225, s[24:27], s46 offen offset:1024 lds
    v_lshlrev_b32 v242, 4, v242
    v_lshl_add_u32 v242, v237, 8, v242
    v_add_u32 v205, s48, v242
    v_lshl_add_u32 v242, v239, 4, v240
    v_lshlrev_b32 v242, 8, v242
    v_xor_b32 v244, v237, v238
    v_lshl_add_u32 v242, v244, 4, v242
    s_lshl_b32 s47, s33, 6
    s_add_u32 s46, s46, 229376
    s_add_u32 m0, s41, 0
    v_xor_b32 v192, s47, v242
    buffer_load_dwordx4 v212, s[16:19], s44 offen offset:0 lds
    v_xor_b32 v193, 64, v192
    v_xor_b32 v194, 128, v192
    v_xor_b32 v195, 192, v192
    v_lshl_add_u32 v242, v237, 4, v239
    v_lshlrev_b32 v242, 8, v242
    v_lshlrev_b32 v244, 2, v239
    v_lshl_add_u32 v244, v243, 1, v244
    v_lshlrev_b32 v244, 4, v244
    v_lshl_add_u32 v244, v240, 3, v244
    buffer_load_dwordx4 v213, s[16:19], s44 offen offset:1024 lds
    v_add_u32 v242, v242, v244
    v_add_u32 v196, 65536, v242
    v_xor_b32 v197, 32, v196
    v_xor_b32_e64 v198, 64, v196
    v_xor_b32 v199, 96, v196
    v_xor_b32 v200, 128, v196
    v_xor_b32 v201, 160, v196
    v_xor_b32 v202, 192, v196
    v_xor_b32 v203, 224, v196
    buffer_load_dwordx4 v214, s[16:19], s44 offen offset:2048 lds
    v_and_b32 v242, 1, v236
    v_cmp_eq_u32 vcc, 0, v242
    v_mov_b32 v242, 0x44444444
    v_mov_b32 v244, 0xeeeeeeee
    v_cndmask_b32 v207, v244, v242, vcc
    v_cmp_eq_u32 vcc, 0, v236
    v_mov_b32 v245, 0
    v_mov_b32 v242, 0x80000000
    v_cndmask_b32 v246, v242, v245, vcc
    buffer_load_dwordx4 v215, s[16:19], s44 offen offset:3072 lds
    s_lshl_b32 s47, s32, 19
    s_add_u32 s4, s54, s47
    s_addc_u32 s5, s55, 0
    s_mov_b32 s6, 524288
    s_mov_b32 s7, 0x20000
    s_add_u32 s8, s56, s47
    s_addc_u32 s9, s57, 0
    s_mov_b32 s10, 524288
    s_mov_b32 s11, 0x20000
    s_mov_b32 s14, 51380224
    s_add_u32 m0, s41, 4096
    s_mov_b32 s15, 0x20000
    buffer_load_dwordx4 v216, s[16:19], s44 offen offset:0 lds
    s_lshl_b32 s64, s34, 3
    s_add_u32 s64, s64, s39
    s_lshl_b32 s64, s64, 2
    s_add_u32 s64, s64, s33
    s_lshl_b32 s64, s64, 7
    s_add_u32 s64, s64, 50331648
    s_lshl_b32 s65, s34, 2
    s_add_u32 s65, s65, s49
    s_lshl_b32 s65, s65, 9
    buffer_load_dwordx4 v217, s[16:19], s44 offen offset:1024 lds
    s_add_u32 s65, s65, 50397184
    v_lshlrev_b32 v208, 30, v236
    v_not_b32 v208, v208
    v_ashrrev_i32 v208, 31, v208
    v_and_b32 v208, 0x3f803f80, v208
    v_mov_b32 v209, v208
    v_mov_b32 v210, v208
    v_mov_b32_e64 v211, v208
    v_accvgpr_write_b32 a32, 0
    buffer_load_dwordx4 v218, s[16:19], s44 offen offset:2048 lds
    v_accvgpr_write_b32 a33, 0
    v_accvgpr_write_b32 a34, 0
    v_accvgpr_write_b32 a35, 0
    v_accvgpr_write_b32 a36, 0
    v_accvgpr_write_b32 a37, 0
    v_accvgpr_write_b32 a38, 0
    v_accvgpr_write_b32 a39, 0
    v_accvgpr_write_b32 a40, 0
    v_accvgpr_write_b32 a41, 0
    buffer_load_dwordx4 v219, s[16:19], s44 offen offset:3072 lds
    v_accvgpr_write_b32 a42, 0
    v_accvgpr_write_b32 a43, 0
    v_accvgpr_write_b32 a44, 0
    v_accvgpr_write_b32 a45, 0
    v_accvgpr_write_b32 a46, 0
    v_accvgpr_write_b32 a47, 0
    s_add_u32 s44, s44, 128
    s_lshl_b32 s28, s32, 2
    s_add_u32 s28, s28, s33
    s_lshl_b32 s28, s28, 11
    s_add_u32 m0, s42, 24576
    s_nop 0
    s_mov_b64 exec, 0
    s_cmp_eq_u32 s33, 0
    s_cbranch_scc1 L_hop0
    s_cmp_eq_u32 s33, 1
    s_cbranch_scc1 L_hop1
    s_cmp_eq_u32 s33, 2
    s_cbranch_scc1 L_hop2
    s_branch L_hop3
L_ret0:
    s_mov_b64 exec, -1
    buffer_load_dwordx4 v220, s[20:23], s45 offen offset:0 lds
    buffer_load_dwordx4 v221, s[20:23], s45 offen offset:1024 lds
    buffer_load_dwordx4 v222, s[20:23], s45 offen offset:2048 lds
    buffer_load_dwordx4 v223, s[20:23], s45 offen offset:3072 lds
    s_add_u32 m0, s43, 24576
    s_nop 0
    s_add_u32 s45, s45, 524288
    s_mov_b64 exec, 0
    s_cmp_eq_u32 s33, 0
    s_cbranch_scc1 L_hop4
    s_cmp_eq_u32 s33, 1
    s_cbranch_scc1 L_hop5
    s_cmp_eq_u32 s33, 2
    s_cbranch_scc1 L_hop6
    s_branch L_hop7
L_ret1:
    s_mov_b64 exec, -1
    buffer_load_dwordx4 v224, s[24:27], s46 offen offset:0 lds
    buffer_load_dwordx4 v225, s[24:27], s46 offen offset:1024 lds
    s_add_u32 s46, s46, 229376
    s_add_u32 m0, s41, 32768
    s_nop 0
    buffer_load_dwordx4 v212, s[16:19], s44 offen offset:0 lds
    buffer_load_dwordx4 v213, s[16:19], s44 offen offset:1024 lds
    s_mov_b64 exec, 0
    s_cmp_eq_u32 s33, 0
    s_cbranch_scc1 L_hop8
    s_cmp_eq_u32 s33, 1
    s_cbranch_scc1 L_hop9
    s_cmp_eq_u32 s33, 2
    s_cbranch_scc1 L_hop10
    s_branch L_hop11
L_ret2:
    s_mov_b64 exec, -1
    buffer_load_dwordx4 v214, s[16:19], s44 offen offset:2048 lds
    buffer_load_dwordx4 v215, s[16:19], s44 offen offset:3072 lds
    s_add_u32 m0, s41, 36864
    s_nop 0
    buffer_load_dwordx4 v216, s[16:19], s44 offen offset:0 lds
    buffer_load_dwordx4 v217, s[16:19], s44 offen offset:1024 lds
    s_mov_b64 exec, 0
    s_cmp_eq_u32 s33, 0
    s_cbranch_scc1 L_hop12
    s_cmp_eq_u32 s33, 1
    s_cbranch_scc1 L_hop13
    s_cmp_eq_u32 s33, 2
    s_cbranch_scc1 L_hop14
    s_branch L_hop15
L_ret3:
    s_mov_b64 exec, -1
    buffer_load_dwordx4 v218, s[16:19], s44 offen offset:2048 lds
    buffer_load_dwordx4 v219, s[16:19], s44 offen offset:3072 lds
    s_lshl_b32 s0, s49, 2
    s_add_u32 s0, s0, s64
    s_lshl_b32 s1, s33, 5
    s_add_u32 s1, s1, s39
    s_lshl_b32 s1, s1, 2
    s_add_u32 s1, s1, s65
    s_lshr_b32 s47, s39, 1
    s_lshl_b32 s47, s47, 7
    s_add_u32 s65, s65, s47
    s_branch L_main
.p2align 12
L_main:
L_hop0:
    s_cbranch_execz L_ret0
    s_waitcnt vmcnt(14)
    s_barrier
    s_nop 0
    ds_read_b64_tr_b16 a[224:225], v232 offset:0
    ds_read_b64_tr_b16 a[226:227], v232 offset:512
    ds_read_b64_tr_b16 a[228:229], v232 offset:4096
    ds_read_b64_tr_b16 a[230:231], v232 offset:4608
    ds_read_b64_tr_b16 a[232:233], v233 offset:0
    ds_read_b64_tr_b16 a[234:235], v233 offset:512
    ds_read_b64_tr_b16 a[236:237], v233 offset:4096
    ds_read_b64_tr_b16 a[238:239], v233 offset:4608
    ds_read_b64_tr_b16 a[176:177], v229 offset:0
    ds_read_b64_tr_b16 a[178:179], v229 offset:1024
    ds_read_b64_tr_b16 a[180:181], v229 offset:8192
    ds_read_b64_tr_b16 a[182:183], v229 offset:9216
    ds_read_b64_tr_b16 a[184:185], v229 offset:8
    ds_read_b64_tr_b16 a[186:187], v229 offset:1032
    ds_read_b64_tr_b16 a[188:189], v229 offset:8200
    ds_read_b64_tr_b16 a[190:191], v229 offset:9224
    ds_read_b64_tr_b16 a[160:161], v228 offset:0
    ds_read_b64_tr_b16 a[162:163], v228 offset:1024
    ds_read_b64_tr_b16 a[164:165], v228 offset:8192
    ds_read_b64_tr_b16 a[166:167], v228 offset:9216
    ds_read_b64_tr_b16 a[168:169], v228 offset:8
    ds_read_b64_tr_b16 a[170:171], v228 offset:1032
    ds_read_b64_tr_b16 a[172:173], v228 offset:8200
    ds_read_b64_tr_b16 a[174:175], v228 offset:9224
    ds_read_b128 a[128:131], v226 offset:0
    ds_read_b128 a[132:135], v227 offset:0
    ds_read_b128 a[136:139], v226 offset:2048
    ds_read_b128 a[140:143], v227 offset:2048
    ds_read_b128 a[144:147], v226 offset:4096
    ds_read_b128 a[148:151], v227 offset:4096
    ds_read_b128 a[152:155], v226 offset:6144
    ds_read_b128 a[156:159], v227 offset:6144
    s_add_u32 s44, s44, 128
    buffer_load_dwordx4 v[248:251], v247, s[16:19], s28 offen offset:0
    buffer_load_dwordx4 v[252:255], v247, s[16:19], s28 offen offset:512
    s_waitcnt lgkmcnt(0)
    v_smfmac_f32_16x16x64_bf16 a[32:35], v[208:211], a[160:167], v207
    ds_read_b64_tr_b16 a[192:193], v230 offset:0
    v_smfmac_f32_16x16x64_bf16 a[36:39], v[208:211], a[168:175], v207
    ds_read_b64_tr_b16 a[194:195], v230 offset:1024
    v_smfmac_f32_16x16x64_bf16 a[40:43], v[208:211], a[224:231], v207
    ds_read_b64_tr_b16 a[196:197], v230 offset:8192
    v_smfmac_f32_16x16x64_bf16 a[44:47], v[208:211], a[232:239], v207
    ds_read_b64_tr_b16 a[198:199], v230 offset:9216
    v_mfma_f32_16x16x32_bf16 v[128:131], a[224:227], a[128:131], 0
    ds_read_b64_tr_b16 a[200:201], v230 offset:8
    v_mfma_f32_16x16x32_bf16 v[128:131], a[228:231], a[132:135], v[128:131]
    ds_read_b64_tr_b16 a[202:203], v230 offset:1032
    v_mfma_f32_16x16x32_bf16 v[132:135], a[236:239], a[132:135], 0
    ds_read_b64_tr_b16 a[204:205], v230 offset:8200
    v_mfma_f32_16x16x32_bf16 v[132:135], a[232:235], a[128:131], v[132:135]
    ds_read_b64_tr_b16 a[206:207], v230 offset:9224
    v_mfma_f32_16x16x32_bf16 v[32:35], a[176:179], a[128:131], 0
    ds_read_b64_tr_b16 a[208:209], v231 offset:0
    s_add_u32 m0, s41, 0
    v_mfma_f32_16x16x32_bf16 v[32:35], a[180:183], a[132:135], v[32:35]
    buffer_load_dwordx4 v212, s[16:19], s44 offen offset:0 lds
    v_mfma_f32_16x16x32_bf16 v[36:39], a[188:191], a[132:135], 0
    ds_read_b64_tr_b16 a[210:211], v231 offset:1024
    v_mfma_f32_16x16x32_bf16 v[36:39], a[184:187], a[128:131], v[36:39]
    ds_read_b64_tr_b16 a[212:213], v231 offset:8192
    v_mfma_f32_16x16x32_bf16 v[0:3], a[160:163], a[128:131], 0
    ds_read_b64_tr_b16 a[214:215], v231 offset:9216
    v_mfma_f32_16x16x32_bf16 v[0:3], a[164:167], a[132:135], v[0:3]
    ds_read_b64_tr_b16 a[216:217], v231 offset:8
    v_mfma_f32_16x16x32_bf16 v[4:7], a[172:175], a[132:135], 0
    buffer_load_dwordx4 v213, s[16:19], s44 offen offset:1024 lds
    v_mfma_f32_16x16x32_bf16 v[4:7], a[168:171], a[128:131], v[4:7]
    ds_read_b64_tr_b16 a[218:219], v231 offset:1032
    v_mfma_f32_16x16x32_bf16 v[12:15], a[168:171], a[136:139], 0
    ds_read_b64_tr_b16 a[220:221], v231 offset:8200
    v_mfma_f32_16x16x32_bf16 v[12:15], a[172:175], a[140:143], v[12:15]
    ds_read_b64_tr_b16 a[222:223], v231 offset:9224
    v_mfma_f32_16x16x32_bf16 v[8:11], a[164:167], a[140:143], 0
    ds_read_b64_tr_b16 a[240:241], v234 offset:0
    v_mfma_f32_16x16x32_bf16 v[8:11], a[160:163], a[136:139], v[8:11]
    buffer_load_dwordx4 v214, s[16:19], s44 offen offset:2048 lds
    v_mfma_f32_16x16x32_bf16 v[44:47], a[184:187], a[136:139], 0
    ds_read_b64_tr_b16 a[242:243], v234 offset:512
    v_mfma_f32_16x16x32_bf16 v[44:47], a[188:191], a[140:143], v[44:47]
    ds_read_b64_tr_b16 a[244:245], v234 offset:4096
    v_mfma_f32_16x16x32_bf16 v[40:43], a[180:183], a[140:143], 0
    ds_read_b64_tr_b16 a[246:247], v234 offset:4608
    v_mfma_f32_16x16x32_bf16 v[40:43], a[176:179], a[136:139], v[40:43]
    ds_read_b64_tr_b16 a[248:249], v235 offset:0
    v_mfma_f32_16x16x32_bf16 v[140:143], a[232:235], a[136:139], 0
    buffer_load_dwordx4 v215, s[16:19], s44 offen offset:3072 lds
    v_mfma_f32_16x16x32_bf16 v[140:143], a[236:239], a[140:143], v[140:143]
    ds_read_b64_tr_b16 a[250:251], v235 offset:512
    s_add_u32 m0, s41, 4096
    v_mfma_f32_16x16x32_bf16 v[136:139], a[228:231], a[140:143], 0
    ds_read_b64_tr_b16 a[252:253], v235 offset:4096
    v_mfma_f32_16x16x32_bf16 v[136:139], a[224:227], a[136:139], v[136:139]
    ds_read_b64_tr_b16 a[254:255], v235 offset:4608
    v_mfma_f32_16x16x32_bf16 v[144:147], a[224:227], a[144:147], 0
    v_mfma_f32_16x16x32_bf16 v[144:147], a[228:231], a[148:151], v[144:147]
    buffer_load_dwordx4 v216, s[16:19], s44 offen offset:0 lds
    v_mfma_f32_16x16x32_bf16 v[148:151], a[236:239], a[148:151], 0
    v_mfma_f32_16x16x32_bf16 v[148:151], a[232:235], a[144:147], v[148:151]
    v_mfma_f32_16x16x32_bf16 v[48:51], a[176:179], a[144:147], 0
    v_mfma_f32_16x16x32_bf16 v[48:51], a[180:183], a[148:151], v[48:51]
    v_mfma_f32_16x16x32_bf16 v[52:55], a[188:191], a[148:151], 0
    buffer_load_dwordx4 v217, s[16:19], s44 offen offset:1024 lds
    v_mfma_f32_16x16x32_bf16 v[52:55], a[184:187], a[144:147], v[52:55]
    v_mfma_f32_16x16x32_bf16 v[16:19], a[160:163], a[144:147], 0
    v_mfma_f32_16x16x32_bf16 v[16:19], a[164:167], a[148:151], v[16:19]
    v_mfma_f32_16x16x32_bf16 v[20:23], a[172:175], a[148:151], 0
    v_mfma_f32_16x16x32_bf16 v[20:23], a[168:171], a[144:147], v[20:23]
    buffer_load_dwordx4 v218, s[16:19], s44 offen offset:2048 lds
    v_mfma_f32_16x16x32_bf16 v[28:31], a[168:171], a[152:155], 0
    v_mfma_f32_16x16x32_bf16 v[28:31], a[172:175], a[156:159], v[28:31]
    v_mfma_f32_16x16x32_bf16 v[24:27], a[164:167], a[156:159], 0
    v_mfma_f32_16x16x32_bf16 v[24:27], a[160:163], a[152:155], v[24:27]
    v_mfma_f32_16x16x32_bf16 v[60:63], a[184:187], a[152:155], 0
    buffer_load_dwordx4 v219, s[16:19], s44 offen offset:3072 lds
    v_mfma_f32_16x16x32_bf16 v[60:63], a[188:191], a[156:159], v[60:63]
    s_add_u32 s44, s44, 128
    v_mfma_f32_16x16x32_bf16 v[56:59], a[180:183], a[156:159], 0
    v_mfma_f32_16x16x32_bf16 v[56:59], a[176:179], a[152:155], v[56:59]
    v_mfma_f32_16x16x32_bf16 v[156:159], a[232:235], a[152:155], 0
    v_mfma_f32_16x16x32_bf16 v[156:159], a[236:239], a[156:159], v[156:159]
    v_mfma_f32_16x16x32_bf16 v[152:155], a[228:231], a[156:159], 0
    v_mfma_f32_16x16x32_bf16 v[152:155], a[224:227], a[152:155], v[152:155]
    s_waitcnt vmcnt(10) lgkmcnt(0)
    v_mfma_f32_16x16x32_bf16 v[64:67], a[192:195], a[128:131], 0
    s_barrier
    v_mfma_f32_16x16x32_bf16 v[64:67], a[196:199], a[132:135], v[64:67]
    ds_read_b64_tr_b16 a[224:225], v232 offset:24576
    s_add_u32 m0, s42, 0
    v_mfma_f32_16x16x32_bf16 v[68:71], a[204:207], a[132:135], 0
    buffer_load_dwordx4 v220, s[20:23], s45 offen offset:0 lds
    v_mfma_f32_16x16x32_bf16 v[68:71], a[200:203], a[128:131], v[68:71]
    ds_read_b64_tr_b16 a[226:227], v232 offset:25088
    v_mfma_f32_16x16x32_bf16 v[96:99], a[208:211], a[128:131], 0
    ds_read_b64_tr_b16 a[228:229], v232 offset:28672
    v_mfma_f32_16x16x32_bf16 v[96:99], a[212:215], a[132:135], v[96:99]
    ds_read_b64_tr_b16 a[230:231], v232 offset:29184
    v_mfma_f32_16x16x32_bf16 v[100:103], a[220:223], a[132:135], 0
    ds_read_b64_tr_b16 a[232:233], v233 offset:24576
    v_mfma_f32_16x16x32_bf16 v[100:103], a[216:219], a[128:131], v[100:103]
    buffer_load_dwordx4 v221, s[20:23], s45 offen offset:1024 lds
    v_mfma_f32_16x16x32_bf16 v[160:163], a[240:243], a[128:131], 0
    ds_read_b64_tr_b16 a[234:235], v233 offset:25088
    v_mfma_f32_16x16x32_bf16 v[160:163], a[244:247], a[132:135], v[160:163]
    ds_read_b64_tr_b16 a[236:237], v233 offset:28672
    s_waitcnt vmcnt(10)
    v_lshlrev_b32_e64 v242, 16, v248
    v_mfma_f32_16x16x32_bf16 v[164:167], a[252:255], a[132:135], 0
    ds_read_b64_tr_b16 a[238:239], v233 offset:29184
    v_and_b32 v243, 0xffff0000, v248
    v_mfma_f32_16x16x32_bf16 v[164:167], a[248:251], a[128:131], v[164:167]
    ds_read_b64_tr_b16 a[176:177], v229 offset:24576
    v_add_f32_e64 v239, v242, v243
    v_mfma_f32_16x16x32_bf16 v[172:175], a[248:251], a[136:139], 0
    buffer_load_dwordx4 v222, s[20:23], s45 offen offset:2048 lds
    v_mfma_f32_16x16x32_bf16 v[172:175], a[252:255], a[140:143], v[172:175]
    ds_read_b64_tr_b16 a[178:179], v229 offset:25600
    v_mul_f32_e64 v240, v242, v242
    v_mfma_f32_16x16x32_bf16 v[168:171], a[244:247], a[140:143], 0
    ds_read_b64_tr_b16 a[180:181], v229 offset:32768
    v_fmac_f32_e64 v240, v243, v243
    v_mfma_f32_16x16x32_bf16 v[168:171], a[240:243], a[136:139], v[168:171]
    ds_read_b64_tr_b16 a[182:183], v229 offset:33792
    v_lshlrev_b32_e64 v242, 16, v249
    v_mfma_f32_16x16x32_bf16 v[108:111], a[216:219], a[136:139], 0
    ds_read_b64_tr_b16 a[184:185], v229 offset:24584
    v_and_b32 v243, 0xffff0000, v249
    v_mfma_f32_16x16x32_bf16 v[108:111], a[220:223], a[140:143], v[108:111]
    buffer_load_dwordx4 v223, s[20:23], s45 offen offset:3072 lds
    v_mfma_f32_16x16x32_bf16 v[104:107], a[212:215], a[140:143], 0
    ds_read_b64_tr_b16 a[186:187], v229 offset:25608
    s_add_u32 m0, s43, 0
    s_add_u32 s45, s45, 524288
    v_add_f32 v239, v239, v242
    v_mfma_f32_16x16x32_bf16 v[104:107], a[208:211], a[136:139], v[104:107]
    ds_read_b64_tr_b16 a[188:189], v229 offset:32776
    v_fmac_f32_e64 v240, v242, v242
    v_mfma_f32_16x16x32_bf16 v[76:79], a[200:203], a[136:139], 0
    ds_read_b64_tr_b16 a[190:191], v229 offset:33800
    v_add_f32_e64 v239, v239, v243
    v_mfma_f32_16x16x32_bf16 v[76:79], a[204:207], a[140:143], v[76:79]
    ds_read_b64_tr_b16 a[160:161], v228 offset:24576
    v_fmac_f32_e64 v240, v243, v243
    v_mfma_f32_16x16x32_bf16 v[72:75], a[196:199], a[140:143], 0
    buffer_load_dwordx4 v224, s[24:27], s46 offen offset:0 lds
    v_mfma_f32_16x16x32_bf16 v[72:75], a[192:195], a[136:139], v[72:75]
    ds_read_b64_tr_b16 a[162:163], v228 offset:25600
    v_lshlrev_b32_e64 v242, 16, v250
    v_mfma_f32_16x16x32_bf16 v[80:83], a[192:195], a[144:147], 0
    ds_read_b64_tr_b16 a[164:165], v228 offset:32768
    v_and_b32 v243, 0xffff0000, v250
    v_mfma_f32_16x16x32_bf16 v[80:83], a[196:199], a[148:151], v[80:83]
    ds_read_b64_tr_b16 a[166:167], v228 offset:33792
    v_add_f32_e64 v239, v239, v242
    v_mfma_f32_16x16x32_bf16 v[84:87], a[204:207], a[148:151], 0
    ds_read_b64_tr_b16 a[168:169], v228 offset:24584
    v_fmac_f32_e64 v240, v242, v242
    v_mfma_f32_16x16x32_bf16 v[84:87], a[200:203], a[144:147], v[84:87]
    buffer_load_dwordx4 v225, s[24:27], s46 offen offset:1024 lds
    v_mfma_f32_16x16x32_bf16 v[112:115], a[208:211], a[144:147], 0
    ds_read_b64_tr_b16 a[170:171], v228 offset:25608
    s_add_u32 s46, s46, 229376
    v_add_f32_e64 v239, v239, v243
    v_mfma_f32_16x16x32_bf16 v[112:115], a[212:215], a[148:151], v[112:115]
    ds_read_b64_tr_b16 a[172:173], v228 offset:32776
    v_fmac_f32_e64 v240, v243, v243
    v_mfma_f32_16x16x32_bf16 v[116:119], a[220:223], a[148:151], 0
    ds_read_b64_tr_b16 a[174:175], v228 offset:33800
    v_lshlrev_b32_e64 v242, 16, v251
    v_mfma_f32_16x16x32_bf16 v[116:119], a[216:219], a[144:147], v[116:119]
    ds_read_b128 a[96:99], v226 offset:32768
    v_and_b32 v243, 0xffff0000, v251
    v_mfma_f32_16x16x32_bf16 v[176:179], a[240:243], a[144:147], 0
    buffer_store_dword v245, v246, s[12:15], s0 offen sc1
    v_mfma_f32_16x16x32_bf16 v[176:179], a[244:247], a[148:151], v[176:179]
    ds_read_b128 a[100:103], v227 offset:32768
    v_add_f32_e64 v239, v239, v242
    v_mfma_f32_16x16x32_bf16 v[180:183], a[252:255], a[148:151], 0
    ds_read_b128 a[104:107], v226 offset:34816
    v_fmac_f32_e64 v240, v242, v242
    v_mfma_f32_16x16x32_bf16 v[180:183], a[248:251], a[144:147], v[180:183]
    ds_read_b128 a[108:111], v227 offset:34816
    v_add_f32_e64 v239, v239, v243
    v_mfma_f32_16x16x32_bf16 v[188:191], a[248:251], a[152:155], 0
    ds_read_b128 a[112:115], v226 offset:36864
    v_fmac_f32_e64 v240, v243, v243
    v_mfma_f32_16x16x32_bf16 v[188:191], a[252:255], a[156:159], v[188:191]
    buffer_store_dword v245, v246, s[12:15], s1 offen sc1
    v_mfma_f32_16x16x32_bf16 v[184:187], a[244:247], a[156:159], 0
    ds_read_b128 a[116:119], v227 offset:36864
    v_lshlrev_b32_e64 v242, 16, v252
    v_mfma_f32_16x16x32_bf16 v[184:187], a[240:243], a[152:155], v[184:187]
    ds_read_b128 a[120:123], v226 offset:38912
    v_and_b32 v243, 0xffff0000, v252
    v_mfma_f32_16x16x32_bf16 v[124:127], a[216:219], a[152:155], 0
    ds_read_b128 a[124:127], v227 offset:38912
    v_add_f32_e64 v239, v239, v242
    v_mfma_f32_16x16x32_bf16 v[124:127], a[220:223], a[156:159], v[124:127]
    v_fmac_f32 v240, v242, v242
    v_add_f32 v239, v239, v243
    v_mfma_f32_16x16x32_bf16 v[120:123], a[212:215], a[156:159], 0
    v_fmac_f32 v240, v243, v243
    v_lshlrev_b32 v242, 16, v253
    v_mfma_f32_16x16x32_bf16 v[120:123], a[208:211], a[152:155], v[120:123]
    v_and_b32 v243, 0xffff0000, v253
    v_add_f32_e64 v239, v239, v242
    v_mfma_f32_16x16x32_bf16 v[92:95], a[200:203], a[152:155], 0
    v_fmac_f32 v240, v242, v242
    v_add_f32 v239, v239, v243
    v_mfma_f32_16x16x32_bf16 v[92:95], a[204:207], a[156:159], v[92:95]
    v_fmac_f32 v240, v243, v243
    v_lshlrev_b32 v242, 16, v254
    v_mfma_f32_16x16x32_bf16 v[88:91], a[196:199], a[156:159], 0
    v_and_b32 v243, 0xffff0000, v254
    v_add_f32_e64 v239, v239, v242
    v_mfma_f32_16x16x32_bf16 v[88:91], a[192:195], a[152:155], v[88:91]
    v_fmac_f32 v240, v242, v242
    v_add_f32 v239, v239, v243
    s_waitcnt lgkmcnt(0)
    v_smfmac_f32_16x16x64_bf16 a[32:35], v[208:211], a[160:167], v207
    ds_read_b64_tr_b16 a[192:193], v230 offset:24576
    v_fmac_f32 v240, v243, v243
    v_smfmac_f32_16x16x64_bf16 a[36:39], v[208:211], a[168:175], v207
    ds_read_b64_tr_b16 a[194:195], v230 offset:25600
    v_lshlrev_b32_e64 v242, 16, v255
    v_smfmac_f32_16x16x64_bf16 a[40:43], v[208:211], a[224:231], v207
    ds_read_b64_tr_b16 a[196:197], v230 offset:32768
    v_and_b32 v243, 0xffff0000, v255
    v_smfmac_f32_16x16x64_bf16 a[44:47], v[208:211], a[232:239], v207
    ds_read_b64_tr_b16 a[198:199], v230 offset:33792
    v_add_f32_e64 v239, v239, v242
    v_mfma_f32_16x16x32_bf16 v[128:131], a[224:227], a[96:99], v[128:131]
    ds_read_b64_tr_b16 a[200:201], v230 offset:24584
    v_fmac_f32_e64 v240, v242, v242
    v_mfma_f32_16x16x32_bf16 v[128:131], a[228:231], a[100:103], v[128:131]
    ds_read_b64_tr_b16 a[202:203], v230 offset:25608
    v_add_f32_e64 v239, v239, v243
    v_mfma_f32_16x16x32_bf16 v[132:135], a[236:239], a[100:103], v[132:135]
    ds_read_b64_tr_b16 a[204:205], v230 offset:32776
    v_fmac_f32_e64 v240, v243, v243
    v_mfma_f32_16x16x32_bf16 v[132:135], a[232:235], a[96:99], v[132:135]
    ds_read_b64_tr_b16 a[206:207], v230 offset:33800
    v_and_b32_e64 v241, 31, v236
    v_mfma_f32_16x16x32_bf16 v[32:35], a[176:179], a[96:99], v[32:35]
    ds_read_b64_tr_b16 a[208:209], v231 offset:24576
    s_add_u32 m0, s41, 32768
    v_add_f32_dpp v239, v239, v239 row_ror:8 row_mask:0xf bank_mask:0xf
    v_mfma_f32_16x16x32_bf16 v[32:35], a[180:183], a[100:103], v[32:35]
    buffer_load_dwordx4 v212, s[16:19], s44 offen offset:0 lds
    v_mfma_f32_16x16x32_bf16 v[36:39], a[188:191], a[100:103], v[36:39]
    ds_read_b64_tr_b16 a[210:211], v231 offset:25600
    v_add_f32_dpp v240, v240, v240 row_ror:8 row_mask:0xf bank_mask:0xf
    v_mfma_f32_16x16x32_bf16 v[36:39], a[184:187], a[96:99], v[36:39]
    ds_read_b64_tr_b16 a[212:213], v231 offset:32768
    v_lshrrev_b32_e64 v248, 5, v236
    v_mfma_f32_16x16x32_bf16 v[0:3], a[160:163], a[96:99], v[0:3]
    ds_read_b64_tr_b16 a[214:215], v231 offset:33792
    v_add_f32_dpp v239, v239, v239 row_ror:4 row_mask:0xf bank_mask:0xf
    v_mfma_f32_16x16x32_bf16 v[0:3], a[164:167], a[100:103], v[0:3]
    ds_read_b64_tr_b16 a[216:217], v231 offset:24584
    v_add_f32_dpp v240, v240, v240 row_ror:4 row_mask:0xf bank_mask:0xf
    v_mfma_f32_16x16x32_bf16 v[4:7], a[172:175], a[100:103], v[4:7]
    buffer_load_dwordx4 v213, s[16:19], s44 offen offset:1024 lds
    v_mfma_f32_16x16x32_bf16 v[4:7], a[168:171], a[96:99], v[4:7]
    ds_read_b64_tr_b16 a[218:219], v231 offset:25608
    v_lshlrev_b32_e64 v248, 4, v248
    v_mfma_f32_16x16x32_bf16 v[12:15], a[168:171], a[104:107], v[12:15]
    ds_read_b64_tr_b16 a[220:221], v231 offset:32776
    v_add_f32_dpp v239, v239, v239 row_ror:2 row_mask:0xf bank_mask:0xf
    v_mfma_f32_16x16x32_bf16 v[12:15], a[172:175], a[108:111], v[12:15]
    ds_read_b64_tr_b16 a[222:223], v231 offset:33800
    v_add_f32_dpp v240, v240, v240 row_ror:2 row_mask:0xf bank_mask:0xf
    v_mfma_f32_16x16x32_bf16 v[8:11], a[164:167], a[108:111], v[8:11]
    ds_read_b64_tr_b16 a[240:241], v234 offset:24576
    v_lshl_add_u32 v248, v241, 8, v248
    v_mfma_f32_16x16x32_bf16 v[8:11], a[160:163], a[104:107], v[8:11]
    buffer_load_dwordx4 v214, s[16:19], s44 offen offset:2048 lds
    v_mfma_f32_16x16x32_bf16 v[44:47], a[184:187], a[104:107], v[44:47]
    ds_read_b64_tr_b16 a[242:243], v234 offset:25088
    v_add_f32_dpp v239, v239, v239 row_ror:1 row_mask:0xf bank_mask:0xf
    v_mfma_f32_16x16x32_bf16 v[44:47], a[188:191], a[108:111], v[44:47]
    ds_read_b64_tr_b16 a[244:245], v234 offset:28672
    v_add_f32_dpp v240, v240, v240 row_ror:1 row_mask:0xf bank_mask:0xf
    v_mfma_f32_16x16x32_bf16 v[40:43], a[180:183], a[108:111], v[40:43]
    ds_read_b64_tr_b16 a[246:247], v234 offset:29184
    v_mov_b32_e64 v242, v239
    v_mfma_f32_16x16x32_bf16 v[40:43], a[176:179], a[104:107], v[40:43]
    ds_read_b64_tr_b16 a[248:249], v235 offset:24576
    v_mov_b32_e64 v243, v240
    v_mfma_f32_16x16x32_bf16 v[140:143], a[232:235], a[104:107], v[140:143]
    buffer_load_dwordx4 v215, s[16:19], s44 offen offset:3072 lds
    v_mfma_f32_16x16x32_bf16 v[140:143], a[236:239], a[108:111], v[140:143]
    ds_read_b64_tr_b16 a[250:251], v235 offset:25088
    s_add_u32 m0, s41, 36864
    v_cmp_gt_u32_e64 vcc, 3, v241
    v_mfma_f32_16x16x32_bf16 v[136:139], a[228:231], a[108:111], v[136:139]
    ds_read_b64_tr_b16 a[252:253], v235 offset:28672
    v_bfrev_b32_e64 v249, 1
    v_mfma_f32_16x16x32_bf16 v[136:139], a[224:227], a[104:107], v[136:139]
    ds_read_b64_tr_b16 a[254:255], v235 offset:29184
    v_permlane16_swap_b32 v239, v242
    v_mfma_f32_16x16x32_bf16 v[144:147], a[224:227], a[112:115], v[144:147]
    v_permlane16_swap_b32 v240, v243
    v_cndmask_b32_e64 v248, v249, v248, vcc
    v_mfma_f32_16x16x32_bf16 v[144:147], a[228:231], a[116:119], v[144:147]
    buffer_load_dwordx4 v216, s[16:19], s44 offen offset:0 lds
    v_mfma_f32_16x16x32_bf16 v[148:151], a[236:239], a[116:119], v[148:151]
    v_cmp_eq_u32_e64 vcc, 1, v241
    v_cmp_eq_u32 s[50:51], 2, v241
    v_mfma_f32_16x16x32_bf16 v[148:151], a[232:235], a[112:115], v[148:151]
    v_add_f32 v239, v239, v242
    v_add_f32 v240, v240, v243
    v_mfma_f32_16x16x32_bf16 v[48:51], a[176:179], a[112:115], v[48:51]
    v_mul_f32 v239, 0xbb000000, v239
    v_mul_f32 v240, 0x3b000000, v240
    v_mfma_f32_16x16x32_bf16 v[48:51], a[180:183], a[116:119], v[48:51]
    v_fma_f32 v240, -v239, v239, v240
    v_max_f32_e64 v240, 0, v240
    v_mfma_f32_16x16x32_bf16 v[52:55], a[188:191], a[116:119], v[52:55]
    buffer_load_dwordx4 v217, s[16:19], s44 offen offset:1024 lds
    v_mfma_f32_16x16x32_bf16 v[52:55], a[184:187], a[112:115], v[52:55]
    v_add_f32 v241, 0x3727c5ac, v240
    v_mfma_f32_16x16x32_bf16 v[16:19], a[160:163], a[112:115], v[16:19]
    v_rsq_f32_e64 v241, v241
    v_mfma_f32_16x16x32_bf16 v[16:19], a[164:167], a[116:119], v[16:19]
    v_mul_f32 v242, v241, v241
    v_mul_f32 v242, v242, v240
    v_mfma_f32_16x16x32_bf16 v[20:23], a[172:175], a[116:119], v[20:23]
    v_add_f32 v242, 0x3727c5ac, v242
    v_mfma_f32_16x16x32_bf16 v[20:23], a[168:171], a[112:115], v[20:23]
    buffer_load_dwordx4 v218, s[16:19], s44 offen offset:2048 lds
    v_mfma_f32_16x16x32_bf16 v[28:31], a[168:171], a[120:123], v[28:31]
    v_rsq_f32_e64 v242, v242
    v_mfma_f32_16x16x32_bf16 v[28:31], a[172:175], a[124:127], v[28:31]
    v_mul_f32_e64 v240, v241, v242
    v_mul_f32 v241, 0x3e0293ee, v241
    v_mfma_f32_16x16x32_bf16 v[24:27], a[164:167], a[124:127], v[24:27]
    v_cndmask_b32_e64 v239, v239, v241, vcc
    v_cndmask_b32 v239, v239, v240, s[50:51]
    v_mfma_f32_16x16x32_bf16 v[24:27], a[160:163], a[120:123], v[24:27]
    v_mov_b32_e64 v244, 1
    v_mfma_f32_16x16x32_bf16 v[60:63], a[184:187], a[120:123], v[60:63]
    buffer_load_dwordx4 v219, s[16:19], s44 offen offset:3072 lds
    v_mfma_f32_16x16x32_bf16 v[60:63], a[188:191], a[124:127], v[60:63]
    s_add_u32 s44, s44, 128
    v_mfma_f32_16x16x32_bf16 v[56:59], a[180:183], a[124:127], v[56:59]
    v_mfma_f32_16x16x32_bf16 v[56:59], a[176:179], a[120:123], v[56:59]
    v_mfma_f32_16x16x32_bf16 v[156:159], a[232:235], a[120:123], v[156:159]
    v_mfma_f32_16x16x32_bf16 v[156:159], a[236:239], a[124:127], v[156:159]
    v_mfma_f32_16x16x32_bf16 v[152:155], a[228:231], a[124:127], v[152:155]
    v_mfma_f32_16x16x32_bf16 v[152:155], a[224:227], a[120:123], v[152:155]
    s_waitcnt vmcnt(10) lgkmcnt(0)
    v_mfma_f32_16x16x32_bf16 v[64:67], a[192:195], a[96:99], v[64:67]
    s_barrier
    v_mfma_f32_16x16x32_bf16 v[64:67], a[196:199], a[100:103], v[64:67]
    ds_read_b64_tr_b16 a[224:225], v232 offset:0
    s_lshr_b32 s47, s32, 3
    s_lshl_b32 s48, s34, 2
    s_add_u32 s47, s47, s48
    s_mul_i32 s47, s47, 768
    s_and_b32 s48, s32, 1
    s_lshl_b32 s48, s48, 7
    s_add_u32 s47, s47, s48
    s_lshl_b32 s48, s33, 5
    s_add_u32 s47, s47, s48
    s_and_b32 s48, s32, 6
    s_lshl_b32 s48, s48, 1
    s_add_u32 s47, s47, s48
    s_add_u32 s47, s47, 50462720
    v_mfma_f32_16x16x32_bf16 v[68:71], a[204:207], a[100:103], v[68:71]
    buffer_store_dword v239, v248, s[12:15], s47 offen sc1
    v_mfma_f32_16x16x32_bf16 v[68:71], a[200:203], a[96:99], v[68:71]
    ds_read_b64_tr_b16 a[226:227], v232 offset:512
    s_add_u32 m0, s42, 24576
    v_mfma_f32_16x16x32_bf16 v[96:99], a[208:211], a[96:99], v[96:99]
    ds_read_b64_tr_b16 a[228:229], v232 offset:4096
    v_mfma_f32_16x16x32_bf16 v[96:99], a[212:215], a[100:103], v[96:99]
    ds_read_b64_tr_b16 a[230:231], v232 offset:4608
    v_mfma_f32_16x16x32_bf16 v[100:103], a[220:223], a[100:103], v[100:103]
    buffer_load_dwordx4 v220, s[20:23], s45 offen offset:0 lds
    v_mfma_f32_16x16x32_bf16 v[100:103], a[216:219], a[96:99], v[100:103]
    ds_read_b64_tr_b16 a[232:233], v233 offset:0
    v_mfma_f32_16x16x32_bf16 v[160:163], a[240:243], a[96:99], v[160:163]
    ds_read_b64_tr_b16 a[234:235], v233 offset:512
    v_mfma_f32_16x16x32_bf16 v[160:163], a[244:247], a[100:103], v[160:163]
    ds_read_b64_tr_b16 a[236:237], v233 offset:4096
    v_mfma_f32_16x16x32_bf16 v[164:167], a[252:255], a[100:103], v[164:167]
    buffer_load_dwordx4 v221, s[20:23], s45 offen offset:1024 lds
    v_mfma_f32_16x16x32_bf16 v[164:167], a[248:251], a[96:99], v[164:167]
    ds_read_b64_tr_b16 a[238:239], v233 offset:4608
    v_mfma_f32_16x16x32_bf16 v[172:175], a[248:251], a[104:107], v[172:175]
    ds_read_b64_tr_b16 a[176:177], v229 offset:0
    v_mfma_f32_16x16x32_bf16 v[172:175], a[252:255], a[108:111], v[172:175]
    ds_read_b64_tr_b16 a[178:179], v229 offset:1024
    v_mfma_f32_16x16x32_bf16 v[168:171], a[244:247], a[108:111], v[168:171]
    buffer_load_dwordx4 v222, s[20:23], s45 offen offset:2048 lds
    v_mfma_f32_16x16x32_bf16 v[168:171], a[240:243], a[104:107], v[168:171]
    ds_read_b64_tr_b16 a[180:181], v229 offset:8192
    v_mfma_f32_16x16x32_bf16 v[108:111], a[216:219], a[104:107], v[108:111]
    ds_read_b64_tr_b16 a[182:183], v229 offset:9216
    v_mfma_f32_16x16x32_bf16 v[108:111], a[220:223], a[108:111], v[108:111]
    ds_read_b64_tr_b16 a[184:185], v229 offset:8
    v_mfma_f32_16x16x32_bf16 v[104:107], a[212:215], a[108:111], v[104:107]
    buffer_load_dwordx4 v223, s[20:23], s45 offen offset:3072 lds
    v_mfma_f32_16x16x32_bf16 v[104:107], a[208:211], a[104:107], v[104:107]
    ds_read_b64_tr_b16 a[186:187], v229 offset:1032
    s_add_u32 m0, s43, 24576
    s_add_u32 s45, s45, 524288
    v_mfma_f32_16x16x32_bf16 v[76:79], a[200:203], a[104:107], v[76:79]
    ds_read_b64_tr_b16 a[188:189], v229 offset:8200
    v_mfma_f32_16x16x32_bf16 v[76:79], a[204:207], a[108:111], v[76:79]
    ds_read_b64_tr_b16 a[190:191], v229 offset:9224
    v_mfma_f32_16x16x32_bf16 v[72:75], a[196:199], a[108:111], v[72:75]
    buffer_load_dwordx4 v224, s[24:27], s46 offen offset:0 lds
    v_mfma_f32_16x16x32_bf16 v[72:75], a[192:195], a[104:107], v[72:75]
    ds_read_b64_tr_b16 a[160:161], v228 offset:0
    v_mfma_f32_16x16x32_bf16 v[80:83], a[192:195], a[112:115], v[80:83]
    ds_read_b64_tr_b16 a[162:163], v228 offset:1024
    v_mfma_f32_16x16x32_bf16 v[80:83], a[196:199], a[116:119], v[80:83]
    ds_read_b64_tr_b16 a[164:165], v228 offset:8192
    v_mfma_f32_16x16x32_bf16 v[84:87], a[204:207], a[116:119], v[84:87]
    buffer_load_dwordx4 v225, s[24:27], s46 offen offset:1024 lds
    v_mfma_f32_16x16x32_bf16 v[84:87], a[200:203], a[112:115], v[84:87]
    ds_read_b64_tr_b16 a[166:167], v228 offset:9216
    s_add_u32 s46, s46, 229376
    s_lshl_b32 s48, s2, 2
    s_add_u32 s48, s48, s33
    s_mov_b32 s28, s68
    s_mov_b32 s29, s69
    s_mov_b32 s30, 1835008
    s_mov_b32 s31, 0x20000
    s_lshr_b32 s47, s48, 3
    s_lshl_b32 s47, s47, 15
    s_and_b32 s48, s48, 7
    s_lshl_b32 s48, s48, 7
    s_add_u32 s47, s47, s48
    v_lshrrev_b32 v239, 3, v236
    v_and_b32 v240, 7, v236
    v_lshlrev_b32_e64 v240, 4, v240
    v_lshl_add_u32 v239, v239, 10, v240
    s_add_u32 m0, s35, 147456
    v_mfma_f32_16x16x32_bf16 v[112:115], a[208:211], a[112:115], v[112:115]
    ds_read_b64_tr_b16 a[168:169], v228 offset:8
    v_mfma_f32_16x16x32_bf16 v[112:115], a[212:215], a[116:119], v[112:115]
    ds_read_b64_tr_b16 a[170:171], v228 offset:1032
    v_mfma_f32_16x16x32_bf16 v[116:119], a[220:223], a[116:119], v[116:119]
    buffer_load_dwordx4 v239, s[28:31], s47 offen offset:0 lds
    v_mfma_f32_16x16x32_bf16 v[116:119], a[216:219], a[112:115], v[116:119]
    ds_read_b64_tr_b16 a[172:173], v228 offset:8200
    s_add_u32 s47, s47, 7168
    v_mfma_f32_16x16x32_bf16 v[176:179], a[240:243], a[112:115], v[176:179]
    ds_read_b64_tr_b16 a[174:175], v228 offset:9224
    v_mfma_f32_16x16x32_bf16 v[176:179], a[244:247], a[116:119], v[176:179]
    ds_read_b128 a[128:131], v226 offset:0
    v_mfma_f32_16x16x32_bf16 v[180:183], a[252:255], a[116:119], v[180:183]
    buffer_load_dwordx4 v239, s[28:31], s47 offen offset:1024 lds
    v_mfma_f32_16x16x32_bf16 v[180:183], a[248:251], a[112:115], v[180:183]
    ds_read_b128 a[132:135], v227 offset:0
    s_add_u32 s47, s47, 7168
    v_mfma_f32_16x16x32_bf16 v[188:191], a[248:251], a[120:123], v[188:191]
    ds_read_b128 a[136:139], v226 offset:2048
    v_mfma_f32_16x16x32_bf16 v[188:191], a[252:255], a[124:127], v[188:191]
    ds_read_b128 a[140:143], v227 offset:2048
    v_mfma_f32_16x16x32_bf16 v[184:187], a[244:247], a[124:127], v[184:187]
    buffer_load_dwordx4 v239, s[28:31], s47 offen offset:2048 lds
    v_mfma_f32_16x16x32_bf16 v[184:187], a[240:243], a[120:123], v[184:187]
    ds_read_b128 a[144:147], v226 offset:4096
    s_add_u32 s47, s47, 7168
    v_mfma_f32_16x16x32_bf16 v[124:127], a[216:219], a[120:123], v[124:127]
    ds_read_b128 a[148:151], v227 offset:4096
    v_mfma_f32_16x16x32_bf16 v[124:127], a[220:223], a[124:127], v[124:127]
    ds_read_b128 a[152:155], v226 offset:6144
    v_mfma_f32_16x16x32_bf16 v[120:123], a[212:215], a[124:127], v[120:123]
    buffer_load_dwordx4 v239, s[28:31], s47 offen offset:3072 lds
    v_mfma_f32_16x16x32_bf16 v[120:123], a[208:211], a[120:123], v[120:123]
    ds_read_b128 a[156:159], v227 offset:6144
    s_add_u32 s47, s47, 7168
    v_mfma_f32_16x16x32_bf16 v[92:95], a[200:203], a[120:123], v[92:95]
    v_mfma_f32_16x16x32_bf16 v[92:95], a[204:207], a[124:127], v[92:95]
    v_mfma_f32_16x16x32_bf16 v[88:91], a[196:199], a[124:127], v[88:91]
    v_mfma_f32_16x16x32_bf16 v[88:91], a[192:195], a[120:123], v[88:91]
    s_waitcnt lgkmcnt(0)
    v_smfmac_f32_16x16x64_bf16 a[32:35], v[208:211], a[160:167], v207
    ds_read_b64_tr_b16 a[192:193], v230 offset:0
    v_smfmac_f32_16x16x64_bf16 a[36:39], v[208:211], a[168:175], v207
    ds_read_b64_tr_b16 a[194:195], v230 offset:1024
    v_smfmac_f32_16x16x64_bf16 a[40:43], v[208:211], a[224:231], v207
    ds_read_b64_tr_b16 a[196:197], v230 offset:8192
    v_smfmac_f32_16x16x64_bf16 a[44:47], v[208:211], a[232:239], v207
    ds_read_b64_tr_b16 a[198:199], v230 offset:9216
    v_mfma_f32_16x16x32_bf16 v[128:131], a[224:227], a[128:131], v[128:131]
    ds_read_b64_tr_b16 a[200:201], v230 offset:8
    v_mfma_f32_16x16x32_bf16 v[128:131], a[228:231], a[132:135], v[128:131]
    ds_read_b64_tr_b16 a[202:203], v230 offset:1032
    v_mfma_f32_16x16x32_bf16 v[132:135], a[236:239], a[132:135], v[132:135]
    ds_read_b64_tr_b16 a[204:205], v230 offset:8200
L_hop1:
    s_cbranch_execz L_ret0
    v_mfma_f32_16x16x32_bf16 v[132:135], a[232:235], a[128:131], v[132:135]
    ds_read_b64_tr_b16 a[206:207], v230 offset:9224
    v_mfma_f32_16x16x32_bf16 v[32:35], a[176:179], a[128:131], v[32:35]
    ds_read_b64_tr_b16 a[208:209], v231 offset:0
    s_add_u32 m0, s41, 0
    v_mfma_f32_16x16x32_bf16 v[32:35], a[180:183], a[132:135], v[32:35]
    buffer_load_dwordx4 v212, s[16:19], s44 offen offset:0 lds
    v_mfma_f32_16x16x32_bf16 v[36:39], a[188:191], a[132:135], v[36:39]
    ds_read_b64_tr_b16 a[210:211], v231 offset:1024
    v_mfma_f32_16x16x32_bf16 v[36:39], a[184:187], a[128:131], v[36:39]
    ds_read_b64_tr_b16 a[212:213], v231 offset:8192
    v_mfma_f32_16x16x32_bf16 v[0:3], a[160:163], a[128:131], v[0:3]
    ds_read_b64_tr_b16 a[214:215], v231 offset:9216
    v_mfma_f32_16x16x32_bf16 v[0:3], a[164:167], a[132:135], v[0:3]
    ds_read_b64_tr_b16 a[216:217], v231 offset:8
    v_mfma_f32_16x16x32_bf16 v[4:7], a[172:175], a[132:135], v[4:7]
    buffer_load_dwordx4 v213, s[16:19], s44 offen offset:1024 lds
    v_mfma_f32_16x16x32_bf16 v[4:7], a[168:171], a[128:131], v[4:7]
    ds_read_b64_tr_b16 a[218:219], v231 offset:1032
    v_mfma_f32_16x16x32_bf16 v[12:15], a[168:171], a[136:139], v[12:15]
    ds_read_b64_tr_b16 a[220:221], v231 offset:8200
    v_mfma_f32_16x16x32_bf16 v[12:15], a[172:175], a[140:143], v[12:15]
    ds_read_b64_tr_b16 a[222:223], v231 offset:9224
    v_mfma_f32_16x16x32_bf16 v[8:11], a[164:167], a[140:143], v[8:11]
    ds_read_b64_tr_b16 a[240:241], v234 offset:0
    v_mfma_f32_16x16x32_bf16 v[8:11], a[160:163], a[136:139], v[8:11]
    buffer_load_dwordx4 v214, s[16:19], s44 offen offset:2048 lds
    v_mfma_f32_16x16x32_bf16 v[44:47], a[184:187], a[136:139], v[44:47]
    ds_read_b64_tr_b16 a[242:243], v234 offset:512
    v_mfma_f32_16x16x32_bf16 v[44:47], a[188:191], a[140:143], v[44:47]
    ds_read_b64_tr_b16 a[244:245], v234 offset:4096
    v_mfma_f32_16x16x32_bf16 v[40:43], a[180:183], a[140:143], v[40:43]
    ds_read_b64_tr_b16 a[246:247], v234 offset:4608
    v_mfma_f32_16x16x32_bf16 v[40:43], a[176:179], a[136:139], v[40:43]
    ds_read_b64_tr_b16 a[248:249], v235 offset:0
    v_mfma_f32_16x16x32_bf16 v[140:143], a[232:235], a[136:139], v[140:143]
    buffer_load_dwordx4 v215, s[16:19], s44 offen offset:3072 lds
    v_mfma_f32_16x16x32_bf16 v[140:143], a[236:239], a[140:143], v[140:143]
    ds_read_b64_tr_b16 a[250:251], v235 offset:512
    s_add_u32 m0, s41, 4096
    v_mfma_f32_16x16x32_bf16 v[136:139], a[228:231], a[140:143], v[136:139]
    ds_read_b64_tr_b16 a[252:253], v235 offset:4096
    v_mfma_f32_16x16x32_bf16 v[136:139], a[224:227], a[136:139], v[136:139]
    ds_read_b64_tr_b16 a[254:255], v235 offset:4608
    v_mfma_f32_16x16x32_bf16 v[144:147], a[224:227], a[144:147], v[144:147]
    v_mfma_f32_16x16x32_bf16 v[144:147], a[228:231], a[148:151], v[144:147]
    buffer_load_dwordx4 v216, s[16:19], s44 offen offset:0 lds
    v_mfma_f32_16x16x32_bf16 v[148:151], a[236:239], a[148:151], v[148:151]
    v_mfma_f32_16x16x32_bf16 v[148:151], a[232:235], a[144:147], v[148:151]
    v_mfma_f32_16x16x32_bf16 v[48:51], a[176:179], a[144:147], v[48:51]
    v_mfma_f32_16x16x32_bf16 v[48:51], a[180:183], a[148:151], v[48:51]
    v_mfma_f32_16x16x32_bf16 v[52:55], a[188:191], a[148:151], v[52:55]
    buffer_load_dwordx4 v217, s[16:19], s44 offen offset:1024 lds
    v_mfma_f32_16x16x32_bf16 v[52:55], a[184:187], a[144:147], v[52:55]
    v_mfma_f32_16x16x32_bf16 v[16:19], a[160:163], a[144:147], v[16:19]
    v_mfma_f32_16x16x32_bf16 v[16:19], a[164:167], a[148:151], v[16:19]
    v_mfma_f32_16x16x32_bf16 v[20:23], a[172:175], a[148:151], v[20:23]
    v_mfma_f32_16x16x32_bf16 v[20:23], a[168:171], a[144:147], v[20:23]
    buffer_load_dwordx4 v218, s[16:19], s44 offen offset:2048 lds
    v_mfma_f32_16x16x32_bf16 v[28:31], a[168:171], a[152:155], v[28:31]
    v_mfma_f32_16x16x32_bf16 v[28:31], a[172:175], a[156:159], v[28:31]
    v_mfma_f32_16x16x32_bf16 v[24:27], a[164:167], a[156:159], v[24:27]
    v_mfma_f32_16x16x32_bf16 v[24:27], a[160:163], a[152:155], v[24:27]
    v_mfma_f32_16x16x32_bf16 v[60:63], a[184:187], a[152:155], v[60:63]
    buffer_load_dwordx4 v219, s[16:19], s44 offen offset:3072 lds
    v_mfma_f32_16x16x32_bf16 v[60:63], a[188:191], a[156:159], v[60:63]
    s_add_u32 s44, s44, 128
    v_mfma_f32_16x16x32_bf16 v[56:59], a[180:183], a[156:159], v[56:59]
    v_mfma_f32_16x16x32_bf16 v[56:59], a[176:179], a[152:155], v[56:59]
    v_mfma_f32_16x16x32_bf16 v[156:159], a[232:235], a[152:155], v[156:159]
    v_mfma_f32_16x16x32_bf16 v[156:159], a[236:239], a[156:159], v[156:159]
    v_mfma_f32_16x16x32_bf16 v[152:155], a[228:231], a[156:159], v[152:155]
    v_mfma_f32_16x16x32_bf16 v[152:155], a[224:227], a[152:155], v[152:155]
    s_waitcnt vmcnt(12) lgkmcnt(0)
    v_mfma_f32_16x16x32_bf16 v[64:67], a[192:195], a[128:131], v[64:67]
    s_barrier
    v_mfma_f32_16x16x32_bf16 v[64:67], a[196:199], a[132:135], v[64:67]
    ds_read_b64_tr_b16 a[224:225], v232 offset:24576
    s_mov_b32 s28, s74
    s_mov_b32 s29, s75
    s_lshl_b32 s50, s34, 5
    s_add_u32 s50, s50, 16
    s_cmp_eq_u32 s33, 0
    s_cselect_b32 s30, 256, 0
    v_mfma_f32_16x16x32_bf16 v[68:71], a[204:207], a[132:135], v[68:71]
    buffer_atomic_add v244, v246, s[28:31], s50 offen sc1
    v_mfma_f32_16x16x32_bf16 v[68:71], a[200:203], a[128:131], v[68:71]
    ds_read_b64_tr_b16 a[226:227], v232 offset:25088
    s_add_u32 m0, s42, 0
    v_mfma_f32_16x16x32_bf16 v[96:99], a[208:211], a[128:131], v[96:99]
    ds_read_b64_tr_b16 a[228:229], v232 offset:28672
    v_mfma_f32_16x16x32_bf16 v[96:99], a[212:215], a[132:135], v[96:99]
    ds_read_b64_tr_b16 a[230:231], v232 offset:29184
    v_mfma_f32_16x16x32_bf16 v[100:103], a[220:223], a[132:135], v[100:103]
    ds_read_b64_tr_b16 a[232:233], v233 offset:24576
    v_mfma_f32_16x16x32_bf16 v[100:103], a[216:219], a[128:131], v[100:103]
    buffer_load_dwordx4 v220, s[20:23], s45 offen offset:0 lds
    v_mfma_f32_16x16x32_bf16 v[160:163], a[240:243], a[128:131], v[160:163]
    ds_read_b64_tr_b16 a[234:235], v233 offset:25088
    v_mfma_f32_16x16x32_bf16 v[160:163], a[244:247], a[132:135], v[160:163]
    ds_read_b64_tr_b16 a[236:237], v233 offset:28672
    v_mfma_f32_16x16x32_bf16 v[164:167], a[252:255], a[132:135], v[164:167]
    ds_read_b64_tr_b16 a[238:239], v233 offset:29184
    v_mfma_f32_16x16x32_bf16 v[164:167], a[248:251], a[128:131], v[164:167]
    ds_read_b64_tr_b16 a[176:177], v229 offset:24576
    v_mfma_f32_16x16x32_bf16 v[172:175], a[248:251], a[136:139], v[172:175]
    buffer_load_dwordx4 v221, s[20:23], s45 offen offset:1024 lds
    v_mfma_f32_16x16x32_bf16 v[172:175], a[252:255], a[140:143], v[172:175]
    ds_read_b64_tr_b16 a[178:179], v229 offset:25600
    v_mfma_f32_16x16x32_bf16 v[168:171], a[244:247], a[140:143], v[168:171]
    ds_read_b64_tr_b16 a[180:181], v229 offset:32768
    v_mfma_f32_16x16x32_bf16 v[168:171], a[240:243], a[136:139], v[168:171]
    ds_read_b64_tr_b16 a[182:183], v229 offset:33792
    v_mfma_f32_16x16x32_bf16 v[108:111], a[216:219], a[136:139], v[108:111]
    ds_read_b64_tr_b16 a[184:185], v229 offset:24584
    v_mfma_f32_16x16x32_bf16 v[108:111], a[220:223], a[140:143], v[108:111]
    buffer_load_dwordx4 v222, s[20:23], s45 offen offset:2048 lds
    v_mfma_f32_16x16x32_bf16 v[104:107], a[212:215], a[140:143], v[104:107]
    ds_read_b64_tr_b16 a[186:187], v229 offset:25608
    v_mfma_f32_16x16x32_bf16 v[104:107], a[208:211], a[136:139], v[104:107]
    ds_read_b64_tr_b16 a[188:189], v229 offset:32776
    v_mfma_f32_16x16x32_bf16 v[76:79], a[200:203], a[136:139], v[76:79]
    ds_read_b64_tr_b16 a[190:191], v229 offset:33800
    v_mfma_f32_16x16x32_bf16 v[76:79], a[204:207], a[140:143], v[76:79]
    ds_read_b64_tr_b16 a[160:161], v228 offset:24576
    v_mfma_f32_16x16x32_bf16 v[72:75], a[196:199], a[140:143], v[72:75]
    buffer_load_dwordx4 v223, s[20:23], s45 offen offset:3072 lds
    v_mfma_f32_16x16x32_bf16 v[72:75], a[192:195], a[136:139], v[72:75]
    ds_read_b64_tr_b16 a[162:163], v228 offset:25600
    s_add_u32 m0, s43, 0
    s_add_u32 s45, s45, 524288
    v_mfma_f32_16x16x32_bf16 v[80:83], a[192:195], a[144:147], v[80:83]
    ds_read_b64_tr_b16 a[164:165], v228 offset:32768
    v_mfma_f32_16x16x32_bf16 v[80:83], a[196:199], a[148:151], v[80:83]
    ds_read_b64_tr_b16 a[166:167], v228 offset:33792
    v_mfma_f32_16x16x32_bf16 v[84:87], a[204:207], a[148:151], v[84:87]
    ds_read_b64_tr_b16 a[168:169], v228 offset:24584
    v_mfma_f32_16x16x32_bf16 v[84:87], a[200:203], a[144:147], v[84:87]
    buffer_load_dwordx4 v224, s[24:27], s46 offen offset:0 lds
    v_mfma_f32_16x16x32_bf16 v[112:115], a[208:211], a[144:147], v[112:115]
    ds_read_b64_tr_b16 a[170:171], v228 offset:25608
    v_mfma_f32_16x16x32_bf16 v[112:115], a[212:215], a[148:151], v[112:115]
    ds_read_b64_tr_b16 a[172:173], v228 offset:32776
    v_mfma_f32_16x16x32_bf16 v[116:119], a[220:223], a[148:151], v[116:119]
    ds_read_b64_tr_b16 a[174:175], v228 offset:33800
    v_mfma_f32_16x16x32_bf16 v[116:119], a[216:219], a[144:147], v[116:119]
    ds_read_b128 a[96:99], v226 offset:32768
    v_mfma_f32_16x16x32_bf16 v[176:179], a[240:243], a[144:147], v[176:179]
    buffer_load_dwordx4 v225, s[24:27], s46 offen offset:1024 lds
    v_mfma_f32_16x16x32_bf16 v[176:179], a[244:247], a[148:151], v[176:179]
    ds_read_b128 a[100:103], v227 offset:32768
    s_add_u32 s46, s46, 229376
    v_mfma_f32_16x16x32_bf16 v[180:183], a[252:255], a[148:151], v[180:183]
    ds_read_b128 a[104:107], v226 offset:34816
    v_mfma_f32_16x16x32_bf16 v[180:183], a[248:251], a[144:147], v[180:183]
    ds_read_b128 a[108:111], v227 offset:34816
    v_mfma_f32_16x16x32_bf16 v[188:191], a[248:251], a[152:155], v[188:191]
    ds_read_b128 a[112:115], v226 offset:36864
    v_mfma_f32_16x16x32_bf16 v[188:191], a[252:255], a[156:159], v[188:191]
    ds_read_b128 a[116:119], v227 offset:36864
    v_mfma_f32_16x16x32_bf16 v[184:187], a[244:247], a[156:159], v[184:187]
    ds_read_b128 a[120:123], v226 offset:38912
    v_mfma_f32_16x16x32_bf16 v[184:187], a[240:243], a[152:155], v[184:187]
    ds_read_b128 a[124:127], v227 offset:38912
    v_mfma_f32_16x16x32_bf16 v[124:127], a[216:219], a[152:155], v[124:127]
    v_mfma_f32_16x16x32_bf16 v[124:127], a[220:223], a[156:159], v[124:127]
    v_mfma_f32_16x16x32_bf16 v[120:123], a[212:215], a[156:159], v[120:123]
    v_mfma_f32_16x16x32_bf16 v[120:123], a[208:211], a[152:155], v[120:123]
    v_mfma_f32_16x16x32_bf16 v[92:95], a[200:203], a[152:155], v[92:95]
    v_mfma_f32_16x16x32_bf16 v[92:95], a[204:207], a[156:159], v[92:95]
    v_mfma_f32_16x16x32_bf16 v[88:91], a[196:199], a[156:159], v[88:91]
    v_mfma_f32_16x16x32_bf16 v[88:91], a[192:195], a[152:155], v[88:91]
    s_waitcnt lgkmcnt(0)
    v_smfmac_f32_16x16x64_bf16 a[32:35], v[208:211], a[160:167], v207
    ds_read_b64_tr_b16 a[192:193], v230 offset:24576
    v_smfmac_f32_16x16x64_bf16 a[36:39], v[208:211], a[168:175], v207
    ds_read_b64_tr_b16 a[194:195], v230 offset:25600
    v_smfmac_f32_16x16x64_bf16 a[40:43], v[208:211], a[224:231], v207
    ds_read_b64_tr_b16 a[196:197], v230 offset:32768
    v_smfmac_f32_16x16x64_bf16 a[44:47], v[208:211], a[232:239], v207
    ds_read_b64_tr_b16 a[198:199], v230 offset:33792
    v_mfma_f32_16x16x32_bf16 v[128:131], a[224:227], a[96:99], v[128:131]
    ds_read_b64_tr_b16 a[200:201], v230 offset:24584
    v_mfma_f32_16x16x32_bf16 v[128:131], a[228:231], a[100:103], v[128:131]
    ds_read_b64_tr_b16 a[202:203], v230 offset:25608
    v_mfma_f32_16x16x32_bf16 v[132:135], a[236:239], a[100:103], v[132:135]
    ds_read_b64_tr_b16 a[204:205], v230 offset:32776
    v_mfma_f32_16x16x32_bf16 v[132:135], a[232:235], a[96:99], v[132:135]
    ds_read_b64_tr_b16 a[206:207], v230 offset:33800
    v_mfma_f32_16x16x32_bf16 v[32:35], a[176:179], a[96:99], v[32:35]
    ds_read_b64_tr_b16 a[208:209], v231 offset:24576
    s_add_u32 m0, s41, 32768
    v_mfma_f32_16x16x32_bf16 v[32:35], a[180:183], a[100:103], v[32:35]
    buffer_load_dwordx4 v212, s[16:19], s44 offen offset:0 lds
    v_mfma_f32_16x16x32_bf16 v[36:39], a[188:191], a[100:103], v[36:39]
    ds_read_b64_tr_b16 a[210:211], v231 offset:25600
    v_mfma_f32_16x16x32_bf16 v[36:39], a[184:187], a[96:99], v[36:39]
    ds_read_b64_tr_b16 a[212:213], v231 offset:32768
    v_mfma_f32_16x16x32_bf16 v[0:3], a[160:163], a[96:99], v[0:3]
    ds_read_b64_tr_b16 a[214:215], v231 offset:33792
    v_mfma_f32_16x16x32_bf16 v[0:3], a[164:167], a[100:103], v[0:3]
    ds_read_b64_tr_b16 a[216:217], v231 offset:24584
    v_mfma_f32_16x16x32_bf16 v[4:7], a[172:175], a[100:103], v[4:7]
    buffer_load_dwordx4 v213, s[16:19], s44 offen offset:1024 lds
    v_mfma_f32_16x16x32_bf16 v[4:7], a[168:171], a[96:99], v[4:7]
    ds_read_b64_tr_b16 a[218:219], v231 offset:25608
    v_mfma_f32_16x16x32_bf16 v[12:15], a[168:171], a[104:107], v[12:15]
    ds_read_b64_tr_b16 a[220:221], v231 offset:32776
    v_mfma_f32_16x16x32_bf16 v[12:15], a[172:175], a[108:111], v[12:15]
    ds_read_b64_tr_b16 a[222:223], v231 offset:33800
    v_mfma_f32_16x16x32_bf16 v[8:11], a[164:167], a[108:111], v[8:11]
    ds_read_b64_tr_b16 a[240:241], v234 offset:24576
    v_mfma_f32_16x16x32_bf16 v[8:11], a[160:163], a[104:107], v[8:11]
    buffer_load_dwordx4 v214, s[16:19], s44 offen offset:2048 lds
    v_mfma_f32_16x16x32_bf16 v[44:47], a[184:187], a[104:107], v[44:47]
    ds_read_b64_tr_b16 a[242:243], v234 offset:25088
    v_mfma_f32_16x16x32_bf16 v[44:47], a[188:191], a[108:111], v[44:47]
    ds_read_b64_tr_b16 a[244:245], v234 offset:28672
    v_mfma_f32_16x16x32_bf16 v[40:43], a[180:183], a[108:111], v[40:43]
    ds_read_b64_tr_b16 a[246:247], v234 offset:29184
    v_mfma_f32_16x16x32_bf16 v[40:43], a[176:179], a[104:107], v[40:43]
    ds_read_b64_tr_b16 a[248:249], v235 offset:24576
    v_mfma_f32_16x16x32_bf16 v[140:143], a[232:235], a[104:107], v[140:143]
    buffer_load_dwordx4 v215, s[16:19], s44 offen offset:3072 lds
    v_mfma_f32_16x16x32_bf16 v[140:143], a[236:239], a[108:111], v[140:143]
    ds_read_b64_tr_b16 a[250:251], v235 offset:25088
    s_add_u32 m0, s41, 36864
    v_mfma_f32_16x16x32_bf16 v[136:139], a[228:231], a[108:111], v[136:139]
    ds_read_b64_tr_b16 a[252:253], v235 offset:28672
    v_mfma_f32_16x16x32_bf16 v[136:139], a[224:227], a[104:107], v[136:139]
    ds_read_b64_tr_b16 a[254:255], v235 offset:29184
    v_mfma_f32_16x16x32_bf16 v[144:147], a[224:227], a[112:115], v[144:147]
    v_mfma_f32_16x16x32_bf16 v[144:147], a[228:231], a[116:119], v[144:147]
    buffer_load_dwordx4 v216, s[16:19], s44 offen offset:0 lds
    v_mfma_f32_16x16x32_bf16 v[148:151], a[236:239], a[116:119], v[148:151]
    v_mfma_f32_16x16x32_bf16 v[148:151], a[232:235], a[112:115], v[148:151]
    v_mfma_f32_16x16x32_bf16 v[48:51], a[176:179], a[112:115], v[48:51]
    v_mfma_f32_16x16x32_bf16 v[48:51], a[180:183], a[116:119], v[48:51]
    v_mfma_f32_16x16x32_bf16 v[52:55], a[188:191], a[116:119], v[52:55]
    buffer_load_dwordx4 v217, s[16:19], s44 offen offset:1024 lds
    v_mfma_f32_16x16x32_bf16 v[52:55], a[184:187], a[112:115], v[52:55]
    v_mfma_f32_16x16x32_bf16 v[16:19], a[160:163], a[112:115], v[16:19]
    v_mfma_f32_16x16x32_bf16 v[16:19], a[164:167], a[116:119], v[16:19]
    v_mfma_f32_16x16x32_bf16 v[20:23], a[172:175], a[116:119], v[20:23]
    v_mfma_f32_16x16x32_bf16 v[20:23], a[168:171], a[112:115], v[20:23]
    buffer_load_dwordx4 v218, s[16:19], s44 offen offset:2048 lds
    v_mfma_f32_16x16x32_bf16 v[28:31], a[168:171], a[120:123], v[28:31]
    v_mfma_f32_16x16x32_bf16 v[28:31], a[172:175], a[124:127], v[28:31]
    v_mfma_f32_16x16x32_bf16 v[24:27], a[164:167], a[124:127], v[24:27]
    v_mfma_f32_16x16x32_bf16 v[24:27], a[160:163], a[120:123], v[24:27]
    v_mfma_f32_16x16x32_bf16 v[60:63], a[184:187], a[120:123], v[60:63]
    buffer_load_dwordx4 v219, s[16:19], s44 offen offset:3072 lds
    v_mfma_f32_16x16x32_bf16 v[60:63], a[188:191], a[124:127], v[60:63]
    s_add_u32 s44, s44, 128
    v_mfma_f32_16x16x32_bf16 v[56:59], a[180:183], a[124:127], v[56:59]
    v_mfma_f32_16x16x32_bf16 v[56:59], a[176:179], a[120:123], v[56:59]
    v_mfma_f32_16x16x32_bf16 v[156:159], a[232:235], a[120:123], v[156:159]
    v_mfma_f32_16x16x32_bf16 v[156:159], a[236:239], a[124:127], v[156:159]
    v_mfma_f32_16x16x32_bf16 v[152:155], a[228:231], a[124:127], v[152:155]
    v_mfma_f32_16x16x32_bf16 v[152:155], a[224:227], a[120:123], v[152:155]
    s_waitcnt vmcnt(8) lgkmcnt(0)
    v_mfma_f32_16x16x32_bf16 v[64:67], a[192:195], a[96:99], v[64:67]
    s_barrier
    v_mfma_f32_16x16x32_bf16 v[64:67], a[196:199], a[100:103], v[64:67]
    ds_read_b64_tr_b16 a[224:225], v232 offset:0
    s_add_u32 m0, s42, 24576
    v_mfma_f32_16x16x32_bf16 v[68:71], a[204:207], a[100:103], v[68:71]
    buffer_load_dwordx4 v220, s[20:23], s45 offen offset:0 lds
    v_mfma_f32_16x16x32_bf16 v[68:71], a[200:203], a[96:99], v[68:71]
    ds_read_b64_tr_b16 a[226:227], v232 offset:512
    v_mfma_f32_16x16x32_bf16 v[96:99], a[208:211], a[96:99], v[96:99]
    ds_read_b64_tr_b16 a[228:229], v232 offset:4096
    v_mfma_f32_16x16x32_bf16 v[96:99], a[212:215], a[100:103], v[96:99]
    ds_read_b64_tr_b16 a[230:231], v232 offset:4608
    v_mfma_f32_16x16x32_bf16 v[100:103], a[220:223], a[100:103], v[100:103]
    buffer_load_dwordx4 v221, s[20:23], s45 offen offset:1024 lds
    v_mfma_f32_16x16x32_bf16 v[100:103], a[216:219], a[96:99], v[100:103]
    ds_read_b64_tr_b16 a[232:233], v233 offset:0
    v_mfma_f32_16x16x32_bf16 v[160:163], a[240:243], a[96:99], v[160:163]
    ds_read_b64_tr_b16 a[234:235], v233 offset:512
    v_mfma_f32_16x16x32_bf16 v[160:163], a[244:247], a[100:103], v[160:163]
    ds_read_b64_tr_b16 a[236:237], v233 offset:4096
    v_mfma_f32_16x16x32_bf16 v[164:167], a[252:255], a[100:103], v[164:167]
    buffer_load_dwordx4 v222, s[20:23], s45 offen offset:2048 lds
    v_mfma_f32_16x16x32_bf16 v[164:167], a[248:251], a[96:99], v[164:167]
    ds_read_b64_tr_b16 a[238:239], v233 offset:4608
    v_mfma_f32_16x16x32_bf16 v[172:175], a[248:251], a[104:107], v[172:175]
    ds_read_b64_tr_b16 a[176:177], v229 offset:0
    v_mfma_f32_16x16x32_bf16 v[172:175], a[252:255], a[108:111], v[172:175]
    ds_read_b64_tr_b16 a[178:179], v229 offset:1024
    v_mfma_f32_16x16x32_bf16 v[168:171], a[244:247], a[108:111], v[168:171]
    buffer_load_dwordx4 v223, s[20:23], s45 offen offset:3072 lds
    v_mfma_f32_16x16x32_bf16 v[168:171], a[240:243], a[104:107], v[168:171]
    ds_read_b64_tr_b16 a[180:181], v229 offset:8192
    s_add_u32 m0, s43, 24576
    s_add_u32 s45, s45, 524288
    v_mfma_f32_16x16x32_bf16 v[108:111], a[216:219], a[104:107], v[108:111]
    ds_read_b64_tr_b16 a[182:183], v229 offset:9216
    v_mfma_f32_16x16x32_bf16 v[108:111], a[220:223], a[108:111], v[108:111]
    ds_read_b64_tr_b16 a[184:185], v229 offset:8
    v_mfma_f32_16x16x32_bf16 v[104:107], a[212:215], a[108:111], v[104:107]
    buffer_load_dwordx4 v224, s[24:27], s46 offen offset:0 lds
    v_mfma_f32_16x16x32_bf16 v[104:107], a[208:211], a[104:107], v[104:107]
    ds_read_b64_tr_b16 a[186:187], v229 offset:1032
    v_mfma_f32_16x16x32_bf16 v[76:79], a[200:203], a[104:107], v[76:79]
    ds_read_b64_tr_b16 a[188:189], v229 offset:8200
    v_mfma_f32_16x16x32_bf16 v[76:79], a[204:207], a[108:111], v[76:79]
    ds_read_b64_tr_b16 a[190:191], v229 offset:9224
    v_mfma_f32_16x16x32_bf16 v[72:75], a[196:199], a[108:111], v[72:75]
    buffer_load_dwordx4 v225, s[24:27], s46 offen offset:1024 lds
    v_mfma_f32_16x16x32_bf16 v[72:75], a[192:195], a[104:107], v[72:75]
    ds_read_b64_tr_b16 a[160:161], v228 offset:0
    s_add_u32 s46, s46, 229376
    s_lshl_b32 s47, s32, 7
    s_add_u32 s28, s66, s47
    s_addc_u32 s29, s67, 0
    s_sub_u32 s30, 3584, s47
    s_cmp_lt_u32 s32, 28
    s_cselect_b32 s30, s30, 0
    s_and_b32 s47, s33, 2
    s_lshl_b32 s47, s47, 5
    v_lshlrev_b32 v239, 3, v237
    v_xor_b32 v240, s47, v239
    v_xor_b32_e64 v241, 64, v240
    v_mfma_f32_16x16x32_bf16 v[80:83], a[192:195], a[112:115], v[80:83]
    ds_read_b64_tr_b16 a[162:163], v228 offset:1024
    v_mfma_f32_16x16x32_bf16 v[80:83], a[196:199], a[116:119], v[80:83]
    ds_read_b64_tr_b16 a[164:165], v228 offset:8192
    v_mfma_f32_16x16x32_bf16 v[84:87], a[204:207], a[116:119], v[84:87]
    buffer_load_dwordx2 a[48:49], v240, s[28:31], 0 offen offset:0
    v_mfma_f32_16x16x32_bf16 v[84:87], a[200:203], a[112:115], v[84:87]
    ds_read_b64_tr_b16 a[166:167], v228 offset:9216
    v_mfma_f32_16x16x32_bf16 v[112:115], a[208:211], a[112:115], v[112:115]
    ds_read_b64_tr_b16 a[168:169], v228 offset:8
    v_mfma_f32_16x16x32_bf16 v[112:115], a[212:215], a[116:119], v[112:115]
    ds_read_b64_tr_b16 a[170:171], v228 offset:1032
    v_mfma_f32_16x16x32_bf16 v[116:119], a[220:223], a[116:119], v[116:119]
    buffer_load_dwordx2 a[50:51], v240, s[28:31], 0 offen offset:32
    v_mfma_f32_16x16x32_bf16 v[116:119], a[216:219], a[112:115], v[116:119]
    ds_read_b64_tr_b16 a[172:173], v228 offset:8200
    v_mfma_f32_16x16x32_bf16 v[176:179], a[240:243], a[112:115], v[176:179]
    ds_read_b64_tr_b16 a[174:175], v228 offset:9224
    v_mfma_f32_16x16x32_bf16 v[176:179], a[244:247], a[116:119], v[176:179]
    ds_read_b128 a[128:131], v226 offset:0
    v_mfma_f32_16x16x32_bf16 v[180:183], a[252:255], a[116:119], v[180:183]
    buffer_load_dwordx2 a[52:53], v241, s[28:31], 0 offen offset:0
    v_mfma_f32_16x16x32_bf16 v[180:183], a[248:251], a[112:115], v[180:183]
    ds_read_b128 a[132:135], v227 offset:0
    v_mfma_f32_16x16x32_bf16 v[188:191], a[248:251], a[120:123], v[188:191]
    ds_read_b128 a[136:139], v226 offset:2048
    v_mfma_f32_16x16x32_bf16 v[188:191], a[252:255], a[124:127], v[188:191]
    ds_read_b128 a[140:143], v227 offset:2048
    v_mfma_f32_16x16x32_bf16 v[184:187], a[244:247], a[124:127], v[184:187]
    buffer_load_dwordx2 a[54:55], v241, s[28:31], 0 offen offset:32
    v_mfma_f32_16x16x32_bf16 v[184:187], a[240:243], a[120:123], v[184:187]
    ds_read_b128 a[144:147], v226 offset:4096
    v_mfma_f32_16x16x32_bf16 v[124:127], a[216:219], a[120:123], v[124:127]
    ds_read_b128 a[148:151], v227 offset:4096
    v_mfma_f32_16x16x32_bf16 v[124:127], a[220:223], a[124:127], v[124:127]
    ds_read_b128 a[152:155], v226 offset:6144
    v_mfma_f32_16x16x32_bf16 v[120:123], a[212:215], a[124:127], v[120:123]
    global_load_dword a56, v206, s[70:71]
    v_mfma_f32_16x16x32_bf16 v[120:123], a[208:211], a[120:123], v[120:123]
    ds_read_b128 a[156:159], v227 offset:6144
    v_mfma_f32_16x16x32_bf16 v[92:95], a[200:203], a[120:123], v[92:95]
    v_mfma_f32_16x16x32_bf16 v[92:95], a[204:207], a[124:127], v[92:95]
    v_mfma_f32_16x16x32_bf16 v[88:91], a[196:199], a[124:127], v[88:91]
    v_mfma_f32_16x16x32_bf16 v[88:91], a[192:195], a[120:123], v[88:91]
    s_waitcnt lgkmcnt(0)
    v_smfmac_f32_16x16x64_bf16 a[32:35], v[208:211], a[160:167], v207
    ds_read_b64_tr_b16 a[192:193], v230 offset:0
    v_smfmac_f32_16x16x64_bf16 a[36:39], v[208:211], a[168:175], v207
    ds_read_b64_tr_b16 a[194:195], v230 offset:1024
    v_smfmac_f32_16x16x64_bf16 a[40:43], v[208:211], a[224:231], v207
    ds_read_b64_tr_b16 a[196:197], v230 offset:8192
    v_smfmac_f32_16x16x64_bf16 a[44:47], v[208:211], a[232:239], v207
    ds_read_b64_tr_b16 a[198:199], v230 offset:9216
    v_mfma_f32_16x16x32_bf16 v[128:131], a[224:227], a[128:131], v[128:131]
    ds_read_b64_tr_b16 a[200:201], v230 offset:8
    v_mfma_f32_16x16x32_bf16 v[128:131], a[228:231], a[132:135], v[128:131]
    ds_read_b64_tr_b16 a[202:203], v230 offset:1032
    v_mfma_f32_16x16x32_bf16 v[132:135], a[236:239], a[132:135], v[132:135]
    ds_read_b64_tr_b16 a[204:205], v230 offset:8200
    v_mfma_f32_16x16x32_bf16 v[132:135], a[232:235], a[128:131], v[132:135]
    ds_read_b64_tr_b16 a[206:207], v230 offset:9224
    v_mfma_f32_16x16x32_bf16 v[32:35], a[176:179], a[128:131], v[32:35]
    ds_read_b64_tr_b16 a[208:209], v231 offset:0
    s_add_u32 m0, s41, 0
    v_mfma_f32_16x16x32_bf16 v[32:35], a[180:183], a[132:135], v[32:35]
    buffer_load_dwordx4 v212, s[16:19], s44 offen offset:0 lds
    v_mfma_f32_16x16x32_bf16 v[36:39], a[188:191], a[132:135], v[36:39]
    ds_read_b64_tr_b16 a[210:211], v231 offset:1024
    v_mfma_f32_16x16x32_bf16 v[36:39], a[184:187], a[128:131], v[36:39]
    ds_read_b64_tr_b16 a[212:213], v231 offset:8192
    v_mfma_f32_16x16x32_bf16 v[0:3], a[160:163], a[128:131], v[0:3]
    ds_read_b64_tr_b16 a[214:215], v231 offset:9216
    v_mfma_f32_16x16x32_bf16 v[0:3], a[164:167], a[132:135], v[0:3]
    ds_read_b64_tr_b16 a[216:217], v231 offset:8
    v_mfma_f32_16x16x32_bf16 v[4:7], a[172:175], a[132:135], v[4:7]
    buffer_load_dwordx4 v213, s[16:19], s44 offen offset:1024 lds
    v_mfma_f32_16x16x32_bf16 v[4:7], a[168:171], a[128:131], v[4:7]
    ds_read_b64_tr_b16 a[218:219], v231 offset:1032
    v_mfma_f32_16x16x32_bf16 v[12:15], a[168:171], a[136:139], v[12:15]
    ds_read_b64_tr_b16 a[220:221], v231 offset:8200
    v_mfma_f32_16x16x32_bf16 v[12:15], a[172:175], a[140:143], v[12:15]
    ds_read_b64_tr_b16 a[222:223], v231 offset:9224
    v_mfma_f32_16x16x32_bf16 v[8:11], a[164:167], a[140:143], v[8:11]
    ds_read_b64_tr_b16 a[240:241], v234 offset:0
    v_mfma_f32_16x16x32_bf16 v[8:11], a[160:163], a[136:139], v[8:11]
    buffer_load_dwordx4 v214, s[16:19], s44 offen offset:2048 lds
    v_mfma_f32_16x16x32_bf16 v[44:47], a[184:187], a[136:139], v[44:47]
    ds_read_b64_tr_b16 a[242:243], v234 offset:512
    v_mfma_f32_16x16x32_bf16 v[44:47], a[188:191], a[140:143], v[44:47]
    ds_read_b64_tr_b16 a[244:245], v234 offset:4096
    v_mfma_f32_16x16x32_bf16 v[40:43], a[180:183], a[140:143], v[40:43]
    ds_read_b64_tr_b16 a[246:247], v234 offset:4608
    v_mfma_f32_16x16x32_bf16 v[40:43], a[176:179], a[136:139], v[40:43]
    ds_read_b64_tr_b16 a[248:249], v235 offset:0
    v_mfma_f32_16x16x32_bf16 v[140:143], a[232:235], a[136:139], v[140:143]
    buffer_load_dwordx4 v215, s[16:19], s44 offen offset:3072 lds
    v_mfma_f32_16x16x32_bf16 v[140:143], a[236:239], a[140:143], v[140:143]
    ds_read_b64_tr_b16 a[250:251], v235 offset:512
    s_add_u32 m0, s41, 4096
    v_mfma_f32_16x16x32_bf16 v[136:139], a[228:231], a[140:143], v[136:139]
    ds_read_b64_tr_b16 a[252:253], v235 offset:4096
    v_mfma_f32_16x16x32_bf16 v[136:139], a[224:227], a[136:139], v[136:139]
    ds_read_b64_tr_b16 a[254:255], v235 offset:4608
    v_mfma_f32_16x16x32_bf16 v[144:147], a[224:227], a[144:147], v[144:147]
    v_mfma_f32_16x16x32_bf16 v[144:147], a[228:231], a[148:151], v[144:147]
    buffer_load_dwordx4 v216, s[16:19], s44 offen offset:0 lds
    v_mfma_f32_16x16x32_bf16 v[148:151], a[236:239], a[148:151], v[148:151]
    v_mfma_f32_16x16x32_bf16 v[148:151], a[232:235], a[144:147], v[148:151]
    v_mfma_f32_16x16x32_bf16 v[48:51], a[176:179], a[144:147], v[48:51]
    v_mfma_f32_16x16x32_bf16 v[48:51], a[180:183], a[148:151], v[48:51]
    v_mfma_f32_16x16x32_bf16 v[52:55], a[188:191], a[148:151], v[52:55]
    buffer_load_dwordx4 v217, s[16:19], s44 offen offset:1024 lds
    v_mfma_f32_16x16x32_bf16 v[52:55], a[184:187], a[144:147], v[52:55]
    v_mfma_f32_16x16x32_bf16 v[16:19], a[160:163], a[144:147], v[16:19]
    v_mfma_f32_16x16x32_bf16 v[16:19], a[164:167], a[148:151], v[16:19]
    v_mfma_f32_16x16x32_bf16 v[20:23], a[172:175], a[148:151], v[20:23]
    v_mfma_f32_16x16x32_bf16 v[20:23], a[168:171], a[144:147], v[20:23]
    buffer_load_dwordx4 v218, s[16:19], s44 offen offset:2048 lds
    v_mfma_f32_16x16x32_bf16 v[28:31], a[168:171], a[152:155], v[28:31]
    v_mfma_f32_16x16x32_bf16 v[28:31], a[172:175], a[156:159], v[28:31]
    v_mfma_f32_16x16x32_bf16 v[24:27], a[164:167], a[156:159], v[24:27]
    v_mfma_f32_16x16x32_bf16 v[24:27], a[160:163], a[152:155], v[24:27]
    v_mfma_f32_16x16x32_bf16 v[60:63], a[184:187], a[152:155], v[60:63]
    buffer_load_dwordx4 v219, s[16:19], s44 offen offset:3072 lds
    v_mfma_f32_16x16x32_bf16 v[60:63], a[188:191], a[156:159], v[60:63]
    s_add_u32 s44, s44, 128
    v_mfma_f32_16x16x32_bf16 v[56:59], a[180:183], a[156:159], v[56:59]
    v_mfma_f32_16x16x32_bf16 v[56:59], a[176:179], a[152:155], v[56:59]
    v_mfma_f32_16x16x32_bf16 v[156:159], a[232:235], a[152:155], v[156:159]
    v_mfma_f32_16x16x32_bf16 v[156:159], a[236:239], a[156:159], v[156:159]
    v_mfma_f32_16x16x32_bf16 v[152:155], a[228:231], a[156:159], v[152:155]
    v_mfma_f32_16x16x32_bf16 v[152:155], a[224:227], a[152:155], v[152:155]
    s_waitcnt vmcnt(13) lgkmcnt(0)
    v_mfma_f32_16x16x32_bf16 v[64:67], a[192:195], a[128:131], v[64:67]
    s_barrier
    v_mfma_f32_16x16x32_bf16 v[64:67], a[196:199], a[132:135], v[64:67]
    ds_read_b64_tr_b16 a[224:225], v232 offset:24576
    s_mov_b32 s28, s74
    s_mov_b32 s29, s75
    s_lshl_b32 s50, s34, 5
    s_add_u32 s50, s50, 16
    s_mov_b32 s30, 256
    v_mov_b32_e64 v242, 0
    v_mfma_f32_16x16x32_bf16 v[68:71], a[204:207], a[132:135], v[68:71]
    buffer_load_dword v243, v242, s[28:31], s50 offen sc1
    v_mfma_f32_16x16x32_bf16 v[68:71], a[200:203], a[128:131], v[68:71]
    ds_read_b64_tr_b16 a[226:227], v232 offset:25088
    s_add_u32 m0, s42, 0
    v_mfma_f32_16x16x32_bf16 v[96:99], a[208:211], a[128:131], v[96:99]
    ds_read_b64_tr_b16 a[228:229], v232 offset:28672
    v_mfma_f32_16x16x32_bf16 v[96:99], a[212:215], a[132:135], v[96:99]
    ds_read_b64_tr_b16 a[230:231], v232 offset:29184
    v_mfma_f32_16x16x32_bf16 v[100:103], a[220:223], a[132:135], v[100:103]
    ds_read_b64_tr_b16 a[232:233], v233 offset:24576
    v_mfma_f32_16x16x32_bf16 v[100:103], a[216:219], a[128:131], v[100:103]
    buffer_load_dwordx4 v220, s[20:23], s45 offen offset:0 lds
    v_mfma_f32_16x16x32_bf16 v[160:163], a[240:243], a[128:131], v[160:163]
    ds_read_b64_tr_b16 a[234:235], v233 offset:25088
    v_mfma_f32_16x16x32_bf16 v[160:163], a[244:247], a[132:135], v[160:163]
    ds_read_b64_tr_b16 a[236:237], v233 offset:28672
    v_mfma_f32_16x16x32_bf16 v[164:167], a[252:255], a[132:135], v[164:167]
    ds_read_b64_tr_b16 a[238:239], v233 offset:29184
    v_mfma_f32_16x16x32_bf16 v[164:167], a[248:251], a[128:131], v[164:167]
    ds_read_b64_tr_b16 a[176:177], v229 offset:24576
    v_mfma_f32_16x16x32_bf16 v[172:175], a[248:251], a[136:139], v[172:175]
    buffer_load_dwordx4 v221, s[20:23], s45 offen offset:1024 lds
    v_mfma_f32_16x16x32_bf16 v[172:175], a[252:255], a[140:143], v[172:175]
    ds_read_b64_tr_b16 a[178:179], v229 offset:25600
    v_mfma_f32_16x16x32_bf16 v[168:171], a[244:247], a[140:143], v[168:171]
    ds_read_b64_tr_b16 a[180:181], v229 offset:32768
    v_mfma_f32_16x16x32_bf16 v[168:171], a[240:243], a[136:139], v[168:171]
    ds_read_b64_tr_b16 a[182:183], v229 offset:33792
    v_mfma_f32_16x16x32_bf16 v[108:111], a[216:219], a[136:139], v[108:111]
    ds_read_b64_tr_b16 a[184:185], v229 offset:24584
    v_mfma_f32_16x16x32_bf16 v[108:111], a[220:223], a[140:143], v[108:111]
    buffer_load_dwordx4 v222, s[20:23], s45 offen offset:2048 lds
    v_mfma_f32_16x16x32_bf16 v[104:107], a[212:215], a[140:143], v[104:107]
    ds_read_b64_tr_b16 a[186:187], v229 offset:25608
    v_mfma_f32_16x16x32_bf16 v[104:107], a[208:211], a[136:139], v[104:107]
    ds_read_b64_tr_b16 a[188:189], v229 offset:32776
    v_mfma_f32_16x16x32_bf16 v[76:79], a[200:203], a[136:139], v[76:79]
    ds_read_b64_tr_b16 a[190:191], v229 offset:33800
    v_mfma_f32_16x16x32_bf16 v[76:79], a[204:207], a[140:143], v[76:79]
    ds_read_b64_tr_b16 a[160:161], v228 offset:24576
    v_mfma_f32_16x16x32_bf16 v[72:75], a[196:199], a[140:143], v[72:75]
    buffer_load_dwordx4 v223, s[20:23], s45 offen offset:3072 lds
    v_mfma_f32_16x16x32_bf16 v[72:75], a[192:195], a[136:139], v[72:75]
    ds_read_b64_tr_b16 a[162:163], v228 offset:25600
    s_add_u32 m0, s43, 0
    s_add_u32 s45, s45, 524288
    v_mfma_f32_16x16x32_bf16 v[80:83], a[192:195], a[144:147], v[80:83]
    ds_read_b64_tr_b16 a[164:165], v228 offset:32768
    v_mfma_f32_16x16x32_bf16 v[80:83], a[196:199], a[148:151], v[80:83]
    ds_read_b64_tr_b16 a[166:167], v228 offset:33792
    v_mfma_f32_16x16x32_bf16 v[84:87], a[204:207], a[148:151], v[84:87]
    ds_read_b64_tr_b16 a[168:169], v228 offset:24584
    v_mfma_f32_16x16x32_bf16 v[84:87], a[200:203], a[144:147], v[84:87]
    buffer_load_dwordx4 v224, s[24:27], s46 offen offset:0 lds
    v_mfma_f32_16x16x32_bf16 v[112:115], a[208:211], a[144:147], v[112:115]
    ds_read_b64_tr_b16 a[170:171], v228 offset:25608
    v_mfma_f32_16x16x32_bf16 v[112:115], a[212:215], a[148:151], v[112:115]
    ds_read_b64_tr_b16 a[172:173], v228 offset:32776
    v_mfma_f32_16x16x32_bf16 v[116:119], a[220:223], a[148:151], v[116:119]
    ds_read_b64_tr_b16 a[174:175], v228 offset:33800
L_hop2:
    s_cbranch_execz L_ret0
    v_mfma_f32_16x16x32_bf16 v[116:119], a[216:219], a[144:147], v[116:119]
    ds_read_b128 a[96:99], v226 offset:32768
    v_mfma_f32_16x16x32_bf16 v[176:179], a[240:243], a[144:147], v[176:179]
    buffer_load_dwordx4 v225, s[24:27], s46 offen offset:1024 lds
    v_mfma_f32_16x16x32_bf16 v[176:179], a[244:247], a[148:151], v[176:179]
    ds_read_b128 a[100:103], v227 offset:32768
    s_add_u32 s46, s46, 229376
    v_mfma_f32_16x16x32_bf16 v[180:183], a[252:255], a[148:151], v[180:183]
    ds_read_b128 a[104:107], v226 offset:34816
    v_mfma_f32_16x16x32_bf16 v[180:183], a[248:251], a[144:147], v[180:183]
    ds_read_b128 a[108:111], v227 offset:34816
    v_mfma_f32_16x16x32_bf16 v[188:191], a[248:251], a[152:155], v[188:191]
    ds_read_b128 a[112:115], v226 offset:36864
    v_mfma_f32_16x16x32_bf16 v[188:191], a[252:255], a[156:159], v[188:191]
    ds_read_b128 a[116:119], v227 offset:36864
    v_mfma_f32_16x16x32_bf16 v[184:187], a[244:247], a[156:159], v[184:187]
    ds_read_b128 a[120:123], v226 offset:38912
    v_mfma_f32_16x16x32_bf16 v[184:187], a[240:243], a[152:155], v[184:187]
    ds_read_b128 a[124:127], v227 offset:38912
    v_mfma_f32_16x16x32_bf16 v[124:127], a[216:219], a[152:155], v[124:127]
    v_mfma_f32_16x16x32_bf16 v[124:127], a[220:223], a[156:159], v[124:127]
    v_mfma_f32_16x16x32_bf16 v[120:123], a[212:215], a[156:159], v[120:123]
    v_mfma_f32_16x16x32_bf16 v[120:123], a[208:211], a[152:155], v[120:123]
    v_mfma_f32_16x16x32_bf16 v[92:95], a[200:203], a[152:155], v[92:95]
    v_mfma_f32_16x16x32_bf16 v[92:95], a[204:207], a[156:159], v[92:95]
    v_mfma_f32_16x16x32_bf16 v[88:91], a[196:199], a[156:159], v[88:91]
    v_mfma_f32_16x16x32_bf16 v[88:91], a[192:195], a[152:155], v[88:91]
    s_waitcnt lgkmcnt(0)
    v_smfmac_f32_16x16x64_bf16 a[32:35], v[208:211], a[160:167], v207
    ds_read_b64_tr_b16 a[192:193], v230 offset:24576
    v_smfmac_f32_16x16x64_bf16 a[36:39], v[208:211], a[168:175], v207
    ds_read_b64_tr_b16 a[194:195], v230 offset:25600
    v_smfmac_f32_16x16x64_bf16 a[40:43], v[208:211], a[224:231], v207
    ds_read_b64_tr_b16 a[196:197], v230 offset:32768
    v_smfmac_f32_16x16x64_bf16 a[44:47], v[208:211], a[232:239], v207
    ds_read_b64_tr_b16 a[198:199], v230 offset:33792
    v_mfma_f32_16x16x32_bf16 v[128:131], a[224:227], a[96:99], v[128:131]
    ds_read_b64_tr_b16 a[200:201], v230 offset:24584
    v_mfma_f32_16x16x32_bf16 v[128:131], a[228:231], a[100:103], v[128:131]
    ds_read_b64_tr_b16 a[202:203], v230 offset:25608
    v_mfma_f32_16x16x32_bf16 v[132:135], a[236:239], a[100:103], v[132:135]
    ds_read_b64_tr_b16 a[204:205], v230 offset:32776
    v_mfma_f32_16x16x32_bf16 v[132:135], a[232:235], a[96:99], v[132:135]
    ds_read_b64_tr_b16 a[206:207], v230 offset:33800
    v_mfma_f32_16x16x32_bf16 v[32:35], a[176:179], a[96:99], v[32:35]
    ds_read_b64_tr_b16 a[208:209], v231 offset:24576
    s_add_u32 m0, s41, 32768
    v_mfma_f32_16x16x32_bf16 v[32:35], a[180:183], a[100:103], v[32:35]
    buffer_load_dwordx4 v212, s[16:19], s44 offen offset:0 lds
    v_mfma_f32_16x16x32_bf16 v[36:39], a[188:191], a[100:103], v[36:39]
    ds_read_b64_tr_b16 a[210:211], v231 offset:25600
    v_mfma_f32_16x16x32_bf16 v[36:39], a[184:187], a[96:99], v[36:39]
    ds_read_b64_tr_b16 a[212:213], v231 offset:32768
    v_mfma_f32_16x16x32_bf16 v[0:3], a[160:163], a[96:99], v[0:3]
    ds_read_b64_tr_b16 a[214:215], v231 offset:33792
    v_mfma_f32_16x16x32_bf16 v[0:3], a[164:167], a[100:103], v[0:3]
    ds_read_b64_tr_b16 a[216:217], v231 offset:24584
    v_mfma_f32_16x16x32_bf16 v[4:7], a[172:175], a[100:103], v[4:7]
    buffer_load_dwordx4 v213, s[16:19], s44 offen offset:1024 lds
    v_mfma_f32_16x16x32_bf16 v[4:7], a[168:171], a[96:99], v[4:7]
    ds_read_b64_tr_b16 a[218:219], v231 offset:25608
    v_mfma_f32_16x16x32_bf16 v[12:15], a[168:171], a[104:107], v[12:15]
    ds_read_b64_tr_b16 a[220:221], v231 offset:32776
    v_mfma_f32_16x16x32_bf16 v[12:15], a[172:175], a[108:111], v[12:15]
    ds_read_b64_tr_b16 a[222:223], v231 offset:33800
    v_mfma_f32_16x16x32_bf16 v[8:11], a[164:167], a[108:111], v[8:11]
    ds_read_b64_tr_b16 a[240:241], v234 offset:24576
    v_mfma_f32_16x16x32_bf16 v[8:11], a[160:163], a[104:107], v[8:11]
    buffer_load_dwordx4 v214, s[16:19], s44 offen offset:2048 lds
    v_mfma_f32_16x16x32_bf16 v[44:47], a[184:187], a[104:107], v[44:47]
    ds_read_b64_tr_b16 a[242:243], v234 offset:25088
    v_mfma_f32_16x16x32_bf16 v[44:47], a[188:191], a[108:111], v[44:47]
    ds_read_b64_tr_b16 a[244:245], v234 offset:28672
    v_mfma_f32_16x16x32_bf16 v[40:43], a[180:183], a[108:111], v[40:43]
    ds_read_b64_tr_b16 a[246:247], v234 offset:29184
    v_mfma_f32_16x16x32_bf16 v[40:43], a[176:179], a[104:107], v[40:43]
    ds_read_b64_tr_b16 a[248:249], v235 offset:24576
    v_mfma_f32_16x16x32_bf16 v[140:143], a[232:235], a[104:107], v[140:143]
    buffer_load_dwordx4 v215, s[16:19], s44 offen offset:3072 lds
    v_mfma_f32_16x16x32_bf16 v[140:143], a[236:239], a[108:111], v[140:143]
    ds_read_b64_tr_b16 a[250:251], v235 offset:25088
    s_add_u32 m0, s41, 36864
    v_mfma_f32_16x16x32_bf16 v[136:139], a[228:231], a[108:111], v[136:139]
    ds_read_b64_tr_b16 a[252:253], v235 offset:28672
    v_mfma_f32_16x16x32_bf16 v[136:139], a[224:227], a[104:107], v[136:139]
    ds_read_b64_tr_b16 a[254:255], v235 offset:29184
    v_mfma_f32_16x16x32_bf16 v[144:147], a[224:227], a[112:115], v[144:147]
    v_mfma_f32_16x16x32_bf16 v[144:147], a[228:231], a[116:119], v[144:147]
    buffer_load_dwordx4 v216, s[16:19], s44 offen offset:0 lds
    v_mfma_f32_16x16x32_bf16 v[148:151], a[236:239], a[116:119], v[148:151]
    v_mfma_f32_16x16x32_bf16 v[148:151], a[232:235], a[112:115], v[148:151]
    v_mfma_f32_16x16x32_bf16 v[48:51], a[176:179], a[112:115], v[48:51]
    v_mfma_f32_16x16x32_bf16 v[48:51], a[180:183], a[116:119], v[48:51]
    v_mfma_f32_16x16x32_bf16 v[52:55], a[188:191], a[116:119], v[52:55]
    buffer_load_dwordx4 v217, s[16:19], s44 offen offset:1024 lds
    v_mfma_f32_16x16x32_bf16 v[52:55], a[184:187], a[112:115], v[52:55]
    v_mfma_f32_16x16x32_bf16 v[16:19], a[160:163], a[112:115], v[16:19]
    v_mfma_f32_16x16x32_bf16 v[16:19], a[164:167], a[116:119], v[16:19]
    v_mfma_f32_16x16x32_bf16 v[20:23], a[172:175], a[116:119], v[20:23]
    v_mfma_f32_16x16x32_bf16 v[20:23], a[168:171], a[112:115], v[20:23]
    buffer_load_dwordx4 v218, s[16:19], s44 offen offset:2048 lds
    v_mfma_f32_16x16x32_bf16 v[28:31], a[168:171], a[120:123], v[28:31]
    v_mfma_f32_16x16x32_bf16 v[28:31], a[172:175], a[124:127], v[28:31]
    v_mfma_f32_16x16x32_bf16 v[24:27], a[164:167], a[124:127], v[24:27]
    v_mfma_f32_16x16x32_bf16 v[24:27], a[160:163], a[120:123], v[24:27]
    v_mfma_f32_16x16x32_bf16 v[60:63], a[184:187], a[120:123], v[60:63]
    buffer_load_dwordx4 v219, s[16:19], s44 offen offset:3072 lds
    v_mfma_f32_16x16x32_bf16 v[60:63], a[188:191], a[124:127], v[60:63]
    s_add_u32 s44, s44, 128
    v_mfma_f32_16x16x32_bf16 v[56:59], a[180:183], a[124:127], v[56:59]
    v_mfma_f32_16x16x32_bf16 v[56:59], a[176:179], a[120:123], v[56:59]
    v_mfma_f32_16x16x32_bf16 v[156:159], a[232:235], a[120:123], v[156:159]
    v_mfma_f32_16x16x32_bf16 v[156:159], a[236:239], a[124:127], v[156:159]
    v_mfma_f32_16x16x32_bf16 v[152:155], a[228:231], a[124:127], v[152:155]
    v_mfma_f32_16x16x32_bf16 v[152:155], a[224:227], a[120:123], v[152:155]
    s_waitcnt vmcnt(8) lgkmcnt(0)
    v_cmp_gt_u32 vcc, 32, v243
    v_mfma_f32_16x16x32_bf16 v[64:67], a[192:195], a[96:99], v[64:67]
    s_barrier
    s_cbranch_vccnz L_wait0
L_go0:
    v_mfma_f32_16x16x32_bf16 v[64:67], a[196:199], a[100:103], v[64:67]
    ds_read_b64_tr_b16 a[224:225], v232 offset:0
    s_add_u32 m0, s42, 24576
    v_mfma_f32_16x16x32_bf16 v[68:71], a[204:207], a[100:103], v[68:71]
    buffer_load_dwordx4 v220, s[20:23], s45 offen offset:0 lds
    v_mfma_f32_16x16x32_bf16 v[68:71], a[200:203], a[96:99], v[68:71]
    ds_read_b64_tr_b16 a[226:227], v232 offset:512
    v_mfma_f32_16x16x32_bf16 v[96:99], a[208:211], a[96:99], v[96:99]
    ds_read_b64_tr_b16 a[228:229], v232 offset:4096
    v_mfma_f32_16x16x32_bf16 v[96:99], a[212:215], a[100:103], v[96:99]
    ds_read_b64_tr_b16 a[230:231], v232 offset:4608
    v_mfma_f32_16x16x32_bf16 v[100:103], a[220:223], a[100:103], v[100:103]
    ds_read_b64_tr_b16 a[232:233], v233 offset:0
    v_mfma_f32_16x16x32_bf16 v[100:103], a[216:219], a[96:99], v[100:103]
    buffer_load_dwordx4 v221, s[20:23], s45 offen offset:1024 lds
    v_mfma_f32_16x16x32_bf16 v[160:163], a[240:243], a[96:99], v[160:163]
    ds_read_b64_tr_b16 a[234:235], v233 offset:512
    v_mfma_f32_16x16x32_bf16 v[160:163], a[244:247], a[100:103], v[160:163]
    ds_read_b64_tr_b16 a[236:237], v233 offset:4096
    v_mfma_f32_16x16x32_bf16 v[164:167], a[252:255], a[100:103], v[164:167]
    ds_read_b64_tr_b16 a[238:239], v233 offset:4608
    v_mfma_f32_16x16x32_bf16 v[164:167], a[248:251], a[96:99], v[164:167]
    ds_read_b64_tr_b16 a[176:177], v229 offset:0
    v_mfma_f32_16x16x32_bf16 v[172:175], a[248:251], a[104:107], v[172:175]
    buffer_load_dwordx4 v222, s[20:23], s45 offen offset:2048 lds
    v_mfma_f32_16x16x32_bf16 v[172:175], a[252:255], a[108:111], v[172:175]
    ds_read_b64_tr_b16 a[178:179], v229 offset:1024
    v_mfma_f32_16x16x32_bf16 v[168:171], a[244:247], a[108:111], v[168:171]
    ds_read_b64_tr_b16 a[180:181], v229 offset:8192
    v_mfma_f32_16x16x32_bf16 v[168:171], a[240:243], a[104:107], v[168:171]
    ds_read_b64_tr_b16 a[182:183], v229 offset:9216
    v_mfma_f32_16x16x32_bf16 v[108:111], a[216:219], a[104:107], v[108:111]
    ds_read_b64_tr_b16 a[184:185], v229 offset:8
    v_mfma_f32_16x16x32_bf16 v[108:111], a[220:223], a[108:111], v[108:111]
    buffer_load_dwordx4 v223, s[20:23], s45 offen offset:3072 lds
    v_mfma_f32_16x16x32_bf16 v[104:107], a[212:215], a[108:111], v[104:107]
    ds_read_b64_tr_b16 a[186:187], v229 offset:1032
    s_add_u32 m0, s43, 24576
    s_add_u32 s45, s45, 524288
    v_mfma_f32_16x16x32_bf16 v[104:107], a[208:211], a[104:107], v[104:107]
    ds_read_b64_tr_b16 a[188:189], v229 offset:8200
    v_mfma_f32_16x16x32_bf16 v[76:79], a[200:203], a[104:107], v[76:79]
    ds_read_b64_tr_b16 a[190:191], v229 offset:9224
    v_mfma_f32_16x16x32_bf16 v[76:79], a[204:207], a[108:111], v[76:79]
    ds_read_b64_tr_b16 a[160:161], v228 offset:0
    v_mfma_f32_16x16x32_bf16 v[72:75], a[196:199], a[108:111], v[72:75]
    buffer_load_dwordx4 v224, s[24:27], s46 offen offset:0 lds
    v_mfma_f32_16x16x32_bf16 v[72:75], a[192:195], a[104:107], v[72:75]
    ds_read_b64_tr_b16 a[162:163], v228 offset:1024
    v_mfma_f32_16x16x32_bf16 v[80:83], a[192:195], a[112:115], v[80:83]
    ds_read_b64_tr_b16 a[164:165], v228 offset:8192
    v_mfma_f32_16x16x32_bf16 v[80:83], a[196:199], a[116:119], v[80:83]
    ds_read_b64_tr_b16 a[166:167], v228 offset:9216
    v_mfma_f32_16x16x32_bf16 v[84:87], a[204:207], a[116:119], v[84:87]
    ds_read_b64_tr_b16 a[168:169], v228 offset:8
    v_mfma_f32_16x16x32_bf16 v[84:87], a[200:203], a[112:115], v[84:87]
    buffer_load_dwordx4 v225, s[24:27], s46 offen offset:1024 lds
    v_mfma_f32_16x16x32_bf16 v[112:115], a[208:211], a[112:115], v[112:115]
    ds_read_b64_tr_b16 a[170:171], v228 offset:1032
    s_add_u32 s46, s46, 229376
    s_lshl_b32 s47, s34, 2
    s_add_u32 s47, s47, s33
    s_lshl_b32 s48, s47, 11
    v_lshl_add_u32 v239, v238, 7, s48
    v_mfma_f32_16x16x32_bf16 v[112:115], a[212:215], a[116:119], v[112:115]
    ds_read_b64_tr_b16 a[172:173], v228 offset:8200
    v_mfma_f32_16x16x32_bf16 v[116:119], a[220:223], a[116:119], v[116:119]
    ds_read_b64_tr_b16 a[174:175], v228 offset:9224
    v_mfma_f32_16x16x32_bf16 v[116:119], a[216:219], a[112:115], v[116:119]
    ds_read_b128 a[128:131], v226 offset:0
    v_mfma_f32_16x16x32_bf16 v[176:179], a[240:243], a[112:115], v[176:179]
    buffer_load_dword a58, v239, s[4:7], 0 offen
    v_mfma_f32_16x16x32_bf16 v[176:179], a[244:247], a[116:119], v[176:179]
    ds_read_b128 a[132:135], v227 offset:0
    v_mfma_f32_16x16x32_bf16 v[180:183], a[252:255], a[116:119], v[180:183]
    ds_read_b128 a[136:139], v226 offset:2048
    v_mfma_f32_16x16x32_bf16 v[180:183], a[248:251], a[112:115], v[180:183]
    ds_read_b128 a[140:143], v227 offset:2048
    v_mfma_f32_16x16x32_bf16 v[188:191], a[248:251], a[120:123], v[188:191]
    ds_read_b128 a[144:147], v226 offset:4096
    v_mfma_f32_16x16x32_bf16 v[188:191], a[252:255], a[124:127], v[188:191]
    buffer_load_dword a59, v239, s[8:11], 0 offen
    v_mfma_f32_16x16x32_bf16 v[184:187], a[244:247], a[124:127], v[184:187]
    ds_read_b128 a[148:151], v227 offset:4096
    s_lshl_b32 s47, s47, 12
    s_lshl_b32 s48, s32, 17
    s_add_u32 s47, s47, s48
    s_lshl_b32 s48, s49, 8
    s_add_u32 s47, s47, s48
    v_and_b32_e64 v240, 1, v236
    v_lshl_add_u32 v240, v240, 7, s47
    v_lshl_add_u32 v240, v237, 10, v240
    v_mfma_f32_16x16x32_bf16 v[184:187], a[240:243], a[120:123], v[184:187]
    ds_read_b128 a[152:155], v226 offset:6144
    v_mfma_f32_16x16x32_bf16 v[124:127], a[216:219], a[120:123], v[124:127]
    ds_read_b128 a[156:159], v227 offset:6144
    v_mfma_f32_16x16x32_bf16 v[124:127], a[220:223], a[124:127], v[124:127]
    v_mfma_f32_16x16x32_bf16 v[120:123], a[212:215], a[124:127], v[120:123]
    global_load_dword a60, v240, s[60:61]
    v_mfma_f32_16x16x32_bf16 v[120:123], a[208:211], a[120:123], v[120:123]
    v_mfma_f32_16x16x32_bf16 v[92:95], a[200:203], a[120:123], v[92:95]
    v_mfma_f32_16x16x32_bf16 v[92:95], a[204:207], a[124:127], v[92:95]
    v_mfma_f32_16x16x32_bf16 v[88:91], a[196:199], a[124:127], v[88:91]
    v_mfma_f32_16x16x32_bf16 v[88:91], a[192:195], a[120:123], v[88:91]
    s_waitcnt lgkmcnt(0)
    v_smfmac_f32_16x16x64_bf16 a[32:35], v[208:211], a[160:167], v207
    ds_read_b64_tr_b16 a[192:193], v230 offset:0
    v_smfmac_f32_16x16x64_bf16 a[36:39], v[208:211], a[168:175], v207
    ds_read_b64_tr_b16 a[194:195], v230 offset:1024
    s_lshl_b32 s48, s34, 2
    s_add_u32 s48, s48, s33
    s_mul_i32 s48, s48, 768
    s_add_u32 s48, s48, 50462720
    v_and_b32 v241, 0xf0, v206
    v_smfmac_f32_16x16x64_bf16 a[40:43], v[208:211], a[224:231], v207
    buffer_load_dwordx4 v[212:215], v241, s[12:15], s48 offen offset:0 sc1
    v_smfmac_f32_16x16x64_bf16 a[44:47], v[208:211], a[232:239], v207
    ds_read_b64_tr_b16 a[196:197], v230 offset:8192
    v_mfma_f32_16x16x32_bf16 v[128:131], a[224:227], a[128:131], v[128:131]
    ds_read_b64_tr_b16 a[198:199], v230 offset:9216
    v_mfma_f32_16x16x32_bf16 v[128:131], a[228:231], a[132:135], v[128:131]
    ds_read_b64_tr_b16 a[200:201], v230 offset:8
    v_mfma_f32_16x16x32_bf16 v[132:135], a[236:239], a[132:135], v[132:135]
    ds_read_b64_tr_b16 a[202:203], v230 offset:1032
    v_mfma_f32_16x16x32_bf16 v[132:135], a[232:235], a[128:131], v[132:135]
    buffer_load_dwordx4 v[216:219], v241, s[12:15], s48 offen offset:256 sc1
    v_mfma_f32_16x16x32_bf16 v[32:35], a[176:179], a[128:131], v[32:35]
    ds_read_b64_tr_b16 a[204:205], v230 offset:8200
    v_mfma_f32_16x16x32_bf16 v[32:35], a[180:183], a[132:135], v[32:35]
    ds_read_b64_tr_b16 a[206:207], v230 offset:9224
    v_mfma_f32_16x16x32_bf16 v[36:39], a[188:191], a[132:135], v[36:39]
    ds_read_b64_tr_b16 a[208:209], v231 offset:0
    v_mfma_f32_16x16x32_bf16 v[36:39], a[184:187], a[128:131], v[36:39]
    ds_read_b64_tr_b16 a[210:211], v231 offset:1024
    v_mfma_f32_16x16x32_bf16 v[0:3], a[160:163], a[128:131], v[0:3]
    buffer_load_dwordx4 v[220:223], v241, s[12:15], s48 offen offset:512 sc1
    v_mfma_f32_16x16x32_bf16 v[0:3], a[164:167], a[132:135], v[0:3]
    ds_read_b64_tr_b16 a[212:213], v231 offset:8192
    v_mfma_f32_16x16x32_bf16 v[4:7], a[172:175], a[132:135], v[4:7]
    ds_read_b64_tr_b16 a[214:215], v231 offset:9216
    v_mfma_f32_16x16x32_bf16 v[4:7], a[168:171], a[128:131], v[4:7]
    ds_read_b64_tr_b16 a[216:217], v231 offset:8
    v_mfma_f32_16x16x32_bf16 v[12:15], a[168:171], a[136:139], v[12:15]
    ds_read_b64_tr_b16 a[218:219], v231 offset:1032
    v_mfma_f32_16x16x32_bf16 v[12:15], a[172:175], a[140:143], v[12:15]
    ds_read_b64_tr_b16 a[220:221], v231 offset:8200
    v_mfma_f32_16x16x32_bf16 v[8:11], a[164:167], a[140:143], v[8:11]
    ds_read_b64_tr_b16 a[222:223], v231 offset:9224
    v_mfma_f32_16x16x32_bf16 v[8:11], a[160:163], a[136:139], v[8:11]
    ds_read_b64_tr_b16 a[240:241], v234 offset:0
    v_mfma_f32_16x16x32_bf16 v[44:47], a[184:187], a[136:139], v[44:47]
    ds_read_b64_tr_b16 a[242:243], v234 offset:512
    v_mfma_f32_16x16x32_bf16 v[44:47], a[188:191], a[140:143], v[44:47]
    ds_read_b64_tr_b16 a[244:245], v234 offset:4096
    v_mfma_f32_16x16x32_bf16 v[40:43], a[180:183], a[140:143], v[40:43]
    ds_read_b64_tr_b16 a[246:247], v234 offset:4608
    v_mfma_f32_16x16x32_bf16 v[40:43], a[176:179], a[136:139], v[40:43]
    ds_read_b64_tr_b16 a[248:249], v235 offset:0
    v_mfma_f32_16x16x32_bf16 v[140:143], a[232:235], a[136:139], v[140:143]
    ds_read_b64_tr_b16 a[250:251], v235 offset:512
    v_mfma_f32_16x16x32_bf16 v[140:143], a[236:239], a[140:143], v[140:143]
    ds_read_b64_tr_b16 a[252:253], v235 offset:4096
    v_mfma_f32_16x16x32_bf16 v[136:139], a[228:231], a[140:143], v[136:139]
    ds_read_b64_tr_b16 a[254:255], v235 offset:4608
    v_mfma_f32_16x16x32_bf16 v[136:139], a[224:227], a[136:139], v[136:139]
    v_mfma_f32_16x16x32_bf16 v[144:147], a[224:227], a[144:147], v[144:147]
    v_mfma_f32_16x16x32_bf16 v[144:147], a[228:231], a[148:151], v[144:147]
    v_mfma_f32_16x16x32_bf16 v[148:151], a[236:239], a[148:151], v[148:151]
    v_mfma_f32_16x16x32_bf16 v[148:151], a[232:235], a[144:147], v[148:151]
    v_mfma_f32_16x16x32_bf16 v[48:51], a[176:179], a[144:147], v[48:51]
    v_mfma_f32_16x16x32_bf16 v[48:51], a[180:183], a[148:151], v[48:51]
    v_mfma_f32_16x16x32_bf16 v[52:55], a[188:191], a[148:151], v[52:55]
    v_mfma_f32_16x16x32_bf16 v[52:55], a[184:187], a[144:147], v[52:55]
    v_mfma_f32_16x16x32_bf16 v[16:19], a[160:163], a[144:147], v[16:19]
    v_mfma_f32_16x16x32_bf16 v[16:19], a[164:167], a[148:151], v[16:19]
    v_mfma_f32_16x16x32_bf16 v[20:23], a[172:175], a[148:151], v[20:23]
    v_mfma_f32_16x16x32_bf16 v[20:23], a[168:171], a[144:147], v[20:23]
    v_mfma_f32_16x16x32_bf16 v[28:31], a[168:171], a[152:155], v[28:31]
    v_mfma_f32_16x16x32_bf16 v[28:31], a[172:175], a[156:159], v[28:31]
    v_mfma_f32_16x16x32_bf16 v[24:27], a[164:167], a[156:159], v[24:27]
    v_mfma_f32_16x16x32_bf16 v[24:27], a[160:163], a[152:155], v[24:27]
    v_mfma_f32_16x16x32_bf16 v[60:63], a[184:187], a[152:155], v[60:63]
    v_mfma_f32_16x16x32_bf16 v[60:63], a[188:191], a[156:159], v[60:63]
    v_mfma_f32_16x16x32_bf16 v[56:59], a[180:183], a[156:159], v[56:59]
    v_mfma_f32_16x16x32_bf16 v[56:59], a[176:179], a[152:155], v[56:59]
    v_mfma_f32_16x16x32_bf16 v[156:159], a[232:235], a[152:155], v[156:159]
    v_mfma_f32_16x16x32_bf16 v[156:159], a[236:239], a[156:159], v[156:159]
    v_mfma_f32_16x16x32_bf16 v[152:155], a[228:231], a[156:159], v[152:155]
    v_mfma_f32_16x16x32_bf16 v[152:155], a[224:227], a[152:155], v[152:155]
    s_waitcnt vmcnt(6) lgkmcnt(0)
    v_mfma_f32_16x16x32_bf16 v[64:67], a[192:195], a[128:131], v[64:67]
    s_barrier
    v_mfma_f32_16x16x32_bf16 v[64:67], a[196:199], a[132:135], v[64:67]
    ds_read_b64_tr_b16 a[224:225], v232 offset:24576
    s_add_u32 m0, s35, 0
    s_mov_b32 s37, 0
    v_mfma_f32_16x16x32_bf16 v[68:71], a[204:207], a[132:135], v[68:71]
    buffer_load_dwordx4 v204, s[4:7], s37 offen offset:0 lds
    v_mfma_f32_16x16x32_bf16 v[68:71], a[200:203], a[128:131], v[68:71]
    ds_read_b64_tr_b16 a[226:227], v232 offset:25088
    v_mfma_f32_16x16x32_bf16 v[96:99], a[208:211], a[128:131], v[96:99]
    ds_read_b64_tr_b16 a[228:229], v232 offset:28672
    v_mfma_f32_16x16x32_bf16 v[96:99], a[212:215], a[132:135], v[96:99]
    ds_read_b64_tr_b16 a[230:231], v232 offset:29184
    v_mfma_f32_16x16x32_bf16 v[100:103], a[220:223], a[132:135], v[100:103]
    ds_read_b64_tr_b16 a[232:233], v233 offset:24576
    v_mfma_f32_16x16x32_bf16 v[100:103], a[216:219], a[128:131], v[100:103]
    buffer_load_dwordx4 v204, s[4:7], s37 offen offset:1024 lds
    v_mfma_f32_16x16x32_bf16 v[160:163], a[240:243], a[128:131], v[160:163]
    ds_read_b64_tr_b16 a[234:235], v233 offset:25088
    v_mfma_f32_16x16x32_bf16 v[160:163], a[244:247], a[132:135], v[160:163]
    ds_read_b64_tr_b16 a[236:237], v233 offset:28672
    v_mfma_f32_16x16x32_bf16 v[164:167], a[252:255], a[132:135], v[164:167]
    ds_read_b64_tr_b16 a[238:239], v233 offset:29184
    v_mfma_f32_16x16x32_bf16 v[164:167], a[248:251], a[128:131], v[164:167]
    ds_read_b64_tr_b16 a[176:177], v229 offset:24576
    v_mfma_f32_16x16x32_bf16 v[172:175], a[248:251], a[136:139], v[172:175]
    buffer_load_dwordx4 v204, s[4:7], s37 offen offset:2048 lds
    v_mfma_f32_16x16x32_bf16 v[172:175], a[252:255], a[140:143], v[172:175]
    ds_read_b64_tr_b16 a[178:179], v229 offset:25600
    v_mfma_f32_16x16x32_bf16 v[168:171], a[244:247], a[140:143], v[168:171]
    ds_read_b64_tr_b16 a[180:181], v229 offset:32768
    v_mfma_f32_16x16x32_bf16 v[168:171], a[240:243], a[136:139], v[168:171]
    ds_read_b64_tr_b16 a[182:183], v229 offset:33792
    v_mfma_f32_16x16x32_bf16 v[108:111], a[216:219], a[136:139], v[108:111]
    ds_read_b64_tr_b16 a[184:185], v229 offset:24584
    v_mfma_f32_16x16x32_bf16 v[108:111], a[220:223], a[140:143], v[108:111]
    buffer_load_dwordx4 v204, s[4:7], s37 offen offset:3072 lds
    v_mfma_f32_16x16x32_bf16 v[104:107], a[212:215], a[140:143], v[104:107]
    ds_read_b64_tr_b16 a[186:187], v229 offset:25608
    s_add_u32 m0, s36, 0
    s_mov_b32 s37, 0
    v_mfma_f32_16x16x32_bf16 v[104:107], a[208:211], a[136:139], v[104:107]
    ds_read_b64_tr_b16 a[188:189], v229 offset:32776
    v_mfma_f32_16x16x32_bf16 v[76:79], a[200:203], a[136:139], v[76:79]
    ds_read_b64_tr_b16 a[190:191], v229 offset:33800
    v_mfma_f32_16x16x32_bf16 v[76:79], a[204:207], a[140:143], v[76:79]
    ds_read_b64_tr_b16 a[160:161], v228 offset:24576
    v_mfma_f32_16x16x32_bf16 v[72:75], a[196:199], a[140:143], v[72:75]
    buffer_load_dwordx4 v205, s[8:11], s37 offen offset:0 lds
    v_mfma_f32_16x16x32_bf16 v[72:75], a[192:195], a[136:139], v[72:75]
    ds_read_b64_tr_b16 a[162:163], v228 offset:25600
    v_mfma_f32_16x16x32_bf16 v[80:83], a[192:195], a[144:147], v[80:83]
    ds_read_b64_tr_b16 a[164:165], v228 offset:32768
    v_mfma_f32_16x16x32_bf16 v[80:83], a[196:199], a[148:151], v[80:83]
    ds_read_b64_tr_b16 a[166:167], v228 offset:33792
    v_mfma_f32_16x16x32_bf16 v[84:87], a[204:207], a[148:151], v[84:87]
    ds_read_b64_tr_b16 a[168:169], v228 offset:24584
    v_mfma_f32_16x16x32_bf16 v[84:87], a[200:203], a[144:147], v[84:87]
    buffer_load_dwordx4 v205, s[8:11], s37 offen offset:1024 lds
    v_mfma_f32_16x16x32_bf16 v[112:115], a[208:211], a[144:147], v[112:115]
    ds_read_b64_tr_b16 a[170:171], v228 offset:25608
    v_mfma_f32_16x16x32_bf16 v[112:115], a[212:215], a[148:151], v[112:115]
    ds_read_b64_tr_b16 a[172:173], v228 offset:32776
    v_mfma_f32_16x16x32_bf16 v[116:119], a[220:223], a[148:151], v[116:119]
    ds_read_b64_tr_b16 a[174:175], v228 offset:33800
    v_mfma_f32_16x16x32_bf16 v[116:119], a[216:219], a[144:147], v[116:119]
    ds_read_b128 a[96:99], v226 offset:32768
    v_mfma_f32_16x16x32_bf16 v[176:179], a[240:243], a[144:147], v[176:179]
    buffer_load_dwordx4 v205, s[8:11], s37 offen offset:2048 lds
    v_mfma_f32_16x16x32_bf16 v[176:179], a[244:247], a[148:151], v[176:179]
    ds_read_b128 a[100:103], v227 offset:32768
    v_mfma_f32_16x16x32_bf16 v[180:183], a[252:255], a[148:151], v[180:183]
    ds_read_b128 a[104:107], v226 offset:34816
    v_mfma_f32_16x16x32_bf16 v[180:183], a[248:251], a[144:147], v[180:183]
    ds_read_b128 a[108:111], v227 offset:34816
    v_mfma_f32_16x16x32_bf16 v[188:191], a[248:251], a[152:155], v[188:191]
    ds_read_b128 a[112:115], v226 offset:36864
    v_mfma_f32_16x16x32_bf16 v[188:191], a[252:255], a[156:159], v[188:191]
    buffer_load_dwordx4 v205, s[8:11], s37 offen offset:3072 lds
    v_mfma_f32_16x16x32_bf16 v[184:187], a[244:247], a[156:159], v[184:187]
    ds_read_b128 a[116:119], v227 offset:36864
    v_mfma_f32_16x16x32_bf16 v[184:187], a[240:243], a[152:155], v[184:187]
    ds_read_b128 a[120:123], v226 offset:38912
    v_mfma_f32_16x16x32_bf16 v[124:127], a[216:219], a[152:155], v[124:127]
    ds_read_b128 a[124:127], v227 offset:38912
    v_mfma_f32_16x16x32_bf16 v[124:127], a[220:223], a[156:159], v[124:127]
    v_mfma_f32_16x16x32_bf16 v[120:123], a[212:215], a[156:159], v[120:123]
    v_mfma_f32_16x16x32_bf16 v[120:123], a[208:211], a[152:155], v[120:123]
    v_mfma_f32_16x16x32_bf16 v[92:95], a[200:203], a[152:155], v[92:95]
    v_mfma_f32_16x16x32_bf16 v[92:95], a[204:207], a[156:159], v[92:95]
    v_mfma_f32_16x16x32_bf16 v[88:91], a[196:199], a[156:159], v[88:91]
    v_mfma_f32_16x16x32_bf16 v[88:91], a[192:195], a[152:155], v[88:91]
    s_waitcnt lgkmcnt(0)
    v_smfmac_f32_16x16x64_bf16 a[32:35], v[208:211], a[160:167], v207
    ds_read_b64_tr_b16 a[192:193], v230 offset:24576
    v_lshlrev_b32 v239, 2, v238
    s_lshl_b32 s47, s33, 7
    s_add_u32 s47, s47, 114688
    v_smfmac_f32_16x16x64_bf16 a[36:39], v[208:211], a[168:175], v207
    ds_read_b64_tr_b16 a[194:195], v230 offset:25600
    v_add_u32 v224, s47, v239
    s_lshr_b32 s47, s33, 1
    s_lshl_b32 s47, s47, 7
    s_add_u32 s47, s47, 115200
    v_smfmac_f32_16x16x64_bf16 a[40:43], v[208:211], a[224:231], v207
    ds_read_b64_tr_b16 a[196:197], v230 offset:32768
    v_add_u32 v225, s47, v239
    v_smfmac_f32_16x16x64_bf16 a[44:47], v[208:211], a[232:239], v207
    ds_read_b64_tr_b16 a[198:199], v230 offset:33792
    v_lshlrev_b32 v239, 4, v237
    s_lshl_b32 s47, s33, 7
    s_add_u32 s47, s47, 114688
    v_mfma_f32_16x16x32_bf16 v[128:131], a[224:227], a[96:99], v[128:131]
    ds_read_b64_tr_b16 a[200:201], v230 offset:24584
    v_add_u32 v226, s47, v239
    s_lshr_b32 s47, s33, 1
    s_lshl_b32 s47, s47, 7
    s_add_u32 s47, s47, 115200
    v_mfma_f32_16x16x32_bf16 v[128:131], a[228:231], a[100:103], v[128:131]
    ds_read_b64_tr_b16 a[202:203], v230 offset:25608
    v_add_u32 v227, s47, v239
    v_mfma_f32_16x16x32_bf16 v[132:135], a[236:239], a[100:103], v[132:135]
    ds_read_b64_tr_b16 a[204:205], v230 offset:32776
    v_accvgpr_read_b32 v240, a32
    v_mfma_f32_16x16x32_bf16 v[132:135], a[232:235], a[96:99], v[132:135]
    ds_read_b64_tr_b16 a[206:207], v230 offset:33800
    v_accvgpr_read_b32 v241, a33
    v_mfma_f32_16x16x32_bf16 v[32:35], a[176:179], a[96:99], v[32:35]
    ds_read_b64_tr_b16 a[208:209], v231 offset:24576
    s_add_u32 m0, s35, 16384
    s_mov_b32 s37, 16384
    v_accvgpr_read_b32 v242, a36
    v_mfma_f32_16x16x32_bf16 v[32:35], a[180:183], a[100:103], v[32:35]
    buffer_load_dwordx4 v204, s[4:7], s37 offen offset:0 lds
    v_mfma_f32_16x16x32_bf16 v[36:39], a[188:191], a[100:103], v[36:39]
    ds_read_b64_tr_b16 a[210:211], v231 offset:25600
    v_accvgpr_read_b32 v243, a37
    v_mfma_f32_16x16x32_bf16 v[36:39], a[184:187], a[96:99], v[36:39]
    ds_read_b64_tr_b16 a[212:213], v231 offset:32768
    v_accvgpr_read_b32 v244, a40
    v_mfma_f32_16x16x32_bf16 v[0:3], a[160:163], a[96:99], v[0:3]
    ds_read_b64_tr_b16 a[214:215], v231 offset:33792
    v_accvgpr_read_b32 v245, a41
    v_mfma_f32_16x16x32_bf16 v[0:3], a[164:167], a[100:103], v[0:3]
    ds_read_b64_tr_b16 a[216:217], v231 offset:24584
    v_accvgpr_read_b32 v246, a44
    v_mfma_f32_16x16x32_bf16 v[4:7], a[172:175], a[100:103], v[4:7]
    buffer_load_dwordx4 v204, s[4:7], s37 offen offset:1024 lds
    v_mfma_f32_16x16x32_bf16 v[4:7], a[168:171], a[96:99], v[4:7]
    ds_read_b64_tr_b16 a[218:219], v231 offset:25608
    v_accvgpr_read_b32 v247, a45
    v_mfma_f32_16x16x32_bf16 v[12:15], a[168:171], a[104:107], v[12:15]
    ds_read_b64_tr_b16 a[220:221], v231 offset:32776
    v_add_f32_e64 v240, v240, v241
    v_mfma_f32_16x16x32_bf16 v[12:15], a[172:175], a[108:111], v[12:15]
    ds_read_b64_tr_b16 a[222:223], v231 offset:33800
    v_add_f32_e64 v242, v242, v243
    v_mfma_f32_16x16x32_bf16 v[8:11], a[164:167], a[108:111], v[8:11]
    ds_read_b64_tr_b16 a[240:241], v234 offset:24576
    v_add_f32_e64 v244, v244, v245
    v_mfma_f32_16x16x32_bf16 v[8:11], a[160:163], a[104:107], v[8:11]
    buffer_load_dwordx4 v204, s[4:7], s37 offen offset:2048 lds
    v_mfma_f32_16x16x32_bf16 v[44:47], a[184:187], a[104:107], v[44:47]
    ds_read_b64_tr_b16 a[242:243], v234 offset:25088
    v_add_f32_e64 v246, v246, v247
    v_mfma_f32_16x16x32_bf16 v[44:47], a[188:191], a[108:111], v[44:47]
    ds_read_b64_tr_b16 a[244:245], v234 offset:28672
    ds_write_b32 v224, v240 offset:0
    v_mfma_f32_16x16x32_bf16 v[40:43], a[180:183], a[108:111], v[40:43]
    ds_read_b64_tr_b16 a[246:247], v234 offset:29184
    ds_write_b32 v224, v242 offset:64
    v_mfma_f32_16x16x32_bf16 v[40:43], a[176:179], a[104:107], v[40:43]
    ds_read_b64_tr_b16 a[248:249], v235 offset:24576
    ds_write_b32 v225, v244 offset:0
    v_mfma_f32_16x16x32_bf16 v[140:143], a[232:235], a[104:107], v[140:143]
    buffer_load_dwordx4 v204, s[4:7], s37 offen offset:3072 lds
    v_mfma_f32_16x16x32_bf16 v[140:143], a[236:239], a[108:111], v[140:143]
    ds_read_b64_tr_b16 a[250:251], v235 offset:25088
    ds_write_b32 v225, v246 offset:64
    v_mfma_f32_16x16x32_bf16 v[136:139], a[228:231], a[108:111], v[136:139]
    ds_read_b64_tr_b16 a[252:253], v235 offset:28672
    v_mfma_f32_16x16x32_bf16 v[136:139], a[224:227], a[104:107], v[136:139]
    ds_read_b64_tr_b16 a[254:255], v235 offset:29184
    v_mfma_f32_16x16x32_bf16 v[144:147], a[224:227], a[112:115], v[144:147]
    v_mfma_f32_16x16x32_bf16 v[144:147], a[228:231], a[116:119], v[144:147]
    v_mfma_f32_16x16x32_bf16 v[148:151], a[236:239], a[116:119], v[148:151]
    v_mfma_f32_16x16x32_bf16 v[148:151], a[232:235], a[112:115], v[148:151]
    v_mfma_f32_16x16x32_bf16 v[48:51], a[176:179], a[112:115], v[48:51]
    v_mfma_f32_16x16x32_bf16 v[48:51], a[180:183], a[116:119], v[48:51]
    v_mfma_f32_16x16x32_bf16 v[52:55], a[188:191], a[116:119], v[52:55]
    v_mfma_f32_16x16x32_bf16 v[52:55], a[184:187], a[112:115], v[52:55]
    v_mfma_f32_16x16x32_bf16 v[16:19], a[160:163], a[112:115], v[16:19]
    v_mfma_f32_16x16x32_bf16 v[16:19], a[164:167], a[116:119], v[16:19]
    v_mfma_f32_16x16x32_bf16 v[20:23], a[172:175], a[116:119], v[20:23]
    v_mfma_f32_16x16x32_bf16 v[20:23], a[168:171], a[112:115], v[20:23]
    v_mfma_f32_16x16x32_bf16 v[28:31], a[168:171], a[120:123], v[28:31]
    v_mfma_f32_16x16x32_bf16 v[28:31], a[172:175], a[124:127], v[28:31]
    v_mfma_f32_16x16x32_bf16 v[24:27], a[164:167], a[124:127], v[24:27]
    v_mfma_f32_16x16x32_bf16 v[24:27], a[160:163], a[120:123], v[24:27]
    v_mfma_f32_16x16x32_bf16 v[60:63], a[184:187], a[120:123], v[60:63]
    v_mfma_f32_16x16x32_bf16 v[60:63], a[188:191], a[124:127], v[60:63]
    v_mfma_f32_16x16x32_bf16 v[56:59], a[180:183], a[124:127], v[56:59]
    v_mfma_f32_16x16x32_bf16 v[56:59], a[176:179], a[120:123], v[56:59]
    v_mfma_f32_16x16x32_bf16 v[156:159], a[232:235], a[120:123], v[156:159]
    v_mfma_f32_16x16x32_bf16 v[156:159], a[236:239], a[124:127], v[156:159]
    v_mfma_f32_16x16x32_bf16 v[152:155], a[228:231], a[124:127], v[152:155]
    v_mfma_f32_16x16x32_bf16 v[152:155], a[224:227], a[120:123], v[152:155]
    s_waitcnt lgkmcnt(0)
    v_mfma_f32_16x16x32_bf16 v[64:67], a[192:195], a[96:99], v[64:67]
    s_barrier
    v_xor_b32_e64 v239, 0, v226
    v_mfma_f32_16x16x32_bf16 v[64:67], a[196:199], a[100:103], v[64:67]
    ds_read_b128 v[240:243], v239
    ds_read_b128 v[244:247], v239 offset:64
    v_mfma_f32_16x16x32_bf16 v[68:71], a[204:207], a[100:103], v[68:71]
    v_xor_b32 v239, 128, v226
    v_mfma_f32_16x16x32_bf16 v[68:71], a[200:203], a[96:99], v[68:71]
    ds_read_b128 v[248:251], v239
    ds_read_b128 v[252:255], v239 offset:64
    s_add_u32 m0, s36, 16384
    s_mov_b32 s37, 16384
    v_mfma_f32_16x16x32_bf16 v[96:99], a[208:211], a[96:99], v[96:99]
    buffer_load_dwordx4 v205, s[8:11], s37 offen offset:0 lds
L_hop3:
    s_cbranch_execz L_ret0
    v_mfma_f32_16x16x32_bf16 v[96:99], a[212:215], a[100:103], v[96:99]
    s_waitcnt vmcnt(13) lgkmcnt(2)
    v_mfma_f32_16x16x32_bf16 v[100:103], a[220:223], a[100:103], v[100:103]
    v_fmac_f32 v0, v212, v240
    v_fmac_f32 v1, v212, v241
    v_mfma_f32_16x16x32_bf16 v[100:103], a[216:219], a[96:99], v[100:103]
    v_fmac_f32 v2, v212, v242
    v_fmac_f32 v3, v212, v243
    v_mfma_f32_16x16x32_bf16 v[160:163], a[240:243], a[96:99], v[160:163]
    v_fmac_f32 v4, v212, v244
    v_fmac_f32 v5, v212, v245
    v_mfma_f32_16x16x32_bf16 v[160:163], a[244:247], a[100:103], v[160:163]
    buffer_load_dwordx4 v205, s[8:11], s37 offen offset:1024 lds
    v_mfma_f32_16x16x32_bf16 v[164:167], a[252:255], a[100:103], v[164:167]
    v_fmac_f32 v6, v212, v246
    v_fmac_f32 v7, v212, v247
    v_mfma_f32_16x16x32_bf16 v[164:167], a[248:251], a[96:99], v[164:167]
    v_mul_f32 v0, v216, v0
    v_mul_f32 v1, v216, v1
    v_mfma_f32_16x16x32_bf16 v[172:175], a[248:251], a[104:107], v[172:175]
    v_mul_f32 v2, v216, v2
    v_mul_f32 v3, v216, v3
    v_mfma_f32_16x16x32_bf16 v[172:175], a[252:255], a[108:111], v[172:175]
    v_mul_f32 v4, v216, v4
    v_mul_f32 v5, v216, v5
    v_mfma_f32_16x16x32_bf16 v[168:171], a[244:247], a[108:111], v[168:171]
    v_mul_f32 v6, v216, v6
    v_mul_f32 v7, v216, v7
    v_mfma_f32_16x16x32_bf16 v[168:171], a[240:243], a[104:107], v[168:171]
    buffer_load_dwordx4 v205, s[8:11], s37 offen offset:2048 lds
    v_mfma_f32_16x16x32_bf16 v[108:111], a[216:219], a[104:107], v[108:111]
    v_cvt_pk_bf16_f32 v0, v0, v1
    v_cvt_pk_bf16_f32 v1, v2, v3
    v_mfma_f32_16x16x32_bf16 v[108:111], a[220:223], a[108:111], v[108:111]
    v_cvt_pk_bf16_f32 v2, v4, v5
    v_cvt_pk_bf16_f32 v3, v6, v7
    v_mfma_f32_16x16x32_bf16 v[104:107], a[212:215], a[108:111], v[104:107]
    v_fmac_f32 v8, v213, v240
    v_fmac_f32 v9, v213, v241
    v_mfma_f32_16x16x32_bf16 v[104:107], a[208:211], a[104:107], v[104:107]
    v_fmac_f32 v10, v213, v242
    v_fmac_f32 v11, v213, v243
    v_mfma_f32_16x16x32_bf16 v[76:79], a[200:203], a[104:107], v[76:79]
    v_fmac_f32 v12, v213, v244
    v_fmac_f32 v13, v213, v245
    v_mfma_f32_16x16x32_bf16 v[76:79], a[204:207], a[108:111], v[76:79]
    buffer_load_dwordx4 v205, s[8:11], s37 offen offset:3072 lds
    v_mfma_f32_16x16x32_bf16 v[72:75], a[196:199], a[108:111], v[72:75]
    v_fmac_f32 v14, v213, v246
    v_fmac_f32 v15, v213, v247
    v_mfma_f32_16x16x32_bf16 v[72:75], a[192:195], a[104:107], v[72:75]
    v_mul_f32 v8, v217, v8
    v_mul_f32 v9, v217, v9
    v_mfma_f32_16x16x32_bf16 v[80:83], a[192:195], a[112:115], v[80:83]
    v_mul_f32 v10, v217, v10
    v_mul_f32 v11, v217, v11
    v_mfma_f32_16x16x32_bf16 v[80:83], a[196:199], a[116:119], v[80:83]
    v_mul_f32 v12, v217, v12
    v_mul_f32 v13, v217, v13
    s_add_u32 m0, s35, 32768
    s_mov_b32 s37, 32768
    v_mfma_f32_16x16x32_bf16 v[84:87], a[204:207], a[116:119], v[84:87]
    v_mul_f32 v14, v217, v14
    v_mul_f32 v15, v217, v15
    v_mfma_f32_16x16x32_bf16 v[84:87], a[200:203], a[112:115], v[84:87]
    buffer_load_dwordx4 v204, s[4:7], s37 offen offset:0 lds
    v_mfma_f32_16x16x32_bf16 v[112:115], a[208:211], a[112:115], v[112:115]
    v_cvt_pk_bf16_f32 v4, v8, v9
    v_cvt_pk_bf16_f32 v5, v10, v11
    v_mfma_f32_16x16x32_bf16 v[112:115], a[212:215], a[116:119], v[112:115]
    v_cvt_pk_bf16_f32 v6, v12, v13
    v_cvt_pk_bf16_f32 v7, v14, v15
    v_mfma_f32_16x16x32_bf16 v[116:119], a[220:223], a[116:119], v[116:119]
    v_fmac_f32 v16, v214, v240
    v_fmac_f32 v17, v214, v241
    v_mfma_f32_16x16x32_bf16 v[116:119], a[216:219], a[112:115], v[116:119]
    v_fmac_f32 v18, v214, v242
    v_fmac_f32 v19, v214, v243
    v_mfma_f32_16x16x32_bf16 v[176:179], a[240:243], a[112:115], v[176:179]
    buffer_load_dwordx4 v204, s[4:7], s37 offen offset:1024 lds
    v_mfma_f32_16x16x32_bf16 v[176:179], a[244:247], a[116:119], v[176:179]
    v_fmac_f32 v20, v214, v244
    v_fmac_f32 v21, v214, v245
    v_mfma_f32_16x16x32_bf16 v[180:183], a[252:255], a[116:119], v[180:183]
    v_fmac_f32 v22, v214, v246
    v_fmac_f32 v23, v214, v247
    v_mfma_f32_16x16x32_bf16 v[180:183], a[248:251], a[112:115], v[180:183]
    v_mul_f32 v16, v218, v16
    v_mul_f32 v17, v218, v17
    v_mfma_f32_16x16x32_bf16 v[188:191], a[248:251], a[120:123], v[188:191]
    v_mul_f32 v18, v218, v18
    v_mul_f32 v19, v218, v19
    v_mfma_f32_16x16x32_bf16 v[188:191], a[252:255], a[124:127], v[188:191]
    v_mul_f32 v20, v218, v20
    v_mul_f32 v21, v218, v21
    v_mfma_f32_16x16x32_bf16 v[184:187], a[244:247], a[124:127], v[184:187]
    buffer_load_dwordx4 v204, s[4:7], s37 offen offset:2048 lds
    v_mfma_f32_16x16x32_bf16 v[184:187], a[240:243], a[120:123], v[184:187]
    v_mul_f32 v22, v218, v22
    v_mul_f32 v23, v218, v23
    v_mfma_f32_16x16x32_bf16 v[124:127], a[216:219], a[120:123], v[124:127]
    v_cvt_pk_bf16_f32 v8, v16, v17
    v_cvt_pk_bf16_f32 v9, v18, v19
    v_mfma_f32_16x16x32_bf16 v[124:127], a[220:223], a[124:127], v[124:127]
    v_cvt_pk_bf16_f32 v10, v20, v21
    v_cvt_pk_bf16_f32 v11, v22, v23
    v_mfma_f32_16x16x32_bf16 v[120:123], a[212:215], a[124:127], v[120:123]
    v_fmac_f32 v24, v215, v240
    v_fmac_f32 v25, v215, v241
    v_mfma_f32_16x16x32_bf16 v[120:123], a[208:211], a[120:123], v[120:123]
    v_fmac_f32 v26, v215, v242
    v_fmac_f32 v27, v215, v243
    v_mfma_f32_16x16x32_bf16 v[92:95], a[200:203], a[120:123], v[92:95]
    buffer_load_dwordx4 v204, s[4:7], s37 offen offset:3072 lds
    v_mfma_f32_16x16x32_bf16 v[92:95], a[204:207], a[124:127], v[92:95]
    v_fmac_f32 v28, v215, v244
    v_fmac_f32 v29, v215, v245
    v_mfma_f32_16x16x32_bf16 v[88:91], a[196:199], a[124:127], v[88:91]
    v_fmac_f32 v30, v215, v246
    v_fmac_f32 v31, v215, v247
    v_mfma_f32_16x16x32_bf16 v[88:91], a[192:195], a[120:123], v[88:91]
    v_mul_f32 v24, v219, v24
    v_mul_f32 v25, v219, v25
    v_mul_f32 v26, v219, v26
    v_mul_f32 v27, v219, v27
    v_mul_f32 v28, v219, v28
    v_mul_f32 v29, v219, v29
    v_mul_f32 v30, v219, v30
    v_mul_f32 v31, v219, v31
    v_cvt_pk_bf16_f32 v12, v24, v25
    v_cvt_pk_bf16_f32 v13, v26, v27
    v_cvt_pk_bf16_f32 v14, v28, v29
    v_cvt_pk_bf16_f32 v15, v30, v31
    v_xor_b32 v239, 256, v226
    ds_read_b128 v[240:243], v239
    ds_read_b128 v[244:247], v239 offset:64
    s_waitcnt lgkmcnt(2)
    s_nop 0
    v_pk_fma_f32 v[32:33], v[212:213], v[248:249], v[32:33] op_sel:[0,0,0] op_sel_hi:[0,1,1]
    v_pk_fma_f32 v[34:35], v[212:213], v[250:251], v[34:35] op_sel:[0,0,0] op_sel_hi:[0,1,1]
    v_pk_fma_f32 v[36:37], v[212:213], v[252:253], v[36:37] op_sel:[0,0,0] op_sel_hi:[0,1,1]
    v_pk_fma_f32 v[38:39], v[212:213], v[254:255], v[38:39] op_sel:[0,0,0] op_sel_hi:[0,1,1]
    v_pk_mul_f32 v[32:33], v[216:217], v[32:33] op_sel:[0,0] op_sel_hi:[0,1]
    v_pk_mul_f32 v[34:35], v[216:217], v[34:35] op_sel:[0,0] op_sel_hi:[0,1]
    v_pk_mul_f32 v[36:37], v[216:217], v[36:37] op_sel:[0,0] op_sel_hi:[0,1]
    v_pk_mul_f32 v[38:39], v[216:217], v[38:39] op_sel:[0,0] op_sel_hi:[0,1]
    v_cvt_pk_bf16_f32 v16, v32, v33
    v_cvt_pk_bf16_f32 v17, v34, v35
    v_cvt_pk_bf16_f32 v18, v36, v37
    v_cvt_pk_bf16_f32 v19, v38, v39
    s_waitcnt vmcnt(16)
    s_add_u32 m0, s35, 49152
    s_mov_b32 s37, 49152
    s_barrier
    buffer_load_dwordx4 v204, s[4:7], s37 offen offset:0 lds
    ds_read_b128 a[192:195], v192 offset:0
    v_pk_fma_f32 v[40:41], v[212:213], v[248:249], v[40:41] op_sel:[1,0,0] op_sel_hi:[1,1,1]
    v_pk_fma_f32 v[42:43], v[212:213], v[250:251], v[42:43] op_sel:[1,0,0] op_sel_hi:[1,1,1]
    v_pk_fma_f32 v[44:45], v[212:213], v[252:253], v[44:45] op_sel:[1,0,0] op_sel_hi:[1,1,1]
    v_pk_fma_f32 v[46:47], v[212:213], v[254:255], v[46:47] op_sel:[1,0,0] op_sel_hi:[1,1,1]
    v_pk_mul_f32 v[40:41], v[216:217], v[40:41] op_sel:[1,0] op_sel_hi:[1,1]
    v_pk_mul_f32 v[42:43], v[216:217], v[42:43] op_sel:[1,0] op_sel_hi:[1,1]
    v_pk_mul_f32 v[44:45], v[216:217], v[44:45] op_sel:[1,0] op_sel_hi:[1,1]
    v_pk_mul_f32 v[46:47], v[216:217], v[46:47] op_sel:[1,0] op_sel_hi:[1,1]
    v_cvt_pk_bf16_f32 v20, v40, v41
    v_cvt_pk_bf16_f32 v21, v42, v43
    v_cvt_pk_bf16_f32 v22, v44, v45
    v_cvt_pk_bf16_f32 v23, v46, v47
    ds_read_b128 a[196:199], v193 offset:0
    v_pk_fma_f32 v[48:49], v[214:215], v[248:249], v[48:49] op_sel:[0,0,0] op_sel_hi:[0,1,1]
    v_pk_fma_f32 v[50:51], v[214:215], v[250:251], v[50:51] op_sel:[0,0,0] op_sel_hi:[0,1,1]
    v_pk_fma_f32 v[52:53], v[214:215], v[252:253], v[52:53] op_sel:[0,0,0] op_sel_hi:[0,1,1]
    v_pk_fma_f32 v[54:55], v[214:215], v[254:255], v[54:55] op_sel:[0,0,0] op_sel_hi:[0,1,1]
    buffer_load_dwordx4 v204, s[4:7], s37 offen offset:1024 lds
    v_pk_mul_f32 v[48:49], v[218:219], v[48:49] op_sel:[0,0] op_sel_hi:[0,1]
    v_pk_mul_f32 v[50:51], v[218:219], v[50:51] op_sel:[0,0] op_sel_hi:[0,1]
    v_pk_mul_f32 v[52:53], v[218:219], v[52:53] op_sel:[0,0] op_sel_hi:[0,1]
    v_pk_mul_f32 v[54:55], v[218:219], v[54:55] op_sel:[0,0] op_sel_hi:[0,1]
    v_cvt_pk_bf16_f32 v24, v48, v49
    v_cvt_pk_bf16_f32 v25, v50, v51
    v_cvt_pk_bf16_f32 v26, v52, v53
    v_cvt_pk_bf16_f32 v27, v54, v55
    ds_read_b128 a[200:203], v194 offset:0
    v_pk_fma_f32 v[56:57], v[214:215], v[248:249], v[56:57] op_sel:[1,0,0] op_sel_hi:[1,1,1]
    v_pk_fma_f32 v[58:59], v[214:215], v[250:251], v[58:59] op_sel:[1,0,0] op_sel_hi:[1,1,1]
    v_pk_fma_f32 v[60:61], v[214:215], v[252:253], v[60:61] op_sel:[1,0,0] op_sel_hi:[1,1,1]
    v_pk_fma_f32 v[62:63], v[214:215], v[254:255], v[62:63] op_sel:[1,0,0] op_sel_hi:[1,1,1]
    v_pk_mul_f32 v[56:57], v[218:219], v[56:57] op_sel:[1,0] op_sel_hi:[1,1]
    v_pk_mul_f32 v[58:59], v[218:219], v[58:59] op_sel:[1,0] op_sel_hi:[1,1]
    v_pk_mul_f32 v[60:61], v[218:219], v[60:61] op_sel:[1,0] op_sel_hi:[1,1]
    v_pk_mul_f32 v[62:63], v[218:219], v[62:63] op_sel:[1,0] op_sel_hi:[1,1]
    v_cvt_pk_bf16_f32 v28, v56, v57
    buffer_load_dwordx4 v204, s[4:7], s37 offen offset:2048 lds
    v_cvt_pk_bf16_f32 v29, v58, v59
    v_cvt_pk_bf16_f32 v30, v60, v61
    v_cvt_pk_bf16_f32 v31, v62, v63
    ds_read_b128 a[204:207], v195 offset:0
    v_xor_b32 v239, 384, v226
    ds_read_b128 v[248:251], v239
    ds_read_b128 v[252:255], v239 offset:64
    s_waitcnt lgkmcnt(6)
    s_nop 0
    v_pk_fma_f32 v[64:65], v[212:213], v[240:241], v[64:65] op_sel:[0,0,0] op_sel_hi:[0,1,1]
    v_pk_fma_f32 v[66:67], v[212:213], v[242:243], v[66:67] op_sel:[0,0,0] op_sel_hi:[0,1,1]
    v_pk_fma_f32 v[68:69], v[212:213], v[244:245], v[68:69] op_sel:[0,0,0] op_sel_hi:[0,1,1]
    v_pk_fma_f32 v[70:71], v[212:213], v[246:247], v[70:71] op_sel:[0,0,0] op_sel_hi:[0,1,1]
    v_pk_mul_f32 v[64:65], v[216:217], v[64:65] op_sel:[0,0] op_sel_hi:[0,1]
    v_pk_mul_f32 v[66:67], v[216:217], v[66:67] op_sel:[0,0] op_sel_hi:[0,1]
    v_pk_mul_f32 v[68:69], v[216:217], v[68:69] op_sel:[0,0] op_sel_hi:[0,1]
    v_pk_mul_f32 v[70:71], v[216:217], v[70:71] op_sel:[0,0] op_sel_hi:[0,1]
    v_cvt_pk_bf16_f32 v32, v64, v65
    v_cvt_pk_bf16_f32 v33, v66, v67
    buffer_load_dwordx4 v204, s[4:7], s37 offen offset:3072 lds
    v_cvt_pk_bf16_f32 v34, v68, v69
    v_cvt_pk_bf16_f32 v35, v70, v71
    ds_read_b128 a[208:211], v192 offset:1024
    v_pk_fma_f32 v[72:73], v[212:213], v[240:241], v[72:73] op_sel:[1,0,0] op_sel_hi:[1,1,1]
    v_pk_fma_f32 v[74:75], v[212:213], v[242:243], v[74:75] op_sel:[1,0,0] op_sel_hi:[1,1,1]
    v_pk_fma_f32 v[76:77], v[212:213], v[244:245], v[76:77] op_sel:[1,0,0] op_sel_hi:[1,1,1]
    v_pk_fma_f32 v[78:79], v[212:213], v[246:247], v[78:79] op_sel:[1,0,0] op_sel_hi:[1,1,1]
    v_pk_mul_f32 v[72:73], v[216:217], v[72:73] op_sel:[1,0] op_sel_hi:[1,1]
    v_pk_mul_f32 v[74:75], v[216:217], v[74:75] op_sel:[1,0] op_sel_hi:[1,1]
    v_pk_mul_f32 v[76:77], v[216:217], v[76:77] op_sel:[1,0] op_sel_hi:[1,1]
    v_pk_mul_f32 v[78:79], v[216:217], v[78:79] op_sel:[1,0] op_sel_hi:[1,1]
    v_cvt_pk_bf16_f32 v36, v72, v73
    v_cvt_pk_bf16_f32 v37, v74, v75
    v_cvt_pk_bf16_f32 v38, v76, v77
    v_cvt_pk_bf16_f32 v39, v78, v79
    ds_read_b128 a[212:215], v193 offset:1024
    v_pk_fma_f32 v[80:81], v[214:215], v[240:241], v[80:81] op_sel:[0,0,0] op_sel_hi:[0,1,1]
    v_pk_fma_f32 v[82:83], v[214:215], v[242:243], v[82:83] op_sel:[0,0,0] op_sel_hi:[0,1,1]
    v_pk_fma_f32 v[84:85], v[214:215], v[244:245], v[84:85] op_sel:[0,0,0] op_sel_hi:[0,1,1]
    v_pk_fma_f32 v[86:87], v[214:215], v[246:247], v[86:87] op_sel:[0,0,0] op_sel_hi:[0,1,1]
    v_pk_mul_f32 v[80:81], v[218:219], v[80:81] op_sel:[0,0] op_sel_hi:[0,1]
    v_pk_mul_f32 v[82:83], v[218:219], v[82:83] op_sel:[0,0] op_sel_hi:[0,1]
    v_pk_mul_f32 v[84:85], v[218:219], v[84:85] op_sel:[0,0] op_sel_hi:[0,1]
    v_pk_mul_f32 v[86:87], v[218:219], v[86:87] op_sel:[0,0] op_sel_hi:[0,1]
    v_cvt_pk_bf16_f32 v40, v80, v81
    v_cvt_pk_bf16_f32 v41, v82, v83
    v_cvt_pk_bf16_f32 v42, v84, v85
    v_cvt_pk_bf16_f32 v43, v86, v87
    ds_read_b128 a[216:219], v194 offset:1024
    v_pk_fma_f32 v[88:89], v[214:215], v[240:241], v[88:89] op_sel:[1,0,0] op_sel_hi:[1,1,1]
    v_pk_fma_f32 v[90:91], v[214:215], v[242:243], v[90:91] op_sel:[1,0,0] op_sel_hi:[1,1,1]
    v_pk_fma_f32 v[92:93], v[214:215], v[244:245], v[92:93] op_sel:[1,0,0] op_sel_hi:[1,1,1]
    v_pk_fma_f32 v[94:95], v[214:215], v[246:247], v[94:95] op_sel:[1,0,0] op_sel_hi:[1,1,1]
    v_pk_mul_f32 v[88:89], v[218:219], v[88:89] op_sel:[1,0] op_sel_hi:[1,1]
    v_pk_mul_f32 v[90:91], v[218:219], v[90:91] op_sel:[1,0] op_sel_hi:[1,1]
    v_pk_mul_f32 v[92:93], v[218:219], v[92:93] op_sel:[1,0] op_sel_hi:[1,1]
    v_pk_mul_f32 v[94:95], v[218:219], v[94:95] op_sel:[1,0] op_sel_hi:[1,1]
    v_cvt_pk_bf16_f32 v44, v88, v89
    v_cvt_pk_bf16_f32 v45, v90, v91
    v_cvt_pk_bf16_f32 v46, v92, v93
    v_cvt_pk_bf16_f32 v47, v94, v95
    ds_read_b128 a[220:223], v195 offset:1024
    v_xor_b32 v239, 0, v227
    ds_read_b128 v[240:243], v239
    ds_read_b128 v[244:247], v239 offset:64
    s_waitcnt lgkmcnt(6)
    v_pk_fma_f32 v[96:97], v[212:213], v[248:249], v[96:97] op_sel:[0,0,0] op_sel_hi:[0,1,1]
    v_pk_fma_f32 v[98:99], v[212:213], v[250:251], v[98:99] op_sel:[0,0,0] op_sel_hi:[0,1,1]
    v_pk_fma_f32 v[100:101], v[212:213], v[252:253], v[100:101] op_sel:[0,0,0] op_sel_hi:[0,1,1]
    v_pk_fma_f32 v[102:103], v[212:213], v[254:255], v[102:103] op_sel:[0,0,0] op_sel_hi:[0,1,1]
    v_pk_mul_f32 v[96:97], v[216:217], v[96:97] op_sel:[0,0] op_sel_hi:[0,1]
    v_pk_mul_f32 v[98:99], v[216:217], v[98:99] op_sel:[0,0] op_sel_hi:[0,1]
    v_pk_mul_f32 v[100:101], v[216:217], v[100:101] op_sel:[0,0] op_sel_hi:[0,1]
    v_pk_mul_f32 v[102:103], v[216:217], v[102:103] op_sel:[0,0] op_sel_hi:[0,1]
    v_cvt_pk_bf16_f32 v48, v96, v97
    v_cvt_pk_bf16_f32 v49, v98, v99
    v_cvt_pk_bf16_f32 v50, v100, v101
    v_cvt_pk_bf16_f32 v51, v102, v103
    v_pk_fma_f32 v[104:105], v[212:213], v[248:249], v[104:105] op_sel:[1,0,0] op_sel_hi:[1,1,1]
    v_pk_fma_f32 v[106:107], v[212:213], v[250:251], v[106:107] op_sel:[1,0,0] op_sel_hi:[1,1,1]
    v_pk_fma_f32 v[108:109], v[212:213], v[252:253], v[108:109] op_sel:[1,0,0] op_sel_hi:[1,1,1]
    v_pk_fma_f32 v[110:111], v[212:213], v[254:255], v[110:111] op_sel:[1,0,0] op_sel_hi:[1,1,1]
    v_pk_mul_f32 v[104:105], v[216:217], v[104:105] op_sel:[1,0] op_sel_hi:[1,1]
    v_pk_mul_f32 v[106:107], v[216:217], v[106:107] op_sel:[1,0] op_sel_hi:[1,1]
    v_pk_mul_f32 v[108:109], v[216:217], v[108:109] op_sel:[1,0] op_sel_hi:[1,1]
    v_pk_mul_f32 v[110:111], v[216:217], v[110:111] op_sel:[1,0] op_sel_hi:[1,1]
    v_cvt_pk_bf16_f32 v52, v104, v105
    v_cvt_pk_bf16_f32 v53, v106, v107
    v_cvt_pk_bf16_f32 v54, v108, v109
    v_cvt_pk_bf16_f32 v55, v110, v111
    v_pk_fma_f32 v[112:113], v[214:215], v[248:249], v[112:113] op_sel:[0,0,0] op_sel_hi:[0,1,1]
    v_pk_fma_f32 v[114:115], v[214:215], v[250:251], v[114:115] op_sel:[0,0,0] op_sel_hi:[0,1,1]
    v_pk_fma_f32 v[116:117], v[214:215], v[252:253], v[116:117] op_sel:[0,0,0] op_sel_hi:[0,1,1]
    v_pk_fma_f32 v[118:119], v[214:215], v[254:255], v[118:119] op_sel:[0,0,0] op_sel_hi:[0,1,1]
    v_pk_mul_f32 v[112:113], v[218:219], v[112:113] op_sel:[0,0] op_sel_hi:[0,1]
    v_pk_mul_f32 v[114:115], v[218:219], v[114:115] op_sel:[0,0] op_sel_hi:[0,1]
    v_pk_mul_f32 v[116:117], v[218:219], v[116:117] op_sel:[0,0] op_sel_hi:[0,1]
    v_pk_mul_f32 v[118:119], v[218:219], v[118:119] op_sel:[0,0] op_sel_hi:[0,1]
    v_cvt_pk_bf16_f32 v56, v112, v113
    v_cvt_pk_bf16_f32 v57, v114, v115
    v_cvt_pk_bf16_f32 v58, v116, v117
    v_cvt_pk_bf16_f32 v59, v118, v119
    v_pk_fma_f32 v[120:121], v[214:215], v[248:249], v[120:121] op_sel:[1,0,0] op_sel_hi:[1,1,1]
    v_pk_fma_f32 v[122:123], v[214:215], v[250:251], v[122:123] op_sel:[1,0,0] op_sel_hi:[1,1,1]
    v_pk_fma_f32 v[124:125], v[214:215], v[252:253], v[124:125] op_sel:[1,0,0] op_sel_hi:[1,1,1]
    v_pk_fma_f32 v[126:127], v[214:215], v[254:255], v[126:127] op_sel:[1,0,0] op_sel_hi:[1,1,1]
    v_pk_mul_f32 v[120:121], v[218:219], v[120:121] op_sel:[1,0] op_sel_hi:[1,1]
    v_pk_mul_f32 v[122:123], v[218:219], v[122:123] op_sel:[1,0] op_sel_hi:[1,1]
    v_pk_mul_f32 v[124:125], v[218:219], v[124:125] op_sel:[1,0] op_sel_hi:[1,1]
    v_pk_mul_f32 v[126:127], v[218:219], v[126:127] op_sel:[1,0] op_sel_hi:[1,1]
    v_cvt_pk_bf16_f32 v60, v120, v121
    v_cvt_pk_bf16_f32 v61, v122, v123
    v_cvt_pk_bf16_f32 v62, v124, v125
    v_cvt_pk_bf16_f32 v63, v126, v127
    v_lshrrev_b32 v239, 2, v238
    v_lshl_add_u32 v239, v237, 2, v239
    s_waitcnt lgkmcnt(2)
    v_mfma_f32_16x16x32_bf16 v[64:67], a[192:195], v[0:3], 0
    v_lshlrev_b32 v239, 7, v239
    v_and_b32 v112, 3, v236
    v_mfma_f32_16x16x32_bf16 v[64:67], a[196:199], v[16:19], v[64:67]
    v_lshl_add_u32 v239, v112, 3, v239
    s_add_u32 s47, s35, 147456
    v_mfma_f32_16x16x32_bf16 v[64:67], a[200:203], v[32:35], v[64:67]
    v_add_u32_e64 v239, s47, v239
    ds_read_b64_tr_b16 v[96:97], v239 offset:0
    v_mfma_f32_16x16x32_bf16 v[64:67], a[204:207], v[48:51], v[64:67]
    ds_read_b64_tr_b16 v[98:99], v239 offset:2048
    ds_read_b64_tr_b16 v[100:101], v239 offset:32
    v_mfma_f32_16x16x32_bf16 v[68:71], a[220:223], v[48:51], 0
    ds_read_b64_tr_b16 v[102:103], v239 offset:2080
    ds_read_b64_tr_b16 v[104:105], v239 offset:64
    v_mfma_f32_16x16x32_bf16 v[68:71], a[216:219], v[32:35], v[68:71]
    ds_read_b64_tr_b16 v[106:107], v239 offset:2112
    ds_read_b64_tr_b16 v[108:109], v239 offset:96
    v_mfma_f32_16x16x32_bf16 v[68:71], a[212:215], v[16:19], v[68:71]
    ds_read_b64_tr_b16 v[110:111], v239 offset:2144
    v_accvgpr_read_b32 v113, a48
    v_mfma_f32_16x16x32_bf16 v[68:71], a[208:211], v[0:3], v[68:71]
    v_accvgpr_read_b32 v115, a49
    v_accvgpr_read_b32 v117, a50
    v_mfma_f32_16x16x32_bf16 v[76:79], a[208:211], v[4:7], 0
    v_accvgpr_read_b32 v119, a51
    v_accvgpr_read_b32 v121, a52
    v_mfma_f32_16x16x32_bf16 v[76:79], a[212:215], v[20:23], v[76:79]
    v_accvgpr_read_b32 v123, a53
    v_accvgpr_read_b32 v125, a54
    v_mfma_f32_16x16x32_bf16 v[76:79], a[216:219], v[36:39], v[76:79]
    v_accvgpr_read_b32 v127, a55
    v_lshlrev_b32_e64 v112, 16, v113
    v_mfma_f32_16x16x32_bf16 v[76:79], a[220:223], v[52:55], v[76:79]
    v_and_b32 v113, 0xffff0000, v113
    v_lshlrev_b32_e64 v114, 16, v115
    v_mfma_f32_16x16x32_bf16 v[72:75], a[204:207], v[52:55], 0
    v_and_b32 v115, 0xffff0000, v115
    v_lshlrev_b32_e64 v116, 16, v117
    v_mfma_f32_16x16x32_bf16 v[72:75], a[200:203], v[36:39], v[72:75]
    v_and_b32 v117, 0xffff0000, v117
    v_lshlrev_b32_e64 v118, 16, v119
    v_mfma_f32_16x16x32_bf16 v[72:75], a[196:199], v[20:23], v[72:75]
    v_and_b32 v119, 0xffff0000, v119
    v_lshlrev_b32_e64 v120, 16, v121
    v_mfma_f32_16x16x32_bf16 v[72:75], a[192:195], v[4:7], v[72:75]
    v_and_b32 v121, 0xffff0000, v121
    v_lshlrev_b32_e64 v122, 16, v123
    v_mfma_f32_16x16x32_bf16 v[80:83], a[192:195], v[8:11], 0
    v_and_b32 v123, 0xffff0000, v123
    v_lshlrev_b32_e64 v124, 16, v125
    v_mfma_f32_16x16x32_bf16 v[80:83], a[196:199], v[24:27], v[80:83]
    v_and_b32 v125, 0xffff0000, v125
    v_lshlrev_b32_e64 v126, 16, v127
    v_mfma_f32_16x16x32_bf16 v[80:83], a[200:203], v[40:43], v[80:83]
    v_and_b32 v127, 0xffff0000, v127
    s_mov_b32 s50, 0xbdd2d3e8
    s_mov_b32 s51, 0xbdd2d3e8
    v_mfma_f32_16x16x32_bf16 v[80:83], a[204:207], v[56:59], v[80:83]
    v_mov_b32 v228, 0xc0135761
    v_mov_b32_e64 v229, 1.0
    v_mfma_f32_16x16x32_bf16 v[84:87], a[220:223], v[56:59], 0
    v_and_b32 v230, 0xff, v205
    v_lshl_add_u32 v230, v237, 10, v230
    v_mfma_f32_16x16x32_bf16 v[84:87], a[216:219], v[40:43], v[84:87]
    s_lshl_b32 s47, s33, 12
    v_add_u32 v230, s47, v230
    s_lshl_b32 s47, s39, 19
    v_mfma_f32_16x16x32_bf16 v[84:87], a[212:215], v[24:27], v[84:87]
    s_lshl_b32 s48, s49, 8
    s_add_u32 s47, s47, s48
    s_add_u32 s16, s60, s47
    v_mfma_f32_16x16x32_bf16 v[84:87], a[208:211], v[8:11], v[84:87]
    s_addc_u32 s17, s61, 0
    s_sub_u32 s18, 4194304, s47
    s_mov_b32 s19, 0x20000
    v_mfma_f32_16x16x32_bf16 v[92:95], a[208:211], v[12:15], 0
    s_mov_b32 s20, s74
    s_mov_b32 s21, s75
    s_mov_b32 s22, 256
    v_mfma_f32_16x16x32_bf16 v[92:95], a[212:215], v[28:31], v[92:95]
    s_mov_b32 s23, 0x20000
    s_lshl_b32 s48, s2, 2
    s_add_u32 s48, s48, s33
    v_mfma_f32_16x16x32_bf16 v[92:95], a[216:219], v[44:47], v[92:95]
    s_and_b32 s47, s48, 7
    s_mul_i32 s47, s47, 56
    s_lshr_b32 s46, s48, 3
    v_mfma_f32_16x16x32_bf16 v[92:95], a[220:223], v[60:63], v[92:95]
    s_add_u32 s47, s47, s46
    s_lshl_b32 s47, s47, 12
    s_add_u32 s47, s47, 7340032
    v_mfma_f32_16x16x32_bf16 v[88:91], a[204:207], v[60:63], 0
    s_cmp_lt_u32 s48, 448
    s_cselect_b32 s14, 51380224, 0
    s_waitcnt lgkmcnt(0)
    v_mfma_f32_16x16x32_bf16 v[88:91], a[200:203], v[44:47], v[88:91]
    buffer_store_dwordx4 v[96:99], v206, s[12:15], s47 offen offset:0 sc1
    v_mfma_f32_16x16x32_bf16 v[88:91], a[196:199], v[28:31], v[88:91]
    buffer_store_dwordx4 v[100:103], v206, s[12:15], s47 offen offset:1024 sc1
    v_mfma_f32_16x16x32_bf16 v[88:91], a[192:195], v[12:15], v[88:91]
    buffer_store_dwordx4 v[104:107], v206, s[12:15], s47 offen offset:2048 sc1
    buffer_store_dwordx4 v[108:111], v206, s[12:15], s47 offen offset:3072 sc1
    s_lshl_b32 s44, s34, 2
    s_add_u32 s44, s44, s33
    s_mul_i32 s44, s44, 229376
    s_lshl_b32 s47, s32, 1
    s_lshr_b32 s48, s33, 1
    s_add_u32 s47, s47, s48
    s_lshl_b32 s47, s47, 12
    s_xor_b32 s48, s47, 4096
    s_add_u32 s47, s47, s44
    s_add_u32 s48, s48, s44
    s_cmp_lt_u32 s32, 28
    s_cselect_b32 s14, 51380224, 0
    v_xor_b32 v239, 128, v227
    ds_read_b128 v[248:251], v239
    ds_read_b128 v[252:255], v239 offset:64
    ds_read_b128 a[192:195], v192 offset:2048
    ds_read_b128 a[196:199], v193 offset:2048
    ds_read_b128 a[200:203], v194 offset:2048
    ds_read_b128 a[204:207], v195 offset:2048
    ds_read_b128 a[208:211], v192 offset:3072
    ds_read_b128 a[212:215], v193 offset:3072
    ds_read_b128 a[216:219], v194 offset:3072
    ds_read_b128 a[220:223], v195 offset:3072
    v_pk_fma_f32 v[128:129], v[212:213], v[240:241], v[128:129] op_sel:[0,0,0] op_sel_hi:[0,1,1]
    v_pk_fma_f32 v[130:131], v[212:213], v[242:243], v[130:131] op_sel:[0,0,0] op_sel_hi:[0,1,1]
    v_pk_fma_f32 v[132:133], v[212:213], v[244:245], v[132:133] op_sel:[0,0,0] op_sel_hi:[0,1,1]
    v_pk_fma_f32 v[134:135], v[212:213], v[246:247], v[134:135] op_sel:[0,0,0] op_sel_hi:[0,1,1]
    v_pk_fma_f32 v[128:129], v[220:221], v[128:129], v[112:113] op_sel:[0,0,0] op_sel_hi:[0,1,1]
    v_pk_fma_f32 v[130:131], v[220:221], v[130:131], v[114:115] op_sel:[0,0,0] op_sel_hi:[0,1,1]
    v_pk_fma_f32 v[132:133], v[220:221], v[132:133], v[116:117] op_sel:[0,0,0] op_sel_hi:[0,1,1]
    v_pk_fma_f32 v[134:135], v[220:221], v[134:135], v[118:119] op_sel:[0,0,0] op_sel_hi:[0,1,1]
    v_pk_mul_f32 v[96:97], v[128:129], v[128:129] op_sel:[0,0] op_sel_hi:[1,1]
    v_pk_mul_f32 v[98:99], v[130:131], v[130:131] op_sel:[0,0] op_sel_hi:[1,1]
    v_pk_mul_f32 v[100:101], v[132:133], v[132:133] op_sel:[0,0] op_sel_hi:[1,1]
    v_pk_mul_f32 v[102:103], v[134:135], v[134:135] op_sel:[0,0] op_sel_hi:[1,1]
    v_pk_fma_f32 v[96:97], v[96:97], s[50:51], v[228:229] op_sel:[0,0,0] op_sel_hi:[1,1,0]
    v_pk_fma_f32 v[98:99], v[98:99], s[50:51], v[228:229] op_sel:[0,0,0] op_sel_hi:[1,1,0]
    v_pk_fma_f32 v[100:101], v[100:101], s[50:51], v[228:229] op_sel:[0,0,0] op_sel_hi:[1,1,0]
    v_pk_fma_f32 v[102:103], v[102:103], s[50:51], v[228:229] op_sel:[0,0,0] op_sel_hi:[1,1,0]
    s_lshl_b32 s46, s49, 17
    s_add_u32 m0, s35, 131072
    v_pk_mul_f32 v[96:97], v[96:97], v[128:129] op_sel:[0,0] op_sel_hi:[1,1]
    buffer_load_dwordx4 v230, s[16:19], s46 offen offset:0 lds
    v_pk_mul_f32 v[98:99], v[98:99], v[130:131] op_sel:[0,0] op_sel_hi:[1,1]
    v_pk_mul_f32 v[100:101], v[100:101], v[132:133] op_sel:[0,0] op_sel_hi:[1,1]
    v_pk_mul_f32 v[102:103], v[102:103], v[134:135] op_sel:[0,0] op_sel_hi:[1,1]
    v_exp_f32 v96, v96
    v_exp_f32 v97, v97
    v_exp_f32 v98, v98
    v_exp_f32 v99, v99
    v_exp_f32 v100, v100
    v_exp_f32 v101, v101
    v_exp_f32 v102, v102
    v_exp_f32_e64 v103, v103
    v_pk_add_f32 v[96:97], v[96:97], v[228:229] op_sel:[0,1] op_sel_hi:[1,1]
    v_pk_add_f32 v[98:99], v[98:99], v[228:229] op_sel:[0,1] op_sel_hi:[1,1]
    v_pk_add_f32 v[100:101], v[100:101], v[228:229] op_sel:[0,1] op_sel_hi:[1,1]
    v_pk_add_f32 v[102:103], v[102:103], v[228:229] op_sel:[0,1] op_sel_hi:[1,1]
    v_rcp_f32 v96, v96
    v_rcp_f32 v97, v97
    v_rcp_f32 v98, v98
    v_rcp_f32 v99, v99
    v_rcp_f32 v100, v100
    v_rcp_f32 v101, v101
    v_rcp_f32 v102, v102
    v_rcp_f32 v103, v103
    v_pk_mul_f32 v[128:129], v[128:129], v[96:97] op_sel:[0,0] op_sel_hi:[1,1]
    v_pk_mul_f32 v[130:131], v[130:131], v[98:99] op_sel:[0,0] op_sel_hi:[1,1]
    s_add_u32 s46, s46, 15360
    v_pk_mul_f32 v[132:133], v[132:133], v[100:101] op_sel:[0,0] op_sel_hi:[1,1]
    buffer_load_dwordx4 v230, s[16:19], s46 offen offset:1024 lds
    v_pk_mul_f32 v[134:135], v[134:135], v[102:103] op_sel:[0,0] op_sel_hi:[1,1]
    v_cvt_pk_bf16_f32 v128, v128, v129
    v_cvt_pk_bf16_f32 v129, v130, v131
    v_cvt_pk_bf16_f32 v130, v132, v133
    v_cvt_pk_bf16_f32 v131, v134, v135
    buffer_store_dwordx4 v[128:131], v206, s[12:15], s47 offen offset:0 sc1
    v_pk_fma_f32 v[136:137], v[212:213], v[240:241], v[136:137] op_sel:[1,0,0] op_sel_hi:[1,1,1]
    v_pk_fma_f32 v[138:139], v[212:213], v[242:243], v[138:139] op_sel:[1,0,0] op_sel_hi:[1,1,1]
    v_pk_fma_f32 v[140:141], v[212:213], v[244:245], v[140:141] op_sel:[1,0,0] op_sel_hi:[1,1,1]
    v_pk_fma_f32 v[142:143], v[212:213], v[246:247], v[142:143] op_sel:[1,0,0] op_sel_hi:[1,1,1]
    v_pk_fma_f32 v[136:137], v[220:221], v[136:137], v[112:113] op_sel:[1,0,0] op_sel_hi:[1,1,1]
    v_pk_fma_f32 v[138:139], v[220:221], v[138:139], v[114:115] op_sel:[1,0,0] op_sel_hi:[1,1,1]
    v_pk_fma_f32 v[140:141], v[220:221], v[140:141], v[116:117] op_sel:[1,0,0] op_sel_hi:[1,1,1]
    v_pk_fma_f32 v[142:143], v[220:221], v[142:143], v[118:119] op_sel:[1,0,0] op_sel_hi:[1,1,1]
    v_pk_mul_f32 v[104:105], v[136:137], v[136:137] op_sel:[0,0] op_sel_hi:[1,1]
    v_pk_mul_f32 v[106:107], v[138:139], v[138:139] op_sel:[0,0] op_sel_hi:[1,1]
    v_pk_mul_f32 v[108:109], v[140:141], v[140:141] op_sel:[0,0] op_sel_hi:[1,1]
    v_pk_mul_f32 v[110:111], v[142:143], v[142:143] op_sel:[0,0] op_sel_hi:[1,1]
    v_pk_fma_f32 v[104:105], v[104:105], s[50:51], v[228:229] op_sel:[0,0,0] op_sel_hi:[1,1,0]
    v_pk_fma_f32 v[106:107], v[106:107], s[50:51], v[228:229] op_sel:[0,0,0] op_sel_hi:[1,1,0]
    v_pk_fma_f32 v[108:109], v[108:109], s[50:51], v[228:229] op_sel:[0,0,0] op_sel_hi:[1,1,0]
    v_pk_fma_f32 v[110:111], v[110:111], s[50:51], v[228:229] op_sel:[0,0,0] op_sel_hi:[1,1,0]
    v_pk_mul_f32 v[104:105], v[104:105], v[136:137] op_sel:[0,0] op_sel_hi:[1,1]
    v_pk_mul_f32 v[106:107], v[106:107], v[138:139] op_sel:[0,0] op_sel_hi:[1,1]
    s_add_u32 s46, s46, 15360
    v_pk_mul_f32 v[108:109], v[108:109], v[140:141] op_sel:[0,0] op_sel_hi:[1,1]
    buffer_load_dwordx4 v230, s[16:19], s46 offen offset:2048 lds
    v_pk_mul_f32 v[110:111], v[110:111], v[142:143] op_sel:[0,0] op_sel_hi:[1,1]
    v_exp_f32 v104, v104
    v_exp_f32 v105, v105
    v_exp_f32 v106, v106
    v_exp_f32 v107, v107
    v_exp_f32 v108, v108
    v_exp_f32 v109, v109
    v_exp_f32 v110, v110
    v_exp_f32 v111, v111
    v_pk_add_f32 v[104:105], v[104:105], v[228:229] op_sel:[0,1] op_sel_hi:[1,1]
    v_pk_add_f32 v[106:107], v[106:107], v[228:229] op_sel:[0,1] op_sel_hi:[1,1]
    v_pk_add_f32 v[108:109], v[108:109], v[228:229] op_sel:[0,1] op_sel_hi:[1,1]
    v_pk_add_f32 v[110:111], v[110:111], v[228:229] op_sel:[0,1] op_sel_hi:[1,1]
    v_rcp_f32 v104, v104
    v_rcp_f32 v105, v105
    v_rcp_f32 v106, v106
    v_rcp_f32 v107, v107
    v_rcp_f32 v108, v108
    v_rcp_f32 v109, v109
    v_rcp_f32 v110, v110
    v_rcp_f32 v111, v111
    v_pk_mul_f32 v[136:137], v[136:137], v[104:105] op_sel:[0,0] op_sel_hi:[1,1]
    v_pk_mul_f32 v[138:139], v[138:139], v[106:107] op_sel:[0,0] op_sel_hi:[1,1]
    v_pk_mul_f32 v[140:141], v[140:141], v[108:109] op_sel:[0,0] op_sel_hi:[1,1]
    v_pk_mul_f32 v[142:143], v[142:143], v[110:111] op_sel:[0,0] op_sel_hi:[1,1]
    v_cvt_pk_bf16_f32 v136, v136, v137
    v_cvt_pk_bf16_f32 v137, v138, v139
    v_cvt_pk_bf16_f32 v138, v140, v141
    v_cvt_pk_bf16_f32 v139, v142, v143
    buffer_store_dwordx4 v[136:139], v206, s[12:15], s47 offen offset:1024 sc1
    v_pk_fma_f32 v[144:145], v[214:215], v[240:241], v[144:145] op_sel:[0,0,0] op_sel_hi:[0,1,1]
    v_pk_fma_f32 v[146:147], v[214:215], v[242:243], v[146:147] op_sel:[0,0,0] op_sel_hi:[0,1,1]
    v_pk_fma_f32 v[148:149], v[214:215], v[244:245], v[148:149] op_sel:[0,0,0] op_sel_hi:[0,1,1]
    v_pk_fma_f32 v[150:151], v[214:215], v[246:247], v[150:151] op_sel:[0,0,0] op_sel_hi:[0,1,1]
    v_pk_fma_f32 v[144:145], v[222:223], v[144:145], v[112:113] op_sel:[0,0,0] op_sel_hi:[0,1,1]
    v_pk_fma_f32 v[146:147], v[222:223], v[146:147], v[114:115] op_sel:[0,0,0] op_sel_hi:[0,1,1]
    v_pk_fma_f32 v[148:149], v[222:223], v[148:149], v[116:117] op_sel:[0,0,0] op_sel_hi:[0,1,1]
    v_pk_fma_f32 v[150:151], v[222:223], v[150:151], v[118:119] op_sel:[0,0,0] op_sel_hi:[0,1,1]
    v_pk_mul_f32 v[96:97], v[144:145], v[144:145] op_sel:[0,0] op_sel_hi:[1,1]
    v_pk_mul_f32 v[98:99], v[146:147], v[146:147] op_sel:[0,0] op_sel_hi:[1,1]
    v_pk_mul_f32 v[100:101], v[148:149], v[148:149] op_sel:[0,0] op_sel_hi:[1,1]
    v_pk_mul_f32 v[102:103], v[150:151], v[150:151] op_sel:[0,0] op_sel_hi:[1,1]
    v_pk_fma_f32 v[96:97], v[96:97], s[50:51], v[228:229] op_sel:[0,0,0] op_sel_hi:[1,1,0]
    v_pk_fma_f32 v[98:99], v[98:99], s[50:51], v[228:229] op_sel:[0,0,0] op_sel_hi:[1,1,0]
    v_pk_fma_f32 v[100:101], v[100:101], s[50:51], v[228:229] op_sel:[0,0,0] op_sel_hi:[1,1,0]
    v_pk_fma_f32 v[102:103], v[102:103], s[50:51], v[228:229] op_sel:[0,0,0] op_sel_hi:[1,1,0]
    v_pk_mul_f32 v[96:97], v[96:97], v[144:145] op_sel:[0,0] op_sel_hi:[1,1]
    v_pk_mul_f32 v[98:99], v[98:99], v[146:147] op_sel:[0,0] op_sel_hi:[1,1]
    v_pk_mul_f32 v[100:101], v[100:101], v[148:149] op_sel:[0,0] op_sel_hi:[1,1]
    v_pk_mul_f32 v[102:103], v[102:103], v[150:151] op_sel:[0,0] op_sel_hi:[1,1]
    v_exp_f32 v96, v96
    v_exp_f32 v97, v97
    v_exp_f32 v98, v98
    v_exp_f32 v99, v99
    v_exp_f32 v100, v100
    v_exp_f32 v101, v101
    v_exp_f32 v102, v102
    v_exp_f32 v103, v103
    v_pk_add_f32 v[96:97], v[96:97], v[228:229] op_sel:[0,1] op_sel_hi:[1,1]
    v_pk_add_f32 v[98:99], v[98:99], v[228:229] op_sel:[0,1] op_sel_hi:[1,1]
    v_pk_add_f32 v[100:101], v[100:101], v[228:229] op_sel:[0,1] op_sel_hi:[1,1]
    v_pk_add_f32 v[102:103], v[102:103], v[228:229] op_sel:[0,1] op_sel_hi:[1,1]
    v_rcp_f32 v96, v96
    v_rcp_f32 v97, v97
    v_rcp_f32 v98, v98
    v_rcp_f32 v99, v99
    v_rcp_f32 v100, v100
    v_rcp_f32 v101, v101
    v_rcp_f32 v102, v102
    v_rcp_f32 v103, v103
    v_pk_mul_f32 v[144:145], v[144:145], v[96:97] op_sel:[0,0] op_sel_hi:[1,1]
L_hop4:
    s_cbranch_execz L_ret1
    s_nop 0
    v_pk_mul_f32 v[146:147], v[146:147], v[98:99] op_sel:[0,0] op_sel_hi:[1,1]
    v_pk_mul_f32 v[148:149], v[148:149], v[100:101] op_sel:[0,0] op_sel_hi:[1,1]
    v_pk_mul_f32 v[150:151], v[150:151], v[102:103] op_sel:[0,0] op_sel_hi:[1,1]
    v_cvt_pk_bf16_f32 v144, v144, v145
    v_cvt_pk_bf16_f32 v145, v146, v147
    v_cvt_pk_bf16_f32 v146, v148, v149
    v_cvt_pk_bf16_f32 v147, v150, v151
    buffer_store_dwordx4 v[144:147], v206, s[12:15], s47 offen offset:2048 sc1
    v_pk_fma_f32 v[152:153], v[214:215], v[240:241], v[152:153] op_sel:[1,0,0] op_sel_hi:[1,1,1]
    v_pk_fma_f32 v[154:155], v[214:215], v[242:243], v[154:155] op_sel:[1,0,0] op_sel_hi:[1,1,1]
    v_pk_fma_f32 v[156:157], v[214:215], v[244:245], v[156:157] op_sel:[1,0,0] op_sel_hi:[1,1,1]
    v_pk_fma_f32 v[158:159], v[214:215], v[246:247], v[158:159] op_sel:[1,0,0] op_sel_hi:[1,1,1]
    v_pk_fma_f32 v[152:153], v[222:223], v[152:153], v[112:113] op_sel:[1,0,0] op_sel_hi:[1,1,1]
    v_pk_fma_f32 v[154:155], v[222:223], v[154:155], v[114:115] op_sel:[1,0,0] op_sel_hi:[1,1,1]
    v_pk_fma_f32 v[156:157], v[222:223], v[156:157], v[116:117] op_sel:[1,0,0] op_sel_hi:[1,1,1]
    v_pk_fma_f32 v[158:159], v[222:223], v[158:159], v[118:119] op_sel:[1,0,0] op_sel_hi:[1,1,1]
    v_pk_mul_f32 v[104:105], v[152:153], v[152:153] op_sel:[0,0] op_sel_hi:[1,1]
    v_pk_mul_f32 v[106:107], v[154:155], v[154:155] op_sel:[0,0] op_sel_hi:[1,1]
    v_pk_mul_f32 v[108:109], v[156:157], v[156:157] op_sel:[0,0] op_sel_hi:[1,1]
    v_pk_mul_f32 v[110:111], v[158:159], v[158:159] op_sel:[0,0] op_sel_hi:[1,1]
    v_pk_fma_f32 v[104:105], v[104:105], s[50:51], v[228:229] op_sel:[0,0,0] op_sel_hi:[1,1,0]
    v_pk_fma_f32 v[106:107], v[106:107], s[50:51], v[228:229] op_sel:[0,0,0] op_sel_hi:[1,1,0]
    v_pk_fma_f32 v[108:109], v[108:109], s[50:51], v[228:229] op_sel:[0,0,0] op_sel_hi:[1,1,0]
    v_pk_fma_f32 v[110:111], v[110:111], s[50:51], v[228:229] op_sel:[0,0,0] op_sel_hi:[1,1,0]
    v_pk_mul_f32 v[104:105], v[104:105], v[152:153] op_sel:[0,0] op_sel_hi:[1,1]
    v_pk_mul_f32 v[106:107], v[106:107], v[154:155] op_sel:[0,0] op_sel_hi:[1,1]
    v_pk_mul_f32 v[108:109], v[108:109], v[156:157] op_sel:[0,0] op_sel_hi:[1,1]
    v_pk_mul_f32 v[110:111], v[110:111], v[158:159] op_sel:[0,0] op_sel_hi:[1,1]
    v_exp_f32 v104, v104
    v_exp_f32 v105, v105
    v_exp_f32 v106, v106
    v_exp_f32 v107, v107
    v_exp_f32 v108, v108
    v_exp_f32 v109, v109
    v_exp_f32 v110, v110
    v_exp_f32 v111, v111
    v_pk_add_f32 v[104:105], v[104:105], v[228:229] op_sel:[0,1] op_sel_hi:[1,1]
    v_pk_add_f32 v[106:107], v[106:107], v[228:229] op_sel:[0,1] op_sel_hi:[1,1]
    v_pk_add_f32 v[108:109], v[108:109], v[228:229] op_sel:[0,1] op_sel_hi:[1,1]
    v_pk_add_f32 v[110:111], v[110:111], v[228:229] op_sel:[0,1] op_sel_hi:[1,1]
    v_rcp_f32 v104, v104
    v_rcp_f32 v105, v105
    v_rcp_f32 v106, v106
    v_rcp_f32 v107, v107
    v_rcp_f32 v108, v108
    v_rcp_f32 v109, v109
    v_rcp_f32 v110, v110
    v_rcp_f32 v111, v111
    v_pk_mul_f32 v[152:153], v[152:153], v[104:105] op_sel:[0,0] op_sel_hi:[1,1]
    v_pk_mul_f32 v[154:155], v[154:155], v[106:107] op_sel:[0,0] op_sel_hi:[1,1]
    v_pk_mul_f32 v[156:157], v[156:157], v[108:109] op_sel:[0,0] op_sel_hi:[1,1]
    v_pk_mul_f32 v[158:159], v[158:159], v[110:111] op_sel:[0,0] op_sel_hi:[1,1]
    v_cvt_pk_bf16_f32 v152, v152, v153
    v_cvt_pk_bf16_f32 v153, v154, v155
    v_cvt_pk_bf16_f32 v154, v156, v157
    v_cvt_pk_bf16_f32 v155, v158, v159
    buffer_store_dwordx4 v[152:155], v206, s[12:15], s47 offen offset:3072 sc1
    s_waitcnt lgkmcnt(8)
    s_nop 0
    v_pk_fma_f32 v[160:161], v[212:213], v[248:249], v[160:161] op_sel:[0,0,0] op_sel_hi:[0,1,1]
    v_pk_fma_f32 v[162:163], v[212:213], v[250:251], v[162:163] op_sel:[0,0,0] op_sel_hi:[0,1,1]
    v_pk_fma_f32 v[164:165], v[212:213], v[252:253], v[164:165] op_sel:[0,0,0] op_sel_hi:[0,1,1]
    v_pk_fma_f32 v[166:167], v[212:213], v[254:255], v[166:167] op_sel:[0,0,0] op_sel_hi:[0,1,1]
    v_pk_fma_f32 v[160:161], v[220:221], v[160:161], v[120:121] op_sel:[0,0,0] op_sel_hi:[0,1,1]
    v_pk_fma_f32 v[162:163], v[220:221], v[162:163], v[122:123] op_sel:[0,0,0] op_sel_hi:[0,1,1]
    v_pk_fma_f32 v[164:165], v[220:221], v[164:165], v[124:125] op_sel:[0,0,0] op_sel_hi:[0,1,1]
    v_pk_fma_f32 v[166:167], v[220:221], v[166:167], v[126:127] op_sel:[0,0,0] op_sel_hi:[0,1,1]
    v_pk_mul_f32 v[96:97], v[160:161], v[160:161] op_sel:[0,0] op_sel_hi:[1,1]
    v_pk_mul_f32 v[98:99], v[162:163], v[162:163] op_sel:[0,0] op_sel_hi:[1,1]
    v_pk_mul_f32 v[100:101], v[164:165], v[164:165] op_sel:[0,0] op_sel_hi:[1,1]
    v_pk_mul_f32 v[102:103], v[166:167], v[166:167] op_sel:[0,0] op_sel_hi:[1,1]
    v_pk_fma_f32 v[96:97], v[96:97], s[50:51], v[228:229] op_sel:[0,0,0] op_sel_hi:[1,1,0]
    v_pk_fma_f32 v[98:99], v[98:99], s[50:51], v[228:229] op_sel:[0,0,0] op_sel_hi:[1,1,0]
    v_pk_fma_f32 v[100:101], v[100:101], s[50:51], v[228:229] op_sel:[0,0,0] op_sel_hi:[1,1,0]
    v_pk_fma_f32 v[102:103], v[102:103], s[50:51], v[228:229] op_sel:[0,0,0] op_sel_hi:[1,1,0]
    v_pk_mul_f32 v[96:97], v[96:97], v[160:161] op_sel:[0,0] op_sel_hi:[1,1]
    v_pk_mul_f32 v[98:99], v[98:99], v[162:163] op_sel:[0,0] op_sel_hi:[1,1]
    v_pk_mul_f32 v[100:101], v[100:101], v[164:165] op_sel:[0,0] op_sel_hi:[1,1]
    v_pk_mul_f32 v[102:103], v[102:103], v[166:167] op_sel:[0,0] op_sel_hi:[1,1]
    v_exp_f32 v96, v96
    v_exp_f32 v97, v97
    v_exp_f32 v98, v98
    v_exp_f32 v99, v99
    v_exp_f32 v100, v100
    v_exp_f32 v101, v101
    v_exp_f32 v102, v102
    v_exp_f32 v103, v103
    v_pk_add_f32 v[96:97], v[96:97], v[228:229] op_sel:[0,1] op_sel_hi:[1,1]
    v_pk_add_f32 v[98:99], v[98:99], v[228:229] op_sel:[0,1] op_sel_hi:[1,1]
    v_pk_add_f32 v[100:101], v[100:101], v[228:229] op_sel:[0,1] op_sel_hi:[1,1]
    v_pk_add_f32 v[102:103], v[102:103], v[228:229] op_sel:[0,1] op_sel_hi:[1,1]
    v_rcp_f32 v96, v96
    v_rcp_f32 v97, v97
    v_rcp_f32 v98, v98
    v_rcp_f32 v99, v99
    v_rcp_f32 v100, v100
    v_rcp_f32 v101, v101
    v_rcp_f32 v102, v102
    v_rcp_f32 v103, v103
    v_pk_mul_f32 v[160:161], v[160:161], v[96:97] op_sel:[0,0] op_sel_hi:[1,1]
    v_pk_mul_f32 v[162:163], v[162:163], v[98:99] op_sel:[0,0] op_sel_hi:[1,1]
    v_pk_mul_f32 v[164:165], v[164:165], v[100:101] op_sel:[0,0] op_sel_hi:[1,1]
    v_pk_mul_f32 v[166:167], v[166:167], v[102:103] op_sel:[0,0] op_sel_hi:[1,1]
    v_cvt_pk_bf16_f32 v160, v160, v161
    v_cvt_pk_bf16_f32 v161, v162, v163
    v_cvt_pk_bf16_f32 v162, v164, v165
    v_cvt_pk_bf16_f32 v163, v166, v167
    buffer_store_dwordx4 v[160:163], v206, s[12:15], s48 offen offset:0 sc1
    v_pk_fma_f32 v[168:169], v[212:213], v[248:249], v[168:169] op_sel:[1,0,0] op_sel_hi:[1,1,1]
    v_pk_fma_f32 v[170:171], v[212:213], v[250:251], v[170:171] op_sel:[1,0,0] op_sel_hi:[1,1,1]
    v_pk_fma_f32 v[172:173], v[212:213], v[252:253], v[172:173] op_sel:[1,0,0] op_sel_hi:[1,1,1]
    v_pk_fma_f32 v[174:175], v[212:213], v[254:255], v[174:175] op_sel:[1,0,0] op_sel_hi:[1,1,1]
    v_pk_fma_f32 v[168:169], v[220:221], v[168:169], v[120:121] op_sel:[1,0,0] op_sel_hi:[1,1,1]
    v_pk_fma_f32 v[170:171], v[220:221], v[170:171], v[122:123] op_sel:[1,0,0] op_sel_hi:[1,1,1]
    v_pk_fma_f32 v[172:173], v[220:221], v[172:173], v[124:125] op_sel:[1,0,0] op_sel_hi:[1,1,1]
    v_pk_fma_f32 v[174:175], v[220:221], v[174:175], v[126:127] op_sel:[1,0,0] op_sel_hi:[1,1,1]
    v_pk_mul_f32 v[104:105], v[168:169], v[168:169] op_sel:[0,0] op_sel_hi:[1,1]
    v_pk_mul_f32 v[106:107], v[170:171], v[170:171] op_sel:[0,0] op_sel_hi:[1,1]
    v_pk_mul_f32 v[108:109], v[172:173], v[172:173] op_sel:[0,0] op_sel_hi:[1,1]
    v_pk_mul_f32 v[110:111], v[174:175], v[174:175] op_sel:[0,0] op_sel_hi:[1,1]
    v_pk_fma_f32 v[104:105], v[104:105], s[50:51], v[228:229] op_sel:[0,0,0] op_sel_hi:[1,1,0]
    v_pk_fma_f32 v[106:107], v[106:107], s[50:51], v[228:229] op_sel:[0,0,0] op_sel_hi:[1,1,0]
    v_pk_fma_f32 v[108:109], v[108:109], s[50:51], v[228:229] op_sel:[0,0,0] op_sel_hi:[1,1,0]
    v_pk_fma_f32 v[110:111], v[110:111], s[50:51], v[228:229] op_sel:[0,0,0] op_sel_hi:[1,1,0]
    v_pk_mul_f32 v[104:105], v[104:105], v[168:169] op_sel:[0,0] op_sel_hi:[1,1]
    v_pk_mul_f32 v[106:107], v[106:107], v[170:171] op_sel:[0,0] op_sel_hi:[1,1]
    v_pk_mul_f32 v[108:109], v[108:109], v[172:173] op_sel:[0,0] op_sel_hi:[1,1]
    v_pk_mul_f32 v[110:111], v[110:111], v[174:175] op_sel:[0,0] op_sel_hi:[1,1]
    v_exp_f32 v104, v104
    v_exp_f32 v105, v105
    v_exp_f32 v106, v106
    v_exp_f32 v107, v107
    v_exp_f32 v108, v108
    v_exp_f32 v109, v109
    v_exp_f32 v110, v110
    v_exp_f32 v111, v111
    v_pk_add_f32 v[104:105], v[104:105], v[228:229] op_sel:[0,1] op_sel_hi:[1,1]
    v_pk_add_f32 v[106:107], v[106:107], v[228:229] op_sel:[0,1] op_sel_hi:[1,1]
    v_pk_add_f32 v[108:109], v[108:109], v[228:229] op_sel:[0,1] op_sel_hi:[1,1]
    v_pk_add_f32 v[110:111], v[110:111], v[228:229] op_sel:[0,1] op_sel_hi:[1,1]
    v_rcp_f32 v104, v104
    v_rcp_f32 v105, v105
    v_rcp_f32 v106, v106
    v_rcp_f32 v107, v107
    v_rcp_f32 v108, v108
    v_rcp_f32 v109, v109
    v_rcp_f32 v110, v110
    v_rcp_f32 v111, v111
    v_pk_mul_f32 v[168:169], v[168:169], v[104:105] op_sel:[0,0] op_sel_hi:[1,1]
    v_pk_mul_f32 v[170:171], v[170:171], v[106:107] op_sel:[0,0] op_sel_hi:[1,1]
    v_pk_mul_f32 v[172:173], v[172:173], v[108:109] op_sel:[0,0] op_sel_hi:[1,1]
    v_pk_mul_f32 v[174:175], v[174:175], v[110:111] op_sel:[0,0] op_sel_hi:[1,1]
    v_cvt_pk_bf16_f32 v168, v168, v169
    v_cvt_pk_bf16_f32 v169, v170, v171
    v_cvt_pk_bf16_f32 v170, v172, v173
    v_cvt_pk_bf16_f32 v171, v174, v175
    buffer_store_dwordx4 v[168:171], v206, s[12:15], s48 offen offset:1024 sc1
    v_pk_fma_f32 v[176:177], v[214:215], v[248:249], v[176:177] op_sel:[0,0,0] op_sel_hi:[0,1,1]
    v_pk_fma_f32 v[178:179], v[214:215], v[250:251], v[178:179] op_sel:[0,0,0] op_sel_hi:[0,1,1]
    v_pk_fma_f32 v[180:181], v[214:215], v[252:253], v[180:181] op_sel:[0,0,0] op_sel_hi:[0,1,1]
    v_pk_fma_f32 v[182:183], v[214:215], v[254:255], v[182:183] op_sel:[0,0,0] op_sel_hi:[0,1,1]
    v_pk_fma_f32 v[176:177], v[222:223], v[176:177], v[120:121] op_sel:[0,0,0] op_sel_hi:[0,1,1]
    v_pk_fma_f32 v[178:179], v[222:223], v[178:179], v[122:123] op_sel:[0,0,0] op_sel_hi:[0,1,1]
    v_pk_fma_f32 v[180:181], v[222:223], v[180:181], v[124:125] op_sel:[0,0,0] op_sel_hi:[0,1,1]
    v_pk_fma_f32 v[182:183], v[222:223], v[182:183], v[126:127] op_sel:[0,0,0] op_sel_hi:[0,1,1]
    v_pk_mul_f32 v[96:97], v[176:177], v[176:177] op_sel:[0,0] op_sel_hi:[1,1]
    v_pk_mul_f32 v[98:99], v[178:179], v[178:179] op_sel:[0,0] op_sel_hi:[1,1]
    v_pk_mul_f32 v[100:101], v[180:181], v[180:181] op_sel:[0,0] op_sel_hi:[1,1]
    v_pk_mul_f32 v[102:103], v[182:183], v[182:183] op_sel:[0,0] op_sel_hi:[1,1]
    v_pk_fma_f32 v[96:97], v[96:97], s[50:51], v[228:229] op_sel:[0,0,0] op_sel_hi:[1,1,0]
    v_pk_fma_f32 v[98:99], v[98:99], s[50:51], v[228:229] op_sel:[0,0,0] op_sel_hi:[1,1,0]
    v_pk_fma_f32 v[100:101], v[100:101], s[50:51], v[228:229] op_sel:[0,0,0] op_sel_hi:[1,1,0]
    v_pk_fma_f32 v[102:103], v[102:103], s[50:51], v[228:229] op_sel:[0,0,0] op_sel_hi:[1,1,0]
    v_pk_mul_f32 v[96:97], v[96:97], v[176:177] op_sel:[0,0] op_sel_hi:[1,1]
    v_pk_mul_f32 v[98:99], v[98:99], v[178:179] op_sel:[0,0] op_sel_hi:[1,1]
    v_pk_mul_f32 v[100:101], v[100:101], v[180:181] op_sel:[0,0] op_sel_hi:[1,1]
    v_pk_mul_f32 v[102:103], v[102:103], v[182:183] op_sel:[0,0] op_sel_hi:[1,1]
    v_exp_f32 v96, v96
    v_exp_f32 v97, v97
    v_exp_f32 v98, v98
    v_exp_f32 v99, v99
    v_exp_f32 v100, v100
    v_exp_f32 v101, v101
    v_exp_f32 v102, v102
    v_exp_f32 v103, v103
    v_pk_add_f32 v[96:97], v[96:97], v[228:229] op_sel:[0,1] op_sel_hi:[1,1]
    v_pk_add_f32 v[98:99], v[98:99], v[228:229] op_sel:[0,1] op_sel_hi:[1,1]
    v_pk_add_f32 v[100:101], v[100:101], v[228:229] op_sel:[0,1] op_sel_hi:[1,1]
    v_pk_add_f32 v[102:103], v[102:103], v[228:229] op_sel:[0,1] op_sel_hi:[1,1]
    v_rcp_f32 v96, v96
    v_rcp_f32 v97, v97
    v_rcp_f32 v98, v98
    v_rcp_f32 v99, v99
    v_rcp_f32 v100, v100
    v_rcp_f32 v101, v101
    v_rcp_f32 v102, v102
    v_rcp_f32 v103, v103
    v_pk_mul_f32 v[176:177], v[176:177], v[96:97] op_sel:[0,0] op_sel_hi:[1,1]
    v_pk_mul_f32 v[178:179], v[178:179], v[98:99] op_sel:[0,0] op_sel_hi:[1,1]
    v_pk_mul_f32 v[180:181], v[180:181], v[100:101] op_sel:[0,0] op_sel_hi:[1,1]
    v_pk_mul_f32 v[182:183], v[182:183], v[102:103] op_sel:[0,0] op_sel_hi:[1,1]
    v_cvt_pk_bf16_f32 v176, v176, v177
    v_cvt_pk_bf16_f32 v177, v178, v179
    v_cvt_pk_bf16_f32 v178, v180, v181
    v_cvt_pk_bf16_f32 v179, v182, v183
    buffer_store_dwordx4 v[176:179], v206, s[12:15], s48 offen offset:2048 sc1
    v_pk_fma_f32 v[184:185], v[214:215], v[248:249], v[184:185] op_sel:[1,0,0] op_sel_hi:[1,1,1]
    v_pk_fma_f32 v[186:187], v[214:215], v[250:251], v[186:187] op_sel:[1,0,0] op_sel_hi:[1,1,1]
    v_pk_fma_f32 v[188:189], v[214:215], v[252:253], v[188:189] op_sel:[1,0,0] op_sel_hi:[1,1,1]
    v_pk_fma_f32 v[190:191], v[214:215], v[254:255], v[190:191] op_sel:[1,0,0] op_sel_hi:[1,1,1]
    v_pk_fma_f32 v[184:185], v[222:223], v[184:185], v[120:121] op_sel:[1,0,0] op_sel_hi:[1,1,1]
    v_pk_fma_f32 v[186:187], v[222:223], v[186:187], v[122:123] op_sel:[1,0,0] op_sel_hi:[1,1,1]
    v_pk_fma_f32 v[188:189], v[222:223], v[188:189], v[124:125] op_sel:[1,0,0] op_sel_hi:[1,1,1]
    v_pk_fma_f32 v[190:191], v[222:223], v[190:191], v[126:127] op_sel:[1,0,0] op_sel_hi:[1,1,1]
    v_pk_mul_f32 v[104:105], v[184:185], v[184:185] op_sel:[0,0] op_sel_hi:[1,1]
    v_pk_mul_f32 v[106:107], v[186:187], v[186:187] op_sel:[0,0] op_sel_hi:[1,1]
    v_pk_mul_f32 v[108:109], v[188:189], v[188:189] op_sel:[0,0] op_sel_hi:[1,1]
    v_pk_mul_f32 v[110:111], v[190:191], v[190:191] op_sel:[0,0] op_sel_hi:[1,1]
    v_pk_fma_f32 v[104:105], v[104:105], s[50:51], v[228:229] op_sel:[0,0,0] op_sel_hi:[1,1,0]
    v_pk_fma_f32 v[106:107], v[106:107], s[50:51], v[228:229] op_sel:[0,0,0] op_sel_hi:[1,1,0]
    v_pk_fma_f32 v[108:109], v[108:109], s[50:51], v[228:229] op_sel:[0,0,0] op_sel_hi:[1,1,0]
    v_pk_fma_f32 v[110:111], v[110:111], s[50:51], v[228:229] op_sel:[0,0,0] op_sel_hi:[1,1,0]
    v_pk_mul_f32 v[104:105], v[104:105], v[184:185] op_sel:[0,0] op_sel_hi:[1,1]
    v_pk_mul_f32 v[106:107], v[106:107], v[186:187] op_sel:[0,0] op_sel_hi:[1,1]
    v_pk_mul_f32 v[108:109], v[108:109], v[188:189] op_sel:[0,0] op_sel_hi:[1,1]
    v_pk_mul_f32 v[110:111], v[110:111], v[190:191] op_sel:[0,0] op_sel_hi:[1,1]
    v_exp_f32 v104, v104
    v_exp_f32 v105, v105
    v_exp_f32 v106, v106
    v_exp_f32 v107, v107
    v_exp_f32 v108, v108
    v_exp_f32 v109, v109
    v_exp_f32 v110, v110
    v_exp_f32 v111, v111
    v_pk_add_f32 v[104:105], v[104:105], v[228:229] op_sel:[0,1] op_sel_hi:[1,1]
    v_pk_add_f32 v[106:107], v[106:107], v[228:229] op_sel:[0,1] op_sel_hi:[1,1]
    v_pk_add_f32 v[108:109], v[108:109], v[228:229] op_sel:[0,1] op_sel_hi:[1,1]
    v_pk_add_f32 v[110:111], v[110:111], v[228:229] op_sel:[0,1] op_sel_hi:[1,1]
    v_rcp_f32 v104, v104
    v_rcp_f32 v105, v105
    v_rcp_f32 v106, v106
    v_rcp_f32 v107, v107
    v_rcp_f32 v108, v108
    v_rcp_f32 v109, v109
    v_rcp_f32 v110, v110
    v_rcp_f32 v111, v111
    v_pk_mul_f32 v[184:185], v[184:185], v[104:105] op_sel:[0,0] op_sel_hi:[1,1]
    v_pk_mul_f32 v[186:187], v[186:187], v[106:107] op_sel:[0,0] op_sel_hi:[1,1]
    v_pk_mul_f32 v[188:189], v[188:189], v[108:109] op_sel:[0,0] op_sel_hi:[1,1]
    v_pk_mul_f32 v[190:191], v[190:191], v[110:111] op_sel:[0,0] op_sel_hi:[1,1]
    v_cvt_pk_bf16_f32 v184, v184, v185
    v_cvt_pk_bf16_f32 v185, v186, v187
    v_cvt_pk_bf16_f32 v186, v188, v189
    v_cvt_pk_bf16_f32 v187, v190, v191
    buffer_store_dwordx4 v[184:187], v206, s[12:15], s48 offen offset:3072 sc1
    s_mov_b32 s14, 51380224
    v_mov_b32 v244, v230
    s_lshl_b32 s47, s33, 6
    v_or_b32 v248, s47, v236
    v_cmp_eq_u32 vcc, 0, v248
    v_mov_b32 v248, 0x80000000
    v_mov_b32_e64 v246, 1
    v_cndmask_b32 v245, v248, 0, vcc
    v_mov_b32 v160, 0x7f800000
    v_mov_b32 v164, 0x7f800000
    v_mov_b32 v168, 0x7f800000
    v_mov_b32 v172, 0x7f800000
    s_waitcnt vmcnt(27)
L_attn:
    v_add_u32 v204, 32768, v204
    s_mov_b32 s37, 32768
    s_lshr_b32 s47, s39, 1
    s_lshl_b32 s44, s34, 2
    s_add_u32 s44, s44, s47
    s_mul_i32 s44, s44, 229376
    s_mul_i32 s47, s33, 57344
    s_add_u32 s44, s44, s47
    s_and_b32 s45, s39, 1
    s_lshl_b32 s48, s49, 1
    s_add_u32 s45, s45, s48
    s_mul_i32 s45, s45, 229376
    s_add_u32 s45, s45, s47
    s_nop 0
    s_add_u32 s45, s45, 7340032
    v_max3_f32 v248, v64, v65, v66
    v_max3_f32 v249, v72, v73, v74
    v_max3_f32 v250, v80, v81, v82
    v_max3_f32 v251, v88, v89, v90
    v_max3_f32 v248, v248, v67, v68
    v_max3_f32 v249, v249, v75, v76
    v_max3_f32 v250, v250, v83, v84
    v_max3_f32 v251, v251, v91, v92
    v_max3_f32 v248, v248, v69, v70
    v_max3_f32 v249, v249, v77, v78
    v_max3_f32 v250, v250, v85, v86
    v_max3_f32 v251, v251, v93, v94
    v_max_f32 v248, v248, v71
    v_max_f32 v249, v249, v79
    v_max_f32 v250, v250, v87
    v_max_f32 v251, v251, v95
    v_mov_b32 v252, v248
    v_mov_b32 v253, v249
    v_mov_b32 v254, v250
    v_mov_b32 v255, v251
    v_permlane32_swap_b32 v248, v252
    v_permlane32_swap_b32 v249, v253
    v_permlane32_swap_b32 v250, v254
    v_permlane32_swap_b32 v251, v255
    v_max_f32 v248, v248, v252
    v_max_f32 v249, v249, v253
    v_max_f32 v250, v250, v254
    v_max_f32 v251, v251, v255
    v_mov_b32 v252, v248
    v_mov_b32 v253, v249
    v_mov_b32 v254, v250
    v_mov_b32 v255, v251
    v_permlane16_swap_b32 v248, v252
    v_permlane16_swap_b32 v249, v253
    v_permlane16_swap_b32 v250, v254
    v_permlane16_swap_b32 v251, v255
    v_max_f32 v248, v248, v252
    v_max_f32 v249, v249, v253
    v_max_f32 v250, v250, v254
    v_max_f32 v251, v251, v255
    v_min_f32_e64 v160, v160, -v248
    v_min_f32_e64 v164, v164, -v249
    v_min_f32_e64 v168, v168, -v250
    v_min_f32_e64 v172, v172, -v251
    v_mov_b32_e64 v161, v160
    v_pk_add_f32 v[64:65], v[64:65], v[160:161] op_sel:[0,0] op_sel_hi:[1,1]
    v_pk_add_f32 v[66:67], v[66:67], v[160:161] op_sel:[0,0] op_sel_hi:[1,1]
    v_pk_add_f32 v[68:69], v[68:69], v[160:161] op_sel:[0,0] op_sel_hi:[1,1]
    v_pk_add_f32 v[70:71], v[70:71], v[160:161] op_sel:[0,0] op_sel_hi:[1,1]
    v_exp_f32 v64, v64
    v_mov_b32 v165, v164
    v_exp_f32 v65, v65
    v_pk_add_f32 v[72:73], v[72:73], v[164:165] op_sel:[0,0] op_sel_hi:[1,1]
    v_cvt_pk_bf16_f32 v64, v64, v65
    v_exp_f32 v66, v66
    v_pk_add_f32 v[74:75], v[74:75], v[164:165] op_sel:[0,0] op_sel_hi:[1,1]
    v_exp_f32 v67, v67
    v_pk_add_f32 v[76:77], v[76:77], v[164:165] op_sel:[0,0] op_sel_hi:[1,1]
    v_cvt_pk_bf16_f32 v65, v66, v67
    v_exp_f32 v68, v68
    v_pk_add_f32 v[78:79], v[78:79], v[164:165] op_sel:[0,0] op_sel_hi:[1,1]
    v_exp_f32 v69, v69
    v_mov_b32 v169, v168
    v_cvt_pk_bf16_f32 v66, v68, v69
    v_exp_f32 v70, v70
    v_pk_add_f32 v[80:81], v[80:81], v[168:169] op_sel:[0,0] op_sel_hi:[1,1]
    v_exp_f32 v71, v71
    v_pk_add_f32 v[82:83], v[82:83], v[168:169] op_sel:[0,0] op_sel_hi:[1,1]
    v_cvt_pk_bf16_f32 v67, v70, v71
    v_exp_f32 v72, v72
    v_pk_add_f32 v[84:85], v[84:85], v[168:169] op_sel:[0,0] op_sel_hi:[1,1]
    v_exp_f32 v73, v73
    v_pk_add_f32 v[86:87], v[86:87], v[168:169] op_sel:[0,0] op_sel_hi:[1,1]
    v_cvt_pk_bf16_f32 v72, v72, v73
    v_exp_f32 v74, v74
    v_mov_b32 v173, v172
    v_exp_f32 v75, v75
    v_pk_add_f32 v[88:89], v[88:89], v[172:173] op_sel:[0,0] op_sel_hi:[1,1]
    v_cvt_pk_bf16_f32 v73, v74, v75
    v_exp_f32 v76, v76
    v_pk_add_f32 v[90:91], v[90:91], v[172:173] op_sel:[0,0] op_sel_hi:[1,1]
    v_exp_f32 v77, v77
    v_pk_add_f32 v[92:93], v[92:93], v[172:173] op_sel:[0,0] op_sel_hi:[1,1]
    v_cvt_pk_bf16_f32 v74, v76, v77
    v_exp_f32 v78, v78
    v_pk_add_f32 v[94:95], v[94:95], v[172:173] op_sel:[0,0] op_sel_hi:[1,1]
    v_exp_f32 v79, v79
    v_mov_b32 v162, v160
    v_cvt_pk_bf16_f32 v75, v78, v79
    v_exp_f32 v80, v80
    v_mov_b32 v163, v160
    v_mov_b32 v166, v164
    v_mov_b32 v167, v164
    v_mov_b32 v170, v168
    v_mov_b32 v171, v168
    v_mov_b32 v174, v172
    v_mov_b32 v175, v172
    s_waitcnt lgkmcnt(0)
    v_mfma_f32_16x16x32_bf16 v[96:99], a[192:195], v[0:3], v[160:163]
    s_barrier
    ds_read_b128 a[144:147], v192 offset:16384
    v_accvgpr_write_b32 a128, 0
    v_mfma_f32_16x16x32_bf16 v[96:99], a[196:199], v[16:19], v[96:99]
    v_exp_f32 v81, v81
    s_lshl_b32 s46, s49, 17
    s_add_u32 s46, s46, 46080
    s_add_u32 m0, s35, 131072
    v_mfma_f32_16x16x32_bf16 v[96:99], a[200:203], v[32:35], v[96:99]
    ds_read_b128 a[148:151], v193 offset:16384
    v_cvt_pk_bf16_f32 v80, v80, v81
    v_mfma_f32_16x16x32_bf16 v[96:99], a[204:207], v[48:51], v[96:99]
    buffer_load_dwordx4 v244, s[16:19], s46 offen offset:3072 lds
    v_mfma_f32_16x16x32_bf16 v[100:103], a[220:223], v[48:51], v[160:163]
    v_exp_f32_e64 v82, v82
    s_add_u32 s46, s46, 19456
    s_add_u32 m0, s35, 147456
    v_mfma_f32_16x16x32_bf16 v[100:103], a[216:219], v[32:35], v[100:103]
    buffer_load_dwordx4 v244, s[16:19], s46 offen offset:0 lds
    v_mfma_f32_16x16x32_bf16 v[100:103], a[212:215], v[16:19], v[100:103]
    v_exp_f32_e64 v83, v83
    s_add_u32 s46, s46, 15360
    v_mfma_f32_16x16x32_bf16 v[100:103], a[208:211], v[0:3], v[100:103]
    ds_read_b128 a[152:155], v194 offset:16384
    v_cvt_pk_bf16_f32 v81, v82, v83
    v_mfma_f32_16x16x32_bf16 v[108:111], a[208:211], v[4:7], v[164:167]
    v_exp_f32_e64 v84, v84
    v_mfma_f32_16x16x32_bf16 v[108:111], a[212:215], v[20:23], v[108:111]
    buffer_load_dwordx4 v244, s[16:19], s46 offen offset:1024 lds
    v_mfma_f32_16x16x32_bf16 v[108:111], a[216:219], v[36:39], v[108:111]
    v_exp_f32_e64 v85, v85
    s_add_u32 s46, s46, 15360
    v_mfma_f32_16x16x32_bf16 v[108:111], a[220:223], v[52:55], v[108:111]
    ds_read_b128 a[156:159], v195 offset:16384
    v_cvt_pk_bf16_f32 v82, v84, v85
    v_mfma_f32_16x16x32_bf16 v[104:107], a[204:207], v[52:55], v[164:167]
    v_exp_f32_e64 v86, v86
    v_mfma_f32_16x16x32_bf16 v[104:107], a[200:203], v[36:39], v[104:107]
    buffer_load_dwordx4 v244, s[16:19], s46 offen offset:2048 lds
    v_mfma_f32_16x16x32_bf16 v[104:107], a[196:199], v[20:23], v[104:107]
    v_exp_f32_e64 v87, v87
    s_add_u32 s46, s46, 15360
    v_mfma_f32_16x16x32_bf16 v[104:107], a[192:195], v[4:7], v[104:107]
    ds_read_b128 a[160:163], v192 offset:17408
    v_cvt_pk_bf16_f32 v83, v86, v87
    v_mfma_f32_16x16x32_bf16 v[112:115], a[192:195], v[8:11], v[168:171]
    v_exp_f32_e64 v88, v88
    v_mfma_f32_16x16x32_bf16 v[112:115], a[196:199], v[24:27], v[112:115]
    buffer_load_dwordx4 v244, s[16:19], s46 offen offset:3072 lds
    v_mfma_f32_16x16x32_bf16 v[112:115], a[200:203], v[40:43], v[112:115]
    v_exp_f32_e64 v89, v89
    v_mfma_f32_16x16x32_bf16 v[112:115], a[204:207], v[56:59], v[112:115]
    ds_read_b128 a[164:167], v193 offset:17408
    v_cvt_pk_bf16_f32 v88, v88, v89
    v_mfma_f32_16x16x32_bf16 v[116:119], a[220:223], v[56:59], v[168:171]
    v_exp_f32_e64 v90, v90
    v_mfma_f32_16x16x32_bf16 v[116:119], a[216:219], v[40:43], v[116:119]
    s_add_u32 m0, s36, 32768
    ds_read_b128 a[168:171], v194 offset:17408
    ds_read_b128 a[172:175], v195 offset:17408
    v_mfma_f32_16x16x32_bf16 v[116:119], a[212:215], v[24:27], v[116:119]
    v_exp_f32_e64 v91, v91
    v_mfma_f32_16x16x32_bf16 v[116:119], a[208:211], v[8:11], v[116:119]
    v_cvt_pk_bf16_f32 v89, v90, v91
    v_accvgpr_write_b32 a129, 0
    v_mfma_f32_16x16x32_bf16 v[124:127], a[208:211], v[12:15], v[172:175]
    v_exp_f32_e64 v92, v92
    v_mfma_f32_16x16x32_bf16 v[124:127], a[212:215], v[28:31], v[124:127]
    buffer_load_dwordx4 v205, s[8:11], s37 offen offset:0 lds
    v_mfma_f32_16x16x32_bf16 v[124:127], a[216:219], v[44:47], v[124:127]
    v_exp_f32_e64 v93, v93
    v_mfma_f32_16x16x32_bf16 v[124:127], a[220:223], v[60:63], v[124:127]
    v_cvt_pk_bf16_f32 v90, v92, v93
    v_accvgpr_write_b32 a132, 0
    v_mfma_f32_16x16x32_bf16 v[120:123], a[204:207], v[60:63], v[172:175]
    v_exp_f32_e64 v94, v94
    v_mfma_f32_16x16x32_bf16 v[120:123], a[200:203], v[44:47], v[120:123]
    buffer_load_dwordx4 v205, s[8:11], s37 offen offset:1024 lds
    v_mfma_f32_16x16x32_bf16 v[120:123], a[196:199], v[28:31], v[120:123]
    v_exp_f32_e64 v95, v95
    v_mfma_f32_16x16x32_bf16 v[120:123], a[192:195], v[12:15], v[120:123]
    v_cvt_pk_bf16_f32 v91, v94, v95
    s_waitcnt lgkmcnt(0)
    v_exp_f32 v96, v96
    v_exp_f32 v97, v97
    v_exp_f32 v98, v98
    v_cvt_pk_bf16_f32 v68, v96, v97
    v_exp_f32 v99, v99
    v_exp_f32 v100, v100
    v_cvt_pk_bf16_f32 v69, v98, v99
    v_exp_f32 v101, v101
    v_exp_f32 v102, v102
    v_cvt_pk_bf16_f32 v70, v100, v101
    v_exp_f32 v103, v103
    v_exp_f32 v104, v104
    v_cvt_pk_bf16_f32 v71, v102, v103
    buffer_load_dwordx4 v205, s[8:11], s37 offen offset:2048 lds
    v_exp_f32 v105, v105
    v_exp_f32 v106, v106
    v_cvt_pk_bf16_f32 v76, v104, v105
    buffer_load_dwordx4 v205, s[8:11], s37 offen offset:3072 lds
    v_exp_f32 v107, v107
    v_exp_f32 v108, v108
    v_cvt_pk_bf16_f32 v77, v106, v107
    s_add_u32 m0, s35, 0
    v_exp_f32 v109, v109
    v_exp_f32 v110, v110
    v_cvt_pk_bf16_f32 v78, v108, v109
    v_exp_f32 v111, v111
    v_accvgpr_write_b32 a133, 0
    v_cvt_pk_bf16_f32 v79, v110, v111
    s_waitcnt lgkmcnt(0)
    v_mfma_f32_16x16x32_bf16 v[128:131], a[144:147], v[0:3], v[160:163]
    ds_read_b64_tr_b16 a[224:225], v196 offset:0
    ds_read_b64_tr_b16 a[226:227], v196 offset:1024
    v_mfma_f32_16x16x32_bf16 v[128:131], a[148:151], v[16:19], v[128:131]
    v_exp_f32 v112, v112
    v_mfma_f32_16x16x32_bf16 v[128:131], a[152:155], v[32:35], v[128:131]
    ds_read_b64_tr_b16 a[228:229], v196 offset:2048
    ds_read_b64_tr_b16 a[230:231], v196 offset:3072
    v_mfma_f32_16x16x32_bf16 v[128:131], a[156:159], v[48:51], v[128:131]
    v_exp_f32_e64 v113, v113
    v_mfma_f32_16x16x32_bf16 v[132:135], a[172:175], v[48:51], v[160:163]
    ds_read_b64_tr_b16 a[232:233], v197 offset:0
    v_cvt_pk_bf16_f32 v84, v112, v113
    v_mfma_f32_16x16x32_bf16 v[132:135], a[168:171], v[32:35], v[132:135]
    ds_read_b64_tr_b16 a[234:235], v197 offset:1024
    ds_read_b64_tr_b16 a[236:237], v197 offset:2048
    v_mfma_f32_16x16x32_bf16 v[132:135], a[164:167], v[16:19], v[132:135]
    v_exp_f32_e64 v114, v114
    v_mfma_f32_16x16x32_bf16 v[132:135], a[160:163], v[0:3], v[132:135]
    ds_read_b64_tr_b16 a[238:239], v197 offset:3072
    ds_read_b64_tr_b16 a[240:241], v198 offset:0
    v_mfma_f32_16x16x32_bf16 v[140:143], a[160:163], v[4:7], v[164:167]
    v_exp_f32_e64 v115, v115
    v_mfma_f32_16x16x32_bf16 v[140:143], a[164:167], v[20:23], v[140:143]
    ds_read_b64_tr_b16 a[242:243], v198 offset:1024
    v_cvt_pk_bf16_f32 v85, v114, v115
    v_mfma_f32_16x16x32_bf16 v[140:143], a[168:171], v[36:39], v[140:143]
    v_exp_f32_e64 v116, v116
    v_mfma_f32_16x16x32_bf16 v[140:143], a[172:175], v[52:55], v[140:143]
    ds_read_b64_tr_b16 a[244:245], v198 offset:2048
    ds_read_b64_tr_b16 a[246:247], v198 offset:3072
    v_mfma_f32_16x16x32_bf16 v[136:139], a[156:159], v[52:55], v[164:167]
    v_exp_f32_e64 v117, v117
    v_mfma_f32_16x16x32_bf16 v[136:139], a[152:155], v[36:39], v[136:139]
    ds_read_b64_tr_b16 a[248:249], v199 offset:0
    v_cvt_pk_bf16_f32 v86, v116, v117
    v_mfma_f32_16x16x32_bf16 v[136:139], a[148:151], v[20:23], v[136:139]
    v_exp_f32_e64 v118, v118
    v_mfma_f32_16x16x32_bf16 v[136:139], a[144:147], v[4:7], v[136:139]
    ds_read_b64_tr_b16 a[250:251], v199 offset:1024
    ds_read_b64_tr_b16 a[252:253], v199 offset:2048
    v_smfmac_f32_16x16x64_bf16 a[128:131], v[208:211], v[64:71], v207
    v_exp_f32_e64 v119, v119
    v_smfmac_f32_16x16x64_bf16 a[132:135], v[208:211], v[72:79], v207
    ds_read_b64_tr_b16 a[254:255], v199 offset:3072
    v_cvt_pk_bf16_f32 v87, v118, v119
    v_mfma_f32_16x16x32_bf16 v[144:147], a[144:147], v[8:11], v[168:171]
    v_exp_f32_e64 v120, v120
    v_mfma_f32_16x16x32_bf16 v[144:147], a[148:151], v[24:27], v[144:147]
    v_accvgpr_write_b32 a136, 0
    v_accvgpr_write_b32 a137, 0
    v_mfma_f32_16x16x32_bf16 v[144:147], a[152:155], v[40:43], v[144:147]
    v_exp_f32_e64 v121, v121
    v_mfma_f32_16x16x32_bf16 v[144:147], a[156:159], v[56:59], v[144:147]
    v_cvt_pk_bf16_f32 v92, v120, v121
    v_accvgpr_write_b32 a140, 0
    v_mfma_f32_16x16x32_bf16 v[148:151], a[172:175], v[56:59], v[168:171]
    v_exp_f32_e64 v122, v122
    v_mfma_f32_16x16x32_bf16 v[148:151], a[168:171], v[40:43], v[148:151]
    buffer_load_dwordx4 v204, s[4:7], s37 offen offset:0 lds
    v_mfma_f32_16x16x32_bf16 v[148:151], a[164:167], v[24:27], v[148:151]
    v_exp_f32_e64 v123, v123
    v_mfma_f32_16x16x32_bf16 v[148:151], a[160:163], v[8:11], v[148:151]
    v_cvt_pk_bf16_f32 v93, v122, v123
    v_accvgpr_write_b32 a141, 0
    v_mfma_f32_16x16x32_bf16 v[156:159], a[160:163], v[12:15], v[172:175]
    v_exp_f32_e64 v124, v124
    v_mfma_f32_16x16x32_bf16 v[156:159], a[164:167], v[28:31], v[156:159]
    buffer_load_dwordx4 v204, s[4:7], s37 offen offset:1024 lds
    v_mfma_f32_16x16x32_bf16 v[156:159], a[168:171], v[44:47], v[156:159]
    v_exp_f32_e64 v125, v125
    v_mfma_f32_16x16x32_bf16 v[156:159], a[172:175], v[60:63], v[156:159]
    v_cvt_pk_bf16_f32 v94, v124, v125
    v_and_b32 v253, 0x1e0, v206
    v_mfma_f32_16x16x32_bf16 v[152:155], a[156:159], v[60:63], v[172:175]
    v_exp_f32_e64 v126, v126
    v_mfma_f32_16x16x32_bf16 v[152:155], a[152:155], v[44:47], v[152:155]
    v_and_b32 v252, 16, v206
    s_lshl_b32 s48, s34, 2
    s_add_u32 s48, s48, s33
    s_lshl_b32 s48, s48, 14
    v_lshl_add_u32 v253, v253, 5, s48
    v_mfma_f32_16x16x32_bf16 v[152:155], a[148:151], v[28:31], v[152:155]
    v_exp_f32_e64 v127, v127
    v_mfma_f32_16x16x32_bf16 v[152:155], a[144:147], v[12:15], v[152:155]
    v_cvt_pk_bf16_f32 v95, v126, v127
    s_waitcnt lgkmcnt(0)
    v_mfma_f32_16x16x32_bf16 a[0:3], a[224:227], v[64:67], 0
    v_exp_f32 v128, v128
    v_mfma_f32_16x16x32_bf16 a[0:3], a[228:231], v[68:71], a[0:3]
    ds_read_b128 a[192:195], v192 offset:18432
    v_lshl_add_u32 v253, v252, 3, v253
    v_mfma_f32_16x16x32_bf16 a[4:7], a[236:239], v[68:71], 0
    v_exp_f32_e64 v129, v129
    v_mfma_f32_16x16x32_bf16 a[4:7], a[232:235], v[64:67], a[4:7]
    ds_read_b128 a[196:199], v193 offset:18432
    v_cvt_pk_bf16_f32 v128, v128, v129
    v_mfma_f32_16x16x32_bf16 a[8:11], a[240:243], v[64:67], 0
    v_exp_f32_e64 v130, v130
    v_mfma_f32_16x16x32_bf16 a[8:11], a[244:247], v[68:71], a[8:11]
    ds_read_b128 a[200:203], v194 offset:18432
    v_accvgpr_write_b32 a176, 0
    v_mfma_f32_16x16x32_bf16 a[12:15], a[252:255], v[68:71], 0
    v_exp_f32_e64 v131, v131
    v_mfma_f32_16x16x32_bf16 a[12:15], a[248:251], v[64:67], a[12:15]
    ds_read_b128 a[204:207], v195 offset:18432
    v_cvt_pk_bf16_f32 v129, v130, v131
    v_mfma_f32_16x16x32_bf16 a[44:47], a[248:251], v[72:75], 0
    v_exp_f32 v132, v132
L_hop5:
    s_cbranch_execz L_ret1
    v_mfma_f32_16x16x32_bf16 a[44:47], a[252:255], v[76:79], a[44:47]
    ds_read_b128 a[208:211], v192 offset:19456
    v_accvgpr_write_b32 a177, 0
    v_mfma_f32_16x16x32_bf16 a[40:43], a[244:247], v[76:79], 0
    v_exp_f32_e64 v133, v133
    v_mfma_f32_16x16x32_bf16 a[40:43], a[240:243], v[72:75], a[40:43]
    ds_read_b128 a[212:215], v193 offset:19456
    v_cvt_pk_bf16_f32 v130, v132, v133
    v_mfma_f32_16x16x32_bf16 a[36:39], a[232:235], v[72:75], 0
    v_exp_f32_e64 v134, v134
    v_mfma_f32_16x16x32_bf16 a[36:39], a[236:239], v[76:79], a[36:39]
    ds_read_b128 a[216:219], v194 offset:19456
    v_accvgpr_write_b32 a178, 0
    v_mfma_f32_16x16x32_bf16 a[32:35], a[228:231], v[76:79], 0
    v_exp_f32_e64 v135, v135
    v_mfma_f32_16x16x32_bf16 a[32:35], a[224:227], v[72:75], a[32:35]
    ds_read_b128 a[220:223], v195 offset:19456
    v_cvt_pk_bf16_f32 v131, v134, v135
    v_smfmac_f32_16x16x64_bf16 a[136:139], v[208:211], v[80:87], v207
    v_exp_f32_e64 v136, v136
    v_smfmac_f32_16x16x64_bf16 a[140:143], v[208:211], v[88:95], v207
    buffer_load_dwordx4 v204, s[4:7], s37 offen offset:2048 lds
    v_mfma_f32_16x16x32_bf16 a[64:67], a[224:227], v[80:83], 0
    v_exp_f32_e64 v137, v137
    v_mfma_f32_16x16x32_bf16 a[64:67], a[228:231], v[84:87], a[64:67]
    v_cvt_pk_bf16_f32 v136, v136, v137
    v_accvgpr_write_b32 a179, 0
    v_mfma_f32_16x16x32_bf16 a[68:71], a[236:239], v[84:87], 0
    v_exp_f32_e64 v138, v138
    v_mfma_f32_16x16x32_bf16 a[68:71], a[232:235], v[80:83], a[68:71]
    buffer_load_dwordx4 v204, s[4:7], s37 offen offset:3072 lds
    v_mfma_f32_16x16x32_bf16 a[72:75], a[240:243], v[80:83], 0
    v_exp_f32_e64 v139, v139
    v_mfma_f32_16x16x32_bf16 a[72:75], a[244:247], v[84:87], a[72:75]
    v_cvt_pk_bf16_f32 v137, v138, v139
    v_accvgpr_write_b32 a180, 0
    v_mfma_f32_16x16x32_bf16 a[76:79], a[252:255], v[84:87], 0
    v_exp_f32_e64 v140, v140
    v_mfma_f32_16x16x32_bf16 a[76:79], a[248:251], v[80:83], a[76:79]
    s_add_u32 s37, s37, 16384
    v_accvgpr_write_b32 a181, 0
    v_accvgpr_write_b32 a182, 0
    v_mfma_f32_16x16x32_bf16 a[108:111], a[248:251], v[88:91], 0
    v_exp_f32_e64 v141, v141
    v_mfma_f32_16x16x32_bf16 a[108:111], a[252:255], v[92:95], a[108:111]
    v_cvt_pk_bf16_f32 v138, v140, v141
    v_accvgpr_write_b32 a183, 0
    v_mfma_f32_16x16x32_bf16 a[104:107], a[244:247], v[92:95], 0
    v_exp_f32_e64 v142, v142
    v_mfma_f32_16x16x32_bf16 a[104:107], a[240:243], v[88:91], a[104:107]
    v_accvgpr_write_b32 a184, 0
    v_accvgpr_write_b32 a185, 0
    v_mfma_f32_16x16x32_bf16 a[100:103], a[232:235], v[88:91], 0
    v_exp_f32_e64 v143, v143
    v_mfma_f32_16x16x32_bf16 a[100:103], a[236:239], v[92:95], a[100:103]
    v_cvt_pk_bf16_f32 v139, v142, v143
    s_waitcnt vmcnt(13)
    v_mfma_f32_16x16x32_bf16 a[96:99], a[228:231], v[92:95], 0
    v_exp_f32 v144, v144
    v_mfma_f32_16x16x32_bf16 a[96:99], a[224:227], v[88:91], a[96:99]
    s_waitcnt lgkmcnt(0)
    v_mfma_f32_16x16x32_bf16 v[96:99], a[192:195], v[0:3], v[160:163]
    s_barrier
    ds_read_b64_tr_b16 a[224:225], v200 offset:0
    s_lshl_b32 s47, s34, 5
    v_mfma_f32_16x16x32_bf16 v[96:99], a[196:199], v[16:19], v[96:99]
    v_exp_f32 v145, v145
    buffer_atomic_add v246, v245, s[20:23], s47 offen sc1
    v_mfma_f32_16x16x32_bf16 v[96:99], a[200:203], v[32:35], v[96:99]
    ds_read_b64_tr_b16 a[226:227], v200 offset:1024
    v_cvt_pk_bf16_f32 v144, v144, v145
    v_mfma_f32_16x16x32_bf16 v[96:99], a[204:207], v[48:51], v[96:99]
    ds_read_b64_tr_b16 a[228:229], v200 offset:2048
    ds_read_b64_tr_b16 a[230:231], v200 offset:3072
    v_mfma_f32_16x16x32_bf16 v[100:103], a[220:223], v[48:51], v[160:163]
    v_exp_f32_e64 v146, v146
    v_mfma_f32_16x16x32_bf16 v[100:103], a[216:219], v[32:35], v[100:103]
    ds_read_b64_tr_b16 a[232:233], v201 offset:0
    ds_read_b64_tr_b16 a[234:235], v201 offset:1024
    v_mfma_f32_16x16x32_bf16 v[100:103], a[212:215], v[16:19], v[100:103]
    v_exp_f32_e64 v147, v147
    v_mfma_f32_16x16x32_bf16 v[100:103], a[208:211], v[0:3], v[100:103]
    ds_read_b64_tr_b16 a[236:237], v201 offset:2048
    v_cvt_pk_bf16_f32 v145, v146, v147
    v_mfma_f32_16x16x32_bf16 v[108:111], a[208:211], v[4:7], v[164:167]
    v_exp_f32_e64 v148, v148
    v_mfma_f32_16x16x32_bf16 v[108:111], a[212:215], v[20:23], v[108:111]
    ds_read_b64_tr_b16 a[238:239], v201 offset:3072
    ds_read_b64_tr_b16 a[240:241], v202 offset:0
    v_mfma_f32_16x16x32_bf16 v[108:111], a[216:219], v[36:39], v[108:111]
    v_exp_f32_e64 v149, v149
    v_mfma_f32_16x16x32_bf16 v[108:111], a[220:223], v[52:55], v[108:111]
    ds_read_b64_tr_b16 a[242:243], v202 offset:1024
    v_cvt_pk_bf16_f32 v146, v148, v149
    v_mfma_f32_16x16x32_bf16 v[104:107], a[204:207], v[52:55], v[164:167]
    v_exp_f32_e64 v150, v150
    v_mfma_f32_16x16x32_bf16 v[104:107], a[200:203], v[36:39], v[104:107]
    ds_read_b64_tr_b16 a[244:245], v202 offset:2048
    ds_read_b64_tr_b16 a[246:247], v202 offset:3072
    v_mfma_f32_16x16x32_bf16 v[104:107], a[196:199], v[20:23], v[104:107]
    v_exp_f32_e64 v151, v151
    v_mfma_f32_16x16x32_bf16 v[104:107], a[192:195], v[4:7], v[104:107]
    ds_read_b64_tr_b16 a[248:249], v203 offset:0
    v_cvt_pk_bf16_f32 v147, v150, v151
    v_mfma_f32_16x16x32_bf16 v[112:115], a[192:195], v[8:11], v[168:171]
    v_exp_f32_e64 v152, v152
    v_mfma_f32_16x16x32_bf16 v[112:115], a[196:199], v[24:27], v[112:115]
    ds_read_b64_tr_b16 a[250:251], v203 offset:1024
    ds_read_b64_tr_b16 a[252:253], v203 offset:2048
    v_mfma_f32_16x16x32_bf16 v[112:115], a[200:203], v[40:43], v[112:115]
    v_exp_f32_e64 v153, v153
    v_mfma_f32_16x16x32_bf16 v[112:115], a[204:207], v[56:59], v[112:115]
    ds_read_b64_tr_b16 a[254:255], v203 offset:3072
    v_cvt_pk_bf16_f32 v152, v152, v153
    v_mfma_f32_16x16x32_bf16 v[116:119], a[220:223], v[56:59], v[168:171]
    v_exp_f32_e64 v154, v154
    v_mfma_f32_16x16x32_bf16 v[116:119], a[216:219], v[40:43], v[116:119]
    s_add_u32 m0, s36, 49152
    v_accvgpr_write_b32 a186, 0
    v_accvgpr_write_b32 a187, 0
    v_mfma_f32_16x16x32_bf16 v[116:119], a[212:215], v[24:27], v[116:119]
    v_exp_f32_e64 v155, v155
    v_mfma_f32_16x16x32_bf16 v[116:119], a[208:211], v[8:11], v[116:119]
    v_cvt_pk_bf16_f32 v153, v154, v155
    v_accvgpr_write_b32 a188, 0
    v_mfma_f32_16x16x32_bf16 v[124:127], a[208:211], v[12:15], v[172:175]
    v_exp_f32_e64 v156, v156
    v_mfma_f32_16x16x32_bf16 v[124:127], a[212:215], v[28:31], v[124:127]
    buffer_load_dwordx4 v205, s[8:11], s37 offen offset:0 lds
    v_mfma_f32_16x16x32_bf16 v[124:127], a[216:219], v[44:47], v[124:127]
    v_exp_f32_e64 v157, v157
    v_mfma_f32_16x16x32_bf16 v[124:127], a[220:223], v[60:63], v[124:127]
    v_cvt_pk_bf16_f32 v154, v156, v157
    v_accvgpr_write_b32 a189, 0
    v_mfma_f32_16x16x32_bf16 v[120:123], a[204:207], v[60:63], v[172:175]
    v_exp_f32_e64 v158, v158
    v_mfma_f32_16x16x32_bf16 v[120:123], a[200:203], v[44:47], v[120:123]
    buffer_load_dwordx4 v205, s[8:11], s37 offen offset:1024 lds
    v_mfma_f32_16x16x32_bf16 v[120:123], a[196:199], v[28:31], v[120:123]
    v_exp_f32_e64 v159, v159
    v_mfma_f32_16x16x32_bf16 v[120:123], a[192:195], v[12:15], v[120:123]
    v_cvt_pk_bf16_f32 v155, v158, v159
    s_waitcnt lgkmcnt(0)
    v_mfma_f32_16x16x32_bf16 a[16:19], a[224:227], v[64:67], 0
    v_exp_f32 v96, v96
    v_mfma_f32_16x16x32_bf16 a[16:19], a[228:231], v[68:71], a[16:19]
    ds_read_b128 a[192:195], v192 offset:32768
    v_accvgpr_write_b32 a190, 0
    v_mfma_f32_16x16x32_bf16 a[20:23], a[236:239], v[68:71], 0
    v_exp_f32_e64 v97, v97
    v_mfma_f32_16x16x32_bf16 a[20:23], a[232:235], v[64:67], a[20:23]
    ds_read_b128 a[196:199], v193 offset:32768
    v_cvt_pk_bf16_f32 v132, v96, v97
    v_mfma_f32_16x16x32_bf16 a[24:27], a[240:243], v[64:67], 0
    v_exp_f32_e64 v98, v98
    v_mfma_f32_16x16x32_bf16 a[24:27], a[244:247], v[68:71], a[24:27]
    ds_read_b128 a[200:203], v194 offset:32768
    v_accvgpr_write_b32 a191, 0
    v_mfma_f32_16x16x32_bf16 a[28:31], a[252:255], v[68:71], 0
    v_exp_f32_e64 v99, v99
    v_mfma_f32_16x16x32_bf16 a[28:31], a[248:251], v[64:67], a[28:31]
    ds_read_b128 a[204:207], v195 offset:32768
    v_cvt_pk_bf16_f32 v133, v98, v99
    v_mfma_f32_16x16x32_bf16 a[60:63], a[248:251], v[72:75], 0
    v_exp_f32_e64 v100, v100
    v_mfma_f32_16x16x32_bf16 a[60:63], a[252:255], v[76:79], a[60:63]
    ds_read_b128 a[208:211], v192 offset:33792
    v_mov_b32_e64 v176, 0
    v_mfma_f32_16x16x32_bf16 a[56:59], a[244:247], v[76:79], 0
    v_exp_f32_e64 v101, v101
    v_mfma_f32_16x16x32_bf16 a[56:59], a[240:243], v[72:75], a[56:59]
    ds_read_b128 a[212:215], v193 offset:33792
    v_cvt_pk_bf16_f32 v134, v100, v101
    v_mfma_f32_16x16x32_bf16 a[52:55], a[232:235], v[72:75], 0
    v_exp_f32_e64 v102, v102
    v_mfma_f32_16x16x32_bf16 a[52:55], a[236:239], v[76:79], a[52:55]
    ds_read_b128 a[216:219], v194 offset:33792
    v_mov_b32_e64 v177, 0
    v_mfma_f32_16x16x32_bf16 a[48:51], a[228:231], v[76:79], 0
    v_exp_f32_e64 v103, v103
    v_mfma_f32_16x16x32_bf16 a[48:51], a[224:227], v[72:75], a[48:51]
    ds_read_b128 a[220:223], v195 offset:33792
    v_cvt_pk_bf16_f32 v135, v102, v103
    v_mfma_f32_16x16x32_bf16 a[80:83], a[224:227], v[80:83], 0
    v_exp_f32_e64 v104, v104
    v_mfma_f32_16x16x32_bf16 a[80:83], a[228:231], v[84:87], a[80:83]
    buffer_load_dwordx4 v205, s[8:11], s37 offen offset:2048 lds
    v_mfma_f32_16x16x32_bf16 a[84:87], a[236:239], v[84:87], 0
    v_exp_f32_e64 v105, v105
    v_mfma_f32_16x16x32_bf16 a[84:87], a[232:235], v[80:83], a[84:87]
    v_cvt_pk_bf16_f32 v140, v104, v105
    v_mov_b32_e64 v178, 0
    v_mfma_f32_16x16x32_bf16 a[88:91], a[240:243], v[80:83], 0
    v_exp_f32_e64 v106, v106
    v_mfma_f32_16x16x32_bf16 a[88:91], a[244:247], v[84:87], a[88:91]
    buffer_load_dwordx4 v205, s[8:11], s37 offen offset:3072 lds
    v_mfma_f32_16x16x32_bf16 a[92:95], a[252:255], v[84:87], 0
    v_exp_f32_e64 v107, v107
    v_mfma_f32_16x16x32_bf16 a[92:95], a[248:251], v[80:83], a[92:95]
    v_cvt_pk_bf16_f32 v141, v106, v107
    v_mov_b32_e64 v179, 0
    v_mfma_f32_16x16x32_bf16 a[124:127], a[248:251], v[88:91], 0
    v_exp_f32_e64 v108, v108
    v_mfma_f32_16x16x32_bf16 a[124:127], a[252:255], v[92:95], a[124:127]
    s_add_u32 m0, s35, 16384
    v_mov_b32 v180, 0
    v_mov_b32 v181, 0
    v_mfma_f32_16x16x32_bf16 a[120:123], a[244:247], v[92:95], 0
    v_exp_f32_e64 v109, v109
    v_mfma_f32_16x16x32_bf16 a[120:123], a[240:243], v[88:91], a[120:123]
    v_cvt_pk_bf16_f32 v142, v108, v109
    v_mov_b32_e64 v182, 0
    v_mfma_f32_16x16x32_bf16 a[116:119], a[232:235], v[88:91], 0
    v_exp_f32_e64 v110, v110
    v_mfma_f32_16x16x32_bf16 a[116:119], a[236:239], v[92:95], a[116:119]
    v_mov_b32 v183, 0
    v_mov_b32 v184, 0
    v_mfma_f32_16x16x32_bf16 a[112:115], a[228:231], v[92:95], 0
    v_exp_f32_e64 v111, v111
    v_mfma_f32_16x16x32_bf16 a[112:115], a[224:227], v[88:91], a[112:115]
    v_cvt_pk_bf16_f32 v143, v110, v111
    s_waitcnt lgkmcnt(0)
    v_mfma_f32_16x16x32_bf16 v[64:67], a[192:195], v[0:3], v[160:163]
    ds_read_b64_tr_b16 a[224:225], v196 offset:16384
    ds_read_b64_tr_b16 a[226:227], v196 offset:17408
    v_mfma_f32_16x16x32_bf16 v[64:67], a[196:199], v[16:19], v[64:67]
    v_exp_f32 v112, v112
    v_mfma_f32_16x16x32_bf16 v[64:67], a[200:203], v[32:35], v[64:67]
    ds_read_b64_tr_b16 a[228:229], v196 offset:18432
    ds_read_b64_tr_b16 a[230:231], v196 offset:19456
    v_mfma_f32_16x16x32_bf16 v[64:67], a[204:207], v[48:51], v[64:67]
    v_exp_f32_e64 v113, v113
    v_mfma_f32_16x16x32_bf16 v[68:71], a[220:223], v[48:51], v[160:163]
    ds_read_b64_tr_b16 a[232:233], v197 offset:16384
    v_cvt_pk_bf16_f32 v148, v112, v113
    v_mfma_f32_16x16x32_bf16 v[68:71], a[216:219], v[32:35], v[68:71]
    ds_read_b64_tr_b16 a[234:235], v197 offset:17408
    ds_read_b64_tr_b16 a[236:237], v197 offset:18432
    v_mfma_f32_16x16x32_bf16 v[68:71], a[212:215], v[16:19], v[68:71]
    v_exp_f32_e64 v114, v114
    v_mfma_f32_16x16x32_bf16 v[68:71], a[208:211], v[0:3], v[68:71]
    ds_read_b64_tr_b16 a[238:239], v197 offset:19456
    ds_read_b64_tr_b16 a[240:241], v198 offset:16384
    v_mfma_f32_16x16x32_bf16 v[76:79], a[208:211], v[4:7], v[164:167]
    v_exp_f32_e64 v115, v115
    v_mfma_f32_16x16x32_bf16 v[76:79], a[212:215], v[20:23], v[76:79]
    ds_read_b64_tr_b16 a[242:243], v198 offset:17408
    v_cvt_pk_bf16_f32 v149, v114, v115
    v_mfma_f32_16x16x32_bf16 v[76:79], a[216:219], v[36:39], v[76:79]
    v_exp_f32_e64 v116, v116
    v_mfma_f32_16x16x32_bf16 v[76:79], a[220:223], v[52:55], v[76:79]
    ds_read_b64_tr_b16 a[244:245], v198 offset:18432
    ds_read_b64_tr_b16 a[246:247], v198 offset:19456
    v_mfma_f32_16x16x32_bf16 v[72:75], a[204:207], v[52:55], v[164:167]
    v_exp_f32_e64 v117, v117
    v_mfma_f32_16x16x32_bf16 v[72:75], a[200:203], v[36:39], v[72:75]
    ds_read_b64_tr_b16 a[248:249], v199 offset:16384
    v_cvt_pk_bf16_f32 v150, v116, v117
    v_mfma_f32_16x16x32_bf16 v[72:75], a[196:199], v[20:23], v[72:75]
    v_exp_f32_e64 v118, v118
    v_mfma_f32_16x16x32_bf16 v[72:75], a[192:195], v[4:7], v[72:75]
    ds_read_b64_tr_b16 a[250:251], v199 offset:17408
    ds_read_b64_tr_b16 a[252:253], v199 offset:18432
    v_smfmac_f32_16x16x64_bf16 a[128:131], v[208:211], v[128:135], v207
    v_exp_f32_e64 v119, v119
    v_smfmac_f32_16x16x64_bf16 a[132:135], v[208:211], v[136:143], v207
    ds_read_b64_tr_b16 a[254:255], v199 offset:19456
    v_cvt_pk_bf16_f32 v151, v118, v119
    v_mfma_f32_16x16x32_bf16 v[80:83], a[192:195], v[8:11], v[168:171]
    v_exp_f32_e64 v120, v120
    v_mfma_f32_16x16x32_bf16 v[80:83], a[196:199], v[24:27], v[80:83]
    v_mov_b32 v185, 0
    v_mov_b32 v186, 0
    v_mfma_f32_16x16x32_bf16 v[80:83], a[200:203], v[40:43], v[80:83]
    v_exp_f32_e64 v121, v121
    v_mfma_f32_16x16x32_bf16 v[80:83], a[204:207], v[56:59], v[80:83]
    v_cvt_pk_bf16_f32 v156, v120, v121
    v_mov_b32_e64 v187, 0
    v_mfma_f32_16x16x32_bf16 v[84:87], a[220:223], v[56:59], v[168:171]
    v_exp_f32_e64 v122, v122
    v_mfma_f32_16x16x32_bf16 v[84:87], a[216:219], v[40:43], v[84:87]
    buffer_load_dwordx4 v204, s[4:7], s37 offen offset:0 lds
    v_mfma_f32_16x16x32_bf16 v[84:87], a[212:215], v[24:27], v[84:87]
    v_exp_f32_e64 v123, v123
    v_mfma_f32_16x16x32_bf16 v[84:87], a[208:211], v[8:11], v[84:87]
    v_cvt_pk_bf16_f32 v157, v122, v123
    v_mov_b32_e64 v188, 0
    v_mfma_f32_16x16x32_bf16 v[92:95], a[208:211], v[12:15], v[172:175]
    v_exp_f32_e64 v124, v124
    v_mfma_f32_16x16x32_bf16 v[92:95], a[212:215], v[28:31], v[92:95]
    buffer_load_dwordx4 v204, s[4:7], s37 offen offset:1024 lds
    v_mfma_f32_16x16x32_bf16 v[92:95], a[216:219], v[44:47], v[92:95]
    v_exp_f32_e64 v125, v125
    v_mfma_f32_16x16x32_bf16 v[92:95], a[220:223], v[60:63], v[92:95]
    v_cvt_pk_bf16_f32 v158, v124, v125
    v_mov_b32_e64 v189, 0
    v_mfma_f32_16x16x32_bf16 v[88:91], a[204:207], v[60:63], v[172:175]
    v_exp_f32_e64 v126, v126
    v_mfma_f32_16x16x32_bf16 v[88:91], a[200:203], v[44:47], v[88:91]
    v_mov_b32 v190, 0
    v_mov_b32 v191, 0
    v_mfma_f32_16x16x32_bf16 v[88:91], a[196:199], v[28:31], v[88:91]
    v_exp_f32_e64 v127, v127
    v_mfma_f32_16x16x32_bf16 v[88:91], a[192:195], v[12:15], v[88:91]
    v_cvt_pk_bf16_f32 v159, v126, v127
    s_waitcnt lgkmcnt(0)
    v_mfma_f32_16x16x32_bf16 a[0:3], a[224:227], v[128:131], a[0:3]
    v_exp_f32 v64, v64
    v_mfma_f32_16x16x32_bf16 a[0:3], a[228:231], v[132:135], a[0:3]
    ds_read_b128 a[192:195], v192 offset:34816
    v_and_b32 v248, 0x70, v206
    v_mfma_f32_16x16x32_bf16 a[4:7], a[236:239], v[132:135], a[4:7]
    v_exp_f32_e64 v65, v65
    v_mfma_f32_16x16x32_bf16 a[4:7], a[232:235], v[128:131], a[4:7]
    ds_read_b128 a[196:199], v193 offset:34816
    v_cvt_pk_bf16_f32 v64, v64, v65
    v_mfma_f32_16x16x32_bf16 a[8:11], a[240:243], v[128:131], a[8:11]
    v_exp_f32_e64 v66, v66
    v_mfma_f32_16x16x32_bf16 a[8:11], a[244:247], v[132:135], a[8:11]
    ds_read_b128 a[200:203], v194 offset:34816
    v_lshlrev_b32_e64 v248, 1, v248
    v_mfma_f32_16x16x32_bf16 a[12:15], a[252:255], v[132:135], a[12:15]
    v_exp_f32_e64 v67, v67
    v_mfma_f32_16x16x32_bf16 a[12:15], a[248:251], v[128:131], a[12:15]
    ds_read_b128 a[204:207], v195 offset:34816
    v_cvt_pk_bf16_f32 v65, v66, v67
    v_mfma_f32_16x16x32_bf16 a[44:47], a[248:251], v[136:139], a[44:47]
    v_exp_f32_e64 v68, v68
    v_mfma_f32_16x16x32_bf16 a[44:47], a[252:255], v[140:143], a[44:47]
    ds_read_b128 a[208:211], v192 offset:35840
    v_accvgpr_write_b32 a144, 0
    v_mfma_f32_16x16x32_bf16 a[40:43], a[244:247], v[140:143], a[40:43]
    v_exp_f32_e64 v69, v69
    v_mfma_f32_16x16x32_bf16 a[40:43], a[240:243], v[136:139], a[40:43]
    ds_read_b128 a[212:215], v193 offset:35840
    v_cvt_pk_bf16_f32 v66, v68, v69
    v_mfma_f32_16x16x32_bf16 a[36:39], a[232:235], v[136:139], a[36:39]
    v_exp_f32_e64 v70, v70
    v_mfma_f32_16x16x32_bf16 a[36:39], a[236:239], v[140:143], a[36:39]
    ds_read_b128 a[216:219], v194 offset:35840
    v_accvgpr_write_b32 a145, 0
    v_mfma_f32_16x16x32_bf16 a[32:35], a[228:231], v[140:143], a[32:35]
    v_exp_f32_e64 v71, v71
    v_mfma_f32_16x16x32_bf16 a[32:35], a[224:227], v[136:139], a[32:35]
    ds_read_b128 a[220:223], v195 offset:35840
    v_cvt_pk_bf16_f32 v67, v70, v71
    v_smfmac_f32_16x16x64_bf16 a[136:139], v[208:211], v[144:151], v207
    v_exp_f32_e64 v72, v72
    v_smfmac_f32_16x16x64_bf16 a[140:143], v[208:211], v[152:159], v207
    buffer_load_dwordx4 v204, s[4:7], s37 offen offset:2048 lds
    v_mfma_f32_16x16x32_bf16 a[64:67], a[224:227], v[144:147], a[64:67]
    v_exp_f32_e64 v73, v73
    v_mfma_f32_16x16x32_bf16 a[64:67], a[228:231], v[148:151], a[64:67]
    v_cvt_pk_bf16_f32 v72, v72, v73
    v_accvgpr_write_b32 a146, 0
    v_mfma_f32_16x16x32_bf16 a[68:71], a[236:239], v[148:151], a[68:71]
    v_exp_f32_e64 v74, v74
    v_mfma_f32_16x16x32_bf16 a[68:71], a[232:235], v[144:147], a[68:71]
    buffer_load_dwordx4 v204, s[4:7], s37 offen offset:3072 lds
    v_mfma_f32_16x16x32_bf16 a[72:75], a[240:243], v[144:147], a[72:75]
    v_exp_f32_e64 v75, v75
    v_mfma_f32_16x16x32_bf16 a[72:75], a[244:247], v[148:151], a[72:75]
    v_cvt_pk_bf16_f32 v73, v74, v75
    v_accvgpr_write_b32 a147, 0
    v_mfma_f32_16x16x32_bf16 a[76:79], a[252:255], v[148:151], a[76:79]
    v_exp_f32_e64 v76, v76
    v_mfma_f32_16x16x32_bf16 a[76:79], a[248:251], v[144:147], a[76:79]
    s_add_u32 s37, s37, 16384
    v_accvgpr_write_b32 a148, 0
    v_accvgpr_write_b32 a149, 0
    v_mfma_f32_16x16x32_bf16 a[108:111], a[248:251], v[152:155], a[108:111]
    v_exp_f32_e64 v77, v77
    v_mfma_f32_16x16x32_bf16 a[108:111], a[252:255], v[156:159], a[108:111]
    v_cvt_pk_bf16_f32 v74, v76, v77
    v_accvgpr_write_b32 a150, 0
    v_mfma_f32_16x16x32_bf16 a[104:107], a[244:247], v[156:159], a[104:107]
    v_exp_f32_e64 v78, v78
    v_mfma_f32_16x16x32_bf16 a[104:107], a[240:243], v[152:155], a[104:107]
    v_accvgpr_write_b32 a151, 0
    v_accvgpr_write_b32 a152, 0
    v_mfma_f32_16x16x32_bf16 a[100:103], a[232:235], v[152:155], a[100:103]
    v_exp_f32_e64 v79, v79
    v_mfma_f32_16x16x32_bf16 a[100:103], a[236:239], v[156:159], a[100:103]
    v_cvt_pk_bf16_f32 v75, v78, v79
    v_accvgpr_write_b32 a153, 0
    v_mfma_f32_16x16x32_bf16 a[96:99], a[228:231], v[156:159], a[96:99]
    v_exp_f32_e64 v80, v80
    v_mfma_f32_16x16x32_bf16 a[96:99], a[224:227], v[152:155], a[96:99]
    s_waitcnt vmcnt(13) lgkmcnt(0)
    v_mfma_f32_16x16x32_bf16 v[96:99], a[192:195], v[0:3], v[160:163]
    s_barrier
    ds_read_b64_tr_b16 a[224:225], v200 offset:16384
    v_mfma_f32_16x16x32_bf16 v[96:99], a[196:199], v[16:19], v[96:99]
    v_exp_f32_e64 v81, v81
    v_mfma_f32_16x16x32_bf16 v[96:99], a[200:203], v[32:35], v[96:99]
    ds_read_b64_tr_b16 a[226:227], v200 offset:17408
    v_cvt_pk_bf16_f32 v80, v80, v81
    v_mfma_f32_16x16x32_bf16 v[96:99], a[204:207], v[48:51], v[96:99]
    ds_read_b64_tr_b16 a[228:229], v200 offset:18432
    ds_read_b64_tr_b16 a[230:231], v200 offset:19456
    v_mfma_f32_16x16x32_bf16 v[100:103], a[220:223], v[48:51], v[160:163]
    v_exp_f32_e64 v82, v82
    v_mfma_f32_16x16x32_bf16 v[100:103], a[216:219], v[32:35], v[100:103]
    ds_read_b64_tr_b16 a[232:233], v201 offset:16384
    ds_read_b64_tr_b16 a[234:235], v201 offset:17408
    v_mfma_f32_16x16x32_bf16 v[100:103], a[212:215], v[16:19], v[100:103]
    v_exp_f32_e64 v83, v83
    v_mfma_f32_16x16x32_bf16 v[100:103], a[208:211], v[0:3], v[100:103]
    ds_read_b64_tr_b16 a[236:237], v201 offset:18432
    v_cvt_pk_bf16_f32 v81, v82, v83
    v_mfma_f32_16x16x32_bf16 v[108:111], a[208:211], v[4:7], v[164:167]
    v_exp_f32_e64 v84, v84
    v_mfma_f32_16x16x32_bf16 v[108:111], a[212:215], v[20:23], v[108:111]
    ds_read_b64_tr_b16 a[238:239], v201 offset:19456
    ds_read_b64_tr_b16 a[240:241], v202 offset:16384
    v_mfma_f32_16x16x32_bf16 v[108:111], a[216:219], v[36:39], v[108:111]
    v_exp_f32_e64 v85, v85
    v_mfma_f32_16x16x32_bf16 v[108:111], a[220:223], v[52:55], v[108:111]
    ds_read_b64_tr_b16 a[242:243], v202 offset:17408
    v_cvt_pk_bf16_f32 v82, v84, v85
    v_mfma_f32_16x16x32_bf16 v[104:107], a[204:207], v[52:55], v[164:167]
    v_exp_f32_e64 v86, v86
    v_mfma_f32_16x16x32_bf16 v[104:107], a[200:203], v[36:39], v[104:107]
    ds_read_b64_tr_b16 a[244:245], v202 offset:18432
    ds_read_b64_tr_b16 a[246:247], v202 offset:19456
    v_mfma_f32_16x16x32_bf16 v[104:107], a[196:199], v[20:23], v[104:107]
    v_exp_f32_e64 v87, v87
    v_mfma_f32_16x16x32_bf16 v[104:107], a[192:195], v[4:7], v[104:107]
    ds_read_b64_tr_b16 a[248:249], v203 offset:16384
    v_cvt_pk_bf16_f32 v83, v86, v87
    v_mfma_f32_16x16x32_bf16 v[112:115], a[192:195], v[8:11], v[168:171]
    v_exp_f32_e64 v88, v88
    v_mfma_f32_16x16x32_bf16 v[112:115], a[196:199], v[24:27], v[112:115]
    ds_read_b64_tr_b16 a[250:251], v203 offset:17408
    ds_read_b64_tr_b16 a[252:253], v203 offset:18432
    v_mfma_f32_16x16x32_bf16 v[112:115], a[200:203], v[40:43], v[112:115]
    v_exp_f32_e64 v89, v89
    v_mfma_f32_16x16x32_bf16 v[112:115], a[204:207], v[56:59], v[112:115]
    ds_read_b64_tr_b16 a[254:255], v203 offset:19456
    v_cvt_pk_bf16_f32 v88, v88, v89
    v_mfma_f32_16x16x32_bf16 v[116:119], a[220:223], v[56:59], v[168:171]
    v_exp_f32_e64 v90, v90
    v_mfma_f32_16x16x32_bf16 v[116:119], a[216:219], v[40:43], v[116:119]
    s_add_u32 m0, s36, 0
    v_accvgpr_write_b32 a154, 0
    v_accvgpr_write_b32 a155, 0
    v_mfma_f32_16x16x32_bf16 v[116:119], a[212:215], v[24:27], v[116:119]
    v_exp_f32 v91, v91
    v_mfma_f32_16x16x32_bf16 v[116:119], a[208:211], v[8:11], v[116:119]
    v_cvt_pk_bf16_f32 v89, v90, v91
    v_accvgpr_write_b32 a156, 0
    v_mfma_f32_16x16x32_bf16 v[124:127], a[208:211], v[12:15], v[172:175]
    v_exp_f32_e64 v92, v92
    v_mfma_f32_16x16x32_bf16 v[124:127], a[212:215], v[28:31], v[124:127]
    buffer_load_dwordx4 v205, s[8:11], s37 offen offset:0 lds
    v_mfma_f32_16x16x32_bf16 v[124:127], a[216:219], v[44:47], v[124:127]
    v_exp_f32_e64 v93, v93
    v_mfma_f32_16x16x32_bf16 v[124:127], a[220:223], v[60:63], v[124:127]
    v_cvt_pk_bf16_f32 v90, v92, v93
    v_accvgpr_write_b32 a157, 0
    v_mfma_f32_16x16x32_bf16 v[120:123], a[204:207], v[60:63], v[172:175]
    v_exp_f32_e64 v94, v94
    v_mfma_f32_16x16x32_bf16 v[120:123], a[200:203], v[44:47], v[120:123]
    buffer_load_dwordx4 v205, s[8:11], s37 offen offset:1024 lds
    v_mfma_f32_16x16x32_bf16 v[120:123], a[196:199], v[28:31], v[120:123]
    v_exp_f32_e64 v95, v95
    v_mfma_f32_16x16x32_bf16 v[120:123], a[192:195], v[12:15], v[120:123]
    v_cvt_pk_bf16_f32 v91, v94, v95
    s_waitcnt lgkmcnt(0)
    v_mfma_f32_16x16x32_bf16 a[16:19], a[224:227], v[128:131], a[16:19]
    v_exp_f32 v96, v96
    v_mfma_f32_16x16x32_bf16 a[16:19], a[228:231], v[132:135], a[16:19]
    ds_read_b128 a[192:195], v192 offset:49152
    v_accvgpr_write_b32 a158, 0
    v_mfma_f32_16x16x32_bf16 a[20:23], a[236:239], v[132:135], a[20:23]
    v_exp_f32_e64 v97, v97
    v_mfma_f32_16x16x32_bf16 a[20:23], a[232:235], v[128:131], a[20:23]
    ds_read_b128 a[196:199], v193 offset:49152
    v_cvt_pk_bf16_f32 v68, v96, v97
    v_mfma_f32_16x16x32_bf16 a[24:27], a[240:243], v[128:131], a[24:27]
    v_exp_f32_e64 v98, v98
    v_mfma_f32_16x16x32_bf16 a[24:27], a[244:247], v[132:135], a[24:27]
    ds_read_b128 a[200:203], v194 offset:49152
    v_accvgpr_write_b32 a159, 0
    v_mfma_f32_16x16x32_bf16 a[28:31], a[252:255], v[132:135], a[28:31]
    v_exp_f32_e64 v99, v99
    v_mfma_f32_16x16x32_bf16 a[28:31], a[248:251], v[128:131], a[28:31]
    ds_read_b128 a[204:207], v195 offset:49152
    v_cvt_pk_bf16_f32 v69, v98, v99
    v_mfma_f32_16x16x32_bf16 a[60:63], a[248:251], v[136:139], a[60:63]
    v_exp_f32_e64 v100, v100
    v_mfma_f32_16x16x32_bf16 a[60:63], a[252:255], v[140:143], a[60:63]
    ds_read_b128 a[208:211], v192 offset:50176
    v_accvgpr_write_b32 a160, 0
    v_mfma_f32_16x16x32_bf16 a[56:59], a[244:247], v[140:143], a[56:59]
    v_exp_f32_e64 v101, v101
    v_mfma_f32_16x16x32_bf16 a[56:59], a[240:243], v[136:139], a[56:59]
    ds_read_b128 a[212:215], v193 offset:50176
    v_cvt_pk_bf16_f32 v70, v100, v101
    v_mfma_f32_16x16x32_bf16 a[52:55], a[232:235], v[136:139], a[52:55]
    v_exp_f32_e64 v102, v102
    v_mfma_f32_16x16x32_bf16 a[52:55], a[236:239], v[140:143], a[52:55]
    ds_read_b128 a[216:219], v194 offset:50176
    v_accvgpr_write_b32 a161, 0
    v_mfma_f32_16x16x32_bf16 a[48:51], a[228:231], v[140:143], a[48:51]
    v_exp_f32_e64 v103, v103
    v_mfma_f32_16x16x32_bf16 a[48:51], a[224:227], v[136:139], a[48:51]
    ds_read_b128 a[220:223], v195 offset:50176
    v_cvt_pk_bf16_f32 v71, v102, v103
    v_mfma_f32_16x16x32_bf16 a[80:83], a[224:227], v[144:147], a[80:83]
    v_exp_f32_e64 v104, v104
    v_mfma_f32_16x16x32_bf16 a[80:83], a[228:231], v[148:151], a[80:83]
    buffer_load_dwordx4 v205, s[8:11], s37 offen offset:2048 lds
    v_mfma_f32_16x16x32_bf16 a[84:87], a[236:239], v[148:151], a[84:87]
    v_exp_f32_e64 v105, v105
    v_mfma_f32_16x16x32_bf16 a[84:87], a[232:235], v[144:147], a[84:87]
    v_cvt_pk_bf16_f32 v76, v104, v105
    v_accvgpr_write_b32 a162, 0
    v_mfma_f32_16x16x32_bf16 a[88:91], a[240:243], v[144:147], a[88:91]
    v_exp_f32_e64 v106, v106
    v_mfma_f32_16x16x32_bf16 a[88:91], a[244:247], v[148:151], a[88:91]
    buffer_load_dwordx4 v205, s[8:11], s37 offen offset:3072 lds
    v_mfma_f32_16x16x32_bf16 a[92:95], a[252:255], v[148:151], a[92:95]
    v_exp_f32_e64 v107, v107
    v_mfma_f32_16x16x32_bf16 a[92:95], a[248:251], v[144:147], a[92:95]
    v_cvt_pk_bf16_f32 v77, v106, v107
    v_accvgpr_write_b32 a163, 0
L_hop6:
    s_cbranch_execz L_ret1
    v_mfma_f32_16x16x32_bf16 a[124:127], a[248:251], v[152:155], a[124:127]
    v_exp_f32 v108, v108
    v_mfma_f32_16x16x32_bf16 a[124:127], a[252:255], v[156:159], a[124:127]
    s_add_u32 m0, s35, 32768
    s_lshl_b32 s47, s49, 2
    s_add_u32 s47, s47, s33
    s_mul_i32 s47, s47, 2560
    s_add_u32 s47, s47, L_trip7-L_pc1
    v_lshrrev_b32 v250, 4, v206
    v_min_u32 v250, 19, v250
    v_mfma_f32_16x16x32_bf16 a[120:123], a[244:247], v[156:159], a[120:123]
    v_exp_f32_e64 v109, v109
    v_mfma_f32_16x16x32_bf16 a[120:123], a[240:243], v[152:155], a[120:123]
    v_cvt_pk_bf16_f32 v78, v108, v109
    v_accvgpr_write_b32 a164, 0
    v_mfma_f32_16x16x32_bf16 a[116:119], a[232:235], v[152:155], a[116:119]
    v_exp_f32_e64 v110, v110
    v_mfma_f32_16x16x32_bf16 a[116:119], a[236:239], v[156:159], a[116:119]
    s_getpc_b64 s[66:67]
L_pc1:
    v_lshl_add_u32 v250, v250, 7, s47
    v_min_u32 v250, L_codeend-L_pc1-4, v250
    v_mfma_f32_16x16x32_bf16 a[112:115], a[228:231], v[156:159], a[112:115]
    v_exp_f32 v111, v111
    v_mfma_f32_16x16x32_bf16 a[112:115], a[224:227], v[152:155], a[112:115]
    v_cvt_pk_bf16_f32 v79, v110, v111
    s_waitcnt lgkmcnt(0)
    v_mfma_f32_16x16x32_bf16 v[128:131], a[192:195], v[0:3], v[160:163]
    ds_read_b64_tr_b16 a[224:225], v196 offset:32768
    ds_read_b64_tr_b16 a[226:227], v196 offset:33792
    v_mfma_f32_16x16x32_bf16 v[128:131], a[196:199], v[16:19], v[128:131]
    v_exp_f32 v112, v112
    v_mfma_f32_16x16x32_bf16 v[128:131], a[200:203], v[32:35], v[128:131]
    ds_read_b64_tr_b16 a[228:229], v196 offset:34816
    ds_read_b64_tr_b16 a[230:231], v196 offset:35840
    v_mfma_f32_16x16x32_bf16 v[128:131], a[204:207], v[48:51], v[128:131]
    v_exp_f32_e64 v113, v113
    v_mfma_f32_16x16x32_bf16 v[132:135], a[220:223], v[48:51], v[160:163]
    ds_read_b64_tr_b16 a[232:233], v197 offset:32768
    v_cvt_pk_bf16_f32 v84, v112, v113
    v_mfma_f32_16x16x32_bf16 v[132:135], a[216:219], v[32:35], v[132:135]
    ds_read_b64_tr_b16 a[234:235], v197 offset:33792
    ds_read_b64_tr_b16 a[236:237], v197 offset:34816
    v_mfma_f32_16x16x32_bf16 v[132:135], a[212:215], v[16:19], v[132:135]
    v_exp_f32_e64 v114, v114
    v_mfma_f32_16x16x32_bf16 v[132:135], a[208:211], v[0:3], v[132:135]
    ds_read_b64_tr_b16 a[238:239], v197 offset:35840
    ds_read_b64_tr_b16 a[240:241], v198 offset:32768
    v_mfma_f32_16x16x32_bf16 v[140:143], a[208:211], v[4:7], v[164:167]
    v_exp_f32_e64 v115, v115
    v_mfma_f32_16x16x32_bf16 v[140:143], a[212:215], v[20:23], v[140:143]
    ds_read_b64_tr_b16 a[242:243], v198 offset:33792
    v_cvt_pk_bf16_f32 v85, v114, v115
    v_mfma_f32_16x16x32_bf16 v[140:143], a[216:219], v[36:39], v[140:143]
    v_exp_f32_e64 v116, v116
    v_mfma_f32_16x16x32_bf16 v[140:143], a[220:223], v[52:55], v[140:143]
    ds_read_b64_tr_b16 a[244:245], v198 offset:34816
    ds_read_b64_tr_b16 a[246:247], v198 offset:35840
    v_mfma_f32_16x16x32_bf16 v[136:139], a[204:207], v[52:55], v[164:167]
    v_exp_f32_e64 v117, v117
    v_mfma_f32_16x16x32_bf16 v[136:139], a[200:203], v[36:39], v[136:139]
    ds_read_b64_tr_b16 a[248:249], v199 offset:32768
    v_cvt_pk_bf16_f32 v86, v116, v117
    v_mfma_f32_16x16x32_bf16 v[136:139], a[196:199], v[20:23], v[136:139]
    v_exp_f32_e64 v118, v118
    v_mfma_f32_16x16x32_bf16 v[136:139], a[192:195], v[4:7], v[136:139]
    ds_read_b64_tr_b16 a[250:251], v199 offset:33792
    ds_read_b64_tr_b16 a[252:253], v199 offset:34816
    v_smfmac_f32_16x16x64_bf16 a[128:131], v[208:211], v[64:71], v207
    v_exp_f32_e64 v119, v119
    v_smfmac_f32_16x16x64_bf16 a[132:135], v[208:211], v[72:79], v207
    ds_read_b64_tr_b16 a[254:255], v199 offset:35840
    v_cvt_pk_bf16_f32 v87, v118, v119
    v_mfma_f32_16x16x32_bf16 v[144:147], a[192:195], v[8:11], v[168:171]
    v_exp_f32_e64 v120, v120
    v_mfma_f32_16x16x32_bf16 v[144:147], a[196:199], v[24:27], v[144:147]
    v_accvgpr_write_b32 a165, 0
    v_accvgpr_write_b32 a166, 0
    v_mfma_f32_16x16x32_bf16 v[144:147], a[200:203], v[40:43], v[144:147]
    v_exp_f32_e64 v121, v121
    v_mfma_f32_16x16x32_bf16 v[144:147], a[204:207], v[56:59], v[144:147]
    v_cvt_pk_bf16_f32 v92, v120, v121
    v_accvgpr_write_b32 a167, 0
    v_mfma_f32_16x16x32_bf16 v[148:151], a[220:223], v[56:59], v[168:171]
    v_exp_f32_e64 v122, v122
    v_mfma_f32_16x16x32_bf16 v[148:151], a[216:219], v[40:43], v[148:151]
    buffer_load_dwordx4 v204, s[4:7], s37 offen offset:0 lds
    v_mfma_f32_16x16x32_bf16 v[148:151], a[212:215], v[24:27], v[148:151]
    v_exp_f32_e64 v123, v123
    v_mfma_f32_16x16x32_bf16 v[148:151], a[208:211], v[8:11], v[148:151]
    v_cvt_pk_bf16_f32 v93, v122, v123
    v_accvgpr_write_b32 a168, 0
    v_mfma_f32_16x16x32_bf16 v[156:159], a[208:211], v[12:15], v[172:175]
    v_exp_f32_e64 v124, v124
    v_mfma_f32_16x16x32_bf16 v[156:159], a[212:215], v[28:31], v[156:159]
    buffer_load_dwordx4 v204, s[4:7], s37 offen offset:1024 lds
    v_mfma_f32_16x16x32_bf16 v[156:159], a[216:219], v[44:47], v[156:159]
    v_exp_f32_e64 v125, v125
    v_mfma_f32_16x16x32_bf16 v[156:159], a[220:223], v[60:63], v[156:159]
    v_cvt_pk_bf16_f32 v94, v124, v125
    v_accvgpr_write_b32 a169, 0
    v_mfma_f32_16x16x32_bf16 v[152:155], a[204:207], v[60:63], v[172:175]
    v_exp_f32_e64 v126, v126
    v_mfma_f32_16x16x32_bf16 v[152:155], a[200:203], v[44:47], v[152:155]
    v_accvgpr_write_b32 a170, 0
    v_accvgpr_write_b32 a171, 0
    v_mfma_f32_16x16x32_bf16 v[152:155], a[196:199], v[28:31], v[152:155]
    v_exp_f32_e64 v127, v127
    v_mfma_f32_16x16x32_bf16 v[152:155], a[192:195], v[12:15], v[152:155]
    v_cvt_pk_bf16_f32 v95, v126, v127
    s_waitcnt lgkmcnt(0)
    v_mfma_f32_16x16x32_bf16 a[0:3], a[224:227], v[64:67], a[0:3]
    v_exp_f32 v128, v128
    v_mfma_f32_16x16x32_bf16 a[0:3], a[228:231], v[68:71], a[0:3]
    ds_read_b128 a[192:195], v192 offset:51200
    v_accvgpr_write_b32 a172, 0
    v_mfma_f32_16x16x32_bf16 a[4:7], a[236:239], v[68:71], a[4:7]
    v_exp_f32_e64 v129, v129
    v_mfma_f32_16x16x32_bf16 a[4:7], a[232:235], v[64:67], a[4:7]
    ds_read_b128 a[196:199], v193 offset:51200
    v_cvt_pk_bf16_f32 v128, v128, v129
    v_mfma_f32_16x16x32_bf16 a[8:11], a[240:243], v[64:67], a[8:11]
    v_exp_f32_e64 v130, v130
    v_mfma_f32_16x16x32_bf16 a[8:11], a[244:247], v[68:71], a[8:11]
    ds_read_b128 a[200:203], v194 offset:51200
    v_accvgpr_write_b32 a173, 0
    v_mfma_f32_16x16x32_bf16 a[12:15], a[252:255], v[68:71], a[12:15]
    v_exp_f32_e64 v131, v131
    v_mfma_f32_16x16x32_bf16 a[12:15], a[248:251], v[64:67], a[12:15]
    ds_read_b128 a[204:207], v195 offset:51200
    v_cvt_pk_bf16_f32 v129, v130, v131
    v_mfma_f32_16x16x32_bf16 a[44:47], a[248:251], v[72:75], a[44:47]
    v_exp_f32_e64 v132, v132
    v_mfma_f32_16x16x32_bf16 a[44:47], a[252:255], v[76:79], a[44:47]
    ds_read_b128 a[208:211], v192 offset:52224
    v_accvgpr_write_b32 a174, 0
    v_mfma_f32_16x16x32_bf16 a[40:43], a[244:247], v[76:79], a[40:43]
    v_exp_f32_e64 v133, v133
    v_mfma_f32_16x16x32_bf16 a[40:43], a[240:243], v[72:75], a[40:43]
    ds_read_b128 a[212:215], v193 offset:52224
    v_cvt_pk_bf16_f32 v130, v132, v133
    v_mfma_f32_16x16x32_bf16 a[36:39], a[232:235], v[72:75], a[36:39]
    v_exp_f32_e64 v134, v134
    v_mfma_f32_16x16x32_bf16 a[36:39], a[236:239], v[76:79], a[36:39]
    ds_read_b128 a[216:219], v194 offset:52224
    v_accvgpr_write_b32 a175, 0
    v_mfma_f32_16x16x32_bf16 a[32:35], a[228:231], v[76:79], a[32:35]
    v_exp_f32_e64 v135, v135
    v_mfma_f32_16x16x32_bf16 a[32:35], a[224:227], v[72:75], a[32:35]
    ds_read_b128 a[220:223], v195 offset:52224
    v_cvt_pk_bf16_f32 v131, v134, v135
    v_smfmac_f32_16x16x64_bf16 a[136:139], v[208:211], v[80:87], v207
    v_exp_f32_e64 v136, v136
    v_smfmac_f32_16x16x64_bf16 a[140:143], v[208:211], v[88:95], v207
    buffer_load_dwordx4 v204, s[4:7], s37 offen offset:2048 lds
    v_mfma_f32_16x16x32_bf16 a[64:67], a[224:227], v[80:83], a[64:67]
    v_exp_f32_e64 v137, v137
    v_mfma_f32_16x16x32_bf16 a[64:67], a[228:231], v[84:87], a[64:67]
    v_cvt_pk_bf16_f32 v136, v136, v137
    v_mfma_f32_16x16x32_bf16 a[68:71], a[236:239], v[84:87], a[68:71]
    v_exp_f32_e64 v138, v138
    v_mfma_f32_16x16x32_bf16 a[68:71], a[232:235], v[80:83], a[68:71]
    buffer_load_dwordx4 v204, s[4:7], s37 offen offset:3072 lds
    v_mfma_f32_16x16x32_bf16 a[72:75], a[240:243], v[80:83], a[72:75]
    v_exp_f32_e64 v139, v139
    v_mfma_f32_16x16x32_bf16 a[72:75], a[244:247], v[84:87], a[72:75]
    v_cvt_pk_bf16_f32 v137, v138, v139
    v_mfma_f32_16x16x32_bf16 a[76:79], a[252:255], v[84:87], a[76:79]
    v_exp_f32_e64 v140, v140
    v_mfma_f32_16x16x32_bf16 a[76:79], a[248:251], v[80:83], a[76:79]
    s_add_u32 s37, s37, 16384
    v_mfma_f32_16x16x32_bf16 a[108:111], a[248:251], v[88:91], a[108:111]
    v_exp_f32_e64 v141, v141
    v_mfma_f32_16x16x32_bf16 a[108:111], a[252:255], v[92:95], a[108:111]
    v_cvt_pk_bf16_f32 v138, v140, v141
    v_mfma_f32_16x16x32_bf16 a[104:107], a[244:247], v[92:95], a[104:107]
    v_exp_f32_e64 v142, v142
    v_mfma_f32_16x16x32_bf16 a[104:107], a[240:243], v[88:91], a[104:107]
    v_mfma_f32_16x16x32_bf16 a[100:103], a[232:235], v[88:91], a[100:103]
    v_exp_f32_e64 v143, v143
    v_mfma_f32_16x16x32_bf16 a[100:103], a[236:239], v[92:95], a[100:103]
    v_cvt_pk_bf16_f32 v139, v142, v143
    v_mfma_f32_16x16x32_bf16 a[96:99], a[228:231], v[92:95], a[96:99]
    v_exp_f32_e64 v144, v144
    v_mfma_f32_16x16x32_bf16 a[96:99], a[224:227], v[88:91], a[96:99]
    s_waitcnt vmcnt(12) lgkmcnt(0)
    v_mfma_f32_16x16x32_bf16 v[96:99], a[192:195], v[0:3], v[160:163]
    s_barrier
    ds_read_b64_tr_b16 a[224:225], v200 offset:32768
    v_mfma_f32_16x16x32_bf16 v[96:99], a[196:199], v[16:19], v[96:99]
    v_exp_f32_e64 v145, v145
    v_mfma_f32_16x16x32_bf16 v[96:99], a[200:203], v[32:35], v[96:99]
    ds_read_b64_tr_b16 a[226:227], v200 offset:33792
    v_cvt_pk_bf16_f32 v144, v144, v145
    v_mfma_f32_16x16x32_bf16 v[96:99], a[204:207], v[48:51], v[96:99]
    ds_read_b64_tr_b16 a[228:229], v200 offset:34816
    ds_read_b64_tr_b16 a[230:231], v200 offset:35840
    v_mfma_f32_16x16x32_bf16 v[100:103], a[220:223], v[48:51], v[160:163]
    v_exp_f32_e64 v146, v146
    v_mfma_f32_16x16x32_bf16 v[100:103], a[216:219], v[32:35], v[100:103]
    ds_read_b64_tr_b16 a[232:233], v201 offset:32768
    ds_read_b64_tr_b16 a[234:235], v201 offset:33792
    v_mfma_f32_16x16x32_bf16 v[100:103], a[212:215], v[16:19], v[100:103]
    v_exp_f32_e64 v147, v147
    v_mfma_f32_16x16x32_bf16 v[100:103], a[208:211], v[0:3], v[100:103]
    ds_read_b64_tr_b16 a[236:237], v201 offset:34816
    v_cvt_pk_bf16_f32 v145, v146, v147
    v_mfma_f32_16x16x32_bf16 v[108:111], a[208:211], v[4:7], v[164:167]
    v_exp_f32_e64 v148, v148
    v_mfma_f32_16x16x32_bf16 v[108:111], a[212:215], v[20:23], v[108:111]
    ds_read_b64_tr_b16 a[238:239], v201 offset:35840
    ds_read_b64_tr_b16 a[240:241], v202 offset:32768
    v_mfma_f32_16x16x32_bf16 v[108:111], a[216:219], v[36:39], v[108:111]
    v_exp_f32_e64 v149, v149
    v_mfma_f32_16x16x32_bf16 v[108:111], a[220:223], v[52:55], v[108:111]
    ds_read_b64_tr_b16 a[242:243], v202 offset:33792
    v_cvt_pk_bf16_f32 v146, v148, v149
    v_mfma_f32_16x16x32_bf16 v[104:107], a[204:207], v[52:55], v[164:167]
    v_exp_f32_e64 v150, v150
    v_mfma_f32_16x16x32_bf16 v[104:107], a[200:203], v[36:39], v[104:107]
    ds_read_b64_tr_b16 a[244:245], v202 offset:34816
    ds_read_b64_tr_b16 a[246:247], v202 offset:35840
    v_mfma_f32_16x16x32_bf16 v[104:107], a[196:199], v[20:23], v[104:107]
    v_exp_f32_e64 v151, v151
    v_mfma_f32_16x16x32_bf16 v[104:107], a[192:195], v[4:7], v[104:107]
    ds_read_b64_tr_b16 a[248:249], v203 offset:32768
    v_cvt_pk_bf16_f32 v147, v150, v151
    v_mfma_f32_16x16x32_bf16 v[112:115], a[192:195], v[8:11], v[168:171]
    v_exp_f32_e64 v152, v152
    v_mfma_f32_16x16x32_bf16 v[112:115], a[196:199], v[24:27], v[112:115]
    ds_read_b64_tr_b16 a[250:251], v203 offset:33792
    ds_read_b64_tr_b16 a[252:253], v203 offset:34816
    v_mfma_f32_16x16x32_bf16 v[112:115], a[200:203], v[40:43], v[112:115]
    v_exp_f32_e64 v153, v153
    v_mfma_f32_16x16x32_bf16 v[112:115], a[204:207], v[56:59], v[112:115]
    ds_read_b64_tr_b16 a[254:255], v203 offset:35840
    v_cvt_pk_bf16_f32 v152, v152, v153
    v_mfma_f32_16x16x32_bf16 v[116:119], a[220:223], v[56:59], v[168:171]
    v_exp_f32_e64 v154, v154
    v_mfma_f32_16x16x32_bf16 v[116:119], a[216:219], v[40:43], v[116:119]
    s_add_u32 m0, s36, 16384
    v_mfma_f32_16x16x32_bf16 v[116:119], a[212:215], v[24:27], v[116:119]
    v_exp_f32_e64 v155, v155
    v_mfma_f32_16x16x32_bf16 v[116:119], a[208:211], v[8:11], v[116:119]
    v_cvt_pk_bf16_f32 v153, v154, v155
    v_mfma_f32_16x16x32_bf16 v[124:127], a[208:211], v[12:15], v[172:175]
    v_exp_f32_e64 v156, v156
    v_mfma_f32_16x16x32_bf16 v[124:127], a[212:215], v[28:31], v[124:127]
    buffer_load_dwordx4 v205, s[8:11], s37 offen offset:0 lds
    v_mfma_f32_16x16x32_bf16 v[124:127], a[216:219], v[44:47], v[124:127]
    v_exp_f32_e64 v157, v157
    v_mfma_f32_16x16x32_bf16 v[124:127], a[220:223], v[60:63], v[124:127]
    v_cvt_pk_bf16_f32 v154, v156, v157
    v_mfma_f32_16x16x32_bf16 v[120:123], a[204:207], v[60:63], v[172:175]
    v_exp_f32_e64 v158, v158
    v_mfma_f32_16x16x32_bf16 v[120:123], a[200:203], v[44:47], v[120:123]
    buffer_load_dwordx4 v205, s[8:11], s37 offen offset:1024 lds
    v_mfma_f32_16x16x32_bf16 v[120:123], a[196:199], v[28:31], v[120:123]
    v_exp_f32_e64 v159, v159
    v_mfma_f32_16x16x32_bf16 v[120:123], a[192:195], v[12:15], v[120:123]
    v_cvt_pk_bf16_f32 v155, v158, v159
    s_waitcnt lgkmcnt(0)
    v_mfma_f32_16x16x32_bf16 a[16:19], a[224:227], v[64:67], a[16:19]
    v_exp_f32 v96, v96
    v_mfma_f32_16x16x32_bf16 a[16:19], a[228:231], v[68:71], a[16:19]
    ds_read_b128 a[192:195], v192 offset:0
    v_mfma_f32_16x16x32_bf16 a[20:23], a[236:239], v[68:71], a[20:23]
    v_exp_f32_e64 v97, v97
    v_mfma_f32_16x16x32_bf16 a[20:23], a[232:235], v[64:67], a[20:23]
    ds_read_b128 a[196:199], v193 offset:0
    v_cvt_pk_bf16_f32 v132, v96, v97
    v_mfma_f32_16x16x32_bf16 a[24:27], a[240:243], v[64:67], a[24:27]
    v_exp_f32_e64 v98, v98
    v_mfma_f32_16x16x32_bf16 a[24:27], a[244:247], v[68:71], a[24:27]
    ds_read_b128 a[200:203], v194 offset:0
    v_mfma_f32_16x16x32_bf16 a[28:31], a[252:255], v[68:71], a[28:31]
    v_exp_f32_e64 v99, v99
    v_mfma_f32_16x16x32_bf16 a[28:31], a[248:251], v[64:67], a[28:31]
    ds_read_b128 a[204:207], v195 offset:0
    v_cvt_pk_bf16_f32 v133, v98, v99
    v_mfma_f32_16x16x32_bf16 a[60:63], a[248:251], v[72:75], a[60:63]
    v_exp_f32_e64 v100, v100
    v_mfma_f32_16x16x32_bf16 a[60:63], a[252:255], v[76:79], a[60:63]
    ds_read_b128 a[208:211], v192 offset:1024
    v_mfma_f32_16x16x32_bf16 a[56:59], a[244:247], v[76:79], a[56:59]
    v_exp_f32_e64 v101, v101
    v_mfma_f32_16x16x32_bf16 a[56:59], a[240:243], v[72:75], a[56:59]
    ds_read_b128 a[212:215], v193 offset:1024
    v_cvt_pk_bf16_f32 v134, v100, v101
    v_mfma_f32_16x16x32_bf16 a[52:55], a[232:235], v[72:75], a[52:55]
    v_exp_f32_e64 v102, v102
    v_mfma_f32_16x16x32_bf16 a[52:55], a[236:239], v[76:79], a[52:55]
    ds_read_b128 a[216:219], v194 offset:1024
    v_mfma_f32_16x16x32_bf16 a[48:51], a[228:231], v[76:79], a[48:51]
    v_exp_f32_e64 v103, v103
    v_mfma_f32_16x16x32_bf16 a[48:51], a[224:227], v[72:75], a[48:51]
    ds_read_b128 a[220:223], v195 offset:1024
    v_cvt_pk_bf16_f32 v135, v102, v103
    v_mfma_f32_16x16x32_bf16 a[80:83], a[224:227], v[80:83], a[80:83]
    v_exp_f32_e64 v104, v104
    v_mfma_f32_16x16x32_bf16 a[80:83], a[228:231], v[84:87], a[80:83]
    buffer_load_dwordx4 v205, s[8:11], s37 offen offset:2048 lds
    v_mfma_f32_16x16x32_bf16 a[84:87], a[236:239], v[84:87], a[84:87]
    v_exp_f32_e64 v105, v105
    v_mfma_f32_16x16x32_bf16 a[84:87], a[232:235], v[80:83], a[84:87]
    v_cvt_pk_bf16_f32 v140, v104, v105
    v_mfma_f32_16x16x32_bf16 a[88:91], a[240:243], v[80:83], a[88:91]
    v_exp_f32_e64 v106, v106
    v_mfma_f32_16x16x32_bf16 a[88:91], a[244:247], v[84:87], a[88:91]
    buffer_load_dwordx4 v205, s[8:11], s37 offen offset:3072 lds
    v_mfma_f32_16x16x32_bf16 a[92:95], a[252:255], v[84:87], a[92:95]
    v_exp_f32_e64 v107, v107
    v_mfma_f32_16x16x32_bf16 a[92:95], a[248:251], v[80:83], a[92:95]
    v_cvt_pk_bf16_f32 v141, v106, v107
    v_mfma_f32_16x16x32_bf16 a[124:127], a[248:251], v[88:91], a[124:127]
    v_exp_f32_e64 v108, v108
    v_mfma_f32_16x16x32_bf16 a[124:127], a[252:255], v[92:95], a[124:127]
    s_add_u32 m0, s35, 49152
    s_mov_b32 s28, s74
    s_mov_b32 s29, s75
    s_mov_b32 s30, 256
    v_mfma_f32_16x16x32_bf16 a[120:123], a[244:247], v[92:95], a[120:123]
    v_exp_f32_e64 v109, v109
    v_mfma_f32_16x16x32_bf16 a[120:123], a[240:243], v[88:91], a[120:123]
    v_cvt_pk_bf16_f32 v142, v108, v109
    v_mfma_f32_16x16x32_bf16 a[116:119], a[232:235], v[88:91], a[116:119]
    v_exp_f32_e64 v110, v110
    v_mfma_f32_16x16x32_bf16 a[116:119], a[236:239], v[92:95], a[116:119]
    buffer_load_dword v249, v248, s[28:31], 0 offen sc1
    v_mfma_f32_16x16x32_bf16 a[112:115], a[228:231], v[92:95], a[112:115]
    v_exp_f32_e64 v111, v111
    v_mfma_f32_16x16x32_bf16 a[112:115], a[224:227], v[88:91], a[112:115]
    v_cvt_pk_bf16_f32 v143, v110, v111
    s_waitcnt lgkmcnt(0)
    v_mfma_f32_16x16x32_bf16 v[64:67], a[192:195], v[0:3], v[160:163]
    ds_read_b64_tr_b16 a[224:225], v196 offset:49152
    ds_read_b64_tr_b16 a[226:227], v196 offset:50176
    v_mfma_f32_16x16x32_bf16 v[64:67], a[196:199], v[16:19], v[64:67]
    v_exp_f32 v112, v112
    v_mfma_f32_16x16x32_bf16 v[64:67], a[200:203], v[32:35], v[64:67]
    ds_read_b64_tr_b16 a[228:229], v196 offset:51200
    ds_read_b64_tr_b16 a[230:231], v196 offset:52224
    v_mfma_f32_16x16x32_bf16 v[64:67], a[204:207], v[48:51], v[64:67]
    v_exp_f32_e64 v113, v113
    v_mfma_f32_16x16x32_bf16 v[68:71], a[220:223], v[48:51], v[160:163]
    ds_read_b64_tr_b16 a[232:233], v197 offset:49152
    v_cvt_pk_bf16_f32 v148, v112, v113
    v_mfma_f32_16x16x32_bf16 v[68:71], a[216:219], v[32:35], v[68:71]
    ds_read_b64_tr_b16 a[234:235], v197 offset:50176
    ds_read_b64_tr_b16 a[236:237], v197 offset:51200
    v_mfma_f32_16x16x32_bf16 v[68:71], a[212:215], v[16:19], v[68:71]
    v_exp_f32_e64 v114, v114
    v_mfma_f32_16x16x32_bf16 v[68:71], a[208:211], v[0:3], v[68:71]
    ds_read_b64_tr_b16 a[238:239], v197 offset:52224
    ds_read_b64_tr_b16 a[240:241], v198 offset:49152
    v_mfma_f32_16x16x32_bf16 v[76:79], a[208:211], v[4:7], v[164:167]
    v_exp_f32_e64 v115, v115
    v_mfma_f32_16x16x32_bf16 v[76:79], a[212:215], v[20:23], v[76:79]
    ds_read_b64_tr_b16 a[242:243], v198 offset:50176
    v_cvt_pk_bf16_f32 v149, v114, v115
    v_mfma_f32_16x16x32_bf16 v[76:79], a[216:219], v[36:39], v[76:79]
    v_exp_f32_e64 v116, v116
    v_mfma_f32_16x16x32_bf16 v[76:79], a[220:223], v[52:55], v[76:79]
    ds_read_b64_tr_b16 a[244:245], v198 offset:51200
    ds_read_b64_tr_b16 a[246:247], v198 offset:52224
    v_mfma_f32_16x16x32_bf16 v[72:75], a[204:207], v[52:55], v[164:167]
    v_exp_f32_e64 v117, v117
    v_mfma_f32_16x16x32_bf16 v[72:75], a[200:203], v[36:39], v[72:75]
    ds_read_b64_tr_b16 a[248:249], v199 offset:49152
    v_cvt_pk_bf16_f32 v150, v116, v117
    v_mfma_f32_16x16x32_bf16 v[72:75], a[196:199], v[20:23], v[72:75]
    v_exp_f32_e64 v118, v118
    v_mfma_f32_16x16x32_bf16 v[72:75], a[192:195], v[4:7], v[72:75]
    ds_read_b64_tr_b16 a[250:251], v199 offset:50176
    ds_read_b64_tr_b16 a[252:253], v199 offset:51200
    v_smfmac_f32_16x16x64_bf16 a[128:131], v[208:211], v[128:135], v207
    v_exp_f32_e64 v119, v119
    v_smfmac_f32_16x16x64_bf16 a[132:135], v[208:211], v[136:143], v207
    ds_read_b64_tr_b16 a[254:255], v199 offset:52224
    v_cvt_pk_bf16_f32 v151, v118, v119
    v_mfma_f32_16x16x32_bf16 v[80:83], a[192:195], v[8:11], v[168:171]
    v_exp_f32_e64 v120, v120
    v_mfma_f32_16x16x32_bf16 v[80:83], a[196:199], v[24:27], v[80:83]
    v_mfma_f32_16x16x32_bf16 v[80:83], a[200:203], v[40:43], v[80:83]
    v_exp_f32_e64 v121, v121
    v_mfma_f32_16x16x32_bf16 v[80:83], a[204:207], v[56:59], v[80:83]
    v_cvt_pk_bf16_f32 v156, v120, v121
    v_mfma_f32_16x16x32_bf16 v[84:87], a[220:223], v[56:59], v[168:171]
    v_exp_f32_e64 v122, v122
    v_mfma_f32_16x16x32_bf16 v[84:87], a[216:219], v[40:43], v[84:87]
    buffer_load_dwordx4 v204, s[4:7], s37 offen offset:0 lds
    v_mfma_f32_16x16x32_bf16 v[84:87], a[212:215], v[24:27], v[84:87]
    v_exp_f32_e64 v123, v123
    v_mfma_f32_16x16x32_bf16 v[84:87], a[208:211], v[8:11], v[84:87]
    v_cvt_pk_bf16_f32 v157, v122, v123
    v_mfma_f32_16x16x32_bf16 v[92:95], a[208:211], v[12:15], v[172:175]
    v_exp_f32_e64 v124, v124
    v_mfma_f32_16x16x32_bf16 v[92:95], a[212:215], v[28:31], v[92:95]
    buffer_load_dwordx4 v204, s[4:7], s37 offen offset:1024 lds
    v_mfma_f32_16x16x32_bf16 v[92:95], a[216:219], v[44:47], v[92:95]
    v_exp_f32_e64 v125, v125
    v_mfma_f32_16x16x32_bf16 v[92:95], a[220:223], v[60:63], v[92:95]
    v_cvt_pk_bf16_f32 v158, v124, v125
    s_waitcnt vmcnt(2)
    v_cmp_gt_u32 vcc, 32, v249
    v_mfma_f32_16x16x32_bf16 v[88:91], a[204:207], v[60:63], v[172:175]
    v_exp_f32_e64 v126, v126
    v_mfma_f32_16x16x32_bf16 v[88:91], a[200:203], v[44:47], v[88:91]
    s_cbranch_vccnz L_wait1
L_go1:
    v_mfma_f32_16x16x32_bf16 v[88:91], a[196:199], v[28:31], v[88:91]
    v_exp_f32 v127, v127
    v_mfma_f32_16x16x32_bf16 v[88:91], a[192:195], v[12:15], v[88:91]
    v_cvt_pk_bf16_f32 v159, v126, v127
    s_waitcnt lgkmcnt(0)
    v_mfma_f32_16x16x32_bf16 a[0:3], a[224:227], v[128:131], a[0:3]
    v_exp_f32 v64, v64
    v_mfma_f32_16x16x32_bf16 a[0:3], a[228:231], v[132:135], a[0:3]
    ds_read_b128 a[192:195], v192 offset:2048
    buffer_load_dwordx4 v[228:231], v206, s[12:15], s45 offen offset:0 sc1
    v_mfma_f32_16x16x32_bf16 a[4:7], a[236:239], v[132:135], a[4:7]
    v_exp_f32_e64 v65, v65
    v_mfma_f32_16x16x32_bf16 a[4:7], a[232:235], v[128:131], a[4:7]
    ds_read_b128 a[196:199], v193 offset:2048
    v_cvt_pk_bf16_f32 v64, v64, v65
    v_mfma_f32_16x16x32_bf16 a[8:11], a[240:243], v[128:131], a[8:11]
    v_exp_f32_e64 v66, v66
    v_mfma_f32_16x16x32_bf16 a[8:11], a[244:247], v[132:135], a[8:11]
    ds_read_b128 a[200:203], v194 offset:2048
    buffer_load_dwordx4 v[232:235], v206, s[12:15], s45 offen offset:1024 sc1
    v_mfma_f32_16x16x32_bf16 a[12:15], a[252:255], v[132:135], a[12:15]
    v_exp_f32_e64 v67, v67
    v_mfma_f32_16x16x32_bf16 a[12:15], a[248:251], v[128:131], a[12:15]
    ds_read_b128 a[204:207], v195 offset:2048
    v_cvt_pk_bf16_f32 v65, v66, v67
    v_mfma_f32_16x16x32_bf16 a[44:47], a[248:251], v[136:139], a[44:47]
    v_exp_f32_e64 v68, v68
    v_mfma_f32_16x16x32_bf16 a[44:47], a[252:255], v[140:143], a[44:47]
    ds_read_b128 a[208:211], v192 offset:3072
    buffer_load_dwordx4 v[236:239], v206, s[12:15], s45 offen offset:2048 sc1
    v_mfma_f32_16x16x32_bf16 a[40:43], a[244:247], v[140:143], a[40:43]
    v_exp_f32_e64 v69, v69
    v_mfma_f32_16x16x32_bf16 a[40:43], a[240:243], v[136:139], a[40:43]
    ds_read_b128 a[212:215], v193 offset:3072
    v_cvt_pk_bf16_f32 v66, v68, v69
    v_mfma_f32_16x16x32_bf16 a[36:39], a[232:235], v[136:139], a[36:39]
    v_exp_f32_e64 v70, v70
    v_mfma_f32_16x16x32_bf16 a[36:39], a[236:239], v[140:143], a[36:39]
    ds_read_b128 a[216:219], v194 offset:3072
    buffer_load_dwordx4 v[240:243], v206, s[12:15], s45 offen offset:3072 sc1
    v_mfma_f32_16x16x32_bf16 a[32:35], a[228:231], v[140:143], a[32:35]
    v_exp_f32_e64 v71, v71
    v_mfma_f32_16x16x32_bf16 a[32:35], a[224:227], v[136:139], a[32:35]
    ds_read_b128 a[220:223], v195 offset:3072
    v_cvt_pk_bf16_f32 v67, v70, v71
    v_smfmac_f32_16x16x64_bf16 a[136:139], v[208:211], v[144:151], v207
    v_exp_f32_e64 v72, v72
    v_smfmac_f32_16x16x64_bf16 a[140:143], v[208:211], v[152:159], v207
    buffer_load_dwordx4 v204, s[4:7], s37 offen offset:2048 lds
    v_mfma_f32_16x16x32_bf16 a[64:67], a[224:227], v[144:147], a[64:67]
    v_exp_f32_e64 v73, v73
    v_mfma_f32_16x16x32_bf16 a[64:67], a[228:231], v[148:151], a[64:67]
    v_cvt_pk_bf16_f32 v72, v72, v73
    buffer_load_dwordx4 v[212:215], v206, s[12:15], s44 offen offset:0 sc1
    v_mfma_f32_16x16x32_bf16 a[68:71], a[236:239], v[148:151], a[68:71]
    v_exp_f32_e64 v74, v74
    v_mfma_f32_16x16x32_bf16 a[68:71], a[232:235], v[144:147], a[68:71]
    buffer_load_dwordx4 v204, s[4:7], s37 offen offset:3072 lds
    v_mfma_f32_16x16x32_bf16 a[72:75], a[240:243], v[144:147], a[72:75]
    v_exp_f32_e64 v75, v75
    v_mfma_f32_16x16x32_bf16 a[72:75], a[244:247], v[148:151], a[72:75]
    v_cvt_pk_bf16_f32 v73, v74, v75
    v_mfma_f32_16x16x32_bf16 a[76:79], a[252:255], v[148:151], a[76:79]
    v_exp_f32_e64 v76, v76
    v_mfma_f32_16x16x32_bf16 a[76:79], a[248:251], v[144:147], a[76:79]
    s_add_u32 s37, s37, 16384
    buffer_load_dwordx4 v[216:219], v206, s[12:15], s44 offen offset:1024 sc1
    v_mfma_f32_16x16x32_bf16 a[108:111], a[248:251], v[152:155], a[108:111]
    v_exp_f32_e64 v77, v77
    v_mfma_f32_16x16x32_bf16 a[108:111], a[252:255], v[156:159], a[108:111]
    v_cvt_pk_bf16_f32 v74, v76, v77
    v_mfma_f32_16x16x32_bf16 a[104:107], a[244:247], v[156:159], a[104:107]
    v_exp_f32_e64 v78, v78
    v_mfma_f32_16x16x32_bf16 a[104:107], a[240:243], v[152:155], a[104:107]
    buffer_load_dwordx4 v[220:223], v206, s[12:15], s44 offen offset:2048 sc1
    v_mfma_f32_16x16x32_bf16 a[100:103], a[232:235], v[152:155], a[100:103]
    v_exp_f32_e64 v79, v79
    v_mfma_f32_16x16x32_bf16 a[100:103], a[236:239], v[156:159], a[100:103]
    v_cvt_pk_bf16_f32 v75, v78, v79
    v_mfma_f32_16x16x32_bf16 a[96:99], a[228:231], v[156:159], a[96:99]
    v_exp_f32_e64 v80, v80
    v_mfma_f32_16x16x32_bf16 a[96:99], a[224:227], v[152:155], a[96:99]
    s_waitcnt lgkmcnt(0)
    buffer_load_dwordx4 v[224:227], v206, s[12:15], s44 offen offset:3072 sc1
    s_add_u32 s44, s44, 4096
    s_add_u32 s45, s45, 4096
    s_mov_b32 s38, 0
.p2align 6
L_loop:
    v_mfma_f32_16x16x32_bf16 v[96:99], a[192:195], v[0:3], v[160:163]
    s_barrier
    ds_read_b64_tr_b16 a[224:225], v200 offset:49152
    v_mfma_f32_16x16x32_bf16 v[96:99], a[196:199], v[16:19], v[96:99]
    v_exp_f32 v81, v81
    v_mfma_f32_16x16x32_bf16 v[96:99], a[200:203], v[32:35], v[96:99]
    ds_read_b64_tr_b16 a[226:227], v200 offset:50176
    v_cvt_pk_bf16_f32 v80, v80, v81
    v_mfma_f32_16x16x32_bf16 v[96:99], a[204:207], v[48:51], v[96:99]
    ds_read_b64_tr_b16 a[228:229], v200 offset:51200
    ds_read_b64_tr_b16 a[230:231], v200 offset:52224
    v_mfma_f32_16x16x32_bf16 v[100:103], a[220:223], v[48:51], v[160:163]
    v_exp_f32_e64 v82, v82
    v_mfma_f32_16x16x32_bf16 v[100:103], a[216:219], v[32:35], v[100:103]
    ds_read_b64_tr_b16 a[232:233], v201 offset:49152
    ds_read_b64_tr_b16 a[234:235], v201 offset:50176
    v_mfma_f32_16x16x32_bf16 v[100:103], a[212:215], v[16:19], v[100:103]
    v_exp_f32_e64 v83, v83
    v_mfma_f32_16x16x32_bf16 v[100:103], a[208:211], v[0:3], v[100:103]
    ds_read_b64_tr_b16 a[236:237], v201 offset:51200
    v_cvt_pk_bf16_f32 v81, v82, v83
    v_mfma_f32_16x16x32_bf16 v[108:111], a[208:211], v[4:7], v[164:167]
    v_exp_f32_e64 v84, v84
    v_mfma_f32_16x16x32_bf16 v[108:111], a[212:215], v[20:23], v[108:111]
    ds_read_b64_tr_b16 a[238:239], v201 offset:52224
    ds_read_b64_tr_b16 a[240:241], v202 offset:49152
L_hop7:
    s_cbranch_execz L_ret1
    v_mfma_f32_16x16x32_bf16 v[108:111], a[216:219], v[36:39], v[108:111]
    v_exp_f32 v85, v85
    v_mfma_f32_16x16x32_bf16 v[108:111], a[220:223], v[52:55], v[108:111]
    ds_read_b64_tr_b16 a[242:243], v202 offset:50176
    v_cvt_pk_bf16_f32 v82, v84, v85
    v_mfma_f32_16x16x32_bf16 v[104:107], a[204:207], v[52:55], v[164:167]
    v_exp_f32_e64 v86, v86
    v_mfma_f32_16x16x32_bf16 v[104:107], a[200:203], v[36:39], v[104:107]
    ds_read_b64_tr_b16 a[244:245], v202 offset:51200
    ds_read_b64_tr_b16 a[246:247], v202 offset:52224
    v_mfma_f32_16x16x32_bf16 v[104:107], a[196:199], v[20:23], v[104:107]
    v_exp_f32_e64 v87, v87
    v_mfma_f32_16x16x32_bf16 v[104:107], a[192:195], v[4:7], v[104:107]
    ds_read_b64_tr_b16 a[248:249], v203 offset:49152
    v_cvt_pk_bf16_f32 v83, v86, v87
    v_mfma_f32_16x16x32_bf16 v[112:115], a[192:195], v[8:11], v[168:171]
    v_exp_f32_e64 v88, v88
    v_mfma_f32_16x16x32_bf16 v[112:115], a[196:199], v[24:27], v[112:115]
    ds_read_b64_tr_b16 a[250:251], v203 offset:50176
    ds_read_b64_tr_b16 a[252:253], v203 offset:51200
    v_mfma_f32_16x16x32_bf16 v[112:115], a[200:203], v[40:43], v[112:115]
    v_exp_f32_e64 v89, v89
    v_mfma_f32_16x16x32_bf16 v[112:115], a[204:207], v[56:59], v[112:115]
    ds_read_b64_tr_b16 a[254:255], v203 offset:52224
    v_cvt_pk_bf16_f32 v88, v88, v89
    v_mfma_f32_16x16x32_bf16 v[116:119], a[220:223], v[56:59], v[168:171]
    v_exp_f32_e64 v90, v90
    v_mfma_f32_16x16x32_bf16 v[116:119], a[216:219], v[40:43], v[116:119]
    s_add_u32 m0, s36, 32768
    v_mfma_f32_16x16x32_bf16 v[116:119], a[212:215], v[24:27], v[116:119]
    v_exp_f32_e64 v91, v91
    v_mfma_f32_16x16x32_bf16 v[116:119], a[208:211], v[8:11], v[116:119]
    v_cvt_pk_bf16_f32 v89, v90, v91
    v_mfma_f32_16x16x32_bf16 v[124:127], a[208:211], v[12:15], v[172:175]
    v_exp_f32_e64 v92, v92
    v_mfma_f32_16x16x32_bf16 v[124:127], a[212:215], v[28:31], v[124:127]
    buffer_load_dwordx4 v205, s[8:11], s37 offen offset:0 lds
    v_mfma_f32_16x16x32_bf16 v[124:127], a[216:219], v[44:47], v[124:127]
    v_exp_f32_e64 v93, v93
    v_mfma_f32_16x16x32_bf16 v[124:127], a[220:223], v[60:63], v[124:127]
    v_cvt_pk_bf16_f32 v90, v92, v93
    v_mfma_f32_16x16x32_bf16 v[120:123], a[204:207], v[60:63], v[172:175]
    v_exp_f32_e64 v94, v94
    v_mfma_f32_16x16x32_bf16 v[120:123], a[200:203], v[44:47], v[120:123]
    buffer_load_dwordx4 v205, s[8:11], s37 offen offset:1024 lds
    v_mfma_f32_16x16x32_bf16 v[120:123], a[196:199], v[28:31], v[120:123]
    v_exp_f32_e64 v95, v95
    v_mfma_f32_16x16x32_bf16 v[120:123], a[192:195], v[12:15], v[120:123]
    v_cvt_pk_bf16_f32 v91, v94, v95
    s_waitcnt lgkmcnt(0)
    v_mfma_f32_16x16x32_bf16 a[16:19], a[224:227], v[128:131], a[16:19]
    v_exp_f32 v96, v96
    v_mfma_f32_16x16x32_bf16 a[16:19], a[228:231], v[132:135], a[16:19]
    ds_read_b128 a[192:195], v192 offset:16384
    v_mfma_f32_16x16x32_bf16 a[20:23], a[236:239], v[132:135], a[20:23]
    v_exp_f32_e64 v97, v97
    v_mfma_f32_16x16x32_bf16 a[20:23], a[232:235], v[128:131], a[20:23]
    ds_read_b128 a[196:199], v193 offset:16384
    v_cvt_pk_bf16_f32 v68, v96, v97
    v_mfma_f32_16x16x32_bf16 a[24:27], a[240:243], v[128:131], a[24:27]
    v_exp_f32_e64 v98, v98
    v_mfma_f32_16x16x32_bf16 a[24:27], a[244:247], v[132:135], a[24:27]
    ds_read_b128 a[200:203], v194 offset:16384
    v_mfma_f32_16x16x32_bf16 a[28:31], a[252:255], v[132:135], a[28:31]
    v_exp_f32_e64 v99, v99
    v_mfma_f32_16x16x32_bf16 a[28:31], a[248:251], v[128:131], a[28:31]
    ds_read_b128 a[204:207], v195 offset:16384
    v_cvt_pk_bf16_f32 v69, v98, v99
    v_mfma_f32_16x16x32_bf16 a[60:63], a[248:251], v[136:139], a[60:63]
    v_exp_f32_e64 v100, v100
    v_mfma_f32_16x16x32_bf16 a[60:63], a[252:255], v[140:143], a[60:63]
    ds_read_b128 a[208:211], v192 offset:17408
    v_mfma_f32_16x16x32_bf16 a[56:59], a[244:247], v[140:143], a[56:59]
    v_exp_f32_e64 v101, v101
    v_mfma_f32_16x16x32_bf16 a[56:59], a[240:243], v[136:139], a[56:59]
    ds_read_b128 a[212:215], v193 offset:17408
    v_cvt_pk_bf16_f32 v70, v100, v101
    v_mfma_f32_16x16x32_bf16 a[52:55], a[232:235], v[136:139], a[52:55]
    v_exp_f32_e64 v102, v102
    v_mfma_f32_16x16x32_bf16 a[52:55], a[236:239], v[140:143], a[52:55]
    ds_read_b128 a[216:219], v194 offset:17408
    v_mfma_f32_16x16x32_bf16 a[48:51], a[228:231], v[140:143], a[48:51]
    v_exp_f32_e64 v103, v103
    v_mfma_f32_16x16x32_bf16 a[48:51], a[224:227], v[136:139], a[48:51]
    ds_read_b128 a[220:223], v195 offset:17408
    v_cvt_pk_bf16_f32 v71, v102, v103
    v_mfma_f32_16x16x32_bf16 a[80:83], a[224:227], v[144:147], a[80:83]
    v_exp_f32_e64 v104, v104
    v_mfma_f32_16x16x32_bf16 a[80:83], a[228:231], v[148:151], a[80:83]
    buffer_load_dwordx4 v205, s[8:11], s37 offen offset:2048 lds
    v_mfma_f32_16x16x32_bf16 a[84:87], a[236:239], v[148:151], a[84:87]
    v_exp_f32_e64 v105, v105
    v_mfma_f32_16x16x32_bf16 a[84:87], a[232:235], v[144:147], a[84:87]
    v_cvt_pk_bf16_f32 v76, v104, v105
    v_mfma_f32_16x16x32_bf16 a[88:91], a[240:243], v[144:147], a[88:91]
    v_exp_f32_e64 v106, v106
    v_mfma_f32_16x16x32_bf16 a[88:91], a[244:247], v[148:151], a[88:91]
    buffer_load_dwordx4 v205, s[8:11], s37 offen offset:3072 lds
    v_mfma_f32_16x16x32_bf16 a[92:95], a[252:255], v[148:151], a[92:95]
    v_exp_f32_e64 v107, v107
    v_mfma_f32_16x16x32_bf16 a[92:95], a[248:251], v[144:147], a[92:95]
    v_cvt_pk_bf16_f32 v77, v106, v107
    v_mfma_f32_16x16x32_bf16 a[124:127], a[248:251], v[152:155], a[124:127]
    v_exp_f32_e64 v108, v108
    v_mfma_f32_16x16x32_bf16 a[124:127], a[252:255], v[156:159], a[124:127]
    s_add_u32 m0, s35, 0
    v_mfma_f32_16x16x32_bf16 a[120:123], a[244:247], v[156:159], a[120:123]
    v_exp_f32 v109, v109
    v_mfma_f32_16x16x32_bf16 a[120:123], a[240:243], v[152:155], a[120:123]
    v_cvt_pk_bf16_f32 v78, v108, v109
    v_mfma_f32_16x16x32_bf16 a[116:119], a[232:235], v[152:155], a[116:119]
    v_exp_f32_e64 v110, v110
    v_mfma_f32_16x16x32_bf16 a[116:119], a[236:239], v[156:159], a[116:119]
    global_load_dword v247, v250, s[66:67]
    v_mfma_f32_16x16x32_bf16 a[112:115], a[228:231], v[156:159], a[112:115]
    v_exp_f32_e64 v111, v111
    v_mfma_f32_16x16x32_bf16 a[112:115], a[224:227], v[152:155], a[112:115]
    v_cvt_pk_bf16_f32 v79, v110, v111
    s_waitcnt lgkmcnt(0)
    v_mfma_f32_16x16x32_bf16 v[128:131], a[192:195], v[0:3], v[160:163]
    ds_read_b64_tr_b16 a[224:225], v196 offset:0
    ds_read_b64_tr_b16 a[226:227], v196 offset:1024
    v_mfma_f32_16x16x32_bf16 v[128:131], a[196:199], v[16:19], v[128:131]
    v_exp_f32 v112, v112
    v_mfma_f32_16x16x32_bf16 v[128:131], a[200:203], v[32:35], v[128:131]
    ds_read_b64_tr_b16 a[228:229], v196 offset:2048
    ds_read_b64_tr_b16 a[230:231], v196 offset:3072
    v_mfma_f32_16x16x32_bf16 v[128:131], a[204:207], v[48:51], v[128:131]
    v_exp_f32_e64 v113, v113
    v_mfma_f32_16x16x32_bf16 v[132:135], a[220:223], v[48:51], v[160:163]
    ds_read_b64_tr_b16 a[232:233], v197 offset:0
    v_cvt_pk_bf16_f32 v84, v112, v113
    v_mfma_f32_16x16x32_bf16 v[132:135], a[216:219], v[32:35], v[132:135]
    ds_read_b64_tr_b16 a[234:235], v197 offset:1024
    ds_read_b64_tr_b16 a[236:237], v197 offset:2048
    v_mfma_f32_16x16x32_bf16 v[132:135], a[212:215], v[16:19], v[132:135]
    v_exp_f32_e64 v114, v114
    v_mfma_f32_16x16x32_bf16 v[132:135], a[208:211], v[0:3], v[132:135]
    ds_read_b64_tr_b16 a[238:239], v197 offset:3072
    ds_read_b64_tr_b16 a[240:241], v198 offset:0
    v_mfma_f32_16x16x32_bf16 v[140:143], a[208:211], v[4:7], v[164:167]
    v_exp_f32_e64 v115, v115
    v_mfma_f32_16x16x32_bf16 v[140:143], a[212:215], v[20:23], v[140:143]
    ds_read_b64_tr_b16 a[242:243], v198 offset:1024
    v_cvt_pk_bf16_f32 v85, v114, v115
    v_mfma_f32_16x16x32_bf16 v[140:143], a[216:219], v[36:39], v[140:143]
    v_exp_f32_e64 v116, v116
    v_mfma_f32_16x16x32_bf16 v[140:143], a[220:223], v[52:55], v[140:143]
    ds_read_b64_tr_b16 a[244:245], v198 offset:2048
    ds_read_b64_tr_b16 a[246:247], v198 offset:3072
    v_mfma_f32_16x16x32_bf16 v[136:139], a[204:207], v[52:55], v[164:167]
    v_exp_f32_e64 v117, v117
    v_mfma_f32_16x16x32_bf16 v[136:139], a[200:203], v[36:39], v[136:139]
    ds_read_b64_tr_b16 a[248:249], v199 offset:0
    v_cvt_pk_bf16_f32 v86, v116, v117
    v_mfma_f32_16x16x32_bf16 v[136:139], a[196:199], v[20:23], v[136:139]
    v_exp_f32_e64 v118, v118
    v_mfma_f32_16x16x32_bf16 v[136:139], a[192:195], v[4:7], v[136:139]
    ds_read_b64_tr_b16 a[250:251], v199 offset:1024
    ds_read_b64_tr_b16 a[252:253], v199 offset:2048
    v_smfmac_f32_16x16x64_bf16 a[128:131], v[208:211], v[64:71], v207
    v_exp_f32_e64 v119, v119
    v_smfmac_f32_16x16x64_bf16 a[132:135], v[208:211], v[72:79], v207
    ds_read_b64_tr_b16 a[254:255], v199 offset:3072
    v_cvt_pk_bf16_f32 v87, v118, v119
    v_mfma_f32_16x16x32_bf16 v[144:147], a[192:195], v[8:11], v[168:171]
    v_exp_f32_e64 v120, v120
    v_mfma_f32_16x16x32_bf16 v[144:147], a[196:199], v[24:27], v[144:147]
    v_mfma_f32_16x16x32_bf16 v[144:147], a[200:203], v[40:43], v[144:147]
    v_exp_f32_e64 v121, v121
    v_mfma_f32_16x16x32_bf16 v[144:147], a[204:207], v[56:59], v[144:147]
    v_cvt_pk_bf16_f32 v92, v120, v121
    v_mfma_f32_16x16x32_bf16 v[148:151], a[220:223], v[56:59], v[168:171]
    v_exp_f32_e64 v122, v122
    v_mfma_f32_16x16x32_bf16 v[148:151], a[216:219], v[40:43], v[148:151]
    buffer_load_dwordx4 v204, s[4:7], s37 offen offset:0 lds
    v_mfma_f32_16x16x32_bf16 v[148:151], a[212:215], v[24:27], v[148:151]
    v_exp_f32_e64 v123, v123
    v_mfma_f32_16x16x32_bf16 v[148:151], a[208:211], v[8:11], v[148:151]
    v_cvt_pk_bf16_f32 v93, v122, v123
    v_mfma_f32_16x16x32_bf16 v[156:159], a[208:211], v[12:15], v[172:175]
    v_exp_f32_e64 v124, v124
    v_mfma_f32_16x16x32_bf16 v[156:159], a[212:215], v[28:31], v[156:159]
    buffer_load_dwordx4 v204, s[4:7], s37 offen offset:1024 lds
    v_mfma_f32_16x16x32_bf16 v[156:159], a[216:219], v[44:47], v[156:159]
    v_exp_f32_e64 v125, v125
    v_mfma_f32_16x16x32_bf16 v[156:159], a[220:223], v[60:63], v[156:159]
    v_cvt_pk_bf16_f32 v94, v124, v125
    v_mfma_f32_16x16x32_bf16 v[152:155], a[204:207], v[60:63], v[172:175]
    v_exp_f32_e64 v126, v126
    v_mfma_f32_16x16x32_bf16 v[152:155], a[200:203], v[44:47], v[152:155]
    v_mfma_f32_16x16x32_bf16 v[152:155], a[196:199], v[28:31], v[152:155]
    v_exp_f32_e64 v127, v127
    v_mfma_f32_16x16x32_bf16 v[152:155], a[192:195], v[12:15], v[152:155]
    v_cvt_pk_bf16_f32 v95, v126, v127
    s_waitcnt lgkmcnt(0)
    v_mfma_f32_16x16x32_bf16 a[0:3], a[224:227], v[64:67], a[0:3]
    v_exp_f32 v128, v128
    v_mfma_f32_16x16x32_bf16 a[0:3], a[228:231], v[68:71], a[0:3]
    ds_read_b128 a[192:195], v192 offset:18432
    v_mfma_f32_16x16x32_bf16 a[4:7], a[236:239], v[68:71], a[4:7]
    v_exp_f32_e64 v129, v129
    v_mfma_f32_16x16x32_bf16 a[4:7], a[232:235], v[64:67], a[4:7]
    ds_read_b128 a[196:199], v193 offset:18432
    v_cvt_pk_bf16_f32 v128, v128, v129
    v_mfma_f32_16x16x32_bf16 a[8:11], a[240:243], v[64:67], a[8:11]
    v_exp_f32_e64 v130, v130
    v_mfma_f32_16x16x32_bf16 a[8:11], a[244:247], v[68:71], a[8:11]
    ds_read_b128 a[200:203], v194 offset:18432
    v_mfma_f32_16x16x32_bf16 a[12:15], a[252:255], v[68:71], a[12:15]
    v_exp_f32_e64 v131, v131
    v_mfma_f32_16x16x32_bf16 a[12:15], a[248:251], v[64:67], a[12:15]
    ds_read_b128 a[204:207], v195 offset:18432
    v_cvt_pk_bf16_f32 v129, v130, v131
    v_mfma_f32_16x16x32_bf16 a[44:47], a[248:251], v[72:75], a[44:47]
    v_exp_f32_e64 v132, v132
    v_mfma_f32_16x16x32_bf16 a[44:47], a[252:255], v[76:79], a[44:47]
    ds_read_b128 a[208:211], v192 offset:19456
    v_mfma_f32_16x16x32_bf16 a[40:43], a[244:247], v[76:79], a[40:43]
    v_exp_f32_e64 v133, v133
    v_mfma_f32_16x16x32_bf16 a[40:43], a[240:243], v[72:75], a[40:43]
    ds_read_b128 a[212:215], v193 offset:19456
    v_cvt_pk_bf16_f32 v130, v132, v133
    v_mfma_f32_16x16x32_bf16 a[36:39], a[232:235], v[72:75], a[36:39]
    v_exp_f32_e64 v134, v134
    v_mfma_f32_16x16x32_bf16 a[36:39], a[236:239], v[76:79], a[36:39]
    ds_read_b128 a[216:219], v194 offset:19456
    v_mfma_f32_16x16x32_bf16 a[32:35], a[228:231], v[76:79], a[32:35]
    v_exp_f32_e64 v135, v135
    v_mfma_f32_16x16x32_bf16 a[32:35], a[224:227], v[72:75], a[32:35]
    ds_read_b128 a[220:223], v195 offset:19456
    v_cvt_pk_bf16_f32 v131, v134, v135
    v_smfmac_f32_16x16x64_bf16 a[136:139], v[208:211], v[80:87], v207
    v_exp_f32_e64 v136, v136
    v_smfmac_f32_16x16x64_bf16 a[140:143], v[208:211], v[88:95], v207
    buffer_load_dwordx4 v204, s[4:7], s37 offen offset:2048 lds
    v_mfma_f32_16x16x32_bf16 a[64:67], a[224:227], v[80:83], a[64:67]
    v_exp_f32_e64 v137, v137
    v_mfma_f32_16x16x32_bf16 a[64:67], a[228:231], v[84:87], a[64:67]
    v_cvt_pk_bf16_f32 v136, v136, v137
    v_mfma_f32_16x16x32_bf16 a[68:71], a[236:239], v[84:87], a[68:71]
    v_exp_f32_e64 v138, v138
    v_mfma_f32_16x16x32_bf16 a[68:71], a[232:235], v[80:83], a[68:71]
    buffer_load_dwordx4 v204, s[4:7], s37 offen offset:3072 lds
    v_mfma_f32_16x16x32_bf16 a[72:75], a[240:243], v[80:83], a[72:75]
    v_exp_f32_e64 v139, v139
    v_mfma_f32_16x16x32_bf16 a[72:75], a[244:247], v[84:87], a[72:75]
    v_cvt_pk_bf16_f32 v137, v138, v139
    v_mfma_f32_16x16x32_bf16 a[76:79], a[252:255], v[84:87], a[76:79]
    v_exp_f32_e64 v140, v140
    v_mfma_f32_16x16x32_bf16 a[76:79], a[248:251], v[80:83], a[76:79]
    s_add_u32 s37, s37, 16384
    v_mfma_f32_16x16x32_bf16 a[108:111], a[248:251], v[88:91], a[108:111]
    v_exp_f32_e64 v141, v141
    v_mfma_f32_16x16x32_bf16 a[108:111], a[252:255], v[92:95], a[108:111]
    v_cvt_pk_bf16_f32 v138, v140, v141
    v_mfma_f32_16x16x32_bf16 a[104:107], a[244:247], v[92:95], a[104:107]
    v_exp_f32_e64 v142, v142
    v_mfma_f32_16x16x32_bf16 a[104:107], a[240:243], v[88:91], a[104:107]
    s_cmp_eq_u32 s38, 4
    s_cselect_b32 s48, 0, 0x80000000
    buffer_load_dword v247, v253, s[16:19], s48 offen
    v_mfma_f32_16x16x32_bf16 a[100:103], a[232:235], v[88:91], a[100:103]
    v_exp_f32 v143, v143
    v_mfma_f32_16x16x32_bf16 a[100:103], a[236:239], v[92:95], a[100:103]
    v_cvt_pk_bf16_f32 v139, v142, v143
    v_mfma_f32_16x16x32_bf16 a[96:99], a[228:231], v[92:95], a[96:99]
    v_exp_f32_e64 v144, v144
    v_mfma_f32_16x16x32_bf16 a[96:99], a[224:227], v[88:91], a[96:99]
    s_waitcnt vmcnt(20) lgkmcnt(0)
    v_mfma_f32_16x16x32_bf16 v[96:99], a[192:195], v[0:3], v[160:163]
    s_barrier
    ds_read_b64_tr_b16 a[224:225], v200 offset:0
    v_mfma_f32_16x16x32_bf16 v[96:99], a[196:199], v[16:19], v[96:99]
    v_exp_f32_e64 v145, v145
    v_mfma_f32_16x16x32_bf16 v[96:99], a[200:203], v[32:35], v[96:99]
    ds_read_b64_tr_b16 a[226:227], v200 offset:1024
    v_cvt_pk_bf16_f32 v144, v144, v145
    v_mfma_f32_16x16x32_bf16 v[96:99], a[204:207], v[48:51], v[96:99]
    ds_read_b64_tr_b16 a[228:229], v200 offset:2048
    ds_read_b64_tr_b16 a[230:231], v200 offset:3072
    v_mfma_f32_16x16x32_bf16 v[100:103], a[220:223], v[48:51], v[160:163]
    v_exp_f32_e64 v146, v146
    v_mfma_f32_16x16x32_bf16 v[100:103], a[216:219], v[32:35], v[100:103]
    ds_read_b64_tr_b16 a[232:233], v201 offset:0
    ds_read_b64_tr_b16 a[234:235], v201 offset:1024
    v_mfma_f32_16x16x32_bf16 v[100:103], a[212:215], v[16:19], v[100:103]
    v_exp_f32_e64 v147, v147
    v_mfma_f32_16x16x32_bf16 v[100:103], a[208:211], v[0:3], v[100:103]
    ds_read_b64_tr_b16 a[236:237], v201 offset:2048
    v_cvt_pk_bf16_f32 v145, v146, v147
    s_waitcnt vmcnt(14)
    s_waitcnt vmcnt(13)
    v_mfma_f32_16x16x32_bf16 a[144:147], v[228:231], v[212:215], a[144:147]
    v_mfma_f32_16x16x32_bf16 a[148:151], v[232:235], v[212:215], a[148:151]
    v_mfma_f32_16x16x32_bf16 a[152:155], v[236:239], v[212:215], a[152:155]
    v_mfma_f32_16x16x32_bf16 a[156:159], v[240:243], v[212:215], a[156:159]
    buffer_load_dwordx4 v[212:215], v206, s[12:15], s44 offen offset:0 sc1
    v_mfma_f32_16x16x32_bf16 v[108:111], a[208:211], v[4:7], v[164:167]
    v_exp_f32_e64 v148, v148
    v_mfma_f32_16x16x32_bf16 v[108:111], a[212:215], v[20:23], v[108:111]
    ds_read_b64_tr_b16 a[238:239], v201 offset:3072
    ds_read_b64_tr_b16 a[240:241], v202 offset:0
    v_mfma_f32_16x16x32_bf16 v[108:111], a[216:219], v[36:39], v[108:111]
    v_exp_f32_e64 v149, v149
    v_mfma_f32_16x16x32_bf16 v[108:111], a[220:223], v[52:55], v[108:111]
    ds_read_b64_tr_b16 a[242:243], v202 offset:1024
    v_cvt_pk_bf16_f32 v146, v148, v149
    v_mfma_f32_16x16x32_bf16 v[104:107], a[204:207], v[52:55], v[164:167]
    v_exp_f32_e64 v150, v150
    v_mfma_f32_16x16x32_bf16 v[104:107], a[200:203], v[36:39], v[104:107]
    ds_read_b64_tr_b16 a[244:245], v202 offset:2048
    ds_read_b64_tr_b16 a[246:247], v202 offset:3072
    v_mfma_f32_16x16x32_bf16 v[104:107], a[196:199], v[20:23], v[104:107]
    v_exp_f32_e64 v151, v151
    v_mfma_f32_16x16x32_bf16 v[104:107], a[192:195], v[4:7], v[104:107]
    ds_read_b64_tr_b16 a[248:249], v203 offset:0
    v_cvt_pk_bf16_f32 v147, v150, v151
    v_mfma_f32_16x16x32_bf16 v[112:115], a[192:195], v[8:11], v[168:171]
    v_exp_f32_e64 v152, v152
    v_mfma_f32_16x16x32_bf16 v[112:115], a[196:199], v[24:27], v[112:115]
    ds_read_b64_tr_b16 a[250:251], v203 offset:1024
    ds_read_b64_tr_b16 a[252:253], v203 offset:2048
    v_mfma_f32_16x16x32_bf16 v[112:115], a[200:203], v[40:43], v[112:115]
    v_exp_f32_e64 v153, v153
    v_mfma_f32_16x16x32_bf16 v[112:115], a[204:207], v[56:59], v[112:115]
    ds_read_b64_tr_b16 a[254:255], v203 offset:3072
    v_cvt_pk_bf16_f32 v152, v152, v153
    v_mfma_f32_16x16x32_bf16 v[116:119], a[220:223], v[56:59], v[168:171]
    v_exp_f32_e64 v154, v154
    v_mfma_f32_16x16x32_bf16 v[116:119], a[216:219], v[40:43], v[116:119]
    s_add_u32 m0, s36, 49152
    v_mfma_f32_16x16x32_bf16 v[116:119], a[212:215], v[24:27], v[116:119]
    v_exp_f32_e64 v155, v155
    v_mfma_f32_16x16x32_bf16 v[116:119], a[208:211], v[8:11], v[116:119]
    v_cvt_pk_bf16_f32 v153, v154, v155
    v_mfma_f32_16x16x32_bf16 v[124:127], a[208:211], v[12:15], v[172:175]
    v_exp_f32_e64 v156, v156
    v_mfma_f32_16x16x32_bf16 v[124:127], a[212:215], v[28:31], v[124:127]
    buffer_load_dwordx4 v205, s[8:11], s37 offen offset:0 lds
    v_mfma_f32_16x16x32_bf16 v[124:127], a[216:219], v[44:47], v[124:127]
    v_exp_f32_e64 v157, v157
    v_mfma_f32_16x16x32_bf16 v[124:127], a[220:223], v[60:63], v[124:127]
    v_cvt_pk_bf16_f32 v154, v156, v157
    v_mfma_f32_16x16x32_bf16 v[120:123], a[204:207], v[60:63], v[172:175]
    v_exp_f32_e64 v158, v158
    v_mfma_f32_16x16x32_bf16 v[120:123], a[200:203], v[44:47], v[120:123]
    buffer_load_dwordx4 v205, s[8:11], s37 offen offset:1024 lds
    v_mfma_f32_16x16x32_bf16 v[120:123], a[196:199], v[28:31], v[120:123]
    v_exp_f32_e64 v159, v159
    v_mfma_f32_16x16x32_bf16 v[120:123], a[192:195], v[12:15], v[120:123]
    v_cvt_pk_bf16_f32 v155, v158, v159
    s_waitcnt lgkmcnt(0)
    v_mfma_f32_16x16x32_bf16 a[16:19], a[224:227], v[64:67], a[16:19]
    v_exp_f32 v96, v96
    v_mfma_f32_16x16x32_bf16 a[16:19], a[228:231], v[68:71], a[16:19]
    ds_read_b128 a[192:195], v192 offset:32768
    v_mfma_f32_16x16x32_bf16 a[20:23], a[236:239], v[68:71], a[20:23]
    v_exp_f32_e64 v97, v97
    v_mfma_f32_16x16x32_bf16 a[20:23], a[232:235], v[64:67], a[20:23]
    ds_read_b128 a[196:199], v193 offset:32768
    v_cvt_pk_bf16_f32 v132, v96, v97
    v_mfma_f32_16x16x32_bf16 a[24:27], a[240:243], v[64:67], a[24:27]
    v_exp_f32_e64 v98, v98
    v_mfma_f32_16x16x32_bf16 a[24:27], a[244:247], v[68:71], a[24:27]
    ds_read_b128 a[200:203], v194 offset:32768
    v_mfma_f32_16x16x32_bf16 a[28:31], a[252:255], v[68:71], a[28:31]
    v_exp_f32_e64 v99, v99
    v_mfma_f32_16x16x32_bf16 a[28:31], a[248:251], v[64:67], a[28:31]
    ds_read_b128 a[204:207], v195 offset:32768
    v_cvt_pk_bf16_f32 v133, v98, v99
    s_waitcnt vmcnt(15)
    v_mfma_f32_16x16x32_bf16 a[160:163], v[228:231], v[216:219], a[160:163]
    v_mfma_f32_16x16x32_bf16 a[164:167], v[232:235], v[216:219], a[164:167]
    v_mfma_f32_16x16x32_bf16 a[168:171], v[236:239], v[216:219], a[168:171]
    v_mfma_f32_16x16x32_bf16 a[172:175], v[240:243], v[216:219], a[172:175]
    buffer_load_dwordx4 v[216:219], v206, s[12:15], s44 offen offset:1024 sc1
    v_mfma_f32_16x16x32_bf16 a[60:63], a[248:251], v[72:75], a[60:63]
    v_exp_f32 v100, v100
    v_mfma_f32_16x16x32_bf16 a[60:63], a[252:255], v[76:79], a[60:63]
    ds_read_b128 a[208:211], v192 offset:33792
    v_mfma_f32_16x16x32_bf16 a[56:59], a[244:247], v[76:79], a[56:59]
    v_exp_f32_e64 v101, v101
    v_mfma_f32_16x16x32_bf16 a[56:59], a[240:243], v[72:75], a[56:59]
    ds_read_b128 a[212:215], v193 offset:33792
    v_cvt_pk_bf16_f32 v134, v100, v101
    v_mfma_f32_16x16x32_bf16 a[52:55], a[232:235], v[72:75], a[52:55]
    v_exp_f32_e64 v102, v102
    v_mfma_f32_16x16x32_bf16 a[52:55], a[236:239], v[76:79], a[52:55]
    ds_read_b128 a[216:219], v194 offset:33792
    v_mfma_f32_16x16x32_bf16 a[48:51], a[228:231], v[76:79], a[48:51]
    v_exp_f32_e64 v103, v103
    v_mfma_f32_16x16x32_bf16 a[48:51], a[224:227], v[72:75], a[48:51]
    ds_read_b128 a[220:223], v195 offset:33792
    v_cvt_pk_bf16_f32 v135, v102, v103
    v_mfma_f32_16x16x32_bf16 a[80:83], a[224:227], v[80:83], a[80:83]
    v_exp_f32_e64 v104, v104
    v_mfma_f32_16x16x32_bf16 a[80:83], a[228:231], v[84:87], a[80:83]
    buffer_load_dwordx4 v205, s[8:11], s37 offen offset:2048 lds
    v_mfma_f32_16x16x32_bf16 a[84:87], a[236:239], v[84:87], a[84:87]
    v_exp_f32_e64 v105, v105
    v_mfma_f32_16x16x32_bf16 a[84:87], a[232:235], v[80:83], a[84:87]
    v_cvt_pk_bf16_f32 v140, v104, v105
    v_mfma_f32_16x16x32_bf16 a[88:91], a[240:243], v[80:83], a[88:91]
    v_exp_f32_e64 v106, v106
    v_mfma_f32_16x16x32_bf16 a[88:91], a[244:247], v[84:87], a[88:91]
    buffer_load_dwordx4 v205, s[8:11], s37 offen offset:3072 lds
    v_mfma_f32_16x16x32_bf16 a[92:95], a[252:255], v[84:87], a[92:95]
    v_exp_f32_e64 v107, v107
    v_mfma_f32_16x16x32_bf16 a[92:95], a[248:251], v[80:83], a[92:95]
    v_cvt_pk_bf16_f32 v141, v106, v107
    v_mfma_f32_16x16x32_bf16 a[124:127], a[248:251], v[88:91], a[124:127]
    v_exp_f32_e64 v108, v108
    v_mfma_f32_16x16x32_bf16 a[124:127], a[252:255], v[92:95], a[124:127]
    s_add_u32 m0, s35, 16384
    v_mfma_f32_16x16x32_bf16 a[120:123], a[244:247], v[92:95], a[120:123]
    v_exp_f32_e64 v109, v109
    v_mfma_f32_16x16x32_bf16 a[120:123], a[240:243], v[88:91], a[120:123]
    v_cvt_pk_bf16_f32 v142, v108, v109
    v_mfma_f32_16x16x32_bf16 a[116:119], a[232:235], v[88:91], a[116:119]
    v_exp_f32_e64 v110, v110
    v_mfma_f32_16x16x32_bf16 a[116:119], a[236:239], v[92:95], a[116:119]
    v_mfma_f32_16x16x32_bf16 a[112:115], a[228:231], v[92:95], a[112:115]
    v_exp_f32_e64 v111, v111
    v_mfma_f32_16x16x32_bf16 a[112:115], a[224:227], v[88:91], a[112:115]
    v_cvt_pk_bf16_f32 v143, v110, v111
    s_waitcnt lgkmcnt(0)
    v_mfma_f32_16x16x32_bf16 v[64:67], a[192:195], v[0:3], v[160:163]
    ds_read_b64_tr_b16 a[224:225], v196 offset:16384
    ds_read_b64_tr_b16 a[226:227], v196 offset:17408
    v_mfma_f32_16x16x32_bf16 v[64:67], a[196:199], v[16:19], v[64:67]
    v_exp_f32 v112, v112
    v_mfma_f32_16x16x32_bf16 v[64:67], a[200:203], v[32:35], v[64:67]
    ds_read_b64_tr_b16 a[228:229], v196 offset:18432
    ds_read_b64_tr_b16 a[230:231], v196 offset:19456
    v_mfma_f32_16x16x32_bf16 v[64:67], a[204:207], v[48:51], v[64:67]
    v_exp_f32_e64 v113, v113
    v_mfma_f32_16x16x32_bf16 v[68:71], a[220:223], v[48:51], v[160:163]
    ds_read_b64_tr_b16 a[232:233], v197 offset:16384
    v_cvt_pk_bf16_f32 v148, v112, v113
    v_mfma_f32_16x16x32_bf16 v[68:71], a[216:219], v[32:35], v[68:71]
    ds_read_b64_tr_b16 a[234:235], v197 offset:17408
    ds_read_b64_tr_b16 a[236:237], v197 offset:18432
    v_mfma_f32_16x16x32_bf16 v[68:71], a[212:215], v[16:19], v[68:71]
    v_exp_f32_e64 v114, v114
    v_mfma_f32_16x16x32_bf16 v[68:71], a[208:211], v[0:3], v[68:71]
    ds_read_b64_tr_b16 a[238:239], v197 offset:19456
    ds_read_b64_tr_b16 a[240:241], v198 offset:16384
    s_waitcnt vmcnt(17)
    v_mfma_f32_16x16x32_bf16 a[176:179], v[228:231], v[220:223], a[176:179]
    v_mfma_f32_16x16x32_bf16 a[180:183], v[232:235], v[220:223], a[180:183]
    v_mfma_f32_16x16x32_bf16 a[184:187], v[236:239], v[220:223], a[184:187]
    v_mfma_f32_16x16x32_bf16 a[188:191], v[240:243], v[220:223], a[188:191]
    buffer_load_dwordx4 v[220:223], v206, s[12:15], s44 offen offset:2048 sc1
    v_mfma_f32_16x16x32_bf16 v[76:79], a[208:211], v[4:7], v[164:167]
    v_exp_f32 v115, v115
    v_mfma_f32_16x16x32_bf16 v[76:79], a[212:215], v[20:23], v[76:79]
    ds_read_b64_tr_b16 a[242:243], v198 offset:17408
    v_cvt_pk_bf16_f32 v149, v114, v115
    v_mfma_f32_16x16x32_bf16 v[76:79], a[216:219], v[36:39], v[76:79]
    v_exp_f32_e64 v116, v116
    v_mfma_f32_16x16x32_bf16 v[76:79], a[220:223], v[52:55], v[76:79]
    ds_read_b64_tr_b16 a[244:245], v198 offset:18432
    ds_read_b64_tr_b16 a[246:247], v198 offset:19456
    v_mfma_f32_16x16x32_bf16 v[72:75], a[204:207], v[52:55], v[164:167]
    v_exp_f32_e64 v117, v117
    v_mfma_f32_16x16x32_bf16 v[72:75], a[200:203], v[36:39], v[72:75]
    ds_read_b64_tr_b16 a[248:249], v199 offset:16384
    v_cvt_pk_bf16_f32 v150, v116, v117
    v_mfma_f32_16x16x32_bf16 v[72:75], a[196:199], v[20:23], v[72:75]
    v_exp_f32_e64 v118, v118
    v_mfma_f32_16x16x32_bf16 v[72:75], a[192:195], v[4:7], v[72:75]
    ds_read_b64_tr_b16 a[250:251], v199 offset:17408
    ds_read_b64_tr_b16 a[252:253], v199 offset:18432
    v_smfmac_f32_16x16x64_bf16 a[128:131], v[208:211], v[128:135], v207
    v_exp_f32_e64 v119, v119
    v_smfmac_f32_16x16x64_bf16 a[132:135], v[208:211], v[136:143], v207
    ds_read_b64_tr_b16 a[254:255], v199 offset:19456
    v_cvt_pk_bf16_f32 v151, v118, v119
    v_mfma_f32_16x16x32_bf16 v[80:83], a[192:195], v[8:11], v[168:171]
    v_exp_f32_e64 v120, v120
    v_mfma_f32_16x16x32_bf16 v[80:83], a[196:199], v[24:27], v[80:83]
    v_mfma_f32_16x16x32_bf16 v[80:83], a[200:203], v[40:43], v[80:83]
    v_exp_f32_e64 v121, v121
    v_mfma_f32_16x16x32_bf16 v[80:83], a[204:207], v[56:59], v[80:83]
    v_cvt_pk_bf16_f32 v156, v120, v121
    v_mfma_f32_16x16x32_bf16 v[84:87], a[220:223], v[56:59], v[168:171]
    v_exp_f32_e64 v122, v122
    v_mfma_f32_16x16x32_bf16 v[84:87], a[216:219], v[40:43], v[84:87]
    buffer_load_dwordx4 v204, s[4:7], s37 offen offset:0 lds
    v_mfma_f32_16x16x32_bf16 v[84:87], a[212:215], v[24:27], v[84:87]
    v_exp_f32_e64 v123, v123
    v_mfma_f32_16x16x32_bf16 v[84:87], a[208:211], v[8:11], v[84:87]
    v_cvt_pk_bf16_f32 v157, v122, v123
    v_mfma_f32_16x16x32_bf16 v[92:95], a[208:211], v[12:15], v[172:175]
    v_exp_f32_e64 v124, v124
    v_mfma_f32_16x16x32_bf16 v[92:95], a[212:215], v[28:31], v[92:95]
    buffer_load_dwordx4 v204, s[4:7], s37 offen offset:1024 lds
    v_mfma_f32_16x16x32_bf16 v[92:95], a[216:219], v[44:47], v[92:95]
    v_exp_f32_e64 v125, v125
    v_mfma_f32_16x16x32_bf16 v[92:95], a[220:223], v[60:63], v[92:95]
    v_cvt_pk_bf16_f32 v158, v124, v125
    v_mfma_f32_16x16x32_bf16 v[88:91], a[204:207], v[60:63], v[172:175]
    v_exp_f32_e64 v126, v126
    v_mfma_f32_16x16x32_bf16 v[88:91], a[200:203], v[44:47], v[88:91]
    v_mfma_f32_16x16x32_bf16 v[88:91], a[196:199], v[28:31], v[88:91]
    v_exp_f32_e64 v127, v127
    v_mfma_f32_16x16x32_bf16 v[88:91], a[192:195], v[12:15], v[88:91]
    v_cvt_pk_bf16_f32 v159, v126, v127
    s_waitcnt lgkmcnt(0)
    v_mfma_f32_16x16x32_bf16 a[0:3], a[224:227], v[128:131], a[0:3]
    v_exp_f32 v64, v64
    v_mfma_f32_16x16x32_bf16 a[0:3], a[228:231], v[132:135], a[0:3]
    ds_read_b128 a[192:195], v192 offset:34816
    s_waitcnt vmcnt(19)
    v_mfma_f32_16x16x32_bf16 v[176:179], v[228:231], v[224:227], v[176:179]
    buffer_load_dwordx4 v[228:231], v206, s[12:15], s45 offen offset:0 sc1
    v_mfma_f32_16x16x32_bf16 v[180:183], v[232:235], v[224:227], v[180:183]
    v_exp_f32 v65, v65
    v_mfma_f32_16x16x32_bf16 v[184:187], v[236:239], v[224:227], v[184:187]
    ds_read_b128 a[196:199], v193 offset:34816
    v_cvt_pk_bf16_f32 v64, v64, v65
    v_mfma_f32_16x16x32_bf16 v[188:191], v[240:243], v[224:227], v[188:191]
    v_exp_f32_e64 v66, v66
    v_mfma_f32_16x16x32_bf16 a[4:7], a[236:239], v[132:135], a[4:7]
    ds_read_b128 a[200:203], v194 offset:34816
L_hop8:
    s_cbranch_execz L_ret2
    v_mfma_f32_16x16x32_bf16 a[4:7], a[232:235], v[128:131], a[4:7]
    buffer_load_dwordx4 v[232:235], v206, s[12:15], s45 offen offset:1024 sc1
    v_mfma_f32_16x16x32_bf16 a[8:11], a[240:243], v[128:131], a[8:11]
    v_exp_f32 v67, v67
    v_mfma_f32_16x16x32_bf16 a[8:11], a[244:247], v[132:135], a[8:11]
    ds_read_b128 a[204:207], v195 offset:34816
    v_cvt_pk_bf16_f32 v65, v66, v67
    v_mfma_f32_16x16x32_bf16 a[12:15], a[252:255], v[132:135], a[12:15]
    v_exp_f32_e64 v68, v68
    v_mfma_f32_16x16x32_bf16 a[12:15], a[248:251], v[128:131], a[12:15]
    ds_read_b128 a[208:211], v192 offset:35840
    v_mfma_f32_16x16x32_bf16 a[44:47], a[248:251], v[136:139], a[44:47]
    buffer_load_dwordx4 v[236:239], v206, s[12:15], s45 offen offset:2048 sc1
    v_mfma_f32_16x16x32_bf16 a[44:47], a[252:255], v[140:143], a[44:47]
    v_exp_f32_e64 v69, v69
    v_mfma_f32_16x16x32_bf16 a[40:43], a[244:247], v[140:143], a[40:43]
    ds_read_b128 a[212:215], v193 offset:35840
    v_cvt_pk_bf16_f32 v66, v68, v69
    v_mfma_f32_16x16x32_bf16 a[40:43], a[240:243], v[136:139], a[40:43]
    v_exp_f32_e64 v70, v70
    v_mfma_f32_16x16x32_bf16 a[36:39], a[232:235], v[136:139], a[36:39]
    ds_read_b128 a[216:219], v194 offset:35840
    v_mfma_f32_16x16x32_bf16 a[36:39], a[236:239], v[140:143], a[36:39]
    buffer_load_dwordx4 v[240:243], v206, s[12:15], s45 offen offset:3072 sc1
    v_mfma_f32_16x16x32_bf16 a[32:35], a[228:231], v[140:143], a[32:35]
    v_exp_f32_e64 v71, v71
    v_mfma_f32_16x16x32_bf16 a[32:35], a[224:227], v[136:139], a[32:35]
    ds_read_b128 a[220:223], v195 offset:35840
    v_cvt_pk_bf16_f32 v67, v70, v71
    v_smfmac_f32_16x16x64_bf16 a[136:139], v[208:211], v[144:151], v207
    v_exp_f32_e64 v72, v72
    v_smfmac_f32_16x16x64_bf16 a[140:143], v[208:211], v[152:159], v207
    buffer_load_dwordx4 v204, s[4:7], s37 offen offset:2048 lds
    v_mfma_f32_16x16x32_bf16 a[64:67], a[224:227], v[144:147], a[64:67]
    v_exp_f32_e64 v73, v73
    v_mfma_f32_16x16x32_bf16 a[64:67], a[228:231], v[148:151], a[64:67]
    v_cvt_pk_bf16_f32 v72, v72, v73
    v_mfma_f32_16x16x32_bf16 a[68:71], a[236:239], v[148:151], a[68:71]
    v_exp_f32_e64 v74, v74
    v_mfma_f32_16x16x32_bf16 a[68:71], a[232:235], v[144:147], a[68:71]
    buffer_load_dwordx4 v204, s[4:7], s37 offen offset:3072 lds
    v_mfma_f32_16x16x32_bf16 a[72:75], a[240:243], v[144:147], a[72:75]
    v_exp_f32_e64 v75, v75
    v_mfma_f32_16x16x32_bf16 a[72:75], a[244:247], v[148:151], a[72:75]
    v_cvt_pk_bf16_f32 v73, v74, v75
    v_mfma_f32_16x16x32_bf16 a[76:79], a[252:255], v[148:151], a[76:79]
    v_exp_f32_e64 v76, v76
    v_mfma_f32_16x16x32_bf16 a[76:79], a[248:251], v[144:147], a[76:79]
    s_add_u32 s37, s37, 16384
    v_mfma_f32_16x16x32_bf16 a[108:111], a[248:251], v[152:155], a[108:111]
    v_exp_f32_e64 v77, v77
    v_mfma_f32_16x16x32_bf16 a[108:111], a[252:255], v[156:159], a[108:111]
    v_cvt_pk_bf16_f32 v74, v76, v77
    v_mfma_f32_16x16x32_bf16 a[104:107], a[244:247], v[156:159], a[104:107]
    v_exp_f32_e64 v78, v78
    v_mfma_f32_16x16x32_bf16 a[104:107], a[240:243], v[152:155], a[104:107]
    buffer_load_dwordx4 v[224:227], v206, s[12:15], s44 offen offset:3072 sc1
    v_mfma_f32_16x16x32_bf16 a[100:103], a[232:235], v[152:155], a[100:103]
    v_exp_f32_e64 v79, v79
    v_mfma_f32_16x16x32_bf16 a[100:103], a[236:239], v[156:159], a[100:103]
    v_cvt_pk_bf16_f32 v75, v78, v79
    v_mfma_f32_16x16x32_bf16 a[96:99], a[228:231], v[156:159], a[96:99]
    v_exp_f32_e64 v80, v80
    v_mfma_f32_16x16x32_bf16 a[96:99], a[224:227], v[152:155], a[96:99]
    s_add_u32 s44, s44, 4096
    s_add_u32 s45, s45, 4096
    s_waitcnt vmcnt(22) lgkmcnt(0)
    v_mfma_f32_16x16x32_bf16 v[96:99], a[192:195], v[0:3], v[160:163]
    s_barrier
    ds_read_b64_tr_b16 a[224:225], v200 offset:16384
    v_mfma_f32_16x16x32_bf16 v[96:99], a[196:199], v[16:19], v[96:99]
    v_exp_f32_e64 v81, v81
    v_mfma_f32_16x16x32_bf16 v[96:99], a[200:203], v[32:35], v[96:99]
    ds_read_b64_tr_b16 a[226:227], v200 offset:17408
    v_cvt_pk_bf16_f32 v80, v80, v81
    v_mfma_f32_16x16x32_bf16 v[96:99], a[204:207], v[48:51], v[96:99]
    ds_read_b64_tr_b16 a[228:229], v200 offset:18432
    ds_read_b64_tr_b16 a[230:231], v200 offset:19456
    v_mfma_f32_16x16x32_bf16 v[100:103], a[220:223], v[48:51], v[160:163]
    v_exp_f32_e64 v82, v82
    v_mfma_f32_16x16x32_bf16 v[100:103], a[216:219], v[32:35], v[100:103]
    ds_read_b64_tr_b16 a[232:233], v201 offset:16384
    ds_read_b64_tr_b16 a[234:235], v201 offset:17408
    v_mfma_f32_16x16x32_bf16 v[100:103], a[212:215], v[16:19], v[100:103]
    v_exp_f32_e64 v83, v83
    v_mfma_f32_16x16x32_bf16 v[100:103], a[208:211], v[0:3], v[100:103]
    ds_read_b64_tr_b16 a[236:237], v201 offset:18432
    v_cvt_pk_bf16_f32 v81, v82, v83
    v_mfma_f32_16x16x32_bf16 v[108:111], a[208:211], v[4:7], v[164:167]
    v_exp_f32_e64 v84, v84
    v_mfma_f32_16x16x32_bf16 v[108:111], a[212:215], v[20:23], v[108:111]
    ds_read_b64_tr_b16 a[238:239], v201 offset:19456
    ds_read_b64_tr_b16 a[240:241], v202 offset:16384
    v_mfma_f32_16x16x32_bf16 v[108:111], a[216:219], v[36:39], v[108:111]
    v_exp_f32_e64 v85, v85
    v_mfma_f32_16x16x32_bf16 v[108:111], a[220:223], v[52:55], v[108:111]
    ds_read_b64_tr_b16 a[242:243], v202 offset:17408
    v_cvt_pk_bf16_f32 v82, v84, v85
    v_mfma_f32_16x16x32_bf16 v[104:107], a[204:207], v[52:55], v[164:167]
    v_exp_f32_e64 v86, v86
    v_mfma_f32_16x16x32_bf16 v[104:107], a[200:203], v[36:39], v[104:107]
    ds_read_b64_tr_b16 a[244:245], v202 offset:18432
    ds_read_b64_tr_b16 a[246:247], v202 offset:19456
    v_mfma_f32_16x16x32_bf16 v[104:107], a[196:199], v[20:23], v[104:107]
    v_exp_f32_e64 v87, v87
    v_mfma_f32_16x16x32_bf16 v[104:107], a[192:195], v[4:7], v[104:107]
    ds_read_b64_tr_b16 a[248:249], v203 offset:16384
    v_cvt_pk_bf16_f32 v83, v86, v87
    v_mfma_f32_16x16x32_bf16 v[112:115], a[192:195], v[8:11], v[168:171]
    v_exp_f32_e64 v88, v88
    v_mfma_f32_16x16x32_bf16 v[112:115], a[196:199], v[24:27], v[112:115]
    ds_read_b64_tr_b16 a[250:251], v203 offset:17408
    ds_read_b64_tr_b16 a[252:253], v203 offset:18432
    v_mfma_f32_16x16x32_bf16 v[112:115], a[200:203], v[40:43], v[112:115]
    v_exp_f32_e64 v89, v89
    v_mfma_f32_16x16x32_bf16 v[112:115], a[204:207], v[56:59], v[112:115]
    ds_read_b64_tr_b16 a[254:255], v203 offset:19456
    v_cvt_pk_bf16_f32 v88, v88, v89
    v_mfma_f32_16x16x32_bf16 v[116:119], a[220:223], v[56:59], v[168:171]
    v_exp_f32_e64 v90, v90
    v_mfma_f32_16x16x32_bf16 v[116:119], a[216:219], v[40:43], v[116:119]
    s_add_u32 m0, s36, 0
    v_mfma_f32_16x16x32_bf16 v[116:119], a[212:215], v[24:27], v[116:119]
    v_exp_f32 v91, v91
    v_mfma_f32_16x16x32_bf16 v[116:119], a[208:211], v[8:11], v[116:119]
    v_cvt_pk_bf16_f32 v89, v90, v91
    v_mfma_f32_16x16x32_bf16 v[124:127], a[208:211], v[12:15], v[172:175]
    v_exp_f32_e64 v92, v92
    v_mfma_f32_16x16x32_bf16 v[124:127], a[212:215], v[28:31], v[124:127]
    buffer_load_dwordx4 v205, s[8:11], s37 offen offset:0 lds
    v_mfma_f32_16x16x32_bf16 v[124:127], a[216:219], v[44:47], v[124:127]
    v_exp_f32_e64 v93, v93
    v_mfma_f32_16x16x32_bf16 v[124:127], a[220:223], v[60:63], v[124:127]
    v_cvt_pk_bf16_f32 v90, v92, v93
    v_mfma_f32_16x16x32_bf16 v[120:123], a[204:207], v[60:63], v[172:175]
    v_exp_f32_e64 v94, v94
    v_mfma_f32_16x16x32_bf16 v[120:123], a[200:203], v[44:47], v[120:123]
    buffer_load_dwordx4 v205, s[8:11], s37 offen offset:1024 lds
    v_mfma_f32_16x16x32_bf16 v[120:123], a[196:199], v[28:31], v[120:123]
    v_exp_f32_e64 v95, v95
    v_mfma_f32_16x16x32_bf16 v[120:123], a[192:195], v[12:15], v[120:123]
    v_cvt_pk_bf16_f32 v91, v94, v95
    s_waitcnt lgkmcnt(0)
    v_mfma_f32_16x16x32_bf16 a[16:19], a[224:227], v[128:131], a[16:19]
    v_exp_f32 v96, v96
    v_mfma_f32_16x16x32_bf16 a[16:19], a[228:231], v[132:135], a[16:19]
    ds_read_b128 a[192:195], v192 offset:49152
    v_mfma_f32_16x16x32_bf16 a[20:23], a[236:239], v[132:135], a[20:23]
    v_exp_f32_e64 v97, v97
    v_mfma_f32_16x16x32_bf16 a[20:23], a[232:235], v[128:131], a[20:23]
    ds_read_b128 a[196:199], v193 offset:49152
    v_cvt_pk_bf16_f32 v68, v96, v97
    v_mfma_f32_16x16x32_bf16 a[24:27], a[240:243], v[128:131], a[24:27]
    v_exp_f32_e64 v98, v98
    v_mfma_f32_16x16x32_bf16 a[24:27], a[244:247], v[132:135], a[24:27]
    ds_read_b128 a[200:203], v194 offset:49152
    v_mfma_f32_16x16x32_bf16 a[28:31], a[252:255], v[132:135], a[28:31]
    v_exp_f32_e64 v99, v99
    v_mfma_f32_16x16x32_bf16 a[28:31], a[248:251], v[128:131], a[28:31]
    ds_read_b128 a[204:207], v195 offset:49152
    v_cvt_pk_bf16_f32 v69, v98, v99
    v_mfma_f32_16x16x32_bf16 a[60:63], a[248:251], v[136:139], a[60:63]
    v_exp_f32_e64 v100, v100
    v_mfma_f32_16x16x32_bf16 a[60:63], a[252:255], v[140:143], a[60:63]
    ds_read_b128 a[208:211], v192 offset:50176
    v_mfma_f32_16x16x32_bf16 a[56:59], a[244:247], v[140:143], a[56:59]
    v_exp_f32_e64 v101, v101
    v_mfma_f32_16x16x32_bf16 a[56:59], a[240:243], v[136:139], a[56:59]
    ds_read_b128 a[212:215], v193 offset:50176
    v_cvt_pk_bf16_f32 v70, v100, v101
    v_mfma_f32_16x16x32_bf16 a[52:55], a[232:235], v[136:139], a[52:55]
    v_exp_f32_e64 v102, v102
    v_mfma_f32_16x16x32_bf16 a[52:55], a[236:239], v[140:143], a[52:55]
    ds_read_b128 a[216:219], v194 offset:50176
    v_mfma_f32_16x16x32_bf16 a[48:51], a[228:231], v[140:143], a[48:51]
    v_exp_f32_e64 v103, v103
    v_mfma_f32_16x16x32_bf16 a[48:51], a[224:227], v[136:139], a[48:51]
    ds_read_b128 a[220:223], v195 offset:50176
    v_cvt_pk_bf16_f32 v71, v102, v103
    v_mfma_f32_16x16x32_bf16 a[80:83], a[224:227], v[144:147], a[80:83]
    v_exp_f32_e64 v104, v104
    v_mfma_f32_16x16x32_bf16 a[80:83], a[228:231], v[148:151], a[80:83]
    buffer_load_dwordx4 v205, s[8:11], s37 offen offset:2048 lds
    v_mfma_f32_16x16x32_bf16 a[84:87], a[236:239], v[148:151], a[84:87]
    v_exp_f32_e64 v105, v105
    v_mfma_f32_16x16x32_bf16 a[84:87], a[232:235], v[144:147], a[84:87]
    v_cvt_pk_bf16_f32 v76, v104, v105
    v_mfma_f32_16x16x32_bf16 a[88:91], a[240:243], v[144:147], a[88:91]
    v_exp_f32_e64 v106, v106
    v_mfma_f32_16x16x32_bf16 a[88:91], a[244:247], v[148:151], a[88:91]
    buffer_load_dwordx4 v205, s[8:11], s37 offen offset:3072 lds
    v_mfma_f32_16x16x32_bf16 a[92:95], a[252:255], v[148:151], a[92:95]
    v_exp_f32_e64 v107, v107
    v_mfma_f32_16x16x32_bf16 a[92:95], a[248:251], v[144:147], a[92:95]
    v_cvt_pk_bf16_f32 v77, v106, v107
    v_mfma_f32_16x16x32_bf16 a[124:127], a[248:251], v[152:155], a[124:127]
    v_exp_f32_e64 v108, v108
    v_mfma_f32_16x16x32_bf16 a[124:127], a[252:255], v[156:159], a[124:127]
    s_add_u32 m0, s35, 32768
    v_mfma_f32_16x16x32_bf16 a[120:123], a[244:247], v[156:159], a[120:123]
    v_exp_f32_e64 v109, v109
    v_mfma_f32_16x16x32_bf16 a[120:123], a[240:243], v[152:155], a[120:123]
    v_cvt_pk_bf16_f32 v78, v108, v109
    v_mfma_f32_16x16x32_bf16 a[116:119], a[232:235], v[152:155], a[116:119]
    v_exp_f32_e64 v110, v110
    v_mfma_f32_16x16x32_bf16 a[116:119], a[236:239], v[156:159], a[116:119]
    v_mfma_f32_16x16x32_bf16 a[112:115], a[228:231], v[156:159], a[112:115]
    v_exp_f32_e64 v111, v111
    v_mfma_f32_16x16x32_bf16 a[112:115], a[224:227], v[152:155], a[112:115]
    v_cvt_pk_bf16_f32 v79, v110, v111
    s_waitcnt lgkmcnt(0)
    v_mfma_f32_16x16x32_bf16 v[128:131], a[192:195], v[0:3], v[160:163]
    ds_read_b64_tr_b16 a[224:225], v196 offset:32768
    ds_read_b64_tr_b16 a[226:227], v196 offset:33792
    v_mfma_f32_16x16x32_bf16 v[128:131], a[196:199], v[16:19], v[128:131]
    v_exp_f32 v112, v112
    v_mfma_f32_16x16x32_bf16 v[128:131], a[200:203], v[32:35], v[128:131]
    ds_read_b64_tr_b16 a[228:229], v196 offset:34816
    ds_read_b64_tr_b16 a[230:231], v196 offset:35840
    v_mfma_f32_16x16x32_bf16 v[128:131], a[204:207], v[48:51], v[128:131]
    v_exp_f32_e64 v113, v113
    v_mfma_f32_16x16x32_bf16 v[132:135], a[220:223], v[48:51], v[160:163]
    ds_read_b64_tr_b16 a[232:233], v197 offset:32768
    v_cvt_pk_bf16_f32 v84, v112, v113
    v_mfma_f32_16x16x32_bf16 v[132:135], a[216:219], v[32:35], v[132:135]
    ds_read_b64_tr_b16 a[234:235], v197 offset:33792
    ds_read_b64_tr_b16 a[236:237], v197 offset:34816
    v_mfma_f32_16x16x32_bf16 v[132:135], a[212:215], v[16:19], v[132:135]
    v_exp_f32_e64 v114, v114
    v_mfma_f32_16x16x32_bf16 v[132:135], a[208:211], v[0:3], v[132:135]
    ds_read_b64_tr_b16 a[238:239], v197 offset:35840
    ds_read_b64_tr_b16 a[240:241], v198 offset:32768
    v_mfma_f32_16x16x32_bf16 v[140:143], a[208:211], v[4:7], v[164:167]
    v_exp_f32_e64 v115, v115
    v_mfma_f32_16x16x32_bf16 v[140:143], a[212:215], v[20:23], v[140:143]
    ds_read_b64_tr_b16 a[242:243], v198 offset:33792
    v_cvt_pk_bf16_f32 v85, v114, v115
    v_mfma_f32_16x16x32_bf16 v[140:143], a[216:219], v[36:39], v[140:143]
    v_exp_f32_e64 v116, v116
    v_mfma_f32_16x16x32_bf16 v[140:143], a[220:223], v[52:55], v[140:143]
    ds_read_b64_tr_b16 a[244:245], v198 offset:34816
    ds_read_b64_tr_b16 a[246:247], v198 offset:35840
    v_mfma_f32_16x16x32_bf16 v[136:139], a[204:207], v[52:55], v[164:167]
    v_exp_f32_e64 v117, v117
    v_mfma_f32_16x16x32_bf16 v[136:139], a[200:203], v[36:39], v[136:139]
    ds_read_b64_tr_b16 a[248:249], v199 offset:32768
    v_cvt_pk_bf16_f32 v86, v116, v117
    v_mfma_f32_16x16x32_bf16 v[136:139], a[196:199], v[20:23], v[136:139]
    v_exp_f32_e64 v118, v118
    v_mfma_f32_16x16x32_bf16 v[136:139], a[192:195], v[4:7], v[136:139]
    ds_read_b64_tr_b16 a[250:251], v199 offset:33792
    ds_read_b64_tr_b16 a[252:253], v199 offset:34816
    v_smfmac_f32_16x16x64_bf16 a[128:131], v[208:211], v[64:71], v207
    v_exp_f32_e64 v119, v119
    v_smfmac_f32_16x16x64_bf16 a[132:135], v[208:211], v[72:79], v207
    ds_read_b64_tr_b16 a[254:255], v199 offset:35840
    v_cvt_pk_bf16_f32 v87, v118, v119
    v_mfma_f32_16x16x32_bf16 v[144:147], a[192:195], v[8:11], v[168:171]
    v_exp_f32_e64 v120, v120
    v_mfma_f32_16x16x32_bf16 v[144:147], a[196:199], v[24:27], v[144:147]
    v_mfma_f32_16x16x32_bf16 v[144:147], a[200:203], v[40:43], v[144:147]
    v_exp_f32_e64 v121, v121
    v_mfma_f32_16x16x32_bf16 v[144:147], a[204:207], v[56:59], v[144:147]
    v_cvt_pk_bf16_f32 v92, v120, v121
    v_mfma_f32_16x16x32_bf16 v[148:151], a[220:223], v[56:59], v[168:171]
    v_exp_f32_e64 v122, v122
    v_mfma_f32_16x16x32_bf16 v[148:151], a[216:219], v[40:43], v[148:151]
    buffer_load_dwordx4 v204, s[4:7], s37 offen offset:0 lds
    v_mfma_f32_16x16x32_bf16 v[148:151], a[212:215], v[24:27], v[148:151]
    v_exp_f32_e64 v123, v123
    v_mfma_f32_16x16x32_bf16 v[148:151], a[208:211], v[8:11], v[148:151]
    v_cvt_pk_bf16_f32 v93, v122, v123
    v_mfma_f32_16x16x32_bf16 v[156:159], a[208:211], v[12:15], v[172:175]
    v_exp_f32_e64 v124, v124
    v_mfma_f32_16x16x32_bf16 v[156:159], a[212:215], v[28:31], v[156:159]
    buffer_load_dwordx4 v204, s[4:7], s37 offen offset:1024 lds
    v_mfma_f32_16x16x32_bf16 v[156:159], a[216:219], v[44:47], v[156:159]
    v_exp_f32_e64 v125, v125
    v_mfma_f32_16x16x32_bf16 v[156:159], a[220:223], v[60:63], v[156:159]
    v_cvt_pk_bf16_f32 v94, v124, v125
    v_mfma_f32_16x16x32_bf16 v[152:155], a[204:207], v[60:63], v[172:175]
    v_exp_f32_e64 v126, v126
    v_mfma_f32_16x16x32_bf16 v[152:155], a[200:203], v[44:47], v[152:155]
    v_mfma_f32_16x16x32_bf16 v[152:155], a[196:199], v[28:31], v[152:155]
    v_exp_f32_e64 v127, v127
    v_mfma_f32_16x16x32_bf16 v[152:155], a[192:195], v[12:15], v[152:155]
    v_cvt_pk_bf16_f32 v95, v126, v127
    s_waitcnt lgkmcnt(0)
    v_mfma_f32_16x16x32_bf16 a[0:3], a[224:227], v[64:67], a[0:3]
    v_exp_f32 v128, v128
    v_mfma_f32_16x16x32_bf16 a[0:3], a[228:231], v[68:71], a[0:3]
    ds_read_b128 a[192:195], v192 offset:51200
    v_mfma_f32_16x16x32_bf16 a[4:7], a[236:239], v[68:71], a[4:7]
    v_exp_f32_e64 v129, v129
    v_mfma_f32_16x16x32_bf16 a[4:7], a[232:235], v[64:67], a[4:7]
    ds_read_b128 a[196:199], v193 offset:51200
    v_cvt_pk_bf16_f32 v128, v128, v129
    v_mfma_f32_16x16x32_bf16 a[8:11], a[240:243], v[64:67], a[8:11]
    v_exp_f32_e64 v130, v130
    v_mfma_f32_16x16x32_bf16 a[8:11], a[244:247], v[68:71], a[8:11]
    ds_read_b128 a[200:203], v194 offset:51200
    v_mfma_f32_16x16x32_bf16 a[12:15], a[252:255], v[68:71], a[12:15]
    v_exp_f32_e64 v131, v131
    v_mfma_f32_16x16x32_bf16 a[12:15], a[248:251], v[64:67], a[12:15]
    ds_read_b128 a[204:207], v195 offset:51200
    v_cvt_pk_bf16_f32 v129, v130, v131
    v_mfma_f32_16x16x32_bf16 a[44:47], a[248:251], v[72:75], a[44:47]
    v_exp_f32_e64 v132, v132
    v_mfma_f32_16x16x32_bf16 a[44:47], a[252:255], v[76:79], a[44:47]
    ds_read_b128 a[208:211], v192 offset:52224
    v_mfma_f32_16x16x32_bf16 a[40:43], a[244:247], v[76:79], a[40:43]
    v_exp_f32_e64 v133, v133
    v_mfma_f32_16x16x32_bf16 a[40:43], a[240:243], v[72:75], a[40:43]
    ds_read_b128 a[212:215], v193 offset:52224
    v_cvt_pk_bf16_f32 v130, v132, v133
    v_mfma_f32_16x16x32_bf16 a[36:39], a[232:235], v[72:75], a[36:39]
    v_exp_f32_e64 v134, v134
    v_mfma_f32_16x16x32_bf16 a[36:39], a[236:239], v[76:79], a[36:39]
    ds_read_b128 a[216:219], v194 offset:52224
    v_mfma_f32_16x16x32_bf16 a[32:35], a[228:231], v[76:79], a[32:35]
    v_exp_f32_e64 v135, v135
    v_mfma_f32_16x16x32_bf16 a[32:35], a[224:227], v[72:75], a[32:35]
    ds_read_b128 a[220:223], v195 offset:52224
    v_cvt_pk_bf16_f32 v131, v134, v135
    v_smfmac_f32_16x16x64_bf16 a[136:139], v[208:211], v[80:87], v207
    v_exp_f32_e64 v136, v136
    v_smfmac_f32_16x16x64_bf16 a[140:143], v[208:211], v[88:95], v207
    buffer_load_dwordx4 v204, s[4:7], s37 offen offset:2048 lds
    v_mfma_f32_16x16x32_bf16 a[64:67], a[224:227], v[80:83], a[64:67]
    v_exp_f32_e64 v137, v137
    v_mfma_f32_16x16x32_bf16 a[64:67], a[228:231], v[84:87], a[64:67]
    v_cvt_pk_bf16_f32 v136, v136, v137
    v_mfma_f32_16x16x32_bf16 a[68:71], a[236:239], v[84:87], a[68:71]
    v_exp_f32_e64 v138, v138
    v_mfma_f32_16x16x32_bf16 a[68:71], a[232:235], v[80:83], a[68:71]
    buffer_load_dwordx4 v204, s[4:7], s37 offen offset:3072 lds
    v_mfma_f32_16x16x32_bf16 a[72:75], a[240:243], v[80:83], a[72:75]
    v_exp_f32_e64 v139, v139
    v_mfma_f32_16x16x32_bf16 a[72:75], a[244:247], v[84:87], a[72:75]
    v_cvt_pk_bf16_f32 v137, v138, v139
    v_mfma_f32_16x16x32_bf16 a[76:79], a[252:255], v[84:87], a[76:79]
    v_exp_f32_e64 v140, v140
    v_mfma_f32_16x16x32_bf16 a[76:79], a[248:251], v[80:83], a[76:79]
    s_add_u32 s37, s37, 16384
    v_mfma_f32_16x16x32_bf16 a[108:111], a[248:251], v[88:91], a[108:111]
    v_exp_f32_e64 v141, v141
    v_mfma_f32_16x16x32_bf16 a[108:111], a[252:255], v[92:95], a[108:111]
    v_cvt_pk_bf16_f32 v138, v140, v141
    v_mfma_f32_16x16x32_bf16 a[104:107], a[244:247], v[92:95], a[104:107]
    v_exp_f32_e64 v142, v142
    v_mfma_f32_16x16x32_bf16 a[104:107], a[240:243], v[88:91], a[104:107]
    v_mfma_f32_16x16x32_bf16 a[100:103], a[232:235], v[88:91], a[100:103]
    v_exp_f32_e64 v143, v143
    v_mfma_f32_16x16x32_bf16 a[100:103], a[236:239], v[92:95], a[100:103]
    v_cvt_pk_bf16_f32 v139, v142, v143
    v_mfma_f32_16x16x32_bf16 a[96:99], a[228:231], v[92:95], a[96:99]
    v_exp_f32_e64 v144, v144
    v_mfma_f32_16x16x32_bf16 a[96:99], a[224:227], v[88:91], a[96:99]
    s_waitcnt vmcnt(18) lgkmcnt(0)
    v_mfma_f32_16x16x32_bf16 v[96:99], a[192:195], v[0:3], v[160:163]
    s_barrier
    ds_read_b64_tr_b16 a[224:225], v200 offset:32768
    v_mfma_f32_16x16x32_bf16 v[96:99], a[196:199], v[16:19], v[96:99]
    v_exp_f32_e64 v145, v145
    v_mfma_f32_16x16x32_bf16 v[96:99], a[200:203], v[32:35], v[96:99]
    ds_read_b64_tr_b16 a[226:227], v200 offset:33792
    v_cvt_pk_bf16_f32 v144, v144, v145
    v_mfma_f32_16x16x32_bf16 v[96:99], a[204:207], v[48:51], v[96:99]
    ds_read_b64_tr_b16 a[228:229], v200 offset:34816
    ds_read_b64_tr_b16 a[230:231], v200 offset:35840
    v_mfma_f32_16x16x32_bf16 v[100:103], a[220:223], v[48:51], v[160:163]
    v_exp_f32_e64 v146, v146
    v_mfma_f32_16x16x32_bf16 v[100:103], a[216:219], v[32:35], v[100:103]
    ds_read_b64_tr_b16 a[232:233], v201 offset:32768
    ds_read_b64_tr_b16 a[234:235], v201 offset:33792
    v_mfma_f32_16x16x32_bf16 v[100:103], a[212:215], v[16:19], v[100:103]
    v_exp_f32_e64 v147, v147
    v_mfma_f32_16x16x32_bf16 v[100:103], a[208:211], v[0:3], v[100:103]
    ds_read_b64_tr_b16 a[236:237], v201 offset:34816
    v_cvt_pk_bf16_f32 v145, v146, v147
    s_waitcnt vmcnt(14)
    s_waitcnt vmcnt(11)
    v_mfma_f32_16x16x32_bf16 a[144:147], v[228:231], v[212:215], a[144:147]
    v_mfma_f32_16x16x32_bf16 a[148:151], v[232:235], v[212:215], a[148:151]
    v_mfma_f32_16x16x32_bf16 a[152:155], v[236:239], v[212:215], a[152:155]
    v_mfma_f32_16x16x32_bf16 a[156:159], v[240:243], v[212:215], a[156:159]
    buffer_load_dwordx4 v[212:215], v206, s[12:15], s44 offen offset:0 sc1
    v_mfma_f32_16x16x32_bf16 v[108:111], a[208:211], v[4:7], v[164:167]
    v_exp_f32_e64 v148, v148
    v_mfma_f32_16x16x32_bf16 v[108:111], a[212:215], v[20:23], v[108:111]
    ds_read_b64_tr_b16 a[238:239], v201 offset:35840
    ds_read_b64_tr_b16 a[240:241], v202 offset:32768
    v_mfma_f32_16x16x32_bf16 v[108:111], a[216:219], v[36:39], v[108:111]
    v_exp_f32_e64 v149, v149
    v_mfma_f32_16x16x32_bf16 v[108:111], a[220:223], v[52:55], v[108:111]
    ds_read_b64_tr_b16 a[242:243], v202 offset:33792
    v_cvt_pk_bf16_f32 v146, v148, v149
    v_mfma_f32_16x16x32_bf16 v[104:107], a[204:207], v[52:55], v[164:167]
    v_exp_f32_e64 v150, v150
    v_mfma_f32_16x16x32_bf16 v[104:107], a[200:203], v[36:39], v[104:107]
    ds_read_b64_tr_b16 a[244:245], v202 offset:34816
    ds_read_b64_tr_b16 a[246:247], v202 offset:35840
    v_mfma_f32_16x16x32_bf16 v[104:107], a[196:199], v[20:23], v[104:107]
    v_exp_f32_e64 v151, v151
    v_mfma_f32_16x16x32_bf16 v[104:107], a[192:195], v[4:7], v[104:107]
    ds_read_b64_tr_b16 a[248:249], v203 offset:32768
    v_cvt_pk_bf16_f32 v147, v150, v151
    v_mfma_f32_16x16x32_bf16 v[112:115], a[192:195], v[8:11], v[168:171]
    v_exp_f32_e64 v152, v152
    v_mfma_f32_16x16x32_bf16 v[112:115], a[196:199], v[24:27], v[112:115]
    ds_read_b64_tr_b16 a[250:251], v203 offset:33792
    ds_read_b64_tr_b16 a[252:253], v203 offset:34816
    v_mfma_f32_16x16x32_bf16 v[112:115], a[200:203], v[40:43], v[112:115]
    v_exp_f32_e64 v153, v153
    v_mfma_f32_16x16x32_bf16 v[112:115], a[204:207], v[56:59], v[112:115]
    ds_read_b64_tr_b16 a[254:255], v203 offset:35840
    v_cvt_pk_bf16_f32 v152, v152, v153
    v_mfma_f32_16x16x32_bf16 v[116:119], a[220:223], v[56:59], v[168:171]
    v_exp_f32_e64 v154, v154
    v_mfma_f32_16x16x32_bf16 v[116:119], a[216:219], v[40:43], v[116:119]
    s_add_u32 m0, s36, 16384
    v_mfma_f32_16x16x32_bf16 v[116:119], a[212:215], v[24:27], v[116:119]
    v_exp_f32_e64 v155, v155
    v_mfma_f32_16x16x32_bf16 v[116:119], a[208:211], v[8:11], v[116:119]
    v_cvt_pk_bf16_f32 v153, v154, v155
    v_mfma_f32_16x16x32_bf16 v[124:127], a[208:211], v[12:15], v[172:175]
    v_exp_f32_e64 v156, v156
    v_mfma_f32_16x16x32_bf16 v[124:127], a[212:215], v[28:31], v[124:127]
    buffer_load_dwordx4 v205, s[8:11], s37 offen offset:0 lds
    v_mfma_f32_16x16x32_bf16 v[124:127], a[216:219], v[44:47], v[124:127]
    v_exp_f32_e64 v157, v157
    v_mfma_f32_16x16x32_bf16 v[124:127], a[220:223], v[60:63], v[124:127]
    v_cvt_pk_bf16_f32 v154, v156, v157
    v_mfma_f32_16x16x32_bf16 v[120:123], a[204:207], v[60:63], v[172:175]
    v_exp_f32_e64 v158, v158
    v_mfma_f32_16x16x32_bf16 v[120:123], a[200:203], v[44:47], v[120:123]
    buffer_load_dwordx4 v205, s[8:11], s37 offen offset:1024 lds
    v_mfma_f32_16x16x32_bf16 v[120:123], a[196:199], v[28:31], v[120:123]
    v_exp_f32_e64 v159, v159
    v_mfma_f32_16x16x32_bf16 v[120:123], a[192:195], v[12:15], v[120:123]
    v_cvt_pk_bf16_f32 v155, v158, v159
    s_waitcnt lgkmcnt(0)
    v_mfma_f32_16x16x32_bf16 a[16:19], a[224:227], v[64:67], a[16:19]
    v_exp_f32 v96, v96
    v_mfma_f32_16x16x32_bf16 a[16:19], a[228:231], v[68:71], a[16:19]
    ds_read_b128 a[192:195], v192 offset:0
    v_mfma_f32_16x16x32_bf16 a[20:23], a[236:239], v[68:71], a[20:23]
    v_exp_f32_e64 v97, v97
    v_mfma_f32_16x16x32_bf16 a[20:23], a[232:235], v[64:67], a[20:23]
    ds_read_b128 a[196:199], v193 offset:0
    v_cvt_pk_bf16_f32 v132, v96, v97
    v_mfma_f32_16x16x32_bf16 a[24:27], a[240:243], v[64:67], a[24:27]
    v_exp_f32_e64 v98, v98
    v_mfma_f32_16x16x32_bf16 a[24:27], a[244:247], v[68:71], a[24:27]
    ds_read_b128 a[200:203], v194 offset:0
    v_mfma_f32_16x16x32_bf16 a[28:31], a[252:255], v[68:71], a[28:31]
    v_exp_f32_e64 v99, v99
    v_mfma_f32_16x16x32_bf16 a[28:31], a[248:251], v[64:67], a[28:31]
    ds_read_b128 a[204:207], v195 offset:0
    v_cvt_pk_bf16_f32 v133, v98, v99
    v_mfma_f32_16x16x32_bf16 a[160:163], v[228:231], v[216:219], a[160:163]
    v_mfma_f32_16x16x32_bf16 a[164:167], v[232:235], v[216:219], a[164:167]
    v_mfma_f32_16x16x32_bf16 a[168:171], v[236:239], v[216:219], a[168:171]
    v_mfma_f32_16x16x32_bf16 a[172:175], v[240:243], v[216:219], a[172:175]
    buffer_load_dwordx4 v[216:219], v206, s[12:15], s44 offen offset:1024 sc1
    v_mfma_f32_16x16x32_bf16 a[60:63], a[248:251], v[72:75], a[60:63]
    v_exp_f32_e64 v100, v100
    v_mfma_f32_16x16x32_bf16 a[60:63], a[252:255], v[76:79], a[60:63]
    ds_read_b128 a[208:211], v192 offset:1024
    v_mfma_f32_16x16x32_bf16 a[56:59], a[244:247], v[76:79], a[56:59]
    v_exp_f32_e64 v101, v101
    v_mfma_f32_16x16x32_bf16 a[56:59], a[240:243], v[72:75], a[56:59]
    ds_read_b128 a[212:215], v193 offset:1024
    v_cvt_pk_bf16_f32 v134, v100, v101
    v_mfma_f32_16x16x32_bf16 a[52:55], a[232:235], v[72:75], a[52:55]
    v_exp_f32_e64 v102, v102
    v_mfma_f32_16x16x32_bf16 a[52:55], a[236:239], v[76:79], a[52:55]
    ds_read_b128 a[216:219], v194 offset:1024
    v_mfma_f32_16x16x32_bf16 a[48:51], a[228:231], v[76:79], a[48:51]
    v_exp_f32_e64 v103, v103
    v_mfma_f32_16x16x32_bf16 a[48:51], a[224:227], v[72:75], a[48:51]
    ds_read_b128 a[220:223], v195 offset:1024
    v_cvt_pk_bf16_f32 v135, v102, v103
    v_mfma_f32_16x16x32_bf16 a[80:83], a[224:227], v[80:83], a[80:83]
    v_exp_f32_e64 v104, v104
    v_mfma_f32_16x16x32_bf16 a[80:83], a[228:231], v[84:87], a[80:83]
    buffer_load_dwordx4 v205, s[8:11], s37 offen offset:2048 lds
    v_mfma_f32_16x16x32_bf16 a[84:87], a[236:239], v[84:87], a[84:87]
    v_exp_f32_e64 v105, v105
    v_mfma_f32_16x16x32_bf16 a[84:87], a[232:235], v[80:83], a[84:87]
    v_cvt_pk_bf16_f32 v140, v104, v105
    v_mfma_f32_16x16x32_bf16 a[88:91], a[240:243], v[80:83], a[88:91]
    v_exp_f32_e64 v106, v106
    v_mfma_f32_16x16x32_bf16 a[88:91], a[244:247], v[84:87], a[88:91]
    buffer_load_dwordx4 v205, s[8:11], s37 offen offset:3072 lds
    v_mfma_f32_16x16x32_bf16 a[92:95], a[252:255], v[84:87], a[92:95]
    v_exp_f32_e64 v107, v107
    v_mfma_f32_16x16x32_bf16 a[92:95], a[248:251], v[80:83], a[92:95]
    v_cvt_pk_bf16_f32 v141, v106, v107
    v_mfma_f32_16x16x32_bf16 a[124:127], a[248:251], v[88:91], a[124:127]
    v_exp_f32_e64 v108, v108
    v_mfma_f32_16x16x32_bf16 a[124:127], a[252:255], v[92:95], a[124:127]
    s_add_u32 m0, s35, 49152
    v_mfma_f32_16x16x32_bf16 a[120:123], a[244:247], v[92:95], a[120:123]
    v_exp_f32_e64 v109, v109
    v_mfma_f32_16x16x32_bf16 a[120:123], a[240:243], v[88:91], a[120:123]
    v_cvt_pk_bf16_f32 v142, v108, v109
    v_mfma_f32_16x16x32_bf16 a[116:119], a[232:235], v[88:91], a[116:119]
    v_exp_f32_e64 v110, v110
    v_mfma_f32_16x16x32_bf16 a[116:119], a[236:239], v[92:95], a[116:119]
    v_mfma_f32_16x16x32_bf16 a[112:115], a[228:231], v[92:95], a[112:115]
    v_exp_f32_e64 v111, v111
    v_mfma_f32_16x16x32_bf16 a[112:115], a[224:227], v[88:91], a[112:115]
    v_cvt_pk_bf16_f32 v143, v110, v111
    s_waitcnt lgkmcnt(0)
    v_mfma_f32_16x16x32_bf16 v[64:67], a[192:195], v[0:3], v[160:163]
    ds_read_b64_tr_b16 a[224:225], v196 offset:49152
    ds_read_b64_tr_b16 a[226:227], v196 offset:50176
    v_mfma_f32_16x16x32_bf16 v[64:67], a[196:199], v[16:19], v[64:67]
    v_exp_f32 v112, v112
L_hop9:
    s_cbranch_execz L_ret2
    v_mfma_f32_16x16x32_bf16 v[64:67], a[200:203], v[32:35], v[64:67]
    ds_read_b64_tr_b16 a[228:229], v196 offset:51200
    ds_read_b64_tr_b16 a[230:231], v196 offset:52224
    v_mfma_f32_16x16x32_bf16 v[64:67], a[204:207], v[48:51], v[64:67]
    v_exp_f32 v113, v113
    v_mfma_f32_16x16x32_bf16 v[68:71], a[220:223], v[48:51], v[160:163]
    ds_read_b64_tr_b16 a[232:233], v197 offset:49152
    v_cvt_pk_bf16_f32 v148, v112, v113
    v_mfma_f32_16x16x32_bf16 v[68:71], a[216:219], v[32:35], v[68:71]
    ds_read_b64_tr_b16 a[234:235], v197 offset:50176
    ds_read_b64_tr_b16 a[236:237], v197 offset:51200
    v_mfma_f32_16x16x32_bf16 v[68:71], a[212:215], v[16:19], v[68:71]
    v_exp_f32_e64 v114, v114
    v_mfma_f32_16x16x32_bf16 v[68:71], a[208:211], v[0:3], v[68:71]
    ds_read_b64_tr_b16 a[238:239], v197 offset:52224
    ds_read_b64_tr_b16 a[240:241], v198 offset:49152
    v_mfma_f32_16x16x32_bf16 a[176:179], v[228:231], v[220:223], a[176:179]
    v_mfma_f32_16x16x32_bf16 a[180:183], v[232:235], v[220:223], a[180:183]
    v_mfma_f32_16x16x32_bf16 a[184:187], v[236:239], v[220:223], a[184:187]
    v_mfma_f32_16x16x32_bf16 a[188:191], v[240:243], v[220:223], a[188:191]
    buffer_load_dwordx4 v[220:223], v206, s[12:15], s44 offen offset:2048 sc1
    v_mfma_f32_16x16x32_bf16 v[76:79], a[208:211], v[4:7], v[164:167]
    v_exp_f32_e64 v115, v115
    v_mfma_f32_16x16x32_bf16 v[76:79], a[212:215], v[20:23], v[76:79]
    ds_read_b64_tr_b16 a[242:243], v198 offset:50176
    v_cvt_pk_bf16_f32 v149, v114, v115
    v_mfma_f32_16x16x32_bf16 v[76:79], a[216:219], v[36:39], v[76:79]
    v_exp_f32_e64 v116, v116
    v_mfma_f32_16x16x32_bf16 v[76:79], a[220:223], v[52:55], v[76:79]
    ds_read_b64_tr_b16 a[244:245], v198 offset:51200
    ds_read_b64_tr_b16 a[246:247], v198 offset:52224
    v_mfma_f32_16x16x32_bf16 v[72:75], a[204:207], v[52:55], v[164:167]
    v_exp_f32_e64 v117, v117
    v_mfma_f32_16x16x32_bf16 v[72:75], a[200:203], v[36:39], v[72:75]
    ds_read_b64_tr_b16 a[248:249], v199 offset:49152
    v_cvt_pk_bf16_f32 v150, v116, v117
    v_mfma_f32_16x16x32_bf16 v[72:75], a[196:199], v[20:23], v[72:75]
    v_exp_f32_e64 v118, v118
    v_mfma_f32_16x16x32_bf16 v[72:75], a[192:195], v[4:7], v[72:75]
    ds_read_b64_tr_b16 a[250:251], v199 offset:50176
    ds_read_b64_tr_b16 a[252:253], v199 offset:51200
    v_smfmac_f32_16x16x64_bf16 a[128:131], v[208:211], v[128:135], v207
    v_exp_f32_e64 v119, v119
    v_smfmac_f32_16x16x64_bf16 a[132:135], v[208:211], v[136:143], v207
    ds_read_b64_tr_b16 a[254:255], v199 offset:52224
    v_cvt_pk_bf16_f32 v151, v118, v119
    v_mfma_f32_16x16x32_bf16 v[80:83], a[192:195], v[8:11], v[168:171]
    v_exp_f32_e64 v120, v120
    v_mfma_f32_16x16x32_bf16 v[80:83], a[196:199], v[24:27], v[80:83]
    v_mfma_f32_16x16x32_bf16 v[80:83], a[200:203], v[40:43], v[80:83]
    v_exp_f32_e64 v121, v121
    v_mfma_f32_16x16x32_bf16 v[80:83], a[204:207], v[56:59], v[80:83]
    v_cvt_pk_bf16_f32 v156, v120, v121
    v_mfma_f32_16x16x32_bf16 v[84:87], a[220:223], v[56:59], v[168:171]
    v_exp_f32_e64 v122, v122
    v_mfma_f32_16x16x32_bf16 v[84:87], a[216:219], v[40:43], v[84:87]
    buffer_load_dwordx4 v204, s[4:7], s37 offen offset:0 lds
    v_mfma_f32_16x16x32_bf16 v[84:87], a[212:215], v[24:27], v[84:87]
    v_exp_f32_e64 v123, v123
    v_mfma_f32_16x16x32_bf16 v[84:87], a[208:211], v[8:11], v[84:87]
    v_cvt_pk_bf16_f32 v157, v122, v123
    v_mfma_f32_16x16x32_bf16 v[92:95], a[208:211], v[12:15], v[172:175]
    v_exp_f32_e64 v124, v124
    v_mfma_f32_16x16x32_bf16 v[92:95], a[212:215], v[28:31], v[92:95]
    buffer_load_dwordx4 v204, s[4:7], s37 offen offset:1024 lds
    v_mfma_f32_16x16x32_bf16 v[92:95], a[216:219], v[44:47], v[92:95]
    v_exp_f32_e64 v125, v125
    v_mfma_f32_16x16x32_bf16 v[92:95], a[220:223], v[60:63], v[92:95]
    v_cvt_pk_bf16_f32 v158, v124, v125
    v_mfma_f32_16x16x32_bf16 v[88:91], a[204:207], v[60:63], v[172:175]
    v_exp_f32_e64 v126, v126
    v_mfma_f32_16x16x32_bf16 v[88:91], a[200:203], v[44:47], v[88:91]
    v_mfma_f32_16x16x32_bf16 v[88:91], a[196:199], v[28:31], v[88:91]
    v_exp_f32_e64 v127, v127
    v_mfma_f32_16x16x32_bf16 v[88:91], a[192:195], v[12:15], v[88:91]
    v_cvt_pk_bf16_f32 v159, v126, v127
    s_waitcnt lgkmcnt(0)
    v_mfma_f32_16x16x32_bf16 a[0:3], a[224:227], v[128:131], a[0:3]
    v_exp_f32 v64, v64
    v_mfma_f32_16x16x32_bf16 a[0:3], a[228:231], v[132:135], a[0:3]
    ds_read_b128 a[192:195], v192 offset:2048
    s_waitcnt vmcnt(17)
    v_mfma_f32_16x16x32_bf16 v[176:179], v[228:231], v[224:227], v[176:179]
    buffer_load_dwordx4 v[228:231], v206, s[12:15], s45 offen offset:0 sc1
    v_mfma_f32_16x16x32_bf16 v[180:183], v[232:235], v[224:227], v[180:183]
    v_exp_f32 v65, v65
    v_mfma_f32_16x16x32_bf16 v[184:187], v[236:239], v[224:227], v[184:187]
    ds_read_b128 a[196:199], v193 offset:2048
    v_cvt_pk_bf16_f32 v64, v64, v65
    v_mfma_f32_16x16x32_bf16 v[188:191], v[240:243], v[224:227], v[188:191]
    v_exp_f32_e64 v66, v66
    v_mfma_f32_16x16x32_bf16 a[4:7], a[236:239], v[132:135], a[4:7]
    ds_read_b128 a[200:203], v194 offset:2048
    v_mfma_f32_16x16x32_bf16 a[4:7], a[232:235], v[128:131], a[4:7]
    buffer_load_dwordx4 v[232:235], v206, s[12:15], s45 offen offset:1024 sc1
    v_mfma_f32_16x16x32_bf16 a[8:11], a[240:243], v[128:131], a[8:11]
    v_exp_f32_e64 v67, v67
    v_mfma_f32_16x16x32_bf16 a[8:11], a[244:247], v[132:135], a[8:11]
    ds_read_b128 a[204:207], v195 offset:2048
    v_cvt_pk_bf16_f32 v65, v66, v67
    v_mfma_f32_16x16x32_bf16 a[12:15], a[252:255], v[132:135], a[12:15]
    v_exp_f32_e64 v68, v68
    v_mfma_f32_16x16x32_bf16 a[12:15], a[248:251], v[128:131], a[12:15]
    ds_read_b128 a[208:211], v192 offset:3072
    v_mfma_f32_16x16x32_bf16 a[44:47], a[248:251], v[136:139], a[44:47]
    buffer_load_dwordx4 v[236:239], v206, s[12:15], s45 offen offset:2048 sc1
    v_mfma_f32_16x16x32_bf16 a[44:47], a[252:255], v[140:143], a[44:47]
    v_exp_f32_e64 v69, v69
    v_mfma_f32_16x16x32_bf16 a[40:43], a[244:247], v[140:143], a[40:43]
    ds_read_b128 a[212:215], v193 offset:3072
    v_cvt_pk_bf16_f32 v66, v68, v69
    v_mfma_f32_16x16x32_bf16 a[40:43], a[240:243], v[136:139], a[40:43]
    v_exp_f32_e64 v70, v70
    v_mfma_f32_16x16x32_bf16 a[36:39], a[232:235], v[136:139], a[36:39]
    ds_read_b128 a[216:219], v194 offset:3072
    v_mfma_f32_16x16x32_bf16 a[36:39], a[236:239], v[140:143], a[36:39]
    buffer_load_dwordx4 v[240:243], v206, s[12:15], s45 offen offset:3072 sc1
    v_mfma_f32_16x16x32_bf16 a[32:35], a[228:231], v[140:143], a[32:35]
    v_exp_f32_e64 v71, v71
    v_mfma_f32_16x16x32_bf16 a[32:35], a[224:227], v[136:139], a[32:35]
    ds_read_b128 a[220:223], v195 offset:3072
    v_cvt_pk_bf16_f32 v67, v70, v71
    v_smfmac_f32_16x16x64_bf16 a[136:139], v[208:211], v[144:151], v207
    v_exp_f32_e64 v72, v72
    v_smfmac_f32_16x16x64_bf16 a[140:143], v[208:211], v[152:159], v207
    buffer_load_dwordx4 v204, s[4:7], s37 offen offset:2048 lds
    v_mfma_f32_16x16x32_bf16 a[64:67], a[224:227], v[144:147], a[64:67]
    v_exp_f32_e64 v73, v73
    v_mfma_f32_16x16x32_bf16 a[64:67], a[228:231], v[148:151], a[64:67]
    v_cvt_pk_bf16_f32 v72, v72, v73
    v_mfma_f32_16x16x32_bf16 a[68:71], a[236:239], v[148:151], a[68:71]
    v_exp_f32_e64 v74, v74
    v_mfma_f32_16x16x32_bf16 a[68:71], a[232:235], v[144:147], a[68:71]
    buffer_load_dwordx4 v204, s[4:7], s37 offen offset:3072 lds
    v_mfma_f32_16x16x32_bf16 a[72:75], a[240:243], v[144:147], a[72:75]
    v_exp_f32_e64 v75, v75
    v_mfma_f32_16x16x32_bf16 a[72:75], a[244:247], v[148:151], a[72:75]
    v_cvt_pk_bf16_f32 v73, v74, v75
    v_mfma_f32_16x16x32_bf16 a[76:79], a[252:255], v[148:151], a[76:79]
    v_exp_f32_e64 v76, v76
    v_mfma_f32_16x16x32_bf16 a[76:79], a[248:251], v[144:147], a[76:79]
    s_add_u32 s37, s37, 16384
    v_mfma_f32_16x16x32_bf16 a[108:111], a[248:251], v[152:155], a[108:111]
    v_exp_f32_e64 v77, v77
    v_mfma_f32_16x16x32_bf16 a[108:111], a[252:255], v[156:159], a[108:111]
    v_cvt_pk_bf16_f32 v74, v76, v77
    v_mfma_f32_16x16x32_bf16 a[104:107], a[244:247], v[156:159], a[104:107]
    v_exp_f32_e64 v78, v78
    v_mfma_f32_16x16x32_bf16 a[104:107], a[240:243], v[152:155], a[104:107]
    buffer_load_dwordx4 v[224:227], v206, s[12:15], s44 offen offset:3072 sc1
    v_mfma_f32_16x16x32_bf16 a[100:103], a[232:235], v[152:155], a[100:103]
    v_exp_f32_e64 v79, v79
    v_mfma_f32_16x16x32_bf16 a[100:103], a[236:239], v[156:159], a[100:103]
    v_cvt_pk_bf16_f32 v75, v78, v79
    v_mfma_f32_16x16x32_bf16 a[96:99], a[228:231], v[156:159], a[96:99]
    v_exp_f32_e64 v80, v80
    v_mfma_f32_16x16x32_bf16 a[96:99], a[224:227], v[152:155], a[96:99]
    s_add_u32 s44, s44, 4096
    s_add_u32 s45, s45, 4096
    s_add_u32 s38, s38, 1
    s_cmp_lt_u32 s38, 6
    s_waitcnt vmcnt(20) lgkmcnt(0)
    s_cbranch_scc1 L_loop
L_trip7:
    v_mfma_f32_16x16x32_bf16 v[96:99], a[192:195], v[0:3], v[160:163]
    s_barrier
    ds_read_b64_tr_b16 a[224:225], v200 offset:49152
    v_mfma_f32_16x16x32_bf16 v[96:99], a[196:199], v[16:19], v[96:99]
    v_exp_f32 v81, v81
    v_mfma_f32_16x16x32_bf16 v[96:99], a[200:203], v[32:35], v[96:99]
    ds_read_b64_tr_b16 a[226:227], v200 offset:50176
    v_cvt_pk_bf16_f32 v80, v80, v81
    v_mfma_f32_16x16x32_bf16 v[96:99], a[204:207], v[48:51], v[96:99]
    ds_read_b64_tr_b16 a[228:229], v200 offset:51200
    ds_read_b64_tr_b16 a[230:231], v200 offset:52224
    v_mfma_f32_16x16x32_bf16 v[100:103], a[220:223], v[48:51], v[160:163]
    v_exp_f32_e64 v82, v82
    v_mfma_f32_16x16x32_bf16 v[100:103], a[216:219], v[32:35], v[100:103]
    ds_read_b64_tr_b16 a[232:233], v201 offset:49152
    ds_read_b64_tr_b16 a[234:235], v201 offset:50176
    v_mfma_f32_16x16x32_bf16 v[100:103], a[212:215], v[16:19], v[100:103]
    v_exp_f32_e64 v83, v83
    v_mfma_f32_16x16x32_bf16 v[100:103], a[208:211], v[0:3], v[100:103]
    ds_read_b64_tr_b16 a[236:237], v201 offset:51200
    v_cvt_pk_bf16_f32 v81, v82, v83
    v_mfma_f32_16x16x32_bf16 v[108:111], a[208:211], v[4:7], v[164:167]
    v_exp_f32_e64 v84, v84
    v_mfma_f32_16x16x32_bf16 v[108:111], a[212:215], v[20:23], v[108:111]
    ds_read_b64_tr_b16 a[238:239], v201 offset:52224
    ds_read_b64_tr_b16 a[240:241], v202 offset:49152
    v_mfma_f32_16x16x32_bf16 v[108:111], a[216:219], v[36:39], v[108:111]
    v_exp_f32_e64 v85, v85
    v_mfma_f32_16x16x32_bf16 v[108:111], a[220:223], v[52:55], v[108:111]
    ds_read_b64_tr_b16 a[242:243], v202 offset:50176
    v_cvt_pk_bf16_f32 v82, v84, v85
    v_mfma_f32_16x16x32_bf16 v[104:107], a[204:207], v[52:55], v[164:167]
    v_exp_f32_e64 v86, v86
    v_mfma_f32_16x16x32_bf16 v[104:107], a[200:203], v[36:39], v[104:107]
    ds_read_b64_tr_b16 a[244:245], v202 offset:51200
    ds_read_b64_tr_b16 a[246:247], v202 offset:52224
    v_mfma_f32_16x16x32_bf16 v[104:107], a[196:199], v[20:23], v[104:107]
    v_exp_f32_e64 v87, v87
    v_mfma_f32_16x16x32_bf16 v[104:107], a[192:195], v[4:7], v[104:107]
    ds_read_b64_tr_b16 a[248:249], v203 offset:49152
    v_cvt_pk_bf16_f32 v83, v86, v87
    v_mfma_f32_16x16x32_bf16 v[112:115], a[192:195], v[8:11], v[168:171]
    v_exp_f32_e64 v88, v88
    v_mfma_f32_16x16x32_bf16 v[112:115], a[196:199], v[24:27], v[112:115]
    ds_read_b64_tr_b16 a[250:251], v203 offset:50176
    ds_read_b64_tr_b16 a[252:253], v203 offset:51200
    v_mfma_f32_16x16x32_bf16 v[112:115], a[200:203], v[40:43], v[112:115]
    v_exp_f32_e64 v89, v89
    v_mfma_f32_16x16x32_bf16 v[112:115], a[204:207], v[56:59], v[112:115]
    ds_read_b64_tr_b16 a[254:255], v203 offset:52224
    v_cvt_pk_bf16_f32 v88, v88, v89
    v_mfma_f32_16x16x32_bf16 v[116:119], a[220:223], v[56:59], v[168:171]
    v_exp_f32_e64 v90, v90
    v_mfma_f32_16x16x32_bf16 v[116:119], a[216:219], v[40:43], v[116:119]
    s_add_u32 m0, s36, 32768
    v_mfma_f32_16x16x32_bf16 v[116:119], a[212:215], v[24:27], v[116:119]
    v_exp_f32_e64 v91, v91
    v_mfma_f32_16x16x32_bf16 v[116:119], a[208:211], v[8:11], v[116:119]
    v_cvt_pk_bf16_f32 v89, v90, v91
    v_mfma_f32_16x16x32_bf16 v[124:127], a[208:211], v[12:15], v[172:175]
    v_exp_f32_e64 v92, v92
    v_mfma_f32_16x16x32_bf16 v[124:127], a[212:215], v[28:31], v[124:127]
    buffer_load_dwordx4 v205, s[8:11], s37 offen offset:0 lds
    v_mfma_f32_16x16x32_bf16 v[124:127], a[216:219], v[44:47], v[124:127]
    v_exp_f32_e64 v93, v93
    v_mfma_f32_16x16x32_bf16 v[124:127], a[220:223], v[60:63], v[124:127]
    v_cvt_pk_bf16_f32 v90, v92, v93
    v_mfma_f32_16x16x32_bf16 v[120:123], a[204:207], v[60:63], v[172:175]
    v_exp_f32_e64 v94, v94
    v_mfma_f32_16x16x32_bf16 v[120:123], a[200:203], v[44:47], v[120:123]
    buffer_load_dwordx4 v205, s[8:11], s37 offen offset:1024 lds
    v_mfma_f32_16x16x32_bf16 v[120:123], a[196:199], v[28:31], v[120:123]
    v_exp_f32_e64 v95, v95
    v_mfma_f32_16x16x32_bf16 v[120:123], a[192:195], v[12:15], v[120:123]
    v_cvt_pk_bf16_f32 v91, v94, v95
    s_waitcnt lgkmcnt(0)
    v_mfma_f32_16x16x32_bf16 a[16:19], a[224:227], v[128:131], a[16:19]
    v_exp_f32 v96, v96
    v_mfma_f32_16x16x32_bf16 a[16:19], a[228:231], v[132:135], a[16:19]
    ds_read_b128 a[192:195], v192 offset:16384
    v_mfma_f32_16x16x32_bf16 a[20:23], a[236:239], v[132:135], a[20:23]
    v_exp_f32_e64 v97, v97
    v_mfma_f32_16x16x32_bf16 a[20:23], a[232:235], v[128:131], a[20:23]
    ds_read_b128 a[196:199], v193 offset:16384
    v_cvt_pk_bf16_f32 v68, v96, v97
    v_mfma_f32_16x16x32_bf16 a[24:27], a[240:243], v[128:131], a[24:27]
    v_exp_f32_e64 v98, v98
    v_mfma_f32_16x16x32_bf16 a[24:27], a[244:247], v[132:135], a[24:27]
    ds_read_b128 a[200:203], v194 offset:16384
    v_mfma_f32_16x16x32_bf16 a[28:31], a[252:255], v[132:135], a[28:31]
    v_exp_f32_e64 v99, v99
    v_mfma_f32_16x16x32_bf16 a[28:31], a[248:251], v[128:131], a[28:31]
    ds_read_b128 a[204:207], v195 offset:16384
    v_cvt_pk_bf16_f32 v69, v98, v99
    v_mfma_f32_16x16x32_bf16 a[60:63], a[248:251], v[136:139], a[60:63]
    v_exp_f32_e64 v100, v100
    v_mfma_f32_16x16x32_bf16 a[60:63], a[252:255], v[140:143], a[60:63]
    ds_read_b128 a[208:211], v192 offset:17408
    v_mfma_f32_16x16x32_bf16 a[56:59], a[244:247], v[140:143], a[56:59]
    v_exp_f32_e64 v101, v101
    v_mfma_f32_16x16x32_bf16 a[56:59], a[240:243], v[136:139], a[56:59]
    ds_read_b128 a[212:215], v193 offset:17408
    v_cvt_pk_bf16_f32 v70, v100, v101
    v_mfma_f32_16x16x32_bf16 a[52:55], a[232:235], v[136:139], a[52:55]
    v_exp_f32_e64 v102, v102
    v_mfma_f32_16x16x32_bf16 a[52:55], a[236:239], v[140:143], a[52:55]
    ds_read_b128 a[216:219], v194 offset:17408
    v_mfma_f32_16x16x32_bf16 a[48:51], a[228:231], v[140:143], a[48:51]
    v_exp_f32_e64 v103, v103
    v_mfma_f32_16x16x32_bf16 a[48:51], a[224:227], v[136:139], a[48:51]
    ds_read_b128 a[220:223], v195 offset:17408
    v_cvt_pk_bf16_f32 v71, v102, v103
    v_mfma_f32_16x16x32_bf16 a[80:83], a[224:227], v[144:147], a[80:83]
    v_exp_f32_e64 v104, v104
    v_mfma_f32_16x16x32_bf16 a[80:83], a[228:231], v[148:151], a[80:83]
    buffer_load_dwordx4 v205, s[8:11], s37 offen offset:2048 lds
    v_mfma_f32_16x16x32_bf16 a[84:87], a[236:239], v[148:151], a[84:87]
    v_exp_f32_e64 v105, v105
    v_mfma_f32_16x16x32_bf16 a[84:87], a[232:235], v[144:147], a[84:87]
    v_cvt_pk_bf16_f32 v76, v104, v105
    v_mfma_f32_16x16x32_bf16 a[88:91], a[240:243], v[144:147], a[88:91]
    v_exp_f32_e64 v106, v106
    v_mfma_f32_16x16x32_bf16 a[88:91], a[244:247], v[148:151], a[88:91]
    buffer_load_dwordx4 v205, s[8:11], s37 offen offset:3072 lds
    v_mfma_f32_16x16x32_bf16 a[92:95], a[252:255], v[148:151], a[92:95]
    v_exp_f32_e64 v107, v107
    v_mfma_f32_16x16x32_bf16 a[92:95], a[248:251], v[144:147], a[92:95]
    v_cvt_pk_bf16_f32 v77, v106, v107
    v_mfma_f32_16x16x32_bf16 a[124:127], a[248:251], v[152:155], a[124:127]
    v_exp_f32_e64 v108, v108
    v_mfma_f32_16x16x32_bf16 a[124:127], a[252:255], v[156:159], a[124:127]
    s_add_u32 m0, s35, 0
    s_xor_b32 s46, s49, 1
    s_lshl_b32 s46, s46, 17
    v_mfma_f32_16x16x32_bf16 a[120:123], a[244:247], v[156:159], a[120:123]
    v_exp_f32 v109, v109
    v_mfma_f32_16x16x32_bf16 a[120:123], a[240:243], v[152:155], a[120:123]
    v_cvt_pk_bf16_f32 v78, v108, v109
    v_mfma_f32_16x16x32_bf16 a[116:119], a[232:235], v[152:155], a[116:119]
    v_exp_f32_e64 v110, v110
    v_mfma_f32_16x16x32_bf16 a[116:119], a[236:239], v[156:159], a[116:119]
    v_mfma_f32_16x16x32_bf16 a[112:115], a[228:231], v[156:159], a[112:115]
    v_exp_f32_e64 v111, v111
    v_mfma_f32_16x16x32_bf16 a[112:115], a[224:227], v[152:155], a[112:115]
    v_cvt_pk_bf16_f32 v79, v110, v111
    s_waitcnt lgkmcnt(0)
    v_mfma_f32_16x16x32_bf16 v[128:131], a[192:195], v[0:3], v[160:163]
    ds_read_b64_tr_b16 a[224:225], v196 offset:0
    ds_read_b64_tr_b16 a[226:227], v196 offset:1024
    v_mfma_f32_16x16x32_bf16 v[128:131], a[196:199], v[16:19], v[128:131]
    v_exp_f32 v112, v112
    v_mfma_f32_16x16x32_bf16 v[128:131], a[200:203], v[32:35], v[128:131]
    ds_read_b64_tr_b16 a[228:229], v196 offset:2048
    ds_read_b64_tr_b16 a[230:231], v196 offset:3072
    v_mfma_f32_16x16x32_bf16 v[128:131], a[204:207], v[48:51], v[128:131]
    v_exp_f32_e64 v113, v113
    v_mfma_f32_16x16x32_bf16 v[132:135], a[220:223], v[48:51], v[160:163]
    ds_read_b64_tr_b16 a[232:233], v197 offset:0
    v_cvt_pk_bf16_f32 v84, v112, v113
    v_mfma_f32_16x16x32_bf16 v[132:135], a[216:219], v[32:35], v[132:135]
    ds_read_b64_tr_b16 a[234:235], v197 offset:1024
    ds_read_b64_tr_b16 a[236:237], v197 offset:2048
    v_mfma_f32_16x16x32_bf16 v[132:135], a[212:215], v[16:19], v[132:135]
    v_exp_f32_e64 v114, v114
    v_mfma_f32_16x16x32_bf16 v[132:135], a[208:211], v[0:3], v[132:135]
    ds_read_b64_tr_b16 a[238:239], v197 offset:3072
    ds_read_b64_tr_b16 a[240:241], v198 offset:0
    v_mfma_f32_16x16x32_bf16 v[140:143], a[208:211], v[4:7], v[164:167]
    v_exp_f32_e64 v115, v115
    v_mfma_f32_16x16x32_bf16 v[140:143], a[212:215], v[20:23], v[140:143]
    ds_read_b64_tr_b16 a[242:243], v198 offset:1024
    v_cvt_pk_bf16_f32 v85, v114, v115
    v_mfma_f32_16x16x32_bf16 v[140:143], a[216:219], v[36:39], v[140:143]
    v_exp_f32_e64 v116, v116
    v_mfma_f32_16x16x32_bf16 v[140:143], a[220:223], v[52:55], v[140:143]
    ds_read_b64_tr_b16 a[244:245], v198 offset:2048
    ds_read_b64_tr_b16 a[246:247], v198 offset:3072
    v_mfma_f32_16x16x32_bf16 v[136:139], a[204:207], v[52:55], v[164:167]
    v_exp_f32_e64 v117, v117
    v_mfma_f32_16x16x32_bf16 v[136:139], a[200:203], v[36:39], v[136:139]
    ds_read_b64_tr_b16 a[248:249], v199 offset:0
    v_cvt_pk_bf16_f32 v86, v116, v117
    v_mfma_f32_16x16x32_bf16 v[136:139], a[196:199], v[20:23], v[136:139]
    v_exp_f32_e64 v118, v118
    v_mfma_f32_16x16x32_bf16 v[136:139], a[192:195], v[4:7], v[136:139]
    ds_read_b64_tr_b16 a[250:251], v199 offset:1024
    ds_read_b64_tr_b16 a[252:253], v199 offset:2048
    v_smfmac_f32_16x16x64_bf16 a[128:131], v[208:211], v[64:71], v207
    v_exp_f32_e64 v119, v119
    v_smfmac_f32_16x16x64_bf16 a[132:135], v[208:211], v[72:79], v207
    ds_read_b64_tr_b16 a[254:255], v199 offset:3072
    v_cvt_pk_bf16_f32 v87, v118, v119
    v_mfma_f32_16x16x32_bf16 v[144:147], a[192:195], v[8:11], v[168:171]
    v_exp_f32_e64 v120, v120
    v_mfma_f32_16x16x32_bf16 v[144:147], a[196:199], v[24:27], v[144:147]
    v_mfma_f32_16x16x32_bf16 v[144:147], a[200:203], v[40:43], v[144:147]
    v_exp_f32_e64 v121, v121
    v_mfma_f32_16x16x32_bf16 v[144:147], a[204:207], v[56:59], v[144:147]
    v_cvt_pk_bf16_f32 v92, v120, v121
    v_mfma_f32_16x16x32_bf16 v[148:151], a[220:223], v[56:59], v[168:171]
    v_exp_f32_e64 v122, v122
    v_mfma_f32_16x16x32_bf16 v[148:151], a[216:219], v[40:43], v[148:151]
    buffer_load_dwordx4 v244, s[16:19], s46 offen offset:0 lds
    v_mfma_f32_16x16x32_bf16 v[148:151], a[212:215], v[24:27], v[148:151]
    v_exp_f32_e64 v123, v123
    v_mfma_f32_16x16x32_bf16 v[148:151], a[208:211], v[8:11], v[148:151]
    s_add_u32 s46, s46, 15360
    v_cvt_pk_bf16_f32 v93, v122, v123
    v_mfma_f32_16x16x32_bf16 v[156:159], a[208:211], v[12:15], v[172:175]
    v_exp_f32_e64 v124, v124
    v_mfma_f32_16x16x32_bf16 v[156:159], a[212:215], v[28:31], v[156:159]
    buffer_load_dwordx4 v244, s[16:19], s46 offen offset:1024 lds
    v_mfma_f32_16x16x32_bf16 v[156:159], a[216:219], v[44:47], v[156:159]
    v_exp_f32_e64 v125, v125
    v_mfma_f32_16x16x32_bf16 v[156:159], a[220:223], v[60:63], v[156:159]
    s_add_u32 s46, s46, 15360
    v_cvt_pk_bf16_f32 v94, v124, v125
    v_mfma_f32_16x16x32_bf16 v[152:155], a[204:207], v[60:63], v[172:175]
    v_exp_f32_e64 v126, v126
    v_mfma_f32_16x16x32_bf16 v[152:155], a[200:203], v[44:47], v[152:155]
    v_mfma_f32_16x16x32_bf16 v[152:155], a[196:199], v[28:31], v[152:155]
    v_exp_f32_e64 v127, v127
    v_mfma_f32_16x16x32_bf16 v[152:155], a[192:195], v[12:15], v[152:155]
    v_cvt_pk_bf16_f32 v95, v126, v127
    s_waitcnt lgkmcnt(0)
    v_mfma_f32_16x16x32_bf16 a[0:3], a[224:227], v[64:67], a[0:3]
    v_exp_f32 v128, v128
    v_mfma_f32_16x16x32_bf16 a[0:3], a[228:231], v[68:71], a[0:3]
    ds_read_b128 a[192:195], v192 offset:18432
    v_mfma_f32_16x16x32_bf16 a[4:7], a[236:239], v[68:71], a[4:7]
    v_exp_f32_e64 v129, v129
    v_mfma_f32_16x16x32_bf16 a[4:7], a[232:235], v[64:67], a[4:7]
    ds_read_b128 a[196:199], v193 offset:18432
    v_cvt_pk_bf16_f32 v128, v128, v129
    v_mfma_f32_16x16x32_bf16 a[8:11], a[240:243], v[64:67], a[8:11]
    v_exp_f32_e64 v130, v130
    v_mfma_f32_16x16x32_bf16 a[8:11], a[244:247], v[68:71], a[8:11]
    ds_read_b128 a[200:203], v194 offset:18432
    v_mfma_f32_16x16x32_bf16 a[12:15], a[252:255], v[68:71], a[12:15]
    v_exp_f32_e64 v131, v131
    v_mfma_f32_16x16x32_bf16 a[12:15], a[248:251], v[64:67], a[12:15]
    ds_read_b128 a[204:207], v195 offset:18432
    v_cvt_pk_bf16_f32 v129, v130, v131
    v_mfma_f32_16x16x32_bf16 a[44:47], a[248:251], v[72:75], a[44:47]
    v_exp_f32_e64 v132, v132
    v_mfma_f32_16x16x32_bf16 a[44:47], a[252:255], v[76:79], a[44:47]
    ds_read_b128 a[208:211], v192 offset:19456
    v_mfma_f32_16x16x32_bf16 a[40:43], a[244:247], v[76:79], a[40:43]
    v_exp_f32_e64 v133, v133
    v_mfma_f32_16x16x32_bf16 a[40:43], a[240:243], v[72:75], a[40:43]
    ds_read_b128 a[212:215], v193 offset:19456
    v_cvt_pk_bf16_f32 v130, v132, v133
    v_mfma_f32_16x16x32_bf16 a[36:39], a[232:235], v[72:75], a[36:39]
    v_exp_f32_e64 v134, v134
    v_mfma_f32_16x16x32_bf16 a[36:39], a[236:239], v[76:79], a[36:39]
    ds_read_b128 a[216:219], v194 offset:19456
    v_mfma_f32_16x16x32_bf16 a[32:35], a[228:231], v[76:79], a[32:35]
    v_exp_f32_e64 v135, v135
    v_mfma_f32_16x16x32_bf16 a[32:35], a[224:227], v[72:75], a[32:35]
    ds_read_b128 a[220:223], v195 offset:19456
    v_cvt_pk_bf16_f32 v131, v134, v135
    v_smfmac_f32_16x16x64_bf16 a[136:139], v[208:211], v[80:87], v207
    v_exp_f32_e64 v136, v136
    v_smfmac_f32_16x16x64_bf16 a[140:143], v[208:211], v[88:95], v207
    buffer_load_dwordx4 v244, s[16:19], s46 offen offset:2048 lds
    v_mfma_f32_16x16x32_bf16 a[64:67], a[224:227], v[80:83], a[64:67]
    v_exp_f32_e64 v137, v137
    v_mfma_f32_16x16x32_bf16 a[64:67], a[228:231], v[84:87], a[64:67]
    s_add_u32 s46, s46, 15360
    v_cvt_pk_bf16_f32 v136, v136, v137
    v_mfma_f32_16x16x32_bf16 a[68:71], a[236:239], v[84:87], a[68:71]
    v_exp_f32_e64 v138, v138
    v_mfma_f32_16x16x32_bf16 a[68:71], a[232:235], v[80:83], a[68:71]
    buffer_load_dwordx4 v244, s[16:19], s46 offen offset:3072 lds
    v_mfma_f32_16x16x32_bf16 a[72:75], a[240:243], v[80:83], a[72:75]
    v_exp_f32_e64 v139, v139
    v_mfma_f32_16x16x32_bf16 a[72:75], a[244:247], v[84:87], a[72:75]
    s_add_u32 s46, s46, 15360
    v_cvt_pk_bf16_f32 v137, v138, v139
    v_mfma_f32_16x16x32_bf16 a[76:79], a[252:255], v[84:87], a[76:79]
    v_exp_f32_e64 v140, v140
    v_mfma_f32_16x16x32_bf16 a[76:79], a[248:251], v[80:83], a[76:79]
    s_add_u32 s37, s37, 16384
    v_mfma_f32_16x16x32_bf16 a[108:111], a[248:251], v[88:91], a[108:111]
    v_exp_f32_e64 v141, v141
    v_mfma_f32_16x16x32_bf16 a[108:111], a[252:255], v[92:95], a[108:111]
    v_cvt_pk_bf16_f32 v138, v140, v141
    v_mfma_f32_16x16x32_bf16 a[104:107], a[244:247], v[92:95], a[104:107]
    v_exp_f32_e64 v142, v142
    v_mfma_f32_16x16x32_bf16 a[104:107], a[240:243], v[88:91], a[104:107]
    v_mfma_f32_16x16x32_bf16 a[100:103], a[232:235], v[88:91], a[100:103]
    v_exp_f32_e64 v143, v143
    v_mfma_f32_16x16x32_bf16 a[100:103], a[236:239], v[92:95], a[100:103]
    v_cvt_pk_bf16_f32 v139, v142, v143
    v_mfma_f32_16x16x32_bf16 a[96:99], a[228:231], v[92:95], a[96:99]
    v_exp_f32_e64 v144, v144
    v_mfma_f32_16x16x32_bf16 a[96:99], a[224:227], v[88:91], a[96:99]
    s_waitcnt vmcnt(18) lgkmcnt(0)
    v_mfma_f32_16x16x32_bf16 v[96:99], a[192:195], v[0:3], v[160:163]
    s_barrier
    ds_read_b64_tr_b16 a[224:225], v200 offset:0
    v_mfma_f32_16x16x32_bf16 v[96:99], a[196:199], v[16:19], v[96:99]
    v_exp_f32_e64 v145, v145
    v_mfma_f32_16x16x32_bf16 v[96:99], a[200:203], v[32:35], v[96:99]
    ds_read_b64_tr_b16 a[226:227], v200 offset:1024
    v_cvt_pk_bf16_f32 v144, v144, v145
    v_mfma_f32_16x16x32_bf16 v[96:99], a[204:207], v[48:51], v[96:99]
    ds_read_b64_tr_b16 a[228:229], v200 offset:2048
    ds_read_b64_tr_b16 a[230:231], v200 offset:3072
    v_mfma_f32_16x16x32_bf16 v[100:103], a[220:223], v[48:51], v[160:163]
    v_exp_f32_e64 v146, v146
    v_mfma_f32_16x16x32_bf16 v[100:103], a[216:219], v[32:35], v[100:103]
    ds_read_b64_tr_b16 a[232:233], v201 offset:0
    ds_read_b64_tr_b16 a[234:235], v201 offset:1024
    v_mfma_f32_16x16x32_bf16 v[100:103], a[212:215], v[16:19], v[100:103]
    v_exp_f32_e64 v147, v147
    v_mfma_f32_16x16x32_bf16 v[100:103], a[208:211], v[0:3], v[100:103]
    ds_read_b64_tr_b16 a[236:237], v201 offset:2048
    v_cvt_pk_bf16_f32 v145, v146, v147
    s_waitcnt vmcnt(14)
    s_waitcnt vmcnt(11)
    v_mfma_f32_16x16x32_bf16 a[144:147], v[228:231], v[212:215], a[144:147]
    v_mfma_f32_16x16x32_bf16 a[148:151], v[232:235], v[212:215], a[148:151]
    v_mfma_f32_16x16x32_bf16 a[152:155], v[236:239], v[212:215], a[152:155]
    v_mfma_f32_16x16x32_bf16 a[156:159], v[240:243], v[212:215], a[156:159]
    buffer_load_dwordx4 v[212:215], v206, s[12:15], s44 offen offset:0 sc1
    v_mfma_f32_16x16x32_bf16 v[108:111], a[208:211], v[4:7], v[164:167]
    v_exp_f32_e64 v148, v148
    v_mfma_f32_16x16x32_bf16 v[108:111], a[212:215], v[20:23], v[108:111]
    ds_read_b64_tr_b16 a[238:239], v201 offset:3072
    ds_read_b64_tr_b16 a[240:241], v202 offset:0
    v_mfma_f32_16x16x32_bf16 v[108:111], a[216:219], v[36:39], v[108:111]
    v_exp_f32_e64 v149, v149
    v_mfma_f32_16x16x32_bf16 v[108:111], a[220:223], v[52:55], v[108:111]
    ds_read_b64_tr_b16 a[242:243], v202 offset:1024
    v_cvt_pk_bf16_f32 v146, v148, v149
    v_mfma_f32_16x16x32_bf16 v[104:107], a[204:207], v[52:55], v[164:167]
    v_exp_f32_e64 v150, v150
    v_mfma_f32_16x16x32_bf16 v[104:107], a[200:203], v[36:39], v[104:107]
    ds_read_b64_tr_b16 a[244:245], v202 offset:2048
    ds_read_b64_tr_b16 a[246:247], v202 offset:3072
    v_mfma_f32_16x16x32_bf16 v[104:107], a[196:199], v[20:23], v[104:107]
    v_exp_f32_e64 v151, v151
    v_mfma_f32_16x16x32_bf16 v[104:107], a[192:195], v[4:7], v[104:107]
    ds_read_b64_tr_b16 a[248:249], v203 offset:0
    v_cvt_pk_bf16_f32 v147, v150, v151
    v_mfma_f32_16x16x32_bf16 v[112:115], a[192:195], v[8:11], v[168:171]
    v_exp_f32_e64 v152, v152
    v_mfma_f32_16x16x32_bf16 v[112:115], a[196:199], v[24:27], v[112:115]
    ds_read_b64_tr_b16 a[250:251], v203 offset:1024
    ds_read_b64_tr_b16 a[252:253], v203 offset:2048
    v_mfma_f32_16x16x32_bf16 v[112:115], a[200:203], v[40:43], v[112:115]
    v_exp_f32_e64 v153, v153
    v_mfma_f32_16x16x32_bf16 v[112:115], a[204:207], v[56:59], v[112:115]
    ds_read_b64_tr_b16 a[254:255], v203 offset:3072
    v_cvt_pk_bf16_f32 v152, v152, v153
    v_mfma_f32_16x16x32_bf16 v[116:119], a[220:223], v[56:59], v[168:171]
    v_exp_f32_e64 v154, v154
    v_mfma_f32_16x16x32_bf16 v[116:119], a[216:219], v[40:43], v[116:119]
    s_add_u32 m0, s36, 49152
L_hop10:
    s_cbranch_execz L_ret2
    v_mfma_f32_16x16x32_bf16 v[116:119], a[212:215], v[24:27], v[116:119]
    v_exp_f32 v155, v155
    v_mfma_f32_16x16x32_bf16 v[116:119], a[208:211], v[8:11], v[116:119]
    v_cvt_pk_bf16_f32 v153, v154, v155
    v_mfma_f32_16x16x32_bf16 v[124:127], a[208:211], v[12:15], v[172:175]
    v_exp_f32_e64 v156, v156
    v_mfma_f32_16x16x32_bf16 v[124:127], a[212:215], v[28:31], v[124:127]
    buffer_load_dwordx4 v205, s[8:11], s37 offen offset:0 lds
    v_mfma_f32_16x16x32_bf16 v[124:127], a[216:219], v[44:47], v[124:127]
    v_exp_f32_e64 v157, v157
    v_mfma_f32_16x16x32_bf16 v[124:127], a[220:223], v[60:63], v[124:127]
    v_cvt_pk_bf16_f32 v154, v156, v157
    v_mfma_f32_16x16x32_bf16 v[120:123], a[204:207], v[60:63], v[172:175]
    v_exp_f32_e64 v158, v158
    v_mfma_f32_16x16x32_bf16 v[120:123], a[200:203], v[44:47], v[120:123]
    buffer_load_dwordx4 v205, s[8:11], s37 offen offset:1024 lds
    v_mfma_f32_16x16x32_bf16 v[120:123], a[196:199], v[28:31], v[120:123]
    v_exp_f32_e64 v159, v159
    v_mfma_f32_16x16x32_bf16 v[120:123], a[192:195], v[12:15], v[120:123]
    v_cvt_pk_bf16_f32 v155, v158, v159
    s_waitcnt lgkmcnt(0)
    v_mfma_f32_16x16x32_bf16 a[16:19], a[224:227], v[64:67], a[16:19]
    v_exp_f32 v96, v96
    v_mfma_f32_16x16x32_bf16 a[16:19], a[228:231], v[68:71], a[16:19]
    ds_read_b128 a[192:195], v192 offset:32768
    v_mfma_f32_16x16x32_bf16 a[20:23], a[236:239], v[68:71], a[20:23]
    v_exp_f32_e64 v97, v97
    v_mfma_f32_16x16x32_bf16 a[20:23], a[232:235], v[64:67], a[20:23]
    ds_read_b128 a[196:199], v193 offset:32768
    v_cvt_pk_bf16_f32 v132, v96, v97
    v_mfma_f32_16x16x32_bf16 a[24:27], a[240:243], v[64:67], a[24:27]
    v_exp_f32_e64 v98, v98
    v_mfma_f32_16x16x32_bf16 a[24:27], a[244:247], v[68:71], a[24:27]
    ds_read_b128 a[200:203], v194 offset:32768
    v_mfma_f32_16x16x32_bf16 a[28:31], a[252:255], v[68:71], a[28:31]
    v_exp_f32_e64 v99, v99
    v_mfma_f32_16x16x32_bf16 a[28:31], a[248:251], v[64:67], a[28:31]
    ds_read_b128 a[204:207], v195 offset:32768
    v_cvt_pk_bf16_f32 v133, v98, v99
    v_mfma_f32_16x16x32_bf16 a[160:163], v[228:231], v[216:219], a[160:163]
    v_mfma_f32_16x16x32_bf16 a[164:167], v[232:235], v[216:219], a[164:167]
    v_mfma_f32_16x16x32_bf16 a[168:171], v[236:239], v[216:219], a[168:171]
    v_mfma_f32_16x16x32_bf16 a[172:175], v[240:243], v[216:219], a[172:175]
    buffer_load_dwordx4 v[216:219], v206, s[12:15], s44 offen offset:1024 sc1
    v_mfma_f32_16x16x32_bf16 a[60:63], a[248:251], v[72:75], a[60:63]
    v_exp_f32_e64 v100, v100
    v_mfma_f32_16x16x32_bf16 a[60:63], a[252:255], v[76:79], a[60:63]
    ds_read_b128 a[208:211], v192 offset:33792
    v_mfma_f32_16x16x32_bf16 a[56:59], a[244:247], v[76:79], a[56:59]
    v_exp_f32_e64 v101, v101
    v_mfma_f32_16x16x32_bf16 a[56:59], a[240:243], v[72:75], a[56:59]
    ds_read_b128 a[212:215], v193 offset:33792
    v_cvt_pk_bf16_f32 v134, v100, v101
    v_mfma_f32_16x16x32_bf16 a[52:55], a[232:235], v[72:75], a[52:55]
    v_exp_f32_e64 v102, v102
    v_mfma_f32_16x16x32_bf16 a[52:55], a[236:239], v[76:79], a[52:55]
    ds_read_b128 a[216:219], v194 offset:33792
    v_mfma_f32_16x16x32_bf16 a[48:51], a[228:231], v[76:79], a[48:51]
    v_exp_f32_e64 v103, v103
    v_mfma_f32_16x16x32_bf16 a[48:51], a[224:227], v[72:75], a[48:51]
    ds_read_b128 a[220:223], v195 offset:33792
    v_cvt_pk_bf16_f32 v135, v102, v103
    v_mfma_f32_16x16x32_bf16 a[80:83], a[224:227], v[80:83], a[80:83]
    v_exp_f32_e64 v104, v104
    v_mfma_f32_16x16x32_bf16 a[80:83], a[228:231], v[84:87], a[80:83]
    buffer_load_dwordx4 v205, s[8:11], s37 offen offset:2048 lds
    v_mfma_f32_16x16x32_bf16 a[84:87], a[236:239], v[84:87], a[84:87]
    v_exp_f32_e64 v105, v105
    v_mfma_f32_16x16x32_bf16 a[84:87], a[232:235], v[80:83], a[84:87]
    v_cvt_pk_bf16_f32 v140, v104, v105
    v_mfma_f32_16x16x32_bf16 a[88:91], a[240:243], v[80:83], a[88:91]
    v_exp_f32_e64 v106, v106
    v_mfma_f32_16x16x32_bf16 a[88:91], a[244:247], v[84:87], a[88:91]
    buffer_load_dwordx4 v205, s[8:11], s37 offen offset:3072 lds
    v_mfma_f32_16x16x32_bf16 a[92:95], a[252:255], v[84:87], a[92:95]
    v_exp_f32_e64 v107, v107
    v_mfma_f32_16x16x32_bf16 a[92:95], a[248:251], v[80:83], a[92:95]
    v_cvt_pk_bf16_f32 v141, v106, v107
    v_mfma_f32_16x16x32_bf16 a[124:127], a[248:251], v[88:91], a[124:127]
    v_exp_f32_e64 v108, v108
    v_mfma_f32_16x16x32_bf16 a[124:127], a[252:255], v[92:95], a[124:127]
    s_add_u32 m0, s35, 16384
    s_xor_b32 s46, s49, 1
    s_lshl_b32 s46, s46, 17
    s_add_u32 s46, s46, 65536
    v_mfma_f32_16x16x32_bf16 a[120:123], a[244:247], v[92:95], a[120:123]
    v_exp_f32_e64 v109, v109
    v_mfma_f32_16x16x32_bf16 a[120:123], a[240:243], v[88:91], a[120:123]
    v_cvt_pk_bf16_f32 v142, v108, v109
    v_mfma_f32_16x16x32_bf16 a[116:119], a[232:235], v[88:91], a[116:119]
    v_exp_f32_e64 v110, v110
    v_mfma_f32_16x16x32_bf16 a[116:119], a[236:239], v[92:95], a[116:119]
    v_mfma_f32_16x16x32_bf16 a[112:115], a[228:231], v[92:95], a[112:115]
    v_exp_f32_e64 v111, v111
    v_mfma_f32_16x16x32_bf16 a[112:115], a[224:227], v[88:91], a[112:115]
    v_cvt_pk_bf16_f32 v143, v110, v111
    s_waitcnt lgkmcnt(0)
    v_mfma_f32_16x16x32_bf16 v[64:67], a[192:195], v[0:3], v[160:163]
    ds_read_b64_tr_b16 a[224:225], v196 offset:16384
    ds_read_b64_tr_b16 a[226:227], v196 offset:17408
    v_mfma_f32_16x16x32_bf16 v[64:67], a[196:199], v[16:19], v[64:67]
    v_exp_f32 v112, v112
    v_mfma_f32_16x16x32_bf16 v[64:67], a[200:203], v[32:35], v[64:67]
    ds_read_b64_tr_b16 a[228:229], v196 offset:18432
    ds_read_b64_tr_b16 a[230:231], v196 offset:19456
    v_mfma_f32_16x16x32_bf16 v[64:67], a[204:207], v[48:51], v[64:67]
    v_exp_f32_e64 v113, v113
    v_mfma_f32_16x16x32_bf16 v[68:71], a[220:223], v[48:51], v[160:163]
    ds_read_b64_tr_b16 a[232:233], v197 offset:16384
    v_cvt_pk_bf16_f32 v148, v112, v113
    v_mfma_f32_16x16x32_bf16 v[68:71], a[216:219], v[32:35], v[68:71]
    ds_read_b64_tr_b16 a[234:235], v197 offset:17408
    ds_read_b64_tr_b16 a[236:237], v197 offset:18432
    v_mfma_f32_16x16x32_bf16 v[68:71], a[212:215], v[16:19], v[68:71]
    v_exp_f32_e64 v114, v114
    v_mfma_f32_16x16x32_bf16 v[68:71], a[208:211], v[0:3], v[68:71]
    ds_read_b64_tr_b16 a[238:239], v197 offset:19456
    ds_read_b64_tr_b16 a[240:241], v198 offset:16384
    v_mfma_f32_16x16x32_bf16 a[176:179], v[228:231], v[220:223], a[176:179]
    v_mfma_f32_16x16x32_bf16 a[180:183], v[232:235], v[220:223], a[180:183]
    v_mfma_f32_16x16x32_bf16 a[184:187], v[236:239], v[220:223], a[184:187]
    v_mfma_f32_16x16x32_bf16 a[188:191], v[240:243], v[220:223], a[188:191]
    buffer_load_dwordx4 v[220:223], v206, s[12:15], s44 offen offset:2048 sc1
    v_mfma_f32_16x16x32_bf16 v[76:79], a[208:211], v[4:7], v[164:167]
    v_exp_f32_e64 v115, v115
    v_mfma_f32_16x16x32_bf16 v[76:79], a[212:215], v[20:23], v[76:79]
    ds_read_b64_tr_b16 a[242:243], v198 offset:17408
    v_cvt_pk_bf16_f32 v149, v114, v115
    v_mfma_f32_16x16x32_bf16 v[76:79], a[216:219], v[36:39], v[76:79]
    v_exp_f32_e64 v116, v116
    v_mfma_f32_16x16x32_bf16 v[76:79], a[220:223], v[52:55], v[76:79]
    ds_read_b64_tr_b16 a[244:245], v198 offset:18432
    ds_read_b64_tr_b16 a[246:247], v198 offset:19456
    v_mfma_f32_16x16x32_bf16 v[72:75], a[204:207], v[52:55], v[164:167]
    v_exp_f32_e64 v117, v117
    v_mfma_f32_16x16x32_bf16 v[72:75], a[200:203], v[36:39], v[72:75]
    ds_read_b64_tr_b16 a[248:249], v199 offset:16384
    v_cvt_pk_bf16_f32 v150, v116, v117
    v_mfma_f32_16x16x32_bf16 v[72:75], a[196:199], v[20:23], v[72:75]
    v_exp_f32_e64 v118, v118
    v_mfma_f32_16x16x32_bf16 v[72:75], a[192:195], v[4:7], v[72:75]
    ds_read_b64_tr_b16 a[250:251], v199 offset:17408
    ds_read_b64_tr_b16 a[252:253], v199 offset:18432
    v_smfmac_f32_16x16x64_bf16 a[128:131], v[208:211], v[128:135], v207
    v_exp_f32_e64 v119, v119
    v_smfmac_f32_16x16x64_bf16 a[132:135], v[208:211], v[136:143], v207
    ds_read_b64_tr_b16 a[254:255], v199 offset:19456
    v_cvt_pk_bf16_f32 v151, v118, v119
    v_mfma_f32_16x16x32_bf16 v[80:83], a[192:195], v[8:11], v[168:171]
    v_exp_f32_e64 v120, v120
    v_mfma_f32_16x16x32_bf16 v[80:83], a[196:199], v[24:27], v[80:83]
    v_mfma_f32_16x16x32_bf16 v[80:83], a[200:203], v[40:43], v[80:83]
    v_exp_f32_e64 v121, v121
    v_mfma_f32_16x16x32_bf16 v[80:83], a[204:207], v[56:59], v[80:83]
    v_cvt_pk_bf16_f32 v156, v120, v121
    v_mfma_f32_16x16x32_bf16 v[84:87], a[220:223], v[56:59], v[168:171]
    v_exp_f32_e64 v122, v122
    v_mfma_f32_16x16x32_bf16 v[84:87], a[216:219], v[40:43], v[84:87]
    buffer_load_dwordx4 v244, s[16:19], s46 offen offset:0 lds
    v_mfma_f32_16x16x32_bf16 v[84:87], a[212:215], v[24:27], v[84:87]
    v_exp_f32_e64 v123, v123
    v_mfma_f32_16x16x32_bf16 v[84:87], a[208:211], v[8:11], v[84:87]
    s_add_u32 s46, s46, 15360
    v_cvt_pk_bf16_f32 v157, v122, v123
    v_mfma_f32_16x16x32_bf16 v[92:95], a[208:211], v[12:15], v[172:175]
    v_exp_f32_e64 v124, v124
    v_mfma_f32_16x16x32_bf16 v[92:95], a[212:215], v[28:31], v[92:95]
    buffer_load_dwordx4 v244, s[16:19], s46 offen offset:1024 lds
    v_mfma_f32_16x16x32_bf16 v[92:95], a[216:219], v[44:47], v[92:95]
    v_exp_f32_e64 v125, v125
    v_mfma_f32_16x16x32_bf16 v[92:95], a[220:223], v[60:63], v[92:95]
    s_add_u32 s46, s46, 15360
    v_cvt_pk_bf16_f32 v158, v124, v125
    v_mfma_f32_16x16x32_bf16 v[88:91], a[204:207], v[60:63], v[172:175]
    v_exp_f32_e64 v126, v126
    v_mfma_f32_16x16x32_bf16 v[88:91], a[200:203], v[44:47], v[88:91]
    v_mfma_f32_16x16x32_bf16 v[88:91], a[196:199], v[28:31], v[88:91]
    v_exp_f32_e64 v127, v127
    v_mfma_f32_16x16x32_bf16 v[88:91], a[192:195], v[12:15], v[88:91]
    v_cvt_pk_bf16_f32 v159, v126, v127
    s_waitcnt lgkmcnt(0)
    v_mfma_f32_16x16x32_bf16 a[0:3], a[224:227], v[128:131], a[0:3]
    v_exp_f32 v64, v64
    v_mfma_f32_16x16x32_bf16 a[0:3], a[228:231], v[132:135], a[0:3]
    ds_read_b128 a[192:195], v192 offset:34816
    s_waitcnt vmcnt(17)
    v_mfma_f32_16x16x32_bf16 v[176:179], v[228:231], v[224:227], v[176:179]
    buffer_load_dwordx4 v[228:231], v206, s[12:15], s45 offen offset:0 sc1
    v_mfma_f32_16x16x32_bf16 v[180:183], v[232:235], v[224:227], v[180:183]
    v_exp_f32 v65, v65
    v_mfma_f32_16x16x32_bf16 v[184:187], v[236:239], v[224:227], v[184:187]
    ds_read_b128 a[196:199], v193 offset:34816
    v_cvt_pk_bf16_f32 v64, v64, v65
    v_mfma_f32_16x16x32_bf16 v[188:191], v[240:243], v[224:227], v[188:191]
    v_exp_f32_e64 v66, v66
    v_mfma_f32_16x16x32_bf16 a[4:7], a[236:239], v[132:135], a[4:7]
    ds_read_b128 a[200:203], v194 offset:34816
    v_mfma_f32_16x16x32_bf16 a[4:7], a[232:235], v[128:131], a[4:7]
    buffer_load_dwordx4 v[232:235], v206, s[12:15], s45 offen offset:1024 sc1
    v_mfma_f32_16x16x32_bf16 a[8:11], a[240:243], v[128:131], a[8:11]
    v_exp_f32_e64 v67, v67
    v_mfma_f32_16x16x32_bf16 a[8:11], a[244:247], v[132:135], a[8:11]
    ds_read_b128 a[204:207], v195 offset:34816
    v_cvt_pk_bf16_f32 v65, v66, v67
    v_mfma_f32_16x16x32_bf16 a[12:15], a[252:255], v[132:135], a[12:15]
    v_exp_f32_e64 v68, v68
    v_mfma_f32_16x16x32_bf16 a[12:15], a[248:251], v[128:131], a[12:15]
    ds_read_b128 a[208:211], v192 offset:35840
    v_mfma_f32_16x16x32_bf16 a[44:47], a[248:251], v[136:139], a[44:47]
    buffer_load_dwordx4 v[236:239], v206, s[12:15], s45 offen offset:2048 sc1
    v_mfma_f32_16x16x32_bf16 a[44:47], a[252:255], v[140:143], a[44:47]
    v_exp_f32_e64 v69, v69
    v_mfma_f32_16x16x32_bf16 a[40:43], a[244:247], v[140:143], a[40:43]
    ds_read_b128 a[212:215], v193 offset:35840
    v_cvt_pk_bf16_f32 v66, v68, v69
    v_mfma_f32_16x16x32_bf16 a[40:43], a[240:243], v[136:139], a[40:43]
    v_exp_f32_e64 v70, v70
    v_mfma_f32_16x16x32_bf16 a[36:39], a[232:235], v[136:139], a[36:39]
    ds_read_b128 a[216:219], v194 offset:35840
    v_mfma_f32_16x16x32_bf16 a[36:39], a[236:239], v[140:143], a[36:39]
    buffer_load_dwordx4 v[240:243], v206, s[12:15], s45 offen offset:3072 sc1
    v_mfma_f32_16x16x32_bf16 a[32:35], a[228:231], v[140:143], a[32:35]
    v_exp_f32_e64 v71, v71
    v_mfma_f32_16x16x32_bf16 a[32:35], a[224:227], v[136:139], a[32:35]
    ds_read_b128 a[220:223], v195 offset:35840
    v_cvt_pk_bf16_f32 v67, v70, v71
    v_smfmac_f32_16x16x64_bf16 a[136:139], v[208:211], v[144:151], v207
    v_exp_f32_e64 v72, v72
    v_smfmac_f32_16x16x64_bf16 a[140:143], v[208:211], v[152:159], v207
    buffer_load_dwordx4 v244, s[16:19], s46 offen offset:2048 lds
    v_mfma_f32_16x16x32_bf16 a[64:67], a[224:227], v[144:147], a[64:67]
    v_exp_f32_e64 v73, v73
    v_mfma_f32_16x16x32_bf16 a[64:67], a[228:231], v[148:151], a[64:67]
    s_add_u32 s46, s46, 15360
    v_cvt_pk_bf16_f32 v72, v72, v73
    v_mfma_f32_16x16x32_bf16 a[68:71], a[236:239], v[148:151], a[68:71]
    v_exp_f32_e64 v74, v74
    v_mfma_f32_16x16x32_bf16 a[68:71], a[232:235], v[144:147], a[68:71]
    buffer_load_dwordx4 v244, s[16:19], s46 offen offset:3072 lds
    v_mfma_f32_16x16x32_bf16 a[72:75], a[240:243], v[144:147], a[72:75]
    v_exp_f32_e64 v75, v75
    v_mfma_f32_16x16x32_bf16 a[72:75], a[244:247], v[148:151], a[72:75]
    s_add_u32 s46, s46, 15360
    v_cvt_pk_bf16_f32 v73, v74, v75
    v_mfma_f32_16x16x32_bf16 a[76:79], a[252:255], v[148:151], a[76:79]
    v_exp_f32_e64 v76, v76
    v_mfma_f32_16x16x32_bf16 a[76:79], a[248:251], v[144:147], a[76:79]
    v_mfma_f32_16x16x32_bf16 a[108:111], a[248:251], v[152:155], a[108:111]
    v_exp_f32_e64 v77, v77
    v_mfma_f32_16x16x32_bf16 a[108:111], a[252:255], v[156:159], a[108:111]
    v_cvt_pk_bf16_f32 v74, v76, v77
    v_mfma_f32_16x16x32_bf16 a[104:107], a[244:247], v[156:159], a[104:107]
    v_exp_f32_e64 v78, v78
    v_mfma_f32_16x16x32_bf16 a[104:107], a[240:243], v[152:155], a[104:107]
    buffer_load_dwordx4 v[224:227], v206, s[12:15], s44 offen offset:3072 sc1
    v_mfma_f32_16x16x32_bf16 a[100:103], a[232:235], v[152:155], a[100:103]
    v_exp_f32_e64 v79, v79
    v_mfma_f32_16x16x32_bf16 a[100:103], a[236:239], v[156:159], a[100:103]
    v_cvt_pk_bf16_f32 v75, v78, v79
    v_mfma_f32_16x16x32_bf16 a[96:99], a[228:231], v[156:159], a[96:99]
    v_exp_f32_e64 v80, v80
    v_mfma_f32_16x16x32_bf16 a[96:99], a[224:227], v[152:155], a[96:99]
    s_waitcnt vmcnt(20) lgkmcnt(0)
    v_mfma_f32_16x16x32_bf16 v[96:99], a[192:195], v[0:3], v[160:163]
    s_barrier
    ds_read_b64_tr_b16 a[224:225], v200 offset:16384
    v_mfma_f32_16x16x32_bf16 v[96:99], a[196:199], v[16:19], v[96:99]
    v_exp_f32_e64 v81, v81
    v_mfma_f32_16x16x32_bf16 v[96:99], a[200:203], v[32:35], v[96:99]
    ds_read_b64_tr_b16 a[226:227], v200 offset:17408
    v_cvt_pk_bf16_f32 v80, v80, v81
    v_mfma_f32_16x16x32_bf16 v[96:99], a[204:207], v[48:51], v[96:99]
    ds_read_b64_tr_b16 a[228:229], v200 offset:18432
    ds_read_b64_tr_b16 a[230:231], v200 offset:19456
    v_mfma_f32_16x16x32_bf16 v[100:103], a[220:223], v[48:51], v[160:163]
    v_exp_f32_e64 v82, v82
    v_mfma_f32_16x16x32_bf16 v[100:103], a[216:219], v[32:35], v[100:103]
    ds_read_b64_tr_b16 a[232:233], v201 offset:16384
    ds_read_b64_tr_b16 a[234:235], v201 offset:17408
    v_mfma_f32_16x16x32_bf16 v[100:103], a[212:215], v[16:19], v[100:103]
    v_exp_f32_e64 v83, v83
    v_mfma_f32_16x16x32_bf16 v[100:103], a[208:211], v[0:3], v[100:103]
    ds_read_b64_tr_b16 a[236:237], v201 offset:18432
    v_cvt_pk_bf16_f32 v81, v82, v83
    v_mfma_f32_16x16x32_bf16 v[108:111], a[208:211], v[4:7], v[164:167]
    v_exp_f32_e64 v84, v84
    v_mfma_f32_16x16x32_bf16 v[108:111], a[212:215], v[20:23], v[108:111]
    ds_read_b64_tr_b16 a[238:239], v201 offset:19456
    ds_read_b64_tr_b16 a[240:241], v202 offset:16384
    v_mfma_f32_16x16x32_bf16 v[108:111], a[216:219], v[36:39], v[108:111]
    v_exp_f32_e64 v85, v85
    v_mfma_f32_16x16x32_bf16 v[108:111], a[220:223], v[52:55], v[108:111]
    ds_read_b64_tr_b16 a[242:243], v202 offset:17408
    v_cvt_pk_bf16_f32 v82, v84, v85
    v_mfma_f32_16x16x32_bf16 v[104:107], a[204:207], v[52:55], v[164:167]
    v_exp_f32_e64 v86, v86
    v_mfma_f32_16x16x32_bf16 v[104:107], a[200:203], v[36:39], v[104:107]
    ds_read_b64_tr_b16 a[244:245], v202 offset:18432
    ds_read_b64_tr_b16 a[246:247], v202 offset:19456
    v_mfma_f32_16x16x32_bf16 v[104:107], a[196:199], v[20:23], v[104:107]
    v_exp_f32_e64 v87, v87
    v_mfma_f32_16x16x32_bf16 v[104:107], a[192:195], v[4:7], v[104:107]
    ds_read_b64_tr_b16 a[248:249], v203 offset:16384
    v_cvt_pk_bf16_f32 v83, v86, v87
    v_mfma_f32_16x16x32_bf16 v[112:115], a[192:195], v[8:11], v[168:171]
    v_exp_f32_e64 v88, v88
    v_mfma_f32_16x16x32_bf16 v[112:115], a[196:199], v[24:27], v[112:115]
    ds_read_b64_tr_b16 a[250:251], v203 offset:17408
    ds_read_b64_tr_b16 a[252:253], v203 offset:18432
    v_mfma_f32_16x16x32_bf16 v[112:115], a[200:203], v[40:43], v[112:115]
    v_exp_f32_e64 v89, v89
    v_mfma_f32_16x16x32_bf16 v[112:115], a[204:207], v[56:59], v[112:115]
    ds_read_b64_tr_b16 a[254:255], v203 offset:19456
    v_cvt_pk_bf16_f32 v88, v88, v89
    v_mfma_f32_16x16x32_bf16 v[116:119], a[220:223], v[56:59], v[168:171]
    v_exp_f32_e64 v90, v90
    v_mfma_f32_16x16x32_bf16 v[116:119], a[216:219], v[40:43], v[116:119]
    s_add_u32 m0, s36, 0
    s_xor_b32 s46, s49, 3
    s_lshl_b32 s46, s46, 17
    v_mfma_f32_16x16x32_bf16 v[116:119], a[212:215], v[24:27], v[116:119]
    v_exp_f32 v91, v91
    v_mfma_f32_16x16x32_bf16 v[116:119], a[208:211], v[8:11], v[116:119]
    v_cvt_pk_bf16_f32 v89, v90, v91
    v_mfma_f32_16x16x32_bf16 v[124:127], a[208:211], v[12:15], v[172:175]
    v_exp_f32_e64 v92, v92
    v_mfma_f32_16x16x32_bf16 v[124:127], a[212:215], v[28:31], v[124:127]
    buffer_load_dwordx4 v244, s[16:19], s46 offen offset:0 lds
    v_mfma_f32_16x16x32_bf16 v[124:127], a[216:219], v[44:47], v[124:127]
    v_exp_f32_e64 v93, v93
    v_mfma_f32_16x16x32_bf16 v[124:127], a[220:223], v[60:63], v[124:127]
    s_add_u32 s46, s46, 15360
    v_cvt_pk_bf16_f32 v90, v92, v93
    v_mfma_f32_16x16x32_bf16 v[120:123], a[204:207], v[60:63], v[172:175]
    v_exp_f32_e64 v94, v94
    v_mfma_f32_16x16x32_bf16 v[120:123], a[200:203], v[44:47], v[120:123]
    buffer_load_dwordx4 v244, s[16:19], s46 offen offset:1024 lds
    v_mfma_f32_16x16x32_bf16 v[120:123], a[196:199], v[28:31], v[120:123]
    v_exp_f32_e64 v95, v95
    v_mfma_f32_16x16x32_bf16 v[120:123], a[192:195], v[12:15], v[120:123]
    s_add_u32 s46, s46, 15360
    v_cvt_pk_bf16_f32 v91, v94, v95
    s_waitcnt lgkmcnt(0)
    v_mfma_f32_16x16x32_bf16 a[16:19], a[224:227], v[128:131], a[16:19]
    v_exp_f32 v96, v96
    v_mfma_f32_16x16x32_bf16 a[16:19], a[228:231], v[132:135], a[16:19]
    ds_read_b128 a[192:195], v192 offset:49152
    v_mfma_f32_16x16x32_bf16 a[20:23], a[236:239], v[132:135], a[20:23]
    v_exp_f32_e64 v97, v97
    v_mfma_f32_16x16x32_bf16 a[20:23], a[232:235], v[128:131], a[20:23]
    ds_read_b128 a[196:199], v193 offset:49152
    v_cvt_pk_bf16_f32 v68, v96, v97
    v_mfma_f32_16x16x32_bf16 a[24:27], a[240:243], v[128:131], a[24:27]
    v_exp_f32_e64 v98, v98
    v_mfma_f32_16x16x32_bf16 a[24:27], a[244:247], v[132:135], a[24:27]
    ds_read_b128 a[200:203], v194 offset:49152
    v_mfma_f32_16x16x32_bf16 a[28:31], a[252:255], v[132:135], a[28:31]
    v_exp_f32_e64 v99, v99
    v_mfma_f32_16x16x32_bf16 a[28:31], a[248:251], v[128:131], a[28:31]
    ds_read_b128 a[204:207], v195 offset:49152
    v_cvt_pk_bf16_f32 v69, v98, v99
    v_mfma_f32_16x16x32_bf16 a[60:63], a[248:251], v[136:139], a[60:63]
    v_exp_f32_e64 v100, v100
    v_mfma_f32_16x16x32_bf16 a[60:63], a[252:255], v[140:143], a[60:63]
    ds_read_b128 a[208:211], v192 offset:50176
    v_mfma_f32_16x16x32_bf16 a[56:59], a[244:247], v[140:143], a[56:59]
    v_exp_f32_e64 v101, v101
    v_mfma_f32_16x16x32_bf16 a[56:59], a[240:243], v[136:139], a[56:59]
    ds_read_b128 a[212:215], v193 offset:50176
    v_cvt_pk_bf16_f32 v70, v100, v101
    v_mfma_f32_16x16x32_bf16 a[52:55], a[232:235], v[136:139], a[52:55]
    v_exp_f32_e64 v102, v102
    v_mfma_f32_16x16x32_bf16 a[52:55], a[236:239], v[140:143], a[52:55]
    ds_read_b128 a[216:219], v194 offset:50176
    v_mfma_f32_16x16x32_bf16 a[48:51], a[228:231], v[140:143], a[48:51]
    v_exp_f32_e64 v103, v103
    v_mfma_f32_16x16x32_bf16 a[48:51], a[224:227], v[136:139], a[48:51]
    ds_read_b128 a[220:223], v195 offset:50176
    v_cvt_pk_bf16_f32 v71, v102, v103
    v_mfma_f32_16x16x32_bf16 a[80:83], a[224:227], v[144:147], a[80:83]
    v_exp_f32_e64 v104, v104
    v_mfma_f32_16x16x32_bf16 a[80:83], a[228:231], v[148:151], a[80:83]
    buffer_load_dwordx4 v244, s[16:19], s46 offen offset:2048 lds
    v_mfma_f32_16x16x32_bf16 a[84:87], a[236:239], v[148:151], a[84:87]
    v_exp_f32_e64 v105, v105
    v_mfma_f32_16x16x32_bf16 a[84:87], a[232:235], v[144:147], a[84:87]
    s_add_u32 s46, s46, 15360
    v_cvt_pk_bf16_f32 v76, v104, v105
    v_mfma_f32_16x16x32_bf16 a[88:91], a[240:243], v[144:147], a[88:91]
    v_exp_f32_e64 v106, v106
    v_mfma_f32_16x16x32_bf16 a[88:91], a[244:247], v[148:151], a[88:91]
    buffer_load_dwordx4 v244, s[16:19], s46 offen offset:3072 lds
    v_mfma_f32_16x16x32_bf16 a[92:95], a[252:255], v[148:151], a[92:95]
    v_exp_f32_e64 v107, v107
    v_mfma_f32_16x16x32_bf16 a[92:95], a[248:251], v[144:147], a[92:95]
    s_add_u32 s46, s46, 15360
    v_cvt_pk_bf16_f32 v77, v106, v107
    v_mfma_f32_16x16x32_bf16 a[124:127], a[248:251], v[152:155], a[124:127]
    v_exp_f32_e64 v108, v108
    v_mfma_f32_16x16x32_bf16 a[124:127], a[252:255], v[156:159], a[124:127]
    s_add_u32 m0, s35, 32768
    s_xor_b32 s46, s49, 2
    s_lshl_b32 s46, s46, 17
    v_mfma_f32_16x16x32_bf16 a[120:123], a[244:247], v[156:159], a[120:123]
    v_exp_f32_e64 v109, v109
    v_mfma_f32_16x16x32_bf16 a[120:123], a[240:243], v[152:155], a[120:123]
    v_cvt_pk_bf16_f32 v78, v108, v109
    v_mfma_f32_16x16x32_bf16 a[116:119], a[232:235], v[152:155], a[116:119]
    v_exp_f32_e64 v110, v110
    v_mfma_f32_16x16x32_bf16 a[116:119], a[236:239], v[156:159], a[116:119]
    v_mfma_f32_16x16x32_bf16 a[112:115], a[228:231], v[156:159], a[112:115]
    v_exp_f32_e64 v111, v111
    v_mfma_f32_16x16x32_bf16 a[112:115], a[224:227], v[152:155], a[112:115]
    v_cvt_pk_bf16_f32 v79, v110, v111
    s_waitcnt lgkmcnt(0)
    v_mfma_f32_16x16x32_bf16 v[128:131], a[192:195], v[0:3], v[160:163]
    ds_read_b64_tr_b16 a[224:225], v196 offset:32768
    ds_read_b64_tr_b16 a[226:227], v196 offset:33792
    v_mfma_f32_16x16x32_bf16 v[128:131], a[196:199], v[16:19], v[128:131]
    v_exp_f32 v112, v112
    v_mfma_f32_16x16x32_bf16 v[128:131], a[200:203], v[32:35], v[128:131]
    ds_read_b64_tr_b16 a[228:229], v196 offset:34816
    ds_read_b64_tr_b16 a[230:231], v196 offset:35840
    v_mfma_f32_16x16x32_bf16 v[128:131], a[204:207], v[48:51], v[128:131]
    v_exp_f32_e64 v113, v113
    v_mfma_f32_16x16x32_bf16 v[132:135], a[220:223], v[48:51], v[160:163]
    ds_read_b64_tr_b16 a[232:233], v197 offset:32768
    v_cvt_pk_bf16_f32 v84, v112, v113
    v_mfma_f32_16x16x32_bf16 v[132:135], a[216:219], v[32:35], v[132:135]
    ds_read_b64_tr_b16 a[234:235], v197 offset:33792
    ds_read_b64_tr_b16 a[236:237], v197 offset:34816
    v_mfma_f32_16x16x32_bf16 v[132:135], a[212:215], v[16:19], v[132:135]
    v_exp_f32_e64 v114, v114
    v_mfma_f32_16x16x32_bf16 v[132:135], a[208:211], v[0:3], v[132:135]
    ds_read_b64_tr_b16 a[238:239], v197 offset:35840
    ds_read_b64_tr_b16 a[240:241], v198 offset:32768
    v_mfma_f32_16x16x32_bf16 v[140:143], a[208:211], v[4:7], v[164:167]
    v_exp_f32_e64 v115, v115
    v_mfma_f32_16x16x32_bf16 v[140:143], a[212:215], v[20:23], v[140:143]
    ds_read_b64_tr_b16 a[242:243], v198 offset:33792
    v_cvt_pk_bf16_f32 v85, v114, v115
    v_mfma_f32_16x16x32_bf16 v[140:143], a[216:219], v[36:39], v[140:143]
    v_exp_f32_e64 v116, v116
    v_mfma_f32_16x16x32_bf16 v[140:143], a[220:223], v[52:55], v[140:143]
    ds_read_b64_tr_b16 a[244:245], v198 offset:34816
    ds_read_b64_tr_b16 a[246:247], v198 offset:35840
    v_mfma_f32_16x16x32_bf16 v[136:139], a[204:207], v[52:55], v[164:167]
    v_exp_f32_e64 v117, v117
    v_mfma_f32_16x16x32_bf16 v[136:139], a[200:203], v[36:39], v[136:139]
    ds_read_b64_tr_b16 a[248:249], v199 offset:32768
    v_cvt_pk_bf16_f32 v86, v116, v117
    v_mfma_f32_16x16x32_bf16 v[136:139], a[196:199], v[20:23], v[136:139]
    v_exp_f32_e64 v118, v118
    v_mfma_f32_16x16x32_bf16 v[136:139], a[192:195], v[4:7], v[136:139]
    ds_read_b64_tr_b16 a[250:251], v199 offset:33792
    ds_read_b64_tr_b16 a[252:253], v199 offset:34816
    v_smfmac_f32_16x16x64_bf16 a[128:131], v[208:211], v[64:71], v207
    v_exp_f32_e64 v119, v119
    v_smfmac_f32_16x16x64_bf16 a[132:135], v[208:211], v[72:79], v207
    ds_read_b64_tr_b16 a[254:255], v199 offset:35840
    v_cvt_pk_bf16_f32 v87, v118, v119
    v_mfma_f32_16x16x32_bf16 v[144:147], a[192:195], v[8:11], v[168:171]
    v_exp_f32_e64 v120, v120
    v_mfma_f32_16x16x32_bf16 v[144:147], a[196:199], v[24:27], v[144:147]
    v_mfma_f32_16x16x32_bf16 v[144:147], a[200:203], v[40:43], v[144:147]
    v_exp_f32_e64 v121, v121
    v_mfma_f32_16x16x32_bf16 v[144:147], a[204:207], v[56:59], v[144:147]
    v_cvt_pk_bf16_f32 v92, v120, v121
    v_mfma_f32_16x16x32_bf16 v[148:151], a[220:223], v[56:59], v[168:171]
    v_exp_f32_e64 v122, v122
    v_mfma_f32_16x16x32_bf16 v[148:151], a[216:219], v[40:43], v[148:151]
    buffer_load_dwordx4 v244, s[16:19], s46 offen offset:0 lds
    v_mfma_f32_16x16x32_bf16 v[148:151], a[212:215], v[24:27], v[148:151]
    v_exp_f32_e64 v123, v123
    v_mfma_f32_16x16x32_bf16 v[148:151], a[208:211], v[8:11], v[148:151]
    s_add_u32 s46, s46, 15360
    v_cvt_pk_bf16_f32 v93, v122, v123
    v_mfma_f32_16x16x32_bf16 v[156:159], a[208:211], v[12:15], v[172:175]
    v_exp_f32_e64 v124, v124
    v_mfma_f32_16x16x32_bf16 v[156:159], a[212:215], v[28:31], v[156:159]
    buffer_load_dwordx4 v244, s[16:19], s46 offen offset:1024 lds
    v_mfma_f32_16x16x32_bf16 v[156:159], a[216:219], v[44:47], v[156:159]
    v_exp_f32_e64 v125, v125
    v_mfma_f32_16x16x32_bf16 v[156:159], a[220:223], v[60:63], v[156:159]
    s_add_u32 s46, s46, 15360
    v_cvt_pk_bf16_f32 v94, v124, v125
    v_mfma_f32_16x16x32_bf16 v[152:155], a[204:207], v[60:63], v[172:175]
    v_exp_f32_e64 v126, v126
    v_mfma_f32_16x16x32_bf16 v[152:155], a[200:203], v[44:47], v[152:155]
    v_mfma_f32_16x16x32_bf16 v[152:155], a[196:199], v[28:31], v[152:155]
    v_exp_f32_e64 v127, v127
    v_mfma_f32_16x16x32_bf16 v[152:155], a[192:195], v[12:15], v[152:155]
    v_cvt_pk_bf16_f32 v95, v126, v127
    s_waitcnt lgkmcnt(0)
    v_mfma_f32_16x16x32_bf16 a[0:3], a[224:227], v[64:67], a[0:3]
    v_exp_f32 v128, v128
    v_mfma_f32_16x16x32_bf16 a[0:3], a[228:231], v[68:71], a[0:3]
    ds_read_b128 a[192:195], v192 offset:51200
    v_mfma_f32_16x16x32_bf16 a[4:7], a[236:239], v[68:71], a[4:7]
    v_exp_f32_e64 v129, v129
    v_mfma_f32_16x16x32_bf16 a[4:7], a[232:235], v[64:67], a[4:7]
    ds_read_b128 a[196:199], v193 offset:51200
    v_cvt_pk_bf16_f32 v128, v128, v129
    v_mfma_f32_16x16x32_bf16 a[8:11], a[240:243], v[64:67], a[8:11]
    v_exp_f32_e64 v130, v130
    v_mfma_f32_16x16x32_bf16 a[8:11], a[244:247], v[68:71], a[8:11]
    ds_read_b128 a[200:203], v194 offset:51200
    v_mfma_f32_16x16x32_bf16 a[12:15], a[252:255], v[68:71], a[12:15]
    v_exp_f32_e64 v131, v131
    v_mfma_f32_16x16x32_bf16 a[12:15], a[248:251], v[64:67], a[12:15]
    ds_read_b128 a[204:207], v195 offset:51200
    v_cvt_pk_bf16_f32 v129, v130, v131
    v_mfma_f32_16x16x32_bf16 a[44:47], a[248:251], v[72:75], a[44:47]
    v_exp_f32_e64 v132, v132
    v_mfma_f32_16x16x32_bf16 a[44:47], a[252:255], v[76:79], a[44:47]
    ds_read_b128 a[208:211], v192 offset:52224
    v_mfma_f32_16x16x32_bf16 a[40:43], a[244:247], v[76:79], a[40:43]
    v_exp_f32_e64 v133, v133
    v_mfma_f32_16x16x32_bf16 a[40:43], a[240:243], v[72:75], a[40:43]
    ds_read_b128 a[212:215], v193 offset:52224
    v_cvt_pk_bf16_f32 v130, v132, v133
    v_mfma_f32_16x16x32_bf16 a[36:39], a[232:235], v[72:75], a[36:39]
    v_exp_f32_e64 v134, v134
    v_mfma_f32_16x16x32_bf16 a[36:39], a[236:239], v[76:79], a[36:39]
    ds_read_b128 a[216:219], v194 offset:52224
L_hop11:
    s_cbranch_execz L_ret2
    v_mfma_f32_16x16x32_bf16 a[32:35], a[228:231], v[76:79], a[32:35]
    v_exp_f32 v135, v135
    v_mfma_f32_16x16x32_bf16 a[32:35], a[224:227], v[72:75], a[32:35]
    ds_read_b128 a[220:223], v195 offset:52224
    v_cvt_pk_bf16_f32 v131, v134, v135
    v_smfmac_f32_16x16x64_bf16 a[136:139], v[208:211], v[80:87], v207
    v_exp_f32_e64 v136, v136
    v_smfmac_f32_16x16x64_bf16 a[140:143], v[208:211], v[88:95], v207
    buffer_load_dwordx4 v244, s[16:19], s46 offen offset:2048 lds
    v_mfma_f32_16x16x32_bf16 a[64:67], a[224:227], v[80:83], a[64:67]
    v_exp_f32_e64 v137, v137
    v_mfma_f32_16x16x32_bf16 a[64:67], a[228:231], v[84:87], a[64:67]
    s_add_u32 s46, s46, 15360
    v_cvt_pk_bf16_f32 v136, v136, v137
    v_mfma_f32_16x16x32_bf16 a[68:71], a[236:239], v[84:87], a[68:71]
    v_exp_f32_e64 v138, v138
    v_mfma_f32_16x16x32_bf16 a[68:71], a[232:235], v[80:83], a[68:71]
    buffer_load_dwordx4 v244, s[16:19], s46 offen offset:3072 lds
    v_mfma_f32_16x16x32_bf16 a[72:75], a[240:243], v[80:83], a[72:75]
    v_exp_f32_e64 v139, v139
    v_mfma_f32_16x16x32_bf16 a[72:75], a[244:247], v[84:87], a[72:75]
    s_add_u32 s46, s46, 15360
    v_cvt_pk_bf16_f32 v137, v138, v139
    v_mfma_f32_16x16x32_bf16 a[76:79], a[252:255], v[84:87], a[76:79]
    v_exp_f32_e64 v140, v140
    v_mfma_f32_16x16x32_bf16 a[76:79], a[248:251], v[80:83], a[76:79]
    v_mfma_f32_16x16x32_bf16 a[108:111], a[248:251], v[88:91], a[108:111]
    v_exp_f32_e64 v141, v141
    v_mfma_f32_16x16x32_bf16 a[108:111], a[252:255], v[92:95], a[108:111]
    v_cvt_pk_bf16_f32 v138, v140, v141
    v_mfma_f32_16x16x32_bf16 a[104:107], a[244:247], v[92:95], a[104:107]
    v_exp_f32_e64 v142, v142
    v_mfma_f32_16x16x32_bf16 a[104:107], a[240:243], v[88:91], a[104:107]
    v_mfma_f32_16x16x32_bf16 a[100:103], a[232:235], v[88:91], a[100:103]
    v_exp_f32_e64 v143, v143
    v_mfma_f32_16x16x32_bf16 a[100:103], a[236:239], v[92:95], a[100:103]
    v_cvt_pk_bf16_f32 v139, v142, v143
    v_mfma_f32_16x16x32_bf16 a[96:99], a[228:231], v[92:95], a[96:99]
    v_exp_f32_e64 v144, v144
    v_mfma_f32_16x16x32_bf16 a[96:99], a[224:227], v[88:91], a[96:99]
    s_waitcnt vmcnt(18) lgkmcnt(0)
    v_mfma_f32_16x16x32_bf16 v[96:99], a[192:195], v[0:3], v[160:163]
    s_barrier
    ds_read_b64_tr_b16 a[224:225], v200 offset:32768
    v_mfma_f32_16x16x32_bf16 v[96:99], a[196:199], v[16:19], v[96:99]
    v_exp_f32_e64 v145, v145
    v_mfma_f32_16x16x32_bf16 v[96:99], a[200:203], v[32:35], v[96:99]
    ds_read_b64_tr_b16 a[226:227], v200 offset:33792
    v_cvt_pk_bf16_f32 v144, v144, v145
    v_mfma_f32_16x16x32_bf16 v[96:99], a[204:207], v[48:51], v[96:99]
    ds_read_b64_tr_b16 a[228:229], v200 offset:34816
    ds_read_b64_tr_b16 a[230:231], v200 offset:35840
    v_mfma_f32_16x16x32_bf16 v[100:103], a[220:223], v[48:51], v[160:163]
    v_exp_f32_e64 v146, v146
    v_mfma_f32_16x16x32_bf16 v[100:103], a[216:219], v[32:35], v[100:103]
    ds_read_b64_tr_b16 a[232:233], v201 offset:32768
    ds_read_b64_tr_b16 a[234:235], v201 offset:33792
    v_mfma_f32_16x16x32_bf16 v[100:103], a[212:215], v[16:19], v[100:103]
    v_exp_f32_e64 v147, v147
    v_mfma_f32_16x16x32_bf16 v[100:103], a[208:211], v[0:3], v[100:103]
    ds_read_b64_tr_b16 a[236:237], v201 offset:34816
    v_cvt_pk_bf16_f32 v145, v146, v147
    s_waitcnt vmcnt(14)
    v_mfma_f32_16x16x32_bf16 a[144:147], v[228:231], v[212:215], a[144:147]
    s_waitcnt vmcnt(13)
    v_mfma_f32_16x16x32_bf16 a[148:151], v[232:235], v[212:215], a[148:151]
    s_waitcnt vmcnt(12)
    v_mfma_f32_16x16x32_bf16 a[152:155], v[236:239], v[212:215], a[152:155]
    s_waitcnt vmcnt(11)
    v_mfma_f32_16x16x32_bf16 a[156:159], v[240:243], v[212:215], a[156:159]
    v_mfma_f32_16x16x32_bf16 v[108:111], a[208:211], v[4:7], v[164:167]
    v_exp_f32_e64 v148, v148
    v_mfma_f32_16x16x32_bf16 v[108:111], a[212:215], v[20:23], v[108:111]
    ds_read_b64_tr_b16 a[238:239], v201 offset:35840
    ds_read_b64_tr_b16 a[240:241], v202 offset:32768
    v_mfma_f32_16x16x32_bf16 v[108:111], a[216:219], v[36:39], v[108:111]
    v_exp_f32_e64 v149, v149
    v_mfma_f32_16x16x32_bf16 v[108:111], a[220:223], v[52:55], v[108:111]
    ds_read_b64_tr_b16 a[242:243], v202 offset:33792
    v_cvt_pk_bf16_f32 v146, v148, v149
    v_mfma_f32_16x16x32_bf16 v[104:107], a[204:207], v[52:55], v[164:167]
    v_exp_f32_e64 v150, v150
    v_mfma_f32_16x16x32_bf16 v[104:107], a[200:203], v[36:39], v[104:107]
    ds_read_b64_tr_b16 a[244:245], v202 offset:34816
    ds_read_b64_tr_b16 a[246:247], v202 offset:35840
    v_mfma_f32_16x16x32_bf16 v[104:107], a[196:199], v[20:23], v[104:107]
    v_exp_f32_e64 v151, v151
    v_mfma_f32_16x16x32_bf16 v[104:107], a[192:195], v[4:7], v[104:107]
    ds_read_b64_tr_b16 a[248:249], v203 offset:32768
    v_cvt_pk_bf16_f32 v147, v150, v151
    v_mfma_f32_16x16x32_bf16 v[112:115], a[192:195], v[8:11], v[168:171]
    v_exp_f32_e64 v152, v152
    v_mfma_f32_16x16x32_bf16 v[112:115], a[196:199], v[24:27], v[112:115]
    ds_read_b64_tr_b16 a[250:251], v203 offset:33792
    ds_read_b64_tr_b16 a[252:253], v203 offset:34816
    v_mfma_f32_16x16x32_bf16 v[112:115], a[200:203], v[40:43], v[112:115]
    v_exp_f32_e64 v153, v153
    v_mfma_f32_16x16x32_bf16 v[112:115], a[204:207], v[56:59], v[112:115]
    ds_read_b64_tr_b16 a[254:255], v203 offset:35840
    v_cvt_pk_bf16_f32 v152, v152, v153
    v_mfma_f32_16x16x32_bf16 v[116:119], a[220:223], v[56:59], v[168:171]
    v_exp_f32_e64 v154, v154
    v_mfma_f32_16x16x32_bf16 v[116:119], a[216:219], v[40:43], v[116:119]
    s_add_u32 m0, s36, 16384
    s_xor_b32 s46, s49, 3
    s_lshl_b32 s46, s46, 17
    s_add_u32 s46, s46, 65536
    v_mfma_f32_16x16x32_bf16 v[116:119], a[212:215], v[24:27], v[116:119]
    v_exp_f32_e64 v155, v155
    v_mfma_f32_16x16x32_bf16 v[116:119], a[208:211], v[8:11], v[116:119]
    v_cvt_pk_bf16_f32 v153, v154, v155
    s_lshl_b32 s47, s2, 6
    s_add_u32 s47, s47, s33
    s_lshl_b32 s47, s47, 10
    v_mfma_f32_16x16x32_bf16 v[124:127], a[208:211], v[12:15], v[172:175]
    v_exp_f32 v156, v156
    v_mfma_f32_16x16x32_bf16 v[124:127], a[212:215], v[28:31], v[124:127]
    buffer_load_dwordx4 v244, s[16:19], s46 offen offset:0 lds
    s_add_u32 s37, s47, 16777216
    v_mfma_f32_16x16x32_bf16 v[124:127], a[216:219], v[44:47], v[124:127]
    v_exp_f32_e64 v157, v157
    v_mfma_f32_16x16x32_bf16 v[124:127], a[220:223], v[60:63], v[124:127]
    s_add_u32 s46, s46, 15360
    v_cvt_pk_bf16_f32 v154, v156, v157
    v_mfma_f32_16x16x32_bf16 v[120:123], a[204:207], v[60:63], v[172:175]
    v_exp_f32_e64 v158, v158
    v_mfma_f32_16x16x32_bf16 v[120:123], a[200:203], v[44:47], v[120:123]
    buffer_load_dwordx4 v244, s[16:19], s46 offen offset:1024 lds
    s_and_b32 s47, s39, 1
    s_lshl_b32 s47, s47, 7
    s_lshl_b32 s48, s49, 8
    s_add_u32 s47, s47, s48
    v_mfma_f32_16x16x32_bf16 v[120:123], a[196:199], v[28:31], v[120:123]
    v_exp_f32_e64 v159, v159
    v_mfma_f32_16x16x32_bf16 v[120:123], a[192:195], v[12:15], v[120:123]
    s_add_u32 s46, s46, 15360
    v_cvt_pk_bf16_f32 v155, v158, v159
    s_waitcnt lgkmcnt(0)
    v_mfma_f32_16x16x32_bf16 a[16:19], a[224:227], v[64:67], a[16:19]
    v_exp_f32 v96, v96
    v_mfma_f32_16x16x32_bf16 a[16:19], a[228:231], v[68:71], a[16:19]
    ds_read_b64_tr_b16 a[208:209], v200 offset:49152
    ds_read_b64_tr_b16 a[192:193], v196 offset:49152
    v_mfma_f32_16x16x32_bf16 a[20:23], a[236:239], v[68:71], a[20:23]
    v_exp_f32_e64 v97, v97
    v_mfma_f32_16x16x32_bf16 a[20:23], a[232:235], v[64:67], a[20:23]
    ds_read_b64_tr_b16 a[194:195], v196 offset:50176
    v_cvt_pk_bf16_f32 v132, v96, v97
    v_mfma_f32_16x16x32_bf16 a[24:27], a[240:243], v[64:67], a[24:27]
    v_exp_f32_e64 v98, v98
    v_mfma_f32_16x16x32_bf16 a[24:27], a[244:247], v[68:71], a[24:27]
    ds_read_b64_tr_b16 a[210:211], v200 offset:50176
    ds_read_b64_tr_b16 a[196:197], v197 offset:49152
    v_mfma_f32_16x16x32_bf16 a[28:31], a[252:255], v[68:71], a[28:31]
    v_exp_f32_e64 v99, v99
    v_mfma_f32_16x16x32_bf16 a[28:31], a[248:251], v[64:67], a[28:31]
    ds_read_b64_tr_b16 a[198:199], v197 offset:50176
    v_cvt_pk_bf16_f32 v133, v98, v99
    v_mfma_f32_16x16x32_bf16 a[160:163], v[228:231], v[216:219], a[160:163]
    ds_read_b64_tr_b16 a[212:213], v201 offset:49152
    ds_read_b64_tr_b16 a[214:215], v201 offset:50176
    v_mfma_f32_16x16x32_bf16 a[164:167], v[232:235], v[216:219], a[164:167]
    ds_read_b64_tr_b16 a[216:217], v202 offset:49152
    ds_read_b64_tr_b16 a[218:219], v202 offset:50176
    v_mfma_f32_16x16x32_bf16 a[168:171], v[236:239], v[216:219], a[168:171]
    ds_read_b64_tr_b16 a[220:221], v203 offset:49152
    ds_read_b64_tr_b16 a[222:223], v203 offset:50176
    v_mfma_f32_16x16x32_bf16 a[172:175], v[240:243], v[216:219], a[172:175]
    v_mfma_f32_16x16x32_bf16 a[60:63], a[248:251], v[72:75], a[60:63]
    v_exp_f32_e64 v100, v100
    v_mfma_f32_16x16x32_bf16 a[60:63], a[252:255], v[76:79], a[60:63]
    ds_read_b64_tr_b16 a[200:201], v198 offset:49152
    v_mfma_f32_16x16x32_bf16 a[56:59], a[244:247], v[76:79], a[56:59]
    v_exp_f32_e64 v101, v101
    v_mfma_f32_16x16x32_bf16 a[56:59], a[240:243], v[72:75], a[56:59]
    ds_read_b64_tr_b16 a[202:203], v198 offset:50176
    v_cvt_pk_bf16_f32 v134, v100, v101
    v_mfma_f32_16x16x32_bf16 a[52:55], a[232:235], v[72:75], a[52:55]
    v_exp_f32_e64 v102, v102
    v_mfma_f32_16x16x32_bf16 a[52:55], a[236:239], v[76:79], a[52:55]
    ds_read_b64_tr_b16 a[204:205], v199 offset:49152
    v_mfma_f32_16x16x32_bf16 a[48:51], a[228:231], v[76:79], a[48:51]
    v_exp_f32_e64 v103, v103
    v_mfma_f32_16x16x32_bf16 a[48:51], a[224:227], v[72:75], a[48:51]
    ds_read_b64_tr_b16 a[206:207], v199 offset:50176
    v_cvt_pk_bf16_f32 v135, v102, v103
    v_mfma_f32_16x16x32_bf16 a[80:83], a[224:227], v[80:83], a[80:83]
    v_exp_f32_e64 v104, v104
    v_mfma_f32_16x16x32_bf16 a[80:83], a[228:231], v[84:87], a[80:83]
    buffer_load_dwordx4 v244, s[16:19], s46 offen offset:2048 lds
    v_mfma_f32_16x16x32_bf16 a[84:87], a[236:239], v[84:87], a[84:87]
    v_exp_f32_e64 v105, v105
    v_mfma_f32_16x16x32_bf16 a[84:87], a[232:235], v[80:83], a[84:87]
    s_add_u32 s46, s46, 15360
    v_cvt_pk_bf16_f32 v140, v104, v105
    v_mfma_f32_16x16x32_bf16 a[88:91], a[240:243], v[80:83], a[88:91]
    v_exp_f32_e64 v106, v106
    v_mfma_f32_16x16x32_bf16 a[88:91], a[244:247], v[84:87], a[88:91]
    buffer_load_dwordx4 v244, s[16:19], s46 offen offset:3072 lds
    v_mfma_f32_16x16x32_bf16 a[92:95], a[252:255], v[84:87], a[92:95]
    v_exp_f32_e64 v107, v107
    v_mfma_f32_16x16x32_bf16 a[92:95], a[248:251], v[80:83], a[92:95]
    s_add_u32 s46, s46, 15360
    v_cvt_pk_bf16_f32 v141, v106, v107
    v_mfma_f32_16x16x32_bf16 a[124:127], a[248:251], v[88:91], a[124:127]
    v_exp_f32_e64 v108, v108
    v_mfma_f32_16x16x32_bf16 a[124:127], a[252:255], v[92:95], a[124:127]
    s_add_u32 m0, s35, 49152
    s_xor_b32 s46, s49, 2
    s_lshl_b32 s46, s46, 17
    s_add_u32 s46, s46, 65536
    v_mfma_f32_16x16x32_bf16 a[120:123], a[244:247], v[92:95], a[120:123]
    v_exp_f32_e64 v109, v109
    v_mfma_f32_16x16x32_bf16 a[120:123], a[240:243], v[88:91], a[120:123]
    v_cvt_pk_bf16_f32 v142, v108, v109
    v_mfma_f32_16x16x32_bf16 a[116:119], a[232:235], v[88:91], a[116:119]
    v_exp_f32_e64 v110, v110
    v_mfma_f32_16x16x32_bf16 a[116:119], a[236:239], v[92:95], a[116:119]
    v_mfma_f32_16x16x32_bf16 a[112:115], a[228:231], v[92:95], a[112:115]
    v_exp_f32_e64 v111, v111
    v_mfma_f32_16x16x32_bf16 a[112:115], a[224:227], v[88:91], a[112:115]
    v_cvt_pk_bf16_f32 v143, v110, v111
    s_waitcnt lgkmcnt(0)
    v_mfma_f32_16x16x32_bf16 a[0:3], a[192:195], v[128:131], a[0:3]
    ds_read_b64_tr_b16 a[224:225], v196 offset:51200
    ds_read_b64_tr_b16 a[226:227], v196 offset:52224
    v_mfma_f32_16x16x32_bf16 a[32:35], a[192:195], v[136:139], a[32:35]
    v_exp_f32 v112, v112
    v_mfma_f32_16x16x32_bf16 a[4:7], a[196:199], v[128:131], a[4:7]
    ds_read_b64_tr_b16 a[228:229], v197 offset:51200
    ds_read_b64_tr_b16 a[230:231], v197 offset:52224
    v_mfma_f32_16x16x32_bf16 a[36:39], a[196:199], v[136:139], a[36:39]
    v_exp_f32_e64 v113, v113
    v_mfma_f32_16x16x32_bf16 a[8:11], a[200:203], v[128:131], a[8:11]
    ds_read_b64_tr_b16 a[232:233], v198 offset:51200
    v_cvt_pk_bf16_f32 v148, v112, v113
    v_mfma_f32_16x16x32_bf16 a[40:43], a[200:203], v[136:139], a[40:43]
    ds_read_b64_tr_b16 a[234:235], v198 offset:52224
    ds_read_b64_tr_b16 a[236:237], v199 offset:51200
    v_mfma_f32_16x16x32_bf16 a[12:15], a[204:207], v[128:131], a[12:15]
    v_exp_f32_e64 v114, v114
    v_mfma_f32_16x16x32_bf16 a[44:47], a[204:207], v[136:139], a[44:47]
    ds_read_b64_tr_b16 a[238:239], v199 offset:52224
    ds_read_b64_tr_b16 a[240:241], v200 offset:51200
    v_mfma_f32_16x16x32_bf16 a[176:179], v[228:231], v[220:223], a[176:179]
    v_mfma_f32_16x16x32_bf16 a[180:183], v[232:235], v[220:223], a[180:183]
    v_mfma_f32_16x16x32_bf16 a[184:187], v[236:239], v[220:223], a[184:187]
    v_mfma_f32_16x16x32_bf16 a[188:191], v[240:243], v[220:223], a[188:191]
    v_mfma_f32_16x16x32_bf16 a[16:19], a[208:211], v[128:131], a[16:19]
    v_exp_f32_e64 v115, v115
    v_mfma_f32_16x16x32_bf16 a[48:51], a[208:211], v[136:139], a[48:51]
    ds_read_b64_tr_b16 a[242:243], v200 offset:52224
    v_cvt_pk_bf16_f32 v149, v114, v115
    v_mfma_f32_16x16x32_bf16 a[20:23], a[212:215], v[128:131], a[20:23]
    v_exp_f32_e64 v116, v116
    v_mfma_f32_16x16x32_bf16 a[52:55], a[212:215], v[136:139], a[52:55]
    ds_read_b64_tr_b16 a[244:245], v201 offset:51200
    ds_read_b64_tr_b16 a[246:247], v201 offset:52224
    v_mfma_f32_16x16x32_bf16 a[24:27], a[216:219], v[128:131], a[24:27]
    v_exp_f32_e64 v117, v117
    v_mfma_f32_16x16x32_bf16 a[56:59], a[216:219], v[136:139], a[56:59]
    ds_read_b64_tr_b16 a[248:249], v202 offset:51200
    v_cvt_pk_bf16_f32 v150, v116, v117
    v_mfma_f32_16x16x32_bf16 a[28:31], a[220:223], v[128:131], a[28:31]
    v_exp_f32_e64 v118, v118
    v_mfma_f32_16x16x32_bf16 a[60:63], a[220:223], v[136:139], a[60:63]
    ds_read_b64_tr_b16 a[250:251], v202 offset:52224
    ds_read_b64_tr_b16 a[252:253], v203 offset:51200
    v_smfmac_f32_16x16x64_bf16 a[128:131], v[208:211], v[128:135], v207
    v_exp_f32_e64 v119, v119
    v_smfmac_f32_16x16x64_bf16 a[132:135], v[208:211], v[136:143], v207
    ds_read_b64_tr_b16 a[254:255], v203 offset:52224
    v_cvt_pk_bf16_f32 v151, v118, v119
    v_mfma_f32_16x16x32_bf16 a[92:95], a[220:223], v[144:147], a[92:95]
    v_exp_f32_e64 v120, v120
    v_mfma_f32_16x16x32_bf16 a[124:127], a[220:223], v[152:155], a[124:127]
    v_lshrrev_b32_e64 v84, 8, v206
    v_lshl_add_u32 v84, v84, 3, s47
    v_mfma_f32_16x16x32_bf16 a[88:91], a[216:219], v[144:147], a[88:91]
    v_exp_f32_e64 v121, v121
    v_mfma_f32_16x16x32_bf16 a[120:123], a[216:219], v[152:155], a[120:123]
    v_cvt_pk_bf16_f32 v156, v120, v121
    v_mfma_f32_16x16x32_bf16 a[84:87], a[212:215], v[144:147], a[84:87]
    v_exp_f32_e64 v122, v122
    v_mfma_f32_16x16x32_bf16 a[116:119], a[212:215], v[152:155], a[116:119]
    buffer_load_dwordx4 v244, s[16:19], s46 offen offset:0 lds
    v_mfma_f32_16x16x32_bf16 a[80:83], a[208:211], v[144:147], a[80:83]
    v_exp_f32_e64 v123, v123
    v_mfma_f32_16x16x32_bf16 a[112:115], a[208:211], v[152:155], a[112:115]
    s_add_u32 s46, s46, 15360
    v_cvt_pk_bf16_f32 v157, v122, v123
    v_mfma_f32_16x16x32_bf16 a[76:79], a[204:207], v[144:147], a[76:79]
    v_exp_f32_e64 v124, v124
    v_mfma_f32_16x16x32_bf16 a[108:111], a[204:207], v[152:155], a[108:111]
    buffer_load_dwordx4 v244, s[16:19], s46 offen offset:1024 lds
    v_mfma_f32_16x16x32_bf16 a[72:75], a[200:203], v[144:147], a[72:75]
    v_exp_f32_e64 v125, v125
    v_mfma_f32_16x16x32_bf16 a[104:107], a[200:203], v[152:155], a[104:107]
    s_add_u32 s46, s46, 15360
    v_cvt_pk_bf16_f32 v158, v124, v125
    v_mfma_f32_16x16x32_bf16 a[68:71], a[196:199], v[144:147], a[68:71]
    v_exp_f32_e64 v126, v126
    v_mfma_f32_16x16x32_bf16 a[100:103], a[196:199], v[152:155], a[100:103]
    v_mfma_f32_16x16x32_bf16 a[64:67], a[192:195], v[144:147], a[64:67]
    v_exp_f32_e64 v127, v127
    v_mfma_f32_16x16x32_bf16 a[96:99], a[192:195], v[152:155], a[96:99]
    v_cvt_pk_bf16_f32 v159, v126, v127
    s_waitcnt lgkmcnt(0)
    v_mfma_f32_16x16x32_bf16 a[0:3], a[224:227], v[132:135], a[0:3]
    v_accvgpr_read_b32 v248, a128
    v_accvgpr_read_b32 v80, a129
    v_mfma_f32_16x16x32_bf16 a[4:7], a[228:231], v[132:135], a[4:7]
    s_waitcnt vmcnt(14)
    v_add_f32 v80, v248, v80
    v_mov_b32 v255, 0
    v_mfma_f32_16x16x32_bf16 v[176:179], v[228:231], v[224:227], v[176:179]
    v_rcp_f32_e64 v248, v80
    v_mfma_f32_16x16x32_bf16 a[8:11], a[232:235], v[132:135], a[8:11]
    v_accvgpr_read_b32 v64, a0
    v_accvgpr_read_b32 v65, a1
    v_mfma_f32_16x16x32_bf16 a[12:15], a[236:239], v[132:135], a[12:15]
    v_accvgpr_read_b32 v66, a2
    v_accvgpr_read_b32 v67, a3
    v_mfma_f32_16x16x32_bf16 a[16:19], a[240:243], v[132:135], a[16:19]
    v_accvgpr_read_b32 v68, a4
    v_accvgpr_read_b32 v69, a5
    v_mfma_f32_16x16x32_bf16 a[20:23], a[244:247], v[132:135], a[20:23]
    v_accvgpr_read_b32 v70, a6
    v_accvgpr_read_b32 v71, a7
    v_mfma_f32_16x16x32_bf16 v[180:183], v[232:235], v[224:227], v[180:183]
    v_mul_f32 v64, v248, v64
    v_mul_f32 v65, v248, v65
    v_mfma_f32_16x16x32_bf16 a[24:27], a[248:251], v[132:135], a[24:27]
    v_mul_f32 v66, v248, v66
    v_mul_f32 v67, v248, v67
    v_mfma_f32_16x16x32_bf16 a[28:31], a[252:255], v[132:135], a[28:31]
    v_mul_f32 v68, v248, v68
    v_mul_f32 v69, v248, v69
    v_mfma_f32_16x16x32_bf16 a[32:35], a[224:227], v[140:143], a[32:35]
    v_mul_f32 v70, v248, v70
    v_mul_f32 v71, v248, v71
    v_mfma_f32_16x16x32_bf16 a[36:39], a[228:231], v[140:143], a[36:39]
    v_cvt_pk_bf16_f32 v128, v64, v65
    v_cvt_pk_bf16_f32 v129, v66, v67
    v_mfma_f32_16x16x32_bf16 v[184:187], v[236:239], v[224:227], v[184:187]
    v_cvt_pk_bf16_f32 v130, v68, v69
    v_cvt_pk_bf16_f32 v131, v70, v71
    v_mfma_f32_16x16x32_bf16 a[40:43], a[232:235], v[140:143], a[40:43]
    s_add_u32 s41, s37, 0
    buffer_store_dwordx4 v[128:131], v206, s[12:15], s41 offen sc1
    v_mfma_f32_16x16x32_bf16 a[44:47], a[236:239], v[140:143], a[44:47]
    v_accvgpr_read_b32 v249, a132
    v_accvgpr_read_b32 v81, a133
    v_mfma_f32_16x16x32_bf16 a[48:51], a[240:243], v[140:143], a[48:51]
    v_add_f32 v81, v249, v81
    v_mfma_f32_16x16x32_bf16 a[52:55], a[244:247], v[140:143], a[52:55]
    v_rcp_f32_e64 v249, v81
    v_mfma_f32_16x16x32_bf16 v[188:191], v[240:243], v[224:227], v[188:191]
    v_accvgpr_read_b32 v72, a8
    v_accvgpr_read_b32 v73, a9
    v_mfma_f32_16x16x32_bf16 a[56:59], a[248:251], v[140:143], a[56:59]
    v_accvgpr_read_b32 v74, a10
    v_accvgpr_read_b32 v75, a11
    v_mfma_f32_16x16x32_bf16 a[60:63], a[252:255], v[140:143], a[60:63]
    v_accvgpr_read_b32 v76, a12
    v_accvgpr_read_b32 v77, a13
    v_smfmac_f32_16x16x64_bf16 a[136:139], v[208:211], v[144:151], v207
    v_accvgpr_read_b32 v78, a14
    v_accvgpr_read_b32 v79, a15
    v_smfmac_f32_16x16x64_bf16 a[140:143], v[208:211], v[152:159], v207
    buffer_load_dwordx4 v244, s[16:19], s46 offen offset:2048 lds
    v_mfma_f32_16x16x32_bf16 a[64:67], a[224:227], v[148:151], a[64:67]
    v_mul_f32 v72, v248, v72
    v_mul_f32 v73, v248, v73
    v_mfma_f32_16x16x32_bf16 a[68:71], a[228:231], v[148:151], a[68:71]
    s_add_u32 s46, s46, 15360
    v_mul_f32 v74, v248, v74
    v_mul_f32 v75, v248, v75
    v_mfma_f32_16x16x32_bf16 a[72:75], a[232:235], v[148:151], a[72:75]
    v_mul_f32 v76, v248, v76
    v_mul_f32 v77, v248, v77
    v_mfma_f32_16x16x32_bf16 a[76:79], a[236:239], v[148:151], a[76:79]
    buffer_load_dwordx4 v244, s[16:19], s46 offen offset:3072 lds
    v_mfma_f32_16x16x32_bf16 a[80:83], a[240:243], v[148:151], a[80:83]
    v_mul_f32 v78, v248, v78
    v_mul_f32 v79, v248, v79
    v_mfma_f32_16x16x32_bf16 a[84:87], a[244:247], v[148:151], a[84:87]
    s_add_u32 s46, s46, 15360
    v_cvt_pk_bf16_f32 v132, v72, v73
    v_cvt_pk_bf16_f32 v133, v74, v75
    v_mfma_f32_16x16x32_bf16 a[88:91], a[248:251], v[148:151], a[88:91]
    v_cvt_pk_bf16_f32 v134, v76, v77
    v_cvt_pk_bf16_f32 v135, v78, v79
    v_mfma_f32_16x16x32_bf16 a[92:95], a[252:255], v[148:151], a[92:95]
    s_add_u32 s41, s37, 16384
    buffer_store_dwordx4 v[132:135], v206, s[12:15], s41 offen sc1
    v_mfma_f32_16x16x32_bf16 a[96:99], a[224:227], v[156:159], a[96:99]
    v_mov_b32 v252, 0
    v_mov_b32 v253, 0
    v_mfma_f32_16x16x32_bf16 a[100:103], a[228:231], v[156:159], a[100:103]
    v_mov_b32_e64 v254, 0
    v_accvgpr_read_b32 v250, a136
    v_mfma_f32_16x16x32_bf16 a[104:107], a[232:235], v[156:159], a[104:107]
    v_accvgpr_read_b32 v82, a137
    v_accvgpr_read_b32 v251, a140
    v_mfma_f32_16x16x32_bf16 a[108:111], a[236:239], v[156:159], a[108:111]
    v_accvgpr_read_b32 v83, a141
    v_add_f32_e64 v82, v250, v82
    v_mfma_f32_16x16x32_bf16 a[112:115], a[240:243], v[156:159], a[112:115]
    v_add_f32_e64 v83, v251, v83
    v_mfma_f32_16x16x32_bf16 a[116:119], a[244:247], v[156:159], a[116:119]
    v_rcp_f32_e64 v250, v82
    v_mfma_f32_16x16x32_bf16 a[120:123], a[248:251], v[156:159], a[120:123]
    v_rcp_f32_e64 v251, v83
    v_mfma_f32_16x16x32_bf16 a[124:127], a[252:255], v[156:159], a[124:127]
    v_max3_f32 v247, v80, v81, v82
    global_load_dwordx2 v[236:237], v84, s[70:71] offset:0
    v_max_f32_e64 v247, v247, v83
    v_accvgpr_read_b32 v64, a16
    v_accvgpr_read_b32 v65, a17
    v_smfmac_f32_16x16x64_bf16 v[252:255], v[208:211], v[128:135], v207
    v_accvgpr_read_b32 v66, a18
    v_accvgpr_read_b32 v67, a19
    v_accvgpr_read_b32 v68, a20
    v_accvgpr_read_b32 v69, a21
    v_accvgpr_read_b32 v70, a22
    v_accvgpr_read_b32 v71, a23
    v_pk_mul_f32 v[64:65], v[248:249], v[64:65] op_sel:[0,0] op_sel_hi:[0,1]
    global_load_dwordx2 v[238:239], v84, s[70:71] offset:32
    v_pk_mul_f32 v[66:67], v[248:249], v[66:67] op_sel:[0,0] op_sel_hi:[0,1]
    v_pk_mul_f32 v[68:69], v[248:249], v[68:69] op_sel:[0,0] op_sel_hi:[0,1]
    v_pk_mul_f32 v[70:71], v[248:249], v[70:71] op_sel:[0,0] op_sel_hi:[0,1]
    v_cvt_pk_bf16_f32 v136, v64, v65
    v_cvt_pk_bf16_f32 v137, v66, v67
    v_cvt_pk_bf16_f32 v138, v68, v69
    v_cvt_pk_bf16_f32 v139, v70, v71
    s_add_u32 s41, s37, 32768
    buffer_store_dwordx4 v[136:139], v206, s[12:15], s41 offen sc1
    v_accvgpr_read_b32 v72, a24
    v_accvgpr_read_b32 v73, a25
    v_accvgpr_read_b32 v74, a26
    v_accvgpr_read_b32 v75, a27
    v_accvgpr_read_b32 v76, a28
    v_accvgpr_read_b32 v77, a29
    v_accvgpr_read_b32 v78, a30
    v_accvgpr_read_b32 v79, a31
    v_pk_mul_f32 v[72:73], v[248:249], v[72:73] op_sel:[0,0] op_sel_hi:[0,1]
    global_load_dwordx2 v[240:241], v84, s[70:71] offset:64
    v_pk_mul_f32 v[74:75], v[248:249], v[74:75] op_sel:[0,0] op_sel_hi:[0,1]
    v_pk_mul_f32 v[76:77], v[248:249], v[76:77] op_sel:[0,0] op_sel_hi:[0,1]
    v_pk_mul_f32 v[78:79], v[248:249], v[78:79] op_sel:[0,0] op_sel_hi:[0,1]
    v_cvt_pk_bf16_f32 v140, v72, v73
    v_cvt_pk_bf16_f32 v141, v74, v75
    v_cvt_pk_bf16_f32 v142, v76, v77
    v_cvt_pk_bf16_f32 v143, v78, v79
    v_accvgpr_read_b32 v64, a32
    v_accvgpr_read_b32 v65, a33
    v_smfmac_f32_16x16x64_bf16 v[252:255], v[208:211], v[136:143], v207
    global_load_dwordx2 v[242:243], v84, s[70:71] offset:96
    v_accvgpr_read_b32 v66, a34
    v_accvgpr_read_b32 v67, a35
    v_accvgpr_read_b32 v68, a36
    v_accvgpr_read_b32 v69, a37
    v_accvgpr_read_b32 v70, a38
    v_accvgpr_read_b32 v71, a39
    v_pk_mul_f32 v[64:65], v[248:249], v[64:65] op_sel:[1,0] op_sel_hi:[1,1]
    v_pk_mul_f32 v[66:67], v[248:249], v[66:67] op_sel:[1,0] op_sel_hi:[1,1]
    v_pk_mul_f32 v[68:69], v[248:249], v[68:69] op_sel:[1,0] op_sel_hi:[1,1]
    v_pk_mul_f32 v[70:71], v[248:249], v[70:71] op_sel:[1,0] op_sel_hi:[1,1]
    v_cvt_pk_bf16_f32 v144, v64, v65
    v_cvt_pk_bf16_f32 v145, v66, v67
    v_cvt_pk_bf16_f32 v146, v68, v69
    v_cvt_pk_bf16_f32 v147, v70, v71
    v_accvgpr_read_b32 v72, a40
    v_accvgpr_read_b32 v73, a41
    v_accvgpr_read_b32 v74, a42
    v_accvgpr_read_b32 v75, a43
    v_accvgpr_read_b32 v76, a44
    s_add_u32 s41, s37, 49152
    buffer_store_dwordx4 v[140:143], v206, s[12:15], s41 offen sc1
    v_accvgpr_read_b32 v77, a45
    v_accvgpr_read_b32 v78, a46
    v_accvgpr_read_b32 v79, a47
    v_pk_mul_f32 v[72:73], v[248:249], v[72:73] op_sel:[1,0] op_sel_hi:[1,1]
    v_pk_mul_f32 v[74:75], v[248:249], v[74:75] op_sel:[1,0] op_sel_hi:[1,1]
    v_pk_mul_f32 v[76:77], v[248:249], v[76:77] op_sel:[1,0] op_sel_hi:[1,1]
    v_pk_mul_f32 v[78:79], v[248:249], v[78:79] op_sel:[1,0] op_sel_hi:[1,1]
    v_cvt_pk_bf16_f32 v148, v72, v73
    v_cvt_pk_bf16_f32 v149, v74, v75
    v_cvt_pk_bf16_f32 v150, v76, v77
    v_cvt_pk_bf16_f32 v151, v78, v79
    v_accvgpr_read_b32 v64, a48
    v_accvgpr_read_b32 v65, a49
    v_smfmac_f32_16x16x64_bf16 v[252:255], v[208:211], v[144:151], v207
    v_accvgpr_read_b32 v66, a50
    v_accvgpr_read_b32 v67, a51
    v_accvgpr_read_b32 v68, a52
    v_accvgpr_read_b32 v69, a53
    v_accvgpr_read_b32 v70, a54
    v_accvgpr_read_b32 v71, a55
    v_pk_mul_f32 v[64:65], v[248:249], v[64:65] op_sel:[1,0] op_sel_hi:[1,1]
    v_pk_mul_f32 v[66:67], v[248:249], v[66:67] op_sel:[1,0] op_sel_hi:[1,1]
    v_pk_mul_f32 v[68:69], v[248:249], v[68:69] op_sel:[1,0] op_sel_hi:[1,1]
    v_pk_mul_f32 v[70:71], v[248:249], v[70:71] op_sel:[1,0] op_sel_hi:[1,1]
    v_cvt_pk_bf16_f32 v152, v64, v65
    v_cvt_pk_bf16_f32 v153, v66, v67
    v_cvt_pk_bf16_f32 v154, v68, v69
    v_cvt_pk_bf16_f32 v155, v70, v71
    v_accvgpr_read_b32 v72, a56
    v_accvgpr_read_b32 v73, a57
    v_accvgpr_read_b32 v74, a58
    v_accvgpr_read_b32 v75, a59
    v_accvgpr_read_b32 v76, a60
    v_accvgpr_read_b32 v77, a61
    v_accvgpr_read_b32 v78, a62
    v_accvgpr_read_b32 v79, a63
    v_pk_mul_f32 v[72:73], v[248:249], v[72:73] op_sel:[1,0] op_sel_hi:[1,1]
    v_pk_mul_f32 v[74:75], v[248:249], v[74:75] op_sel:[1,0] op_sel_hi:[1,1]
    v_pk_mul_f32 v[76:77], v[248:249], v[76:77] op_sel:[1,0] op_sel_hi:[1,1]
    s_add_u32 s41, s37, 4096
    buffer_store_dwordx4 v[144:147], v206, s[12:15], s41 offen sc1
    v_pk_mul_f32 v[78:79], v[248:249], v[78:79] op_sel:[1,0] op_sel_hi:[1,1]
    v_cvt_pk_bf16_f32 v156, v72, v73
    v_cvt_pk_bf16_f32 v157, v74, v75
    v_cvt_pk_bf16_f32 v158, v76, v77
    v_cvt_pk_bf16_f32 v159, v78, v79
    v_accvgpr_read_b32 v64, a64
    v_accvgpr_read_b32 v65, a65
    v_smfmac_f32_16x16x64_bf16 v[252:255], v[208:211], v[152:159], v207
    v_accvgpr_read_b32 v66, a66
    v_accvgpr_read_b32 v67, a67
    v_accvgpr_read_b32 v68, a68
    v_accvgpr_read_b32 v69, a69
    v_accvgpr_read_b32 v70, a70
L_hop12:
    s_cbranch_execz L_ret3
    s_nop 0
    v_accvgpr_read_b32 v71, a71
    v_pk_mul_f32 v[64:65], v[250:251], v[64:65] op_sel:[0,0] op_sel_hi:[0,1]
    v_pk_mul_f32 v[66:67], v[250:251], v[66:67] op_sel:[0,0] op_sel_hi:[0,1]
    v_pk_mul_f32 v[68:69], v[250:251], v[68:69] op_sel:[0,0] op_sel_hi:[0,1]
    v_pk_mul_f32 v[70:71], v[250:251], v[70:71] op_sel:[0,0] op_sel_hi:[0,1]
    v_cvt_pk_bf16_f32 v160, v64, v65
    v_cvt_pk_bf16_f32 v161, v66, v67
    v_cvt_pk_bf16_f32 v162, v68, v69
    v_cvt_pk_bf16_f32 v163, v70, v71
    v_accvgpr_read_b32 v72, a72
    v_accvgpr_read_b32 v73, a73
    v_accvgpr_read_b32 v74, a74
    v_accvgpr_read_b32 v75, a75
    v_accvgpr_read_b32 v76, a76
    v_accvgpr_read_b32 v77, a77
    v_accvgpr_read_b32 v78, a78
    v_accvgpr_read_b32 v79, a79
    v_pk_mul_f32 v[72:73], v[250:251], v[72:73] op_sel:[0,0] op_sel_hi:[0,1]
    v_pk_mul_f32 v[74:75], v[250:251], v[74:75] op_sel:[0,0] op_sel_hi:[0,1]
    v_pk_mul_f32 v[76:77], v[250:251], v[76:77] op_sel:[0,0] op_sel_hi:[0,1]
    v_pk_mul_f32 v[78:79], v[250:251], v[78:79] op_sel:[0,0] op_sel_hi:[0,1]
    v_cvt_pk_bf16_f32 v164, v72, v73
    v_cvt_pk_bf16_f32 v165, v74, v75
    v_cvt_pk_bf16_f32 v166, v76, v77
    v_cvt_pk_bf16_f32 v167, v78, v79
    v_accvgpr_read_b32 v64, a80
    v_accvgpr_read_b32 v65, a81
    v_smfmac_f32_16x16x64_bf16 v[252:255], v[208:211], v[160:167], v207
    s_add_u32 s41, s37, 20480
    buffer_store_dwordx4 v[148:151], v206, s[12:15], s41 offen sc1
    v_accvgpr_read_b32 v66, a82
    v_accvgpr_read_b32 v67, a83
    v_accvgpr_read_b32 v68, a84
    v_accvgpr_read_b32 v69, a85
    v_accvgpr_read_b32 v70, a86
    v_accvgpr_read_b32 v71, a87
    v_pk_mul_f32 v[64:65], v[250:251], v[64:65] op_sel:[0,0] op_sel_hi:[0,1]
    v_pk_mul_f32 v[66:67], v[250:251], v[66:67] op_sel:[0,0] op_sel_hi:[0,1]
    v_pk_mul_f32 v[68:69], v[250:251], v[68:69] op_sel:[0,0] op_sel_hi:[0,1]
    v_pk_mul_f32 v[70:71], v[250:251], v[70:71] op_sel:[0,0] op_sel_hi:[0,1]
    v_cvt_pk_bf16_f32 v168, v64, v65
    v_cvt_pk_bf16_f32 v169, v66, v67
    v_cvt_pk_bf16_f32 v170, v68, v69
    v_cvt_pk_bf16_f32 v171, v70, v71
    v_accvgpr_read_b32 v72, a88
    v_accvgpr_read_b32 v73, a89
    v_accvgpr_read_b32 v74, a90
    v_accvgpr_read_b32 v75, a91
    v_accvgpr_read_b32 v76, a92
    v_accvgpr_read_b32 v77, a93
    v_accvgpr_read_b32 v78, a94
    v_accvgpr_read_b32 v79, a95
    v_pk_mul_f32 v[72:73], v[250:251], v[72:73] op_sel:[0,0] op_sel_hi:[0,1]
    v_pk_mul_f32 v[74:75], v[250:251], v[74:75] op_sel:[0,0] op_sel_hi:[0,1]
    v_pk_mul_f32 v[76:77], v[250:251], v[76:77] op_sel:[0,0] op_sel_hi:[0,1]
    v_pk_mul_f32 v[78:79], v[250:251], v[78:79] op_sel:[0,0] op_sel_hi:[0,1]
    v_cvt_pk_bf16_f32 v172, v72, v73
    v_cvt_pk_bf16_f32 v173, v74, v75
    v_cvt_pk_bf16_f32 v174, v76, v77
    v_cvt_pk_bf16_f32 v175, v78, v79
    v_accvgpr_read_b32 v64, a96
    v_accvgpr_read_b32 v65, a97
    v_smfmac_f32_16x16x64_bf16 v[252:255], v[208:211], v[168:175], v207
    v_accvgpr_read_b32 v66, a98
    v_accvgpr_read_b32 v67, a99
    v_accvgpr_read_b32 v68, a100
    v_accvgpr_read_b32 v69, a101
    v_accvgpr_read_b32 v70, a102
    v_accvgpr_read_b32 v71, a103
    s_add_u32 s41, s37, 36864
    buffer_store_dwordx4 v[152:155], v206, s[12:15], s41 offen sc1
    v_pk_mul_f32 v[64:65], v[250:251], v[64:65] op_sel:[1,0] op_sel_hi:[1,1]
    v_pk_mul_f32 v[66:67], v[250:251], v[66:67] op_sel:[1,0] op_sel_hi:[1,1]
    v_pk_mul_f32 v[68:69], v[250:251], v[68:69] op_sel:[1,0] op_sel_hi:[1,1]
    v_pk_mul_f32 v[70:71], v[250:251], v[70:71] op_sel:[1,0] op_sel_hi:[1,1]
    v_cvt_pk_bf16_f32 v212, v64, v65
    v_cvt_pk_bf16_f32 v213, v66, v67
    v_cvt_pk_bf16_f32 v214, v68, v69
    v_cvt_pk_bf16_f32 v215, v70, v71
    v_accvgpr_read_b32 v72, a104
    v_accvgpr_read_b32 v73, a105
    v_accvgpr_read_b32 v74, a106
    v_accvgpr_read_b32 v75, a107
    v_accvgpr_read_b32 v76, a108
    v_accvgpr_read_b32 v77, a109
    v_accvgpr_read_b32 v78, a110
    v_accvgpr_read_b32 v79, a111
    v_pk_mul_f32 v[72:73], v[250:251], v[72:73] op_sel:[1,0] op_sel_hi:[1,1]
    v_pk_mul_f32 v[74:75], v[250:251], v[74:75] op_sel:[1,0] op_sel_hi:[1,1]
    v_pk_mul_f32 v[76:77], v[250:251], v[76:77] op_sel:[1,0] op_sel_hi:[1,1]
    v_pk_mul_f32 v[78:79], v[250:251], v[78:79] op_sel:[1,0] op_sel_hi:[1,1]
    v_cvt_pk_bf16_f32 v216, v72, v73
    v_cvt_pk_bf16_f32 v217, v74, v75
    v_cvt_pk_bf16_f32 v218, v76, v77
    v_cvt_pk_bf16_f32 v219, v78, v79
    v_accvgpr_read_b32 v64, a112
    v_accvgpr_read_b32 v65, a113
    v_smfmac_f32_16x16x64_bf16 v[252:255], v[208:211], v[212:219], v207
    v_accvgpr_read_b32 v66, a114
    v_accvgpr_read_b32 v67, a115
    v_accvgpr_read_b32 v68, a116
    v_accvgpr_read_b32 v69, a117
    v_accvgpr_read_b32 v70, a118
    v_accvgpr_read_b32 v71, a119
    v_pk_mul_f32 v[64:65], v[250:251], v[64:65] op_sel:[1,0] op_sel_hi:[1,1]
    v_pk_mul_f32 v[66:67], v[250:251], v[66:67] op_sel:[1,0] op_sel_hi:[1,1]
    v_pk_mul_f32 v[68:69], v[250:251], v[68:69] op_sel:[1,0] op_sel_hi:[1,1]
    v_pk_mul_f32 v[70:71], v[250:251], v[70:71] op_sel:[1,0] op_sel_hi:[1,1]
    v_cvt_pk_bf16_f32 v220, v64, v65
    s_add_u32 s41, s37, 53248
    buffer_store_dwordx4 v[156:159], v206, s[12:15], s41 offen sc1
    v_cvt_pk_bf16_f32 v221, v66, v67
    v_cvt_pk_bf16_f32 v222, v68, v69
    v_cvt_pk_bf16_f32 v223, v70, v71
    v_add_u32 v228, 65536, v196
    v_add_u32 v229, 65536, v197
    v_add_u32 v230, 65536, v198
    ds_read_b64_tr_b16 a[128:129], v228 offset:0
    ds_read_b64_tr_b16 a[130:131], v228 offset:1024
    ds_read_b64_tr_b16 a[132:133], v229 offset:0
    ds_read_b64_tr_b16 a[134:135], v229 offset:1024
    ds_read_b64_tr_b16 a[136:137], v230 offset:0
    ds_read_b64_tr_b16 a[138:139], v230 offset:1024
    v_accvgpr_read_b32 v72, a120
    v_accvgpr_read_b32 v73, a121
    v_accvgpr_read_b32 v74, a122
    v_accvgpr_read_b32 v75, a123
    v_accvgpr_read_b32 v76, a124
    v_accvgpr_read_b32 v77, a125
    v_accvgpr_read_b32 v78, a126
    v_accvgpr_read_b32 v79, a127
    v_pk_mul_f32 v[72:73], v[250:251], v[72:73] op_sel:[1,0] op_sel_hi:[1,1]
    v_pk_mul_f32 v[74:75], v[250:251], v[74:75] op_sel:[1,0] op_sel_hi:[1,1]
    v_pk_mul_f32 v[76:77], v[250:251], v[76:77] op_sel:[1,0] op_sel_hi:[1,1]
    v_pk_mul_f32 v[78:79], v[250:251], v[78:79] op_sel:[1,0] op_sel_hi:[1,1]
    v_cvt_pk_bf16_f32 v224, v72, v73
    v_cvt_pk_bf16_f32 v225, v74, v75
    v_cvt_pk_bf16_f32 v226, v76, v77
    v_cvt_pk_bf16_f32 v227, v78, v79
    v_add_u32 v231, 65536, v199
    v_add_u32 v232, 65536, v200
    v_add_u32 v233, 65536, v201
    v_add_u32 v234, 65536, v202
    v_add_u32 v235, 65536, v203
    v_smfmac_f32_16x16x64_bf16 v[252:255], v[208:211], v[220:227], v207
    s_waitcnt lgkmcnt(4)
    v_mfma_f32_16x16x32_bf16 v[64:67], a[128:131], v[128:131], 0
    ds_read_b64_tr_b16 a[140:141], v231 offset:0
    ds_read_b64_tr_b16 a[142:143], v231 offset:1024
    v_mfma_f32_16x16x32_bf16 v[72:75], a[128:131], v[144:147], 0
    v_mfma_f32_16x16x32_bf16 v[80:83], a[128:131], v[160:163], 0
    s_add_u32 s41, s37, 8192
    buffer_store_dwordx4 v[160:163], v206, s[12:15], s41 offen sc1
    v_mfma_f32_16x16x32_bf16 v[88:91], a[128:131], v[212:215], 0
    s_waitcnt lgkmcnt(4)
    v_mfma_f32_16x16x32_bf16 v[92:95], a[132:135], v[212:215], 0
    ds_read_b64_tr_b16 a[128:129], v228 offset:2048
    ds_read_b64_tr_b16 a[130:131], v228 offset:3072
    v_mfma_f32_16x16x32_bf16 v[84:87], a[132:135], v[160:163], 0
    v_add_f32_e64 v248, v252, v253
    v_mov_b32 v249, 0x53800000
    v_mfma_f32_16x16x32_bf16 v[76:79], a[132:135], v[144:147], 0
    v_mfma_f32_16x16x32_bf16 v[68:71], a[132:135], v[128:131], 0
    v_fma_f32 v247, v248, 0, v247
    s_lshl_b32 s47, s33, 2
    s_add_u32 s47, s47, 98304
    s_waitcnt lgkmcnt(4)
    v_mfma_f32_16x16x32_bf16 v[96:99], a[136:139], v[128:131], 0
    ds_read_b64_tr_b16 a[132:133], v229 offset:2048
    ds_read_b64_tr_b16 a[134:135], v229 offset:3072
    v_mfma_f32_16x16x32_bf16 v[104:107], a[136:139], v[144:147], 0
    v_cmp_nlt_f32 vcc, v247, v249
    v_mov_b32 v250, s47
    v_mfma_f32_16x16x32_bf16 v[112:115], a[136:139], v[160:163], 0
    v_mfma_f32_16x16x32_bf16 v[120:123], a[136:139], v[212:215], 0
    s_or_b32 s48, vcc_lo, vcc_hi
    v_mov_b32 v251, s48
    v_mov_b32 v248, 98304
    s_waitcnt lgkmcnt(4)
    v_mfma_f32_16x16x32_bf16 v[124:127], a[140:143], v[212:215], 0
    ds_read_b64_tr_b16 a[136:137], v230 offset:2048
    ds_read_b64_tr_b16 a[138:139], v230 offset:3072
    v_mfma_f32_16x16x32_bf16 v[116:119], a[140:143], v[160:163], 0
    ds_write_b32 v250, v251
    v_mfma_f32_16x16x32_bf16 v[108:111], a[140:143], v[144:147], 0
    v_mfma_f32_16x16x32_bf16 v[100:103], a[140:143], v[128:131], 0
    s_waitcnt lgkmcnt(5)
    v_mfma_f32_16x16x32_bf16 v[64:67], a[128:131], v[132:135], v[64:67]
    ds_read_b64_tr_b16 a[140:141], v231 offset:2048
    ds_read_b64_tr_b16 a[142:143], v231 offset:3072
    v_mfma_f32_16x16x32_bf16 v[72:75], a[128:131], v[148:151], v[72:75]
    v_mfma_f32_16x16x32_bf16 v[80:83], a[128:131], v[164:167], v[80:83]
    s_add_u32 s41, s37, 24576
    buffer_store_dwordx4 v[164:167], v206, s[12:15], s41 offen sc1
    v_mfma_f32_16x16x32_bf16 v[88:91], a[128:131], v[216:219], v[88:91]
    s_waitcnt lgkmcnt(5)
    v_mfma_f32_16x16x32_bf16 v[92:95], a[132:135], v[216:219], v[92:95]
    ds_read_b64_tr_b16 a[128:129], v228 offset:16384
    ds_read_b64_tr_b16 a[130:131], v228 offset:17408
    v_mfma_f32_16x16x32_bf16 v[84:87], a[132:135], v[164:167], v[84:87]
    s_waitcnt lgkmcnt(4)
    s_barrier
    ds_read_b128 v[252:255], v248
    v_mfma_f32_16x16x32_bf16 v[76:79], a[132:135], v[148:151], v[76:79]
    v_mfma_f32_16x16x32_bf16 v[68:71], a[132:135], v[132:135], v[68:71]
    v_mfma_f32_16x16x32_bf16 v[96:99], a[136:139], v[132:135], v[96:99]
    ds_read_b64_tr_b16 a[132:133], v229 offset:16384
    ds_read_b64_tr_b16 a[134:135], v229 offset:17408
    v_mfma_f32_16x16x32_bf16 v[104:107], a[136:139], v[148:151], v[104:107]
    v_mfma_f32_16x16x32_bf16 v[112:115], a[136:139], v[164:167], v[112:115]
    v_mfma_f32_16x16x32_bf16 v[120:123], a[136:139], v[216:219], v[120:123]
    s_waitcnt lgkmcnt(5)
    v_mfma_f32_16x16x32_bf16 v[124:127], a[140:143], v[216:219], v[124:127]
    ds_read_b64_tr_b16 a[136:137], v230 offset:16384
    ds_read_b64_tr_b16 a[138:139], v230 offset:17408
    v_mfma_f32_16x16x32_bf16 v[116:119], a[140:143], v[164:167], v[116:119]
    v_mfma_f32_16x16x32_bf16 v[108:111], a[140:143], v[148:151], v[108:111]
    s_add_u32 s41, s37, 40960
    buffer_store_dwordx4 v[168:171], v206, s[12:15], s41 offen sc1
    v_mfma_f32_16x16x32_bf16 v[100:103], a[140:143], v[132:135], v[100:103]
    s_waitcnt lgkmcnt(5)
    v_mfma_f32_16x16x32_bf16 v[64:67], a[128:131], v[136:139], v[64:67]
    ds_read_b64_tr_b16 a[140:141], v231 offset:16384
    ds_read_b64_tr_b16 a[142:143], v231 offset:17408
    v_mfma_f32_16x16x32_bf16 v[72:75], a[128:131], v[152:155], v[72:75]
    s_waitcnt lgkmcnt(6)
    v_or3_b32 v248, v252, v253, v254
    v_or_b32_e64 v248, v248, v255
    v_mfma_f32_16x16x32_bf16 v[80:83], a[128:131], v[168:171], v[80:83]
    v_mfma_f32_16x16x32_bf16 v[88:91], a[128:131], v[220:223], v[88:91]
    v_readfirstlane_b32 s47, v248
    v_cmp_eq_u32 vcc, 0, v206
    s_waitcnt lgkmcnt(4)
    v_mfma_f32_16x16x32_bf16 v[92:95], a[132:135], v[220:223], v[92:95]
    ds_read_b64_tr_b16 a[128:129], v228 offset:18432
    ds_read_b64_tr_b16 a[130:131], v228 offset:19456
    v_mfma_f32_16x16x32_bf16 v[84:87], a[132:135], v[168:171], v[84:87]
    s_andn2_b32 s47, s47, s40
    s_cbranch_scc1 L_redo
    v_bfrev_b32 v245, 1
    v_lshrrev_b32 v249, 8, v206
    s_and_b32 s47, s39, 1
    s_lshl_b32 s47, s47, 7
    s_lshl_b32 s48, s49, 8
    s_add_u32 s47, s47, s48
    v_mfma_f32_16x16x32_bf16 v[76:79], a[132:135], v[152:155], v[76:79]
    v_mfma_f32_16x16x32_bf16 v[68:71], a[132:135], v[136:139], v[68:71]
    v_cndmask_b32 v245, v245, 0, vcc
    v_lshl_add_u32 v249, v249, 3, s47
    s_lshr_b32 s47, s39, 1
    s_lshl_b32 s48, s34, 2
    s_add_u32 s47, s47, s48
    s_waitcnt lgkmcnt(4)
    v_mfma_f32_16x16x32_bf16 v[96:99], a[136:139], v[136:139], v[96:99]
    ds_read_b64_tr_b16 a[132:133], v229 offset:18432
    ds_read_b64_tr_b16 a[134:135], v229 offset:19456
    v_mfma_f32_16x16x32_bf16 v[104:107], a[136:139], v[152:155], v[104:107]
    v_and_b32 v252, 0xf0, v206
    v_lshl_add_u32 v249, v252, 6, v249
    s_lshl_b32 s47, s47, 2
    s_add_u32 s47, s47, s33
    s_lshl_b32 s47, s47, 14
    v_mfma_f32_16x16x32_bf16 v[112:115], a[136:139], v[168:171], v[112:115]
    s_add_u32 s41, s37, 57344
    buffer_store_dwordx4 v[172:175], v206, s[12:15], s41 offen sc1
    v_mfma_f32_16x16x32_bf16 v[120:123], a[136:139], v[220:223], v[120:123]
    v_add_u32 v249, s47, v249
    v_bfe_u32 v250, v206, 4, 2
    s_waitcnt lgkmcnt(4)
    v_mfma_f32_16x16x32_bf16 v[124:127], a[140:143], v[220:223], v[124:127]
    ds_read_b64_tr_b16 a[136:137], v230 offset:18432
    ds_read_b64_tr_b16 a[138:139], v230 offset:19456
    v_mfma_f32_16x16x32_bf16 v[116:119], a[140:143], v[168:171], v[116:119]
    v_max_u32 v250, 1, v250
    v_xor_b32 v250, s49, v250
    v_mfma_f32_16x16x32_bf16 v[108:111], a[140:143], v[152:155], v[108:111]
    v_mfma_f32_16x16x32_bf16 v[100:103], a[140:143], v[136:139], v[100:103]
    v_lshlrev_b32 v250, 2, v250
    s_waitcnt lgkmcnt(4)
    v_mfma_f32_16x16x32_bf16 v[64:67], a[128:131], v[140:143], v[64:67]
    ds_read_b64_tr_b16 a[140:141], v231 offset:18432
    ds_read_b64_tr_b16 a[142:143], v231 offset:19456
    v_mfma_f32_16x16x32_bf16 v[72:75], a[128:131], v[156:159], v[72:75]
    v_and_b32 v251, 0x70, v206
    v_lshrrev_b32 v251, 2, v251
    s_lshl_b32 s47, s33, 14
    s_add_u32 s47, s47, 98304
    v_mfma_f32_16x16x32_bf16 v[80:83], a[128:131], v[172:175], v[80:83]
    v_mfma_f32_16x16x32_bf16 v[88:91], a[128:131], v[224:227], v[88:91]
    v_add_u32 v248, s47, v206
    s_lshl_b32 s47, s33, 12
    s_add_u32 s47, s47, 98304
    s_waitcnt lgkmcnt(4)
    v_mfma_f32_16x16x32_bf16 v[92:95], a[132:135], v[224:227], v[92:95]
    ds_read_b64_tr_b16 a[128:129], v232 offset:0
    ds_read_b64_tr_b16 a[130:131], v232 offset:1024
    v_mfma_f32_16x16x32_bf16 v[84:87], a[132:135], v[172:175], v[84:87]
    v_add_u32 v253, s47, v206
    v_mfma_f32_16x16x32_bf16 v[76:79], a[132:135], v[156:159], v[76:79]
    v_mfma_f32_16x16x32_bf16 v[68:71], a[132:135], v[140:143], v[68:71]
    s_xor_b32 s4, s37, 524288
    s_xor_b32 s5, s37, 1048576
    s_xor_b32 s6, s37, 1572864
    s_add_u32 s8, s37, 16777216
    s_waitcnt lgkmcnt(4)
    v_mfma_f32_16x16x32_bf16 v[96:99], a[136:139], v[140:143], v[96:99]
    ds_read_b64_tr_b16 a[132:133], v233 offset:0
    ds_read_b64_tr_b16 a[134:135], v233 offset:1024
    v_mfma_f32_16x16x32_bf16 v[104:107], a[136:139], v[156:159], v[104:107]
    s_lshr_b32 s47, s2, 3
    s_lshl_b32 s47, s47, 19
    s_add_u32 s9, s47, 33554432
    v_mfma_f32_16x16x32_bf16 v[112:115], a[136:139], v[172:175], v[112:115]
    s_add_u32 s41, s37, 12288
    buffer_store_dwordx4 v[212:215], v206, s[12:15], s41 offen sc1
    v_mfma_f32_16x16x32_bf16 v[120:123], a[136:139], v[224:227], v[120:123]
    s_and_b32 s47, s39, 1
    s_lshl_b32 s47, s47, 15
    s_add_u32 s9, s9, s47
    s_waitcnt lgkmcnt(4)
    v_mfma_f32_16x16x32_bf16 v[124:127], a[140:143], v[224:227], v[124:127]
    ds_read_b64_tr_b16 a[136:137], v234 offset:0
    ds_read_b64_tr_b16 a[138:139], v234 offset:1024
    v_mfma_f32_16x16x32_bf16 v[116:119], a[140:143], v[172:175], v[116:119]
    s_lshr_b32 s47, s39, 1
    s_xor_b32 s47, s47, s33
    s_lshl_b32 s47, s47, 10
    s_add_u32 s9, s9, s47
    v_mfma_f32_16x16x32_bf16 v[108:111], a[140:143], v[156:159], v[108:111]
    v_mfma_f32_16x16x32_bf16 v[100:103], a[140:143], v[140:143], v[100:103]
    s_lshl_b32 s47, s33, 12
    s_add_u32 s9, s9, s47
    s_waitcnt lgkmcnt(4)
    v_mfma_f32_16x16x32_bf16 v[0:3], a[128:131], v[128:131], 0
    ds_read_b64_tr_b16 a[140:141], v235 offset:0
    ds_read_b64_tr_b16 a[142:143], v235 offset:1024
    v_mfma_f32_16x16x32_bf16 v[8:11], a[128:131], v[144:147], 0
    v_mfma_f32_16x16x32_bf16 v[16:19], a[128:131], v[160:163], 0
    v_mfma_f32_16x16x32_bf16 v[24:27], a[128:131], v[212:215], 0
    s_mov_b32 s28, s12
    s_mov_b32 s29, s13
    s_lshl_b32 s45, s33, 1
    s_xor_b32 s45, s45, s39
    s_waitcnt lgkmcnt(4)
    v_mfma_f32_16x16x32_bf16 v[28:31], a[132:135], v[212:215], 0
    ds_read_b64_tr_b16 a[128:129], v232 offset:2048
    ds_read_b64_tr_b16 a[130:131], v232 offset:3072
    v_mfma_f32_16x16x32_bf16 v[20:23], a[132:135], v[160:163], 0
    v_mfma_f32_16x16x32_bf16 v[12:15], a[132:135], v[144:147], 0
    s_add_u32 s41, s37, 28672
    buffer_store_dwordx4 v[216:219], v206, s[12:15], s41 offen sc1
    v_mfma_f32_16x16x32_bf16 v[4:7], a[132:135], v[128:131], 0
    s_waitcnt lgkmcnt(4)
    v_mfma_f32_16x16x32_bf16 v[32:35], a[136:139], v[128:131], 0
    ds_read_b64_tr_b16 a[132:133], v233 offset:2048
    ds_read_b64_tr_b16 a[134:135], v233 offset:3072
    v_mfma_f32_16x16x32_bf16 v[40:43], a[136:139], v[144:147], 0
    v_mfma_f32_16x16x32_bf16 v[48:51], a[136:139], v[160:163], 0
    v_mfma_f32_16x16x32_bf16 v[56:59], a[136:139], v[212:215], 0
    s_waitcnt lgkmcnt(4)
    v_mfma_f32_16x16x32_bf16 v[60:63], a[140:143], v[212:215], 0
    ds_read_b64_tr_b16 a[136:137], v234 offset:2048
    ds_read_b64_tr_b16 a[138:139], v234 offset:3072
    v_mfma_f32_16x16x32_bf16 v[52:55], a[140:143], v[160:163], 0
    v_mfma_f32_16x16x32_bf16 v[44:47], a[140:143], v[144:147], 0
    v_mfma_f32_16x16x32_bf16 v[36:39], a[140:143], v[128:131], 0
    s_waitcnt lgkmcnt(4)
    v_mfma_f32_16x16x32_bf16 v[0:3], a[128:131], v[132:135], v[0:3]
    ds_read_b64_tr_b16 a[140:141], v235 offset:2048
    ds_read_b64_tr_b16 a[142:143], v235 offset:3072
    v_mfma_f32_16x16x32_bf16 v[8:11], a[128:131], v[148:151], v[8:11]
    v_mfma_f32_16x16x32_bf16 v[16:19], a[128:131], v[164:167], v[16:19]
    v_mfma_f32_16x16x32_bf16 v[24:27], a[128:131], v[216:219], v[24:27]
    s_waitcnt lgkmcnt(4)
    v_mfma_f32_16x16x32_bf16 v[28:31], a[132:135], v[216:219], v[28:31]
    ds_read_b64_tr_b16 a[128:129], v232 offset:16384
    ds_read_b64_tr_b16 a[130:131], v232 offset:17408
    v_mfma_f32_16x16x32_bf16 v[20:23], a[132:135], v[164:167], v[20:23]
    v_mfma_f32_16x16x32_bf16 v[12:15], a[132:135], v[148:151], v[12:15]
    s_add_u32 s41, s37, 45056
    buffer_store_dwordx4 v[220:223], v206, s[12:15], s41 offen sc1
    v_mfma_f32_16x16x32_bf16 v[4:7], a[132:135], v[132:135], v[4:7]
    s_waitcnt lgkmcnt(4)
    v_mfma_f32_16x16x32_bf16 v[32:35], a[136:139], v[132:135], v[32:35]
    ds_read_b64_tr_b16 a[132:133], v233 offset:16384
    ds_read_b64_tr_b16 a[134:135], v233 offset:17408
    v_mfma_f32_16x16x32_bf16 v[40:43], a[136:139], v[148:151], v[40:43]
    v_mfma_f32_16x16x32_bf16 v[48:51], a[136:139], v[164:167], v[48:51]
    v_mfma_f32_16x16x32_bf16 v[56:59], a[136:139], v[216:219], v[56:59]
    s_waitcnt lgkmcnt(4)
    v_mfma_f32_16x16x32_bf16 v[60:63], a[140:143], v[216:219], v[60:63]
    ds_read_b64_tr_b16 a[136:137], v234 offset:16384
    ds_read_b64_tr_b16 a[138:139], v234 offset:17408
    v_mfma_f32_16x16x32_bf16 v[52:55], a[140:143], v[164:167], v[52:55]
    v_mfma_f32_16x16x32_bf16 v[44:47], a[140:143], v[148:151], v[44:47]
    v_mfma_f32_16x16x32_bf16 v[36:39], a[140:143], v[132:135], v[36:39]
    s_waitcnt lgkmcnt(4)
    v_mfma_f32_16x16x32_bf16 v[0:3], a[128:131], v[136:139], v[0:3]
    ds_read_b64_tr_b16 a[140:141], v235 offset:16384
    ds_read_b64_tr_b16 a[142:143], v235 offset:17408
    v_mfma_f32_16x16x32_bf16 v[8:11], a[128:131], v[152:155], v[8:11]
    v_mfma_f32_16x16x32_bf16 v[16:19], a[128:131], v[168:171], v[16:19]
    s_add_u32 s41, s37, 61440
    buffer_store_dwordx4 v[224:227], v206, s[12:15], s41 offen sc1
    v_mfma_f32_16x16x32_bf16 v[24:27], a[128:131], v[220:223], v[24:27]
    s_waitcnt lgkmcnt(4)
    v_mfma_f32_16x16x32_bf16 v[28:31], a[132:135], v[220:223], v[28:31]
    ds_read_b64_tr_b16 a[128:129], v232 offset:18432
    ds_read_b64_tr_b16 a[130:131], v232 offset:19456
    v_mfma_f32_16x16x32_bf16 v[20:23], a[132:135], v[168:171], v[20:23]
    v_mfma_f32_16x16x32_bf16 v[12:15], a[132:135], v[152:155], v[12:15]
    v_mfma_f32_16x16x32_bf16 v[4:7], a[132:135], v[136:139], v[4:7]
    s_waitcnt lgkmcnt(4)
    v_mfma_f32_16x16x32_bf16 v[32:35], a[136:139], v[136:139], v[32:35]
    ds_read_b64_tr_b16 a[132:133], v233 offset:18432
    ds_read_b64_tr_b16 a[134:135], v233 offset:19456
    v_mfma_f32_16x16x32_bf16 v[40:43], a[136:139], v[152:155], v[40:43]
    v_mfma_f32_16x16x32_bf16 v[48:51], a[136:139], v[168:171], v[48:51]
    v_mfma_f32_16x16x32_bf16 v[56:59], a[136:139], v[220:223], v[56:59]
    s_waitcnt lgkmcnt(4)
    v_mfma_f32_16x16x32_bf16 v[60:63], a[140:143], v[220:223], v[60:63]
    ds_read_b64_tr_b16 a[136:137], v234 offset:18432
    ds_read_b64_tr_b16 a[138:139], v234 offset:19456
    v_mfma_f32_16x16x32_bf16 v[52:55], a[140:143], v[168:171], v[52:55]
    v_mfma_f32_16x16x32_bf16 v[44:47], a[140:143], v[152:155], v[44:47]
    v_mfma_f32_16x16x32_bf16 v[36:39], a[140:143], v[136:139], v[36:39]
    s_waitcnt lgkmcnt(4)
    v_mfma_f32_16x16x32_bf16 v[0:3], a[128:131], v[140:143], v[0:3]
    ds_read_b64_tr_b16 a[140:141], v235 offset:18432
    ds_read_b64_tr_b16 a[142:143], v235 offset:19456
    v_mfma_f32_16x16x32_bf16 v[8:11], a[128:131], v[156:159], v[8:11]
    v_mfma_f32_16x16x32_bf16 v[16:19], a[128:131], v[172:175], v[16:19]
    v_mfma_f32_16x16x32_bf16 v[24:27], a[128:131], v[224:227], v[24:27]
    s_waitcnt lgkmcnt(4)
    v_mfma_f32_16x16x32_bf16 v[28:31], a[132:135], v[224:227], v[28:31]
    v_mfma_f32_16x16x32_bf16 v[20:23], a[132:135], v[172:175], v[20:23]
    v_mfma_f32_16x16x32_bf16 v[12:15], a[132:135], v[156:159], v[12:15]
    v_mfma_f32_16x16x32_bf16 v[4:7], a[132:135], v[140:143], v[4:7]
    s_waitcnt lgkmcnt(2)
    v_mfma_f32_16x16x32_bf16 v[32:35], a[136:139], v[140:143], v[32:35]
    v_mfma_f32_16x16x32_bf16 v[40:43], a[136:139], v[156:159], v[40:43]
    v_mfma_f32_16x16x32_bf16 v[48:51], a[136:139], v[172:175], v[48:51]
    v_mfma_f32_16x16x32_bf16 v[56:59], a[136:139], v[224:227], v[56:59]
    s_waitcnt lgkmcnt(0)
    v_mfma_f32_16x16x32_bf16 v[60:63], a[140:143], v[224:227], v[60:63]
    v_mfma_f32_16x16x32_bf16 v[52:55], a[140:143], v[172:175], v[52:55]
    v_mfma_f32_16x16x32_bf16 v[44:47], a[140:143], v[156:159], v[44:47]
    v_mfma_f32_16x16x32_bf16 v[36:39], a[140:143], v[140:143], v[36:39]
    s_barrier
    s_waitcnt vmcnt(0)
    s_nop 0
    buffer_store_dword v246, v245, s[12:15], s0 offen sc1
    ds_write_b128 v248, a[144:147] offset:0
    ds_write_b128 v248, a[148:151] offset:1024
    ds_write_b128 v248, a[152:155] offset:2048
    ds_write_b128 v248, a[156:159] offset:3072
    ds_write_b128 v248, a[160:163] offset:4096
    ds_write_b128 v248, a[164:167] offset:5120
    ds_write_b128 v248, a[168:171] offset:6144
    ds_write_b128 v248, a[172:175] offset:7168
    ds_write_b128 v248, a[176:179] offset:8192
    ds_write_b128 v248, a[180:183] offset:9216
    ds_write_b128 v248, a[184:187] offset:10240
    ds_write_b128 v248, a[188:191] offset:11264
    ds_write_b128 v248, v[176:179] offset:12288
    ds_write_b128 v248, v[180:183] offset:13312
    ds_write_b128 v248, v[184:187] offset:14336
    ds_write_b128 v248, v[188:191] offset:15360
    v_subrev_u32 v228, 65536, v196
    v_subrev_u32 v229, 65536, v197
    v_subrev_u32 v230, 65536, v198
    v_subrev_u32 v231, 65536, v199
    v_subrev_u32 v232, 65536, v200
    v_subrev_u32 v233, 65536, v201
    buffer_load_dword v252, v250, s[12:15], s64 offen sc1
    v_subrev_u32 v234, 65536, v202
    v_subrev_u32 v235, 65536, v203
    s_waitcnt lgkmcnt(0)
    s_barrier
    ds_read_b128 v[128:131], v253 offset:0
    ds_read_b128 v[132:135], v253 offset:1024
    ds_read_b128 v[136:139], v253 offset:2048
    ds_read_b128 v[140:143], v253 offset:3072
    ds_read_b128 v[144:147], v253 offset:16384
    ds_read_b128 v[148:151], v253 offset:17408
    ds_read_b128 v[152:155], v253 offset:18432
    ds_read_b128 v[156:159], v253 offset:19456
    ds_read_b128 v[160:163], v253 offset:32768
    ds_read_b128 v[164:167], v253 offset:33792
    ds_read_b128 v[168:171], v253 offset:34816
    ds_read_b128 v[172:175], v253 offset:35840
    s_waitcnt lgkmcnt(8)
    ds_read_b128 v[212:215], v253 offset:49152
    ds_read_b128 v[216:219], v253 offset:50176
    ds_read_b128 v[220:223], v253 offset:51200
    ds_read_b128 v[224:227], v253 offset:52224
    v_lshlrev_b32 v176, 16, v236
    v_and_b32 v177, 0xffff0000, v236
    v_lshlrev_b32 v178, 16, v237
    v_and_b32 v179, 0xffff0000, v237
    v_lshlrev_b32 v180, 16, v238
    v_and_b32 v181, 0xffff0000, v238
    v_lshlrev_b32 v182, 16, v239
    v_and_b32 v183, 0xffff0000, v239
    v_lshlrev_b32 v184, 16, v240
    v_and_b32 v185, 0xffff0000, v240
    v_lshlrev_b32 v186, 16, v241
    v_and_b32 v187, 0xffff0000, v241
    v_lshlrev_b32 v188, 16, v242
    v_and_b32 v189, 0xffff0000, v242
    v_lshlrev_b32 v190, 16, v243
    v_and_b32 v191, 0xffff0000, v243
    v_mov_b32 v236, 0xbfb8aa3b
    v_mov_b32 v237, 1.0
    v_pk_add_f32 v[128:129], v[128:129], v[176:177] op_sel:[0,0] op_sel_hi:[1,1]
    v_pk_add_f32 v[130:131], v[130:131], v[178:179] op_sel:[0,0] op_sel_hi:[1,1]
    v_pk_add_f32 v[132:133], v[132:133], v[180:181] op_sel:[0,0] op_sel_hi:[1,1]
    v_pk_add_f32 v[134:135], v[134:135], v[182:183] op_sel:[0,0] op_sel_hi:[1,1]
    v_pk_add_f32 v[136:137], v[136:137], v[184:185] op_sel:[0,0] op_sel_hi:[1,1]
    v_pk_add_f32 v[138:139], v[138:139], v[186:187] op_sel:[0,0] op_sel_hi:[1,1]
    v_pk_add_f32 v[140:141], v[140:141], v[188:189] op_sel:[0,0] op_sel_hi:[1,1]
    v_pk_add_f32 v[142:143], v[142:143], v[190:191] op_sel:[0,0] op_sel_hi:[1,1]
    s_waitcnt lgkmcnt(8)
    v_pk_add_f32 v[128:129], v[128:129], v[144:145] op_sel:[0,0] op_sel_hi:[1,1]
    v_pk_add_f32 v[130:131], v[130:131], v[146:147] op_sel:[0,0] op_sel_hi:[1,1]
    v_pk_add_f32 v[132:133], v[132:133], v[148:149] op_sel:[0,0] op_sel_hi:[1,1]
    v_pk_add_f32 v[134:135], v[134:135], v[150:151] op_sel:[0,0] op_sel_hi:[1,1]
    v_pk_add_f32 v[136:137], v[136:137], v[152:153] op_sel:[0,0] op_sel_hi:[1,1]
    v_pk_add_f32 v[138:139], v[138:139], v[154:155] op_sel:[0,0] op_sel_hi:[1,1]
    s_waitcnt vmcnt(0)
    v_cmp_gt_u32 vcc, 1, v252
    v_pk_add_f32 v[140:141], v[140:141], v[156:157] op_sel:[0,0] op_sel_hi:[1,1]
    v_pk_add_f32 v[142:143], v[142:143], v[158:159] op_sel:[0,0] op_sel_hi:[1,1]
    s_cbranch_vccnz L_wait2
L_go2:
    s_waitcnt lgkmcnt(4)
    s_add_u32 s47, s4, 0
    buffer_load_dwordx4 a[0:3], v206, s[12:15], s47 offen sc1
    v_pk_add_f32 v[128:129], v[128:129], v[160:161] op_sel:[0,0] op_sel_hi:[1,1]
    v_pk_add_f32 v[130:131], v[130:131], v[162:163] op_sel:[0,0] op_sel_hi:[1,1]
    v_pk_add_f32 v[132:133], v[132:133], v[164:165] op_sel:[0,0] op_sel_hi:[1,1]
    v_pk_add_f32 v[134:135], v[134:135], v[166:167] op_sel:[0,0] op_sel_hi:[1,1]
    v_pk_add_f32 v[136:137], v[136:137], v[168:169] op_sel:[0,0] op_sel_hi:[1,1]
    v_pk_add_f32 v[138:139], v[138:139], v[170:171] op_sel:[0,0] op_sel_hi:[1,1]
    v_pk_add_f32 v[140:141], v[140:141], v[172:173] op_sel:[0,0] op_sel_hi:[1,1]
    v_pk_add_f32 v[142:143], v[142:143], v[174:175] op_sel:[0,0] op_sel_hi:[1,1]
    s_add_u32 s47, s4, 4096
    buffer_load_dwordx4 a[4:7], v206, s[12:15], s47 offen sc1
    s_waitcnt lgkmcnt(0)
    s_nop 0
    v_pk_add_f32 v[128:129], v[128:129], v[212:213] op_sel:[0,0] op_sel_hi:[1,1]
    v_pk_add_f32 v[130:131], v[130:131], v[214:215] op_sel:[0,0] op_sel_hi:[1,1]
    v_pk_add_f32 v[132:133], v[132:133], v[216:217] op_sel:[0,0] op_sel_hi:[1,1]
    v_pk_add_f32 v[134:135], v[134:135], v[218:219] op_sel:[0,0] op_sel_hi:[1,1]
    v_pk_add_f32 v[136:137], v[136:137], v[220:221] op_sel:[0,0] op_sel_hi:[1,1]
    v_pk_add_f32 v[138:139], v[138:139], v[222:223] op_sel:[0,0] op_sel_hi:[1,1]
    v_pk_add_f32 v[140:141], v[140:141], v[224:225] op_sel:[0,0] op_sel_hi:[1,1]
    v_pk_add_f32 v[142:143], v[142:143], v[226:227] op_sel:[0,0] op_sel_hi:[1,1]
    s_add_u32 s47, s4, 8192
    buffer_load_dwordx4 a[8:11], v206, s[12:15], s47 offen sc1
    v_pk_mul_f32 v[176:177], v[128:129], v[236:237] op_sel:[0,0] op_sel_hi:[1,0]
    v_pk_mul_f32 v[178:179], v[130:131], v[236:237] op_sel:[0,0] op_sel_hi:[1,0]
    v_pk_mul_f32 v[180:181], v[132:133], v[236:237] op_sel:[0,0] op_sel_hi:[1,0]
L_hop13:
    s_cbranch_execz L_ret3
    s_nop 0
    v_pk_mul_f32 v[182:183], v[134:135], v[236:237] op_sel:[0,0] op_sel_hi:[1,0]
    v_pk_mul_f32 v[184:185], v[136:137], v[236:237] op_sel:[0,0] op_sel_hi:[1,0]
    v_pk_mul_f32 v[186:187], v[138:139], v[236:237] op_sel:[0,0] op_sel_hi:[1,0]
    v_pk_mul_f32 v[188:189], v[140:141], v[236:237] op_sel:[0,0] op_sel_hi:[1,0]
    v_pk_mul_f32 v[190:191], v[142:143], v[236:237] op_sel:[0,0] op_sel_hi:[1,0]
    s_add_u32 s47, s4, 12288
    buffer_load_dwordx4 a[12:15], v206, s[12:15], s47 offen sc1
    v_exp_f32 v176, v176
    v_exp_f32 v177, v177
    v_exp_f32 v178, v178
    v_exp_f32 v179, v179
    v_exp_f32 v180, v180
    v_exp_f32 v181, v181
    v_exp_f32 v182, v182
    v_exp_f32 v183, v183
    s_add_u32 s47, s5, 0
    buffer_load_dwordx4 a[64:67], v206, s[12:15], s47 offen sc1
    v_exp_f32 v184, v184
    v_exp_f32 v185, v185
    v_exp_f32 v186, v186
    v_exp_f32 v187, v187
    v_exp_f32 v188, v188
    v_exp_f32 v189, v189
    v_exp_f32 v190, v190
    v_exp_f32_e64 v191, v191
    s_add_u32 s47, s5, 4096
    buffer_load_dwordx4 a[68:71], v206, s[12:15], s47 offen sc1
    v_pk_add_f32 v[176:177], v[176:177], v[236:237] op_sel:[0,1] op_sel_hi:[1,1]
    v_pk_add_f32 v[178:179], v[178:179], v[236:237] op_sel:[0,1] op_sel_hi:[1,1]
    v_pk_add_f32 v[180:181], v[180:181], v[236:237] op_sel:[0,1] op_sel_hi:[1,1]
    v_pk_add_f32 v[182:183], v[182:183], v[236:237] op_sel:[0,1] op_sel_hi:[1,1]
    v_pk_add_f32 v[184:185], v[184:185], v[236:237] op_sel:[0,1] op_sel_hi:[1,1]
    v_pk_add_f32 v[186:187], v[186:187], v[236:237] op_sel:[0,1] op_sel_hi:[1,1]
    v_pk_add_f32 v[188:189], v[188:189], v[236:237] op_sel:[0,1] op_sel_hi:[1,1]
    v_pk_add_f32 v[190:191], v[190:191], v[236:237] op_sel:[0,1] op_sel_hi:[1,1]
    s_add_u32 s47, s5, 8192
    buffer_load_dwordx4 a[72:75], v206, s[12:15], s47 offen sc1
    v_rcp_f32 v176, v176
    v_rcp_f32 v177, v177
    v_rcp_f32 v178, v178
    v_rcp_f32 v179, v179
    v_rcp_f32 v180, v180
    v_rcp_f32 v181, v181
    v_rcp_f32 v182, v182
    v_rcp_f32 v183, v183
    s_add_u32 s47, s5, 12288
    buffer_load_dwordx4 a[76:79], v206, s[12:15], s47 offen sc1
    v_rcp_f32 v184, v184
    v_rcp_f32 v185, v185
    v_rcp_f32 v186, v186
    v_rcp_f32 v187, v187
    v_rcp_f32 v188, v188
    v_rcp_f32 v189, v189
    v_rcp_f32 v190, v190
    v_rcp_f32 v191, v191
    s_add_u32 s47, s6, 0
    s_nop 0
    buffer_load_dwordx4 a[192:195], v206, s[12:15], s47 offen sc1
    ds_read_b64_tr_b16 a[128:129], v228 offset:0
    ds_read_b64_tr_b16 a[130:131], v228 offset:1024
    v_pk_mul_f32 v[128:129], v[128:129], v[176:177] op_sel:[0,0] op_sel_hi:[1,1]
    v_pk_mul_f32 v[130:131], v[130:131], v[178:179] op_sel:[0,0] op_sel_hi:[1,1]
    v_pk_mul_f32 v[132:133], v[132:133], v[180:181] op_sel:[0,0] op_sel_hi:[1,1]
    v_pk_mul_f32 v[134:135], v[134:135], v[182:183] op_sel:[0,0] op_sel_hi:[1,1]
    v_pk_mul_f32 v[136:137], v[136:137], v[184:185] op_sel:[0,0] op_sel_hi:[1,1]
    v_pk_mul_f32 v[138:139], v[138:139], v[186:187] op_sel:[0,0] op_sel_hi:[1,1]
    s_add_u32 s47, s6, 4096
    buffer_load_dwordx4 a[196:199], v206, s[12:15], s47 offen sc1
    v_pk_mul_f32 v[140:141], v[140:141], v[188:189] op_sel:[0,0] op_sel_hi:[1,1]
    v_pk_mul_f32 v[142:143], v[142:143], v[190:191] op_sel:[0,0] op_sel_hi:[1,1]
    ds_read_b64_tr_b16 a[132:133], v229 offset:0
    ds_read_b64_tr_b16 a[134:135], v229 offset:1024
    ds_read_b64_tr_b16 a[136:137], v230 offset:0
    ds_read_b64_tr_b16 a[138:139], v230 offset:1024
    s_waitcnt lgkmcnt(4)
    s_waitcnt vmcnt(6)
    v_mfma_f32_16x16x32_bf16 v[64:67], a[128:131], a[0:3], v[64:67]
    ds_read_b64_tr_b16 a[140:141], v231 offset:0
    ds_read_b64_tr_b16 a[142:143], v231 offset:1024
    v_mfma_f32_16x16x32_bf16 v[72:75], a[128:131], a[4:7], v[72:75]
    s_add_u32 s47, s6, 8192
    buffer_load_dwordx4 a[200:203], v206, s[12:15], s47 offen sc1
    v_mfma_f32_16x16x32_bf16 v[80:83], a[128:131], a[8:11], v[80:83]
    ds_read_b64_tr_b16 v[144:145], v230 offset:34816
    v_mfma_f32_16x16x32_bf16 v[88:91], a[128:131], a[12:15], v[88:91]
    ds_read_b64_tr_b16 v[146:147], v230 offset:35840
    s_waitcnt lgkmcnt(6)
    v_mfma_f32_16x16x32_bf16 v[92:95], a[132:135], a[12:15], v[92:95]
    ds_read_b64_tr_b16 a[128:129], v232 offset:0
    ds_read_b64_tr_b16 a[130:131], v232 offset:1024
    v_mfma_f32_16x16x32_bf16 v[84:87], a[132:135], a[8:11], v[84:87]
    ds_read_b64_tr_b16 v[148:149], v231 offset:34816
    v_mfma_f32_16x16x32_bf16 v[76:79], a[132:135], a[4:7], v[76:79]
    s_add_u32 s47, s6, 12288
    buffer_load_dwordx4 a[204:207], v206, s[12:15], s47 offen sc1
    v_mfma_f32_16x16x32_bf16 v[68:71], a[132:135], a[0:3], v[68:71]
    ds_read_b64_tr_b16 v[150:151], v231 offset:35840
    s_waitcnt lgkmcnt(8)
    v_mfma_f32_16x16x32_bf16 v[96:99], a[136:139], a[0:3], v[96:99]
    ds_read_b64_tr_b16 a[132:133], v233 offset:0
    ds_read_b64_tr_b16 a[134:135], v233 offset:1024
    v_mfma_f32_16x16x32_bf16 v[104:107], a[136:139], a[4:7], v[104:107]
    ds_read_b64_tr_b16 v[152:153], v198 offset:2048
    v_mfma_f32_16x16x32_bf16 v[112:115], a[136:139], a[8:11], v[112:115]
    s_add_u32 s47, s4, 16384
    buffer_load_dwordx4 a[16:19], v206, s[12:15], s47 offen sc1
    v_mfma_f32_16x16x32_bf16 v[120:123], a[136:139], a[12:15], v[120:123]
    ds_read_b64_tr_b16 v[154:155], v198 offset:3072
    s_waitcnt lgkmcnt(10)
    v_mfma_f32_16x16x32_bf16 v[124:127], a[140:143], a[12:15], v[124:127]
    ds_read_b64_tr_b16 a[136:137], v234 offset:0
    ds_read_b64_tr_b16 a[138:139], v234 offset:1024
    v_mfma_f32_16x16x32_bf16 v[116:119], a[140:143], a[8:11], v[116:119]
    ds_read_b64_tr_b16 v[156:157], v199 offset:2048
    v_mfma_f32_16x16x32_bf16 v[108:111], a[140:143], a[4:7], v[108:111]
    ds_read_b64_tr_b16 v[158:159], v199 offset:3072
    v_mfma_f32_16x16x32_bf16 v[100:103], a[140:143], a[0:3], v[100:103]
    s_add_u32 s47, s4, 20480
    buffer_load_dwordx4 a[20:23], v206, s[12:15], s47 offen sc1
    s_waitcnt lgkmcnt(10)
    v_mfma_f32_16x16x32_bf16 v[0:3], a[128:131], a[0:3], v[0:3]
    ds_read_b64_tr_b16 a[140:141], v235 offset:0
    ds_read_b64_tr_b16 a[142:143], v235 offset:1024
    v_mfma_f32_16x16x32_bf16 v[8:11], a[128:131], a[4:7], v[8:11]
    ds_read_b64_tr_b16 v[160:161], v230 offset:16384
    v_mfma_f32_16x16x32_bf16 v[16:19], a[128:131], a[8:11], v[16:19]
    ds_read_b64_tr_b16 v[162:163], v230 offset:17408
    v_mfma_f32_16x16x32_bf16 v[24:27], a[128:131], a[12:15], v[24:27]
    s_add_u32 s47, s4, 24576
    buffer_load_dwordx4 a[24:27], v206, s[12:15], s47 offen sc1
    s_waitcnt lgkmcnt(10)
    v_mfma_f32_16x16x32_bf16 v[28:31], a[132:135], a[12:15], v[28:31]
    ds_read_b64_tr_b16 a[128:129], v228 offset:32768
    ds_read_b64_tr_b16 a[130:131], v228 offset:33792
    v_mfma_f32_16x16x32_bf16 v[20:23], a[132:135], a[8:11], v[20:23]
    ds_read_b64_tr_b16 v[164:165], v231 offset:16384
    v_mfma_f32_16x16x32_bf16 v[12:15], a[132:135], a[4:7], v[12:15]
    ds_read_b64_tr_b16 v[166:167], v231 offset:17408
    v_mfma_f32_16x16x32_bf16 v[4:7], a[132:135], a[0:3], v[4:7]
    ds_read_b64_tr_b16 v[168:169], v230 offset:49152
    s_waitcnt lgkmcnt(11)
    v_mfma_f32_16x16x32_bf16 v[32:35], a[136:139], a[0:3], v[32:35]
    ds_read_b64_tr_b16 a[132:133], v229 offset:32768
    ds_read_b64_tr_b16 a[134:135], v229 offset:33792
    v_mfma_f32_16x16x32_bf16 v[40:43], a[136:139], a[4:7], v[40:43]
    s_add_u32 s47, s4, 28672
    buffer_load_dwordx4 a[28:31], v206, s[12:15], s47 offen sc1
    v_mfma_f32_16x16x32_bf16 v[48:51], a[136:139], a[8:11], v[48:51]
    ds_read_b64_tr_b16 v[170:171], v230 offset:50176
    v_mfma_f32_16x16x32_bf16 v[56:59], a[136:139], a[12:15], v[56:59]
    ds_read_b64_tr_b16 v[172:173], v231 offset:49152
    s_waitcnt lgkmcnt(11)
    v_mfma_f32_16x16x32_bf16 v[60:63], a[140:143], a[12:15], v[60:63]
    ds_read_b64_tr_b16 a[136:137], v230 offset:32768
    ds_read_b64_tr_b16 a[138:139], v230 offset:33792
    v_mfma_f32_16x16x32_bf16 v[52:55], a[140:143], a[8:11], v[52:55]
    s_add_u32 s47, s5, 16384
    buffer_load_dwordx4 a[80:83], v206, s[12:15], s47 offen sc1
    v_mfma_f32_16x16x32_bf16 v[44:47], a[140:143], a[4:7], v[44:47]
    ds_read_b64_tr_b16 v[174:175], v231 offset:50176
    v_mfma_f32_16x16x32_bf16 v[36:39], a[140:143], a[0:3], v[36:39]
    ds_read_b64_tr_b16 v[176:177], v198 offset:16384
    s_waitcnt lgkmcnt(11)
    s_waitcnt vmcnt(9)
    v_mfma_f32_16x16x32_bf16 v[64:67], a[128:131], a[64:67], v[64:67]
    ds_read_b64_tr_b16 a[140:141], v231 offset:32768
    ds_read_b64_tr_b16 a[142:143], v231 offset:33792
    v_mfma_f32_16x16x32_bf16 v[72:75], a[128:131], a[68:71], v[72:75]
    s_add_u32 s47, s6, 16384
    buffer_load_dwordx4 a[208:211], v206, s[12:15], s47 offen sc1
    v_mfma_f32_16x16x32_bf16 v[80:83], a[128:131], a[72:75], v[80:83]
    ds_read_b64_tr_b16 v[178:179], v198 offset:17408
    v_mfma_f32_16x16x32_bf16 v[88:91], a[128:131], a[76:79], v[88:91]
    ds_read_b64_tr_b16 v[180:181], v199 offset:16384
    s_waitcnt lgkmcnt(10)
    v_mfma_f32_16x16x32_bf16 v[92:95], a[132:135], a[76:79], v[92:95]
    ds_read_b64_tr_b16 a[128:129], v232 offset:32768
    ds_read_b64_tr_b16 a[130:131], v232 offset:33792
    v_mfma_f32_16x16x32_bf16 v[84:87], a[132:135], a[72:75], v[84:87]
    s_add_u32 s47, s4, 32768
    buffer_load_dwordx4 a[32:35], v206, s[12:15], s47 offen sc1
    v_mfma_f32_16x16x32_bf16 v[76:79], a[132:135], a[68:71], v[76:79]
    ds_read_b64_tr_b16 v[182:183], v199 offset:17408
    v_mfma_f32_16x16x32_bf16 v[68:71], a[132:135], a[64:67], v[68:71]
    ds_read_b64_tr_b16 v[184:185], v230 offset:18432
    s_waitcnt lgkmcnt(10)
    v_mfma_f32_16x16x32_bf16 v[96:99], a[136:139], a[64:67], v[96:99]
    ds_read_b64_tr_b16 a[132:133], v233 offset:32768
    ds_read_b64_tr_b16 a[134:135], v233 offset:33792
    v_mfma_f32_16x16x32_bf16 v[104:107], a[136:139], a[68:71], v[104:107]
    ds_read_b64_tr_b16 v[186:187], v230 offset:19456
    v_mfma_f32_16x16x32_bf16 v[112:115], a[136:139], a[72:75], v[112:115]
    s_add_u32 s47, s5, 32768
    buffer_load_dwordx4 a[96:99], v206, s[12:15], s47 offen sc1
    v_mfma_f32_16x16x32_bf16 v[120:123], a[136:139], a[76:79], v[120:123]
    ds_read_b64_tr_b16 v[188:189], v231 offset:18432
    s_waitcnt lgkmcnt(10)
    v_mfma_f32_16x16x32_bf16 v[124:127], a[140:143], a[76:79], v[124:127]
    ds_read_b64_tr_b16 a[136:137], v234 offset:32768
    ds_read_b64_tr_b16 a[138:139], v234 offset:33792
    v_mfma_f32_16x16x32_bf16 v[116:119], a[140:143], a[72:75], v[116:119]
    ds_read_b64_tr_b16 v[190:191], v231 offset:19456
    v_mfma_f32_16x16x32_bf16 v[108:111], a[140:143], a[68:71], v[108:111]
    s_add_u32 s47, s6, 32768
    buffer_load_dwordx4 a[224:227], v206, s[12:15], s47 offen sc1
    v_mfma_f32_16x16x32_bf16 v[100:103], a[140:143], a[64:67], v[100:103]
    ds_read_b64_tr_b16 v[212:213], v230 offset:51200
    s_waitcnt lgkmcnt(10)
    v_mfma_f32_16x16x32_bf16 v[0:3], a[128:131], a[64:67], v[0:3]
    ds_read_b64_tr_b16 a[140:141], v235 offset:32768
    ds_read_b64_tr_b16 a[142:143], v235 offset:33792
    v_mfma_f32_16x16x32_bf16 v[8:11], a[128:131], a[68:71], v[8:11]
    ds_read_b64_tr_b16 v[214:215], v230 offset:52224
    v_mfma_f32_16x16x32_bf16 v[16:19], a[128:131], a[72:75], v[16:19]
    ds_read_b64_tr_b16 v[216:217], v231 offset:51200
    v_mfma_f32_16x16x32_bf16 v[24:27], a[128:131], a[76:79], v[24:27]
    s_add_u32 s47, s4, 49152
    buffer_load_dwordx4 a[48:51], v206, s[12:15], s47 offen sc1
    s_waitcnt lgkmcnt(10)
    v_mfma_f32_16x16x32_bf16 v[28:31], a[132:135], a[76:79], v[28:31]
    ds_read_b64_tr_b16 a[128:129], v196 offset:0
    ds_read_b64_tr_b16 a[130:131], v196 offset:1024
    v_mfma_f32_16x16x32_bf16 v[20:23], a[132:135], a[72:75], v[20:23]
    ds_read_b64_tr_b16 v[218:219], v231 offset:52224
    v_mfma_f32_16x16x32_bf16 v[12:15], a[132:135], a[68:71], v[12:15]
    ds_read_b64_tr_b16 v[220:221], v198 offset:18432
    v_mfma_f32_16x16x32_bf16 v[4:7], a[132:135], a[64:67], v[4:7]
    s_add_u32 s47, s5, 49152
    buffer_load_dwordx4 a[112:115], v206, s[12:15], s47 offen sc1
    s_waitcnt lgkmcnt(10)
    v_mfma_f32_16x16x32_bf16 v[32:35], a[136:139], a[64:67], v[32:35]
    ds_read_b64_tr_b16 a[132:133], v197 offset:0
    ds_read_b64_tr_b16 a[134:135], v197 offset:1024
    v_mfma_f32_16x16x32_bf16 v[40:43], a[136:139], a[68:71], v[40:43]
    ds_read_b64_tr_b16 v[222:223], v198 offset:19456
    v_mfma_f32_16x16x32_bf16 v[48:51], a[136:139], a[72:75], v[48:51]
    ds_read_b64_tr_b16 v[224:225], v199 offset:18432
    v_mfma_f32_16x16x32_bf16 v[56:59], a[136:139], a[76:79], v[56:59]
    ds_read_b64_tr_b16 v[226:227], v199 offset:19456
    s_waitcnt lgkmcnt(11)
    v_mfma_f32_16x16x32_bf16 v[60:63], a[140:143], a[76:79], v[60:63]
    ds_read_b64_tr_b16 a[136:137], v198 offset:0
    ds_read_b64_tr_b16 a[138:139], v198 offset:1024
    v_mfma_f32_16x16x32_bf16 v[52:55], a[140:143], a[72:75], v[52:55]
    s_add_u32 s47, s6, 49152
    buffer_load_dwordx4 a[240:243], v206, s[12:15], s47 offen sc1
    v_mfma_f32_16x16x32_bf16 v[44:47], a[140:143], a[68:71], v[44:47]
    ds_read_b64_tr_b16 a[144:145], v228 offset:34816
    v_mfma_f32_16x16x32_bf16 v[36:39], a[140:143], a[64:67], v[36:39]
    ds_read_b64_tr_b16 a[146:147], v228 offset:35840
    s_waitcnt lgkmcnt(11)
    s_waitcnt vmcnt(12)
    v_mfma_f32_16x16x32_bf16 v[64:67], a[128:131], a[192:195], v[64:67]
    ds_read_b64_tr_b16 a[140:141], v199 offset:0
    ds_read_b64_tr_b16 a[142:143], v199 offset:1024
    v_mfma_f32_16x16x32_bf16 v[72:75], a[128:131], a[196:199], v[72:75]
    s_add_u32 s47, s5, 20480
    buffer_load_dwordx4 a[84:87], v206, s[12:15], s47 offen sc1
    v_mfma_f32_16x16x32_bf16 v[80:83], a[128:131], a[200:203], v[80:83]
    ds_read_b64_tr_b16 a[148:149], v229 offset:34816
    v_mfma_f32_16x16x32_bf16 v[88:91], a[128:131], a[204:207], v[88:91]
    ds_read_b64_tr_b16 a[150:151], v229 offset:35840
    s_waitcnt lgkmcnt(11)
    v_mfma_f32_16x16x32_bf16 v[92:95], a[132:135], a[204:207], v[92:95]
    ds_read_b64_tr_b16 a[128:129], v200 offset:0
    ds_read_b64_tr_b16 a[130:131], v200 offset:1024
    v_mfma_f32_16x16x32_bf16 v[84:87], a[132:135], a[200:203], v[84:87]
    s_add_u32 s47, s6, 20480
    buffer_load_dwordx4 a[212:215], v206, s[12:15], s47 offen sc1
    v_mfma_f32_16x16x32_bf16 v[76:79], a[132:135], a[196:199], v[76:79]
    ds_read_b64_tr_b16 a[152:153], v196 offset:2048
    v_mfma_f32_16x16x32_bf16 v[68:71], a[132:135], a[192:195], v[68:71]
    ds_read_b64_tr_b16 a[154:155], v196 offset:3072
    s_waitcnt lgkmcnt(10)
    v_mfma_f32_16x16x32_bf16 v[96:99], a[136:139], a[192:195], v[96:99]
    ds_read_b64_tr_b16 a[132:133], v201 offset:0
    ds_read_b64_tr_b16 a[134:135], v201 offset:1024
    v_mfma_f32_16x16x32_bf16 v[104:107], a[136:139], a[196:199], v[104:107]
    s_add_u32 s47, s4, 36864
    buffer_load_dwordx4 a[36:39], v206, s[12:15], s47 offen sc1
    v_mfma_f32_16x16x32_bf16 v[112:115], a[136:139], a[200:203], v[112:115]
    ds_read_b64_tr_b16 a[156:157], v197 offset:2048
    v_mfma_f32_16x16x32_bf16 v[120:123], a[136:139], a[204:207], v[120:123]
    ds_read_b64_tr_b16 a[158:159], v197 offset:3072
    s_waitcnt lgkmcnt(10)
    v_mfma_f32_16x16x32_bf16 v[124:127], a[140:143], a[204:207], v[124:127]
    ds_read_b64_tr_b16 a[136:137], v202 offset:0
    ds_read_b64_tr_b16 a[138:139], v202 offset:1024
    v_mfma_f32_16x16x32_bf16 v[116:119], a[140:143], a[200:203], v[116:119]
    ds_read_b64_tr_b16 a[160:161], v228 offset:16384
    v_mfma_f32_16x16x32_bf16 v[108:111], a[140:143], a[196:199], v[108:111]
    s_add_u32 s47, s5, 36864
    buffer_load_dwordx4 a[100:103], v206, s[12:15], s47 offen sc1
    v_mfma_f32_16x16x32_bf16 v[100:103], a[140:143], a[192:195], v[100:103]
    ds_read_b64_tr_b16 a[162:163], v228 offset:17408
    s_waitcnt lgkmcnt(10)
    v_mfma_f32_16x16x32_bf16 v[0:3], a[128:131], a[192:195], v[0:3]
    ds_read_b64_tr_b16 a[140:141], v203 offset:0
    ds_read_b64_tr_b16 a[142:143], v203 offset:1024
    v_mfma_f32_16x16x32_bf16 v[8:11], a[128:131], a[196:199], v[8:11]
    ds_read_b64_tr_b16 a[164:165], v229 offset:16384
    v_mfma_f32_16x16x32_bf16 v[16:19], a[128:131], a[200:203], v[16:19]
    s_add_u32 s47, s6, 36864
    buffer_load_dwordx4 a[228:231], v206, s[12:15], s47 offen sc1
    v_mfma_f32_16x16x32_bf16 v[24:27], a[128:131], a[204:207], v[24:27]
    ds_read_b64_tr_b16 a[166:167], v229 offset:17408
    s_waitcnt lgkmcnt(10)
    v_mfma_f32_16x16x32_bf16 v[28:31], a[132:135], a[204:207], v[28:31]
    ds_read_b64_tr_b16 a[128:129], v228 offset:2048
    ds_read_b64_tr_b16 a[130:131], v228 offset:3072
    v_mfma_f32_16x16x32_bf16 v[20:23], a[132:135], a[200:203], v[20:23]
    ds_read_b64_tr_b16 a[168:169], v228 offset:49152
    v_mfma_f32_16x16x32_bf16 v[12:15], a[132:135], a[196:199], v[12:15]
    ds_read_b64_tr_b16 a[170:171], v228 offset:50176
    v_mfma_f32_16x16x32_bf16 v[4:7], a[132:135], a[192:195], v[4:7]
    s_add_u32 s47, s4, 53248
    buffer_load_dwordx4 a[52:55], v206, s[12:15], s47 offen sc1
    s_waitcnt lgkmcnt(10)
    v_mfma_f32_16x16x32_bf16 v[32:35], a[136:139], a[192:195], v[32:35]
    ds_read_b64_tr_b16 a[132:133], v229 offset:2048
    ds_read_b64_tr_b16 a[134:135], v229 offset:3072
    v_mfma_f32_16x16x32_bf16 v[40:43], a[136:139], a[196:199], v[40:43]
    ds_read_b64_tr_b16 a[172:173], v229 offset:49152
    v_mfma_f32_16x16x32_bf16 v[48:51], a[136:139], a[200:203], v[48:51]
    ds_read_b64_tr_b16 a[174:175], v229 offset:50176
    v_mfma_f32_16x16x32_bf16 v[56:59], a[136:139], a[204:207], v[56:59]
    s_add_u32 s47, s5, 53248
    buffer_load_dwordx4 a[116:119], v206, s[12:15], s47 offen sc1
    s_waitcnt lgkmcnt(10)
    v_mfma_f32_16x16x32_bf16 v[60:63], a[140:143], a[204:207], v[60:63]
    ds_read_b64_tr_b16 a[136:137], v230 offset:2048
    ds_read_b64_tr_b16 a[138:139], v230 offset:3072
    v_mfma_f32_16x16x32_bf16 v[52:55], a[140:143], a[200:203], v[52:55]
    ds_read_b64_tr_b16 a[176:177], v196 offset:16384
    v_mfma_f32_16x16x32_bf16 v[44:47], a[140:143], a[196:199], v[44:47]
    ds_read_b64_tr_b16 a[178:179], v196 offset:17408
    v_mfma_f32_16x16x32_bf16 v[36:39], a[140:143], a[192:195], v[36:39]
    ds_read_b64_tr_b16 a[180:181], v197 offset:16384
    s_barrier
    s_waitcnt lgkmcnt(11)
    s_waitcnt vmcnt(15)
    v_mfma_f32_16x16x32_bf16 v[64:67], a[128:131], a[16:19], v[64:67]
    ds_read_b64_tr_b16 a[140:141], v231 offset:2048
    ds_read_b64_tr_b16 a[142:143], v231 offset:3072
    v_mfma_f32_16x16x32_bf16 v[72:75], a[128:131], a[20:23], v[72:75]
    s_add_u32 s47, s6, 53248
    buffer_load_dwordx4 a[244:247], v206, s[12:15], s47 offen sc1
    v_mfma_f32_16x16x32_bf16 v[80:83], a[128:131], a[24:27], v[80:83]
    ds_read_b64_tr_b16 a[182:183], v197 offset:17408
    v_mfma_f32_16x16x32_bf16 v[88:91], a[128:131], a[28:31], v[88:91]
    ds_read_b64_tr_b16 a[184:185], v228 offset:18432
    s_waitcnt lgkmcnt(11)
    v_mfma_f32_16x16x32_bf16 v[92:95], a[132:135], a[28:31], v[92:95]
    ds_read_b64_tr_b16 a[128:129], v232 offset:2048
    ds_read_b64_tr_b16 a[130:131], v232 offset:3072
    v_mfma_f32_16x16x32_bf16 v[84:87], a[132:135], a[24:27], v[84:87]
    s_add_u32 s47, s5, 24576
    buffer_load_dwordx4 a[88:91], v206, s[12:15], s47 offen sc1
    v_mfma_f32_16x16x32_bf16 v[76:79], a[132:135], a[20:23], v[76:79]
    ds_read_b64_tr_b16 a[186:187], v228 offset:19456
    v_mfma_f32_16x16x32_bf16 v[68:71], a[132:135], a[16:19], v[68:71]
    ds_read_b64_tr_b16 a[188:189], v229 offset:18432
    s_waitcnt lgkmcnt(11)
    v_mfma_f32_16x16x32_bf16 v[96:99], a[136:139], a[16:19], v[96:99]
    ds_read_b64_tr_b16 a[132:133], v233 offset:2048
    ds_read_b64_tr_b16 a[134:135], v233 offset:3072
    v_mfma_f32_16x16x32_bf16 v[104:107], a[136:139], a[20:23], v[104:107]
    s_add_u32 s47, s6, 24576
    buffer_load_dwordx4 a[216:219], v206, s[12:15], s47 offen sc1
    v_mfma_f32_16x16x32_bf16 v[112:115], a[136:139], a[24:27], v[112:115]
    ds_read_b64_tr_b16 a[190:191], v229 offset:19456
    v_mfma_f32_16x16x32_bf16 v[120:123], a[136:139], a[28:31], v[120:123]
    ds_read_b64_tr_b16 a[0:1], v228 offset:51200
    s_waitcnt lgkmcnt(10)
    v_mfma_f32_16x16x32_bf16 v[124:127], a[140:143], a[28:31], v[124:127]
    ds_read_b64_tr_b16 a[136:137], v234 offset:2048
    ds_read_b64_tr_b16 a[138:139], v234 offset:3072
    v_mfma_f32_16x16x32_bf16 v[116:119], a[140:143], a[24:27], v[116:119]
    s_add_u32 s47, s4, 40960
    buffer_load_dwordx4 a[40:43], v206, s[12:15], s47 offen sc1
    v_mfma_f32_16x16x32_bf16 v[108:111], a[140:143], a[20:23], v[108:111]
    ds_read_b64_tr_b16 a[2:3], v228 offset:52224
    v_mfma_f32_16x16x32_bf16 v[100:103], a[140:143], a[16:19], v[100:103]
    ds_read_b64_tr_b16 a[4:5], v229 offset:51200
    s_waitcnt lgkmcnt(10)
    v_mfma_f32_16x16x32_bf16 v[0:3], a[128:131], a[16:19], v[0:3]
    ds_read_b64_tr_b16 a[140:141], v235 offset:2048
    ds_read_b64_tr_b16 a[142:143], v235 offset:3072
    v_mfma_f32_16x16x32_bf16 v[8:11], a[128:131], a[20:23], v[8:11]
    ds_read_b64_tr_b16 a[6:7], v229 offset:52224
    v_mfma_f32_16x16x32_bf16 v[16:19], a[128:131], a[24:27], v[16:19]
    s_add_u32 s47, s5, 40960
    buffer_load_dwordx4 a[104:107], v206, s[12:15], s47 offen sc1
    v_mfma_f32_16x16x32_bf16 v[24:27], a[128:131], a[28:31], v[24:27]
    ds_read_b64_tr_b16 a[8:9], v196 offset:18432
    s_waitcnt lgkmcnt(10)
    v_mfma_f32_16x16x32_bf16 v[28:31], a[132:135], a[28:31], v[28:31]
    v_mfma_f32_16x16x32_bf16 v[20:23], a[132:135], a[24:27], v[20:23]
    ds_read_b64_tr_b16 a[10:11], v196 offset:19456
    v_mfma_f32_16x16x32_bf16 v[12:15], a[132:135], a[20:23], v[12:15]
    s_add_u32 s47, s6, 40960
    buffer_load_dwordx4 a[232:235], v206, s[12:15], s47 offen sc1
    v_mfma_f32_16x16x32_bf16 v[4:7], a[132:135], a[16:19], v[4:7]
    ds_read_b64_tr_b16 a[12:13], v197 offset:18432
    s_waitcnt lgkmcnt(8)
    v_mfma_f32_16x16x32_bf16 v[32:35], a[136:139], a[16:19], v[32:35]
    v_mfma_f32_16x16x32_bf16 v[40:43], a[136:139], a[20:23], v[40:43]
    ds_read_b64_tr_b16 a[14:15], v197 offset:19456
    v_mfma_f32_16x16x32_bf16 v[48:51], a[136:139], a[24:27], v[48:51]
    v_mfma_f32_16x16x32_bf16 v[56:59], a[136:139], a[28:31], v[56:59]
    s_add_u32 s47, s4, 57344
    buffer_load_dwordx4 a[56:59], v206, s[12:15], s47 offen sc1
    s_waitcnt lgkmcnt(5)
    v_mfma_f32_16x16x32_bf16 v[60:63], a[140:143], a[28:31], v[60:63]
    v_mfma_f32_16x16x32_bf16 v[52:55], a[140:143], a[24:27], v[52:55]
    v_mfma_f32_16x16x32_bf16 v[44:47], a[140:143], a[20:23], v[44:47]
    v_mfma_f32_16x16x32_bf16 v[36:39], a[140:143], a[16:19], v[36:39]
    s_add_u32 s47, s5, 57344
    buffer_load_dwordx4 a[120:123], v206, s[12:15], s47 offen sc1
    s_waitcnt lgkmcnt(0)
    s_waitcnt vmcnt(22)
    v_mfma_f32_16x16x32_bf16 v[64:67], a[144:147], a[80:83], v[64:67]
    v_mfma_f32_16x16x32_bf16 v[68:71], a[148:151], a[80:83], v[68:71]
    s_waitcnt vmcnt(21)
    v_mfma_f32_16x16x32_bf16 v[64:67], a[152:155], a[208:211], v[64:67]
    ds_read_b64_tr_b16 a[64:65], v232 offset:34816
    v_mfma_f32_16x16x32_bf16 v[68:71], a[156:159], a[208:211], v[68:71]
    ds_read_b64_tr_b16 a[66:67], v232 offset:35840
    s_waitcnt vmcnt(20)
    v_mfma_f32_16x16x32_bf16 v[64:67], a[160:163], a[32:35], v[64:67]
    s_add_u32 s47, s6, 57344
    buffer_load_dwordx4 a[248:251], v206, s[12:15], s47 offen sc1
    v_mfma_f32_16x16x32_bf16 v[68:71], a[164:167], a[32:35], v[68:71]
    ds_read_b64_tr_b16 a[68:69], v233 offset:34816
    s_waitcnt vmcnt(20)
    v_mfma_f32_16x16x32_bf16 v[64:67], a[168:171], a[96:99], v[64:67]
    ds_read_b64_tr_b16 a[70:71], v233 offset:35840
    v_mfma_f32_16x16x32_bf16 v[68:71], a[172:175], a[96:99], v[68:71]
    s_waitcnt vmcnt(19)
    v_mfma_f32_16x16x32_bf16 v[64:67], a[176:179], a[224:227], v[64:67]
    s_add_u32 s47, s5, 28672
    buffer_load_dwordx4 a[92:95], v206, s[12:15], s47 offen sc1
    v_mfma_f32_16x16x32_bf16 v[68:71], a[180:183], a[224:227], v[68:71]
    s_waitcnt vmcnt(19)
    v_mfma_f32_16x16x32_bf16 v[64:67], a[184:187], a[48:51], v[64:67]
    v_mfma_f32_16x16x32_bf16 v[68:71], a[188:191], a[48:51], v[68:71]
    ds_read_b64_tr_b16 a[72:73], v200 offset:2048
    s_waitcnt vmcnt(18)
    v_mfma_f32_16x16x32_bf16 v[64:67], a[0:3], a[112:115], v[64:67]
    ds_read_b64_tr_b16 a[74:75], v200 offset:3072
    v_mfma_f32_16x16x32_bf16 v[68:71], a[4:7], a[112:115], v[68:71]
    s_add_u32 s47, s6, 28672
    buffer_load_dwordx4 a[220:223], v206, s[12:15], s47 offen sc1
    s_waitcnt vmcnt(18)
    v_mfma_f32_16x16x32_bf16 v[64:67], a[8:11], a[240:243], v[64:67]
    ds_read_b64_tr_b16 a[76:77], v201 offset:2048
    v_mfma_f32_16x16x32_bf16 v[68:71], a[12:15], a[240:243], v[68:71]
    ds_read_b64_tr_b16 a[78:79], v201 offset:3072
    v_mfma_f32_16x16x32_bf16 v[96:99], v[144:147], a[80:83], v[96:99]
    ds_read_b64_tr_b16 a[192:193], v232 offset:16384
    v_mfma_f32_16x16x32_bf16 v[96:99], v[152:155], a[208:211], v[96:99]
    s_add_u32 s47, s4, 45056
    buffer_load_dwordx4 a[44:47], v206, s[12:15], s47 offen sc1
    v_mfma_f32_16x16x32_bf16 v[96:99], v[160:163], a[32:35], v[96:99]
    ds_read_b64_tr_b16 a[194:195], v232 offset:17408
    v_mfma_f32_16x16x32_bf16 v[96:99], v[168:171], a[96:99], v[96:99]
    ds_read_b64_tr_b16 a[196:197], v233 offset:16384
    v_mfma_f32_16x16x32_bf16 v[96:99], v[176:179], a[224:227], v[96:99]
    ds_read_b64_tr_b16 a[198:199], v233 offset:17408
    v_mfma_f32_16x16x32_bf16 v[96:99], v[184:187], a[48:51], v[96:99]
    ds_read_b64_tr_b16 a[200:201], v232 offset:49152
    v_mfma_f32_16x16x32_bf16 v[96:99], v[212:215], a[112:115], v[96:99]
    s_add_u32 s47, s5, 45056
    buffer_load_dwordx4 a[108:111], v206, s[12:15], s47 offen sc1
    v_mfma_f32_16x16x32_bf16 v[96:99], v[220:223], a[240:243], v[96:99]
    v_cvt_pk_bf16_f32 v64, v64, v65
    v_cvt_pk_bf16_f32 v65, v66, v67
    v_mfma_f32_16x16x32_bf16 v[100:103], v[224:227], a[240:243], v[100:103]
    v_cvt_pk_bf16_f32 v66, v68, v69
    v_cvt_pk_bf16_f32 v67, v70, v71
    v_mfma_f32_16x16x32_bf16 v[100:103], v[216:219], a[112:115], v[100:103]
    s_xor_b32 s48, s8, 0
    s_cmp_eq_u32 s45, 0
    s_cselect_b32 s30, 0, 51380224
    v_mfma_f32_16x16x32_bf16 v[100:103], v[188:191], a[48:51], v[100:103]
    buffer_store_dwordx4 v[64:67], v206, s[28:31], s48 offen sc1
    v_mfma_f32_16x16x32_bf16 v[100:103], v[180:183], a[224:227], v[100:103]
    ds_read_b64_tr_b16 a[202:203], v232 offset:50176
    v_mfma_f32_16x16x32_bf16 v[100:103], v[172:175], a[96:99], v[100:103]
    ds_read_b64_tr_b16 a[204:205], v233 offset:49152
    v_mfma_f32_16x16x32_bf16 v[100:103], v[164:167], a[32:35], v[100:103]
    s_add_u32 s47, s6, 45056
    buffer_load_dwordx4 a[236:239], v206, s[12:15], s47 offen sc1
    v_mfma_f32_16x16x32_bf16 v[100:103], v[156:159], a[208:211], v[100:103]
    ds_read_b64_tr_b16 a[206:207], v233 offset:50176
    v_mfma_f32_16x16x32_bf16 v[100:103], v[148:151], a[80:83], v[100:103]
    ds_read_b64_tr_b16 a[16:17], v200 offset:16384
    s_waitcnt vmcnt(21)
    v_mfma_f32_16x16x32_bf16 v[72:75], a[144:147], a[84:87], v[72:75]
    s_add_u32 s47, s4, 61440
    buffer_load_dwordx4 a[60:63], v206, s[12:15], s47 offen sc1
    v_mfma_f32_16x16x32_bf16 v[76:79], a[148:151], a[84:87], v[76:79]
    ds_read_b64_tr_b16 a[18:19], v200 offset:17408
    s_waitcnt vmcnt(21)
    v_mfma_f32_16x16x32_bf16 v[72:75], a[152:155], a[212:215], v[72:75]
    ds_read_b64_tr_b16 a[20:21], v201 offset:16384
    v_mfma_f32_16x16x32_bf16 v[76:79], a[156:159], a[212:215], v[76:79]
    ds_read_b64_tr_b16 a[22:23], v201 offset:17408
    s_waitcnt vmcnt(20)
    v_mfma_f32_16x16x32_bf16 v[72:75], a[160:163], a[36:39], v[72:75]
    ds_read_b64_tr_b16 a[24:25], v232 offset:18432
    v_mfma_f32_16x16x32_bf16 v[76:79], a[164:167], a[36:39], v[76:79]
    s_add_u32 s47, s5, 61440
    buffer_load_dwordx4 a[124:127], v206, s[12:15], s47 offen sc1
    s_waitcnt vmcnt(20)
    v_mfma_f32_16x16x32_bf16 v[72:75], a[168:171], a[100:103], v[72:75]
    ds_read_b64_tr_b16 a[26:27], v232 offset:19456
    v_mfma_f32_16x16x32_bf16 v[76:79], a[172:175], a[100:103], v[76:79]
    v_cvt_pk_bf16_f32 v96, v96, v97
    v_cvt_pk_bf16_f32 v97, v98, v99
    s_waitcnt vmcnt(19)
    v_mfma_f32_16x16x32_bf16 v[72:75], a[176:179], a[228:231], v[72:75]
    v_cvt_pk_bf16_f32 v98, v100, v101
    v_cvt_pk_bf16_f32 v99, v102, v103
    v_mfma_f32_16x16x32_bf16 v[76:79], a[180:183], a[228:231], v[76:79]
    s_xor_b32 s48, s8, 16384
    s_waitcnt vmcnt(18)
    v_mfma_f32_16x16x32_bf16 v[72:75], a[184:187], a[52:55], v[72:75]
    buffer_store_dwordx4 v[96:99], v206, s[28:31], s48 offen sc1
    v_mfma_f32_16x16x32_bf16 v[76:79], a[188:191], a[52:55], v[76:79]
    ds_read_b64_tr_b16 a[28:29], v233 offset:18432
    s_waitcnt vmcnt(18)
    v_mfma_f32_16x16x32_bf16 v[72:75], a[0:3], a[116:119], v[72:75]
    ds_read_b64_tr_b16 a[30:31], v233 offset:19456
    v_mfma_f32_16x16x32_bf16 v[76:79], a[4:7], a[116:119], v[76:79]
    s_add_u32 s47, s6, 61440
    buffer_load_dwordx4 a[252:255], v206, s[12:15], s47 offen sc1
    s_waitcnt vmcnt(18)
    v_mfma_f32_16x16x32_bf16 v[72:75], a[8:11], a[244:247], v[72:75]
    ds_read_b64_tr_b16 a[128:129], v232 offset:51200
    v_mfma_f32_16x16x32_bf16 v[76:79], a[12:15], a[244:247], v[76:79]
    ds_read_b64_tr_b16 a[130:131], v232 offset:52224
    v_mfma_f32_16x16x32_bf16 v[104:107], v[144:147], a[84:87], v[104:107]
    global_load_dwordx2 v[192:193], v249, s[52:53] offset:0
    v_mfma_f32_16x16x32_bf16 v[104:107], v[152:155], a[212:215], v[104:107]
    ds_read_b64_tr_b16 a[132:133], v233 offset:51200
    v_mfma_f32_16x16x32_bf16 v[104:107], v[160:163], a[36:39], v[104:107]
    ds_read_b64_tr_b16 a[134:135], v233 offset:52224
    v_mfma_f32_16x16x32_bf16 v[104:107], v[168:171], a[100:103], v[104:107]
    ds_read_b64_tr_b16 a[136:137], v200 offset:18432
    v_mfma_f32_16x16x32_bf16 v[104:107], v[176:179], a[228:231], v[104:107]
    ds_read_b64_tr_b16 a[138:139], v200 offset:19456
    v_mfma_f32_16x16x32_bf16 v[104:107], v[184:187], a[52:55], v[104:107]
    global_load_dwordx2 v[194:195], v249, s[52:53] offset:32
    v_mfma_f32_16x16x32_bf16 v[104:107], v[212:215], a[116:119], v[104:107]
    ds_read_b64_tr_b16 a[140:141], v201 offset:18432
    v_mfma_f32_16x16x32_bf16 v[104:107], v[220:223], a[244:247], v[104:107]
    v_cvt_pk_bf16_f32 v72, v72, v73
    v_cvt_pk_bf16_f32 v73, v74, v75
    v_mfma_f32_16x16x32_bf16 v[108:111], v[224:227], a[244:247], v[108:111]
    v_cvt_pk_bf16_f32 v74, v76, v77
    v_cvt_pk_bf16_f32 v75, v78, v79
    v_mfma_f32_16x16x32_bf16 v[108:111], v[216:219], a[116:119], v[108:111]
    s_xor_b32 s48, s8, 5120
    v_mfma_f32_16x16x32_bf16 v[108:111], v[188:191], a[52:55], v[108:111]
    buffer_store_dwordx4 v[72:75], v206, s[28:31], s48 offen sc1
    v_mfma_f32_16x16x32_bf16 v[108:111], v[180:183], a[228:231], v[108:111]
    ds_read_b64_tr_b16 a[142:143], v201 offset:19456
    v_mfma_f32_16x16x32_bf16 v[108:111], v[172:175], a[100:103], v[108:111]
L_hop14:
    s_cbranch_execz L_ret3
    v_mfma_f32_16x16x32_bf16 v[108:111], v[164:167], a[36:39], v[108:111]
    global_load_dwordx2 v[208:209], v249, s[52:53] offset:64
    v_mfma_f32_16x16x32_bf16 v[108:111], v[156:159], a[212:215], v[108:111]
    v_mfma_f32_16x16x32_bf16 v[108:111], v[148:151], a[84:87], v[108:111]
    s_waitcnt vmcnt(21)
    v_mfma_f32_16x16x32_bf16 v[80:83], a[144:147], a[88:91], v[80:83]
    global_load_dwordx2 v[210:211], v249, s[52:53] offset:96
    v_mfma_f32_16x16x32_bf16 v[84:87], a[148:151], a[88:91], v[84:87]
    s_waitcnt vmcnt(21)
    v_mfma_f32_16x16x32_bf16 v[80:83], a[152:155], a[216:219], v[80:83]
    v_mfma_f32_16x16x32_bf16 v[84:87], a[156:159], a[216:219], v[84:87]
    s_waitcnt vmcnt(20)
    v_mfma_f32_16x16x32_bf16 v[80:83], a[160:163], a[40:43], v[80:83]
    v_mfma_f32_16x16x32_bf16 v[84:87], a[164:167], a[40:43], v[84:87]
    s_waitcnt vmcnt(19)
    v_mfma_f32_16x16x32_bf16 v[80:83], a[168:171], a[104:107], v[80:83]
    v_mfma_f32_16x16x32_bf16 v[84:87], a[172:175], a[104:107], v[84:87]
    v_cvt_pk_bf16_f32 v104, v104, v105
    v_cvt_pk_bf16_f32 v105, v106, v107
    s_waitcnt vmcnt(18)
    v_mfma_f32_16x16x32_bf16 v[80:83], a[176:179], a[232:235], v[80:83]
    v_cvt_pk_bf16_f32 v106, v108, v109
    v_cvt_pk_bf16_f32 v107, v110, v111
    v_mfma_f32_16x16x32_bf16 v[84:87], a[180:183], a[232:235], v[84:87]
    s_xor_b32 s48, s8, 21504
    s_waitcnt vmcnt(17)
    v_mfma_f32_16x16x32_bf16 v[80:83], a[184:187], a[56:59], v[80:83]
    buffer_store_dwordx4 v[104:107], v206, s[28:31], s48 offen sc1
    v_mfma_f32_16x16x32_bf16 v[84:87], a[188:191], a[56:59], v[84:87]
    s_waitcnt vmcnt(17)
    v_mfma_f32_16x16x32_bf16 v[80:83], a[0:3], a[120:123], v[80:83]
    v_mfma_f32_16x16x32_bf16 v[84:87], a[4:7], a[120:123], v[84:87]
    s_waitcnt vmcnt(16)
    v_mfma_f32_16x16x32_bf16 v[80:83], a[8:11], a[248:251], v[80:83]
    v_mfma_f32_16x16x32_bf16 v[84:87], a[12:15], a[248:251], v[84:87]
    v_mfma_f32_16x16x32_bf16 v[112:115], v[144:147], a[88:91], v[112:115]
    v_mfma_f32_16x16x32_bf16 v[112:115], v[152:155], a[216:219], v[112:115]
    v_mfma_f32_16x16x32_bf16 v[112:115], v[160:163], a[40:43], v[112:115]
    v_mfma_f32_16x16x32_bf16 v[112:115], v[168:171], a[104:107], v[112:115]
    v_mfma_f32_16x16x32_bf16 v[112:115], v[176:179], a[232:235], v[112:115]
    v_mfma_f32_16x16x32_bf16 v[112:115], v[184:187], a[56:59], v[112:115]
    v_mfma_f32_16x16x32_bf16 v[112:115], v[212:215], a[120:123], v[112:115]
    v_mfma_f32_16x16x32_bf16 v[112:115], v[220:223], a[248:251], v[112:115]
    v_cvt_pk_bf16_f32 v80, v80, v81
    v_cvt_pk_bf16_f32 v81, v82, v83
    v_mfma_f32_16x16x32_bf16 v[116:119], v[224:227], a[248:251], v[116:119]
    v_cvt_pk_bf16_f32 v82, v84, v85
    v_cvt_pk_bf16_f32 v83, v86, v87
    v_mfma_f32_16x16x32_bf16 v[116:119], v[216:219], a[120:123], v[116:119]
    s_xor_b32 s48, s8, 10240
    v_mfma_f32_16x16x32_bf16 v[116:119], v[188:191], a[56:59], v[116:119]
    buffer_store_dwordx4 v[80:83], v206, s[28:31], s48 offen sc1
    v_mfma_f32_16x16x32_bf16 v[116:119], v[180:183], a[232:235], v[116:119]
    v_mfma_f32_16x16x32_bf16 v[116:119], v[172:175], a[104:107], v[116:119]
    v_mfma_f32_16x16x32_bf16 v[116:119], v[164:167], a[40:43], v[116:119]
    v_mfma_f32_16x16x32_bf16 v[116:119], v[156:159], a[216:219], v[116:119]
    v_mfma_f32_16x16x32_bf16 v[116:119], v[148:151], a[88:91], v[116:119]
    s_waitcnt vmcnt(16)
    v_mfma_f32_16x16x32_bf16 v[88:91], a[144:147], a[92:95], v[88:91]
    v_mfma_f32_16x16x32_bf16 v[92:95], a[148:151], a[92:95], v[92:95]
    s_waitcnt vmcnt(15)
    v_mfma_f32_16x16x32_bf16 v[88:91], a[152:155], a[220:223], v[88:91]
    v_mfma_f32_16x16x32_bf16 v[92:95], a[156:159], a[220:223], v[92:95]
    s_waitcnt vmcnt(14)
    v_mfma_f32_16x16x32_bf16 v[88:91], a[160:163], a[44:47], v[88:91]
    v_mfma_f32_16x16x32_bf16 v[92:95], a[164:167], a[44:47], v[92:95]
    s_waitcnt vmcnt(13)
    v_mfma_f32_16x16x32_bf16 v[88:91], a[168:171], a[108:111], v[88:91]
    v_mfma_f32_16x16x32_bf16 v[92:95], a[172:175], a[108:111], v[92:95]
    v_cvt_pk_bf16_f32 v112, v112, v113
    v_cvt_pk_bf16_f32 v113, v114, v115
    s_waitcnt vmcnt(11)
    v_mfma_f32_16x16x32_bf16 v[88:91], a[176:179], a[236:239], v[88:91]
    v_cvt_pk_bf16_f32 v114, v116, v117
    v_cvt_pk_bf16_f32 v115, v118, v119
    v_mfma_f32_16x16x32_bf16 v[92:95], a[180:183], a[236:239], v[92:95]
    s_xor_b32 s48, s8, 26624
    s_waitcnt vmcnt(10)
    v_mfma_f32_16x16x32_bf16 v[88:91], a[184:187], a[60:63], v[88:91]
    buffer_store_dwordx4 v[112:115], v206, s[28:31], s48 offen sc1
    v_mfma_f32_16x16x32_bf16 v[92:95], a[188:191], a[60:63], v[92:95]
    s_waitcnt vmcnt(10)
    v_mfma_f32_16x16x32_bf16 v[88:91], a[0:3], a[124:127], v[88:91]
    v_mfma_f32_16x16x32_bf16 v[92:95], a[4:7], a[124:127], v[92:95]
    s_waitcnt vmcnt(8)
    v_mfma_f32_16x16x32_bf16 v[88:91], a[8:11], a[252:255], v[88:91]
    v_mfma_f32_16x16x32_bf16 v[92:95], a[12:15], a[252:255], v[92:95]
    v_mfma_f32_16x16x32_bf16 v[120:123], v[144:147], a[92:95], v[120:123]
    v_mfma_f32_16x16x32_bf16 v[120:123], v[152:155], a[220:223], v[120:123]
    v_mfma_f32_16x16x32_bf16 v[120:123], v[160:163], a[44:47], v[120:123]
    v_mfma_f32_16x16x32_bf16 v[120:123], v[168:171], a[108:111], v[120:123]
    v_mfma_f32_16x16x32_bf16 v[120:123], v[176:179], a[236:239], v[120:123]
    v_mfma_f32_16x16x32_bf16 v[120:123], v[184:187], a[60:63], v[120:123]
    v_mfma_f32_16x16x32_bf16 v[120:123], v[212:215], a[124:127], v[120:123]
    v_mfma_f32_16x16x32_bf16 v[120:123], v[220:223], a[252:255], v[120:123]
    v_cvt_pk_bf16_f32 v88, v88, v89
    v_cvt_pk_bf16_f32 v89, v90, v91
    v_mfma_f32_16x16x32_bf16 v[124:127], v[224:227], a[252:255], v[124:127]
    v_cvt_pk_bf16_f32 v90, v92, v93
    v_cvt_pk_bf16_f32 v91, v94, v95
    v_mfma_f32_16x16x32_bf16 v[124:127], v[216:219], a[124:127], v[124:127]
    s_xor_b32 s48, s8, 15360
    v_mfma_f32_16x16x32_bf16 v[124:127], v[188:191], a[60:63], v[124:127]
    buffer_store_dwordx4 v[88:91], v206, s[28:31], s48 offen sc1
    v_mfma_f32_16x16x32_bf16 v[124:127], v[180:183], a[236:239], v[124:127]
    v_mfma_f32_16x16x32_bf16 v[124:127], v[172:175], a[108:111], v[124:127]
    v_mfma_f32_16x16x32_bf16 v[124:127], v[164:167], a[44:47], v[124:127]
    v_mfma_f32_16x16x32_bf16 v[124:127], v[156:159], a[220:223], v[124:127]
    v_mfma_f32_16x16x32_bf16 v[124:127], v[148:151], a[92:95], v[124:127]
    s_waitcnt lgkmcnt(0)
    v_mfma_f32_16x16x32_bf16 v[0:3], a[64:67], a[80:83], v[0:3]
    v_mfma_f32_16x16x32_bf16 v[0:3], a[72:75], a[208:211], v[0:3]
    v_mfma_f32_16x16x32_bf16 v[0:3], a[192:195], a[32:35], v[0:3]
    ds_read_b64_tr_b16 a[144:145], v234 offset:34816
    v_mfma_f32_16x16x32_bf16 v[0:3], a[200:203], a[96:99], v[0:3]
    ds_read_b64_tr_b16 a[146:147], v234 offset:35840
    v_mfma_f32_16x16x32_bf16 v[0:3], a[16:19], a[224:227], v[0:3]
    ds_read_b64_tr_b16 a[148:149], v235 offset:34816
    v_mfma_f32_16x16x32_bf16 v[0:3], a[24:27], a[48:51], v[0:3]
    ds_read_b64_tr_b16 a[150:151], v235 offset:35840
    v_mfma_f32_16x16x32_bf16 v[0:3], a[128:131], a[112:115], v[0:3]
    ds_read_b64_tr_b16 a[152:153], v202 offset:2048
    v_mfma_f32_16x16x32_bf16 v[0:3], a[136:139], a[240:243], v[0:3]
    v_cvt_pk_bf16_f32 v120, v120, v121
    v_cvt_pk_bf16_f32 v121, v122, v123
    v_mfma_f32_16x16x32_bf16 v[4:7], a[140:143], a[240:243], v[4:7]
    v_cvt_pk_bf16_f32 v122, v124, v125
    v_cvt_pk_bf16_f32 v123, v126, v127
    v_mfma_f32_16x16x32_bf16 v[4:7], a[132:135], a[112:115], v[4:7]
    s_xor_b32 s48, s8, 31744
    v_mfma_f32_16x16x32_bf16 v[4:7], a[28:31], a[48:51], v[4:7]
    buffer_store_dwordx4 v[120:123], v206, s[28:31], s48 offen sc1
    v_mfma_f32_16x16x32_bf16 v[4:7], a[20:23], a[224:227], v[4:7]
    ds_read_b64_tr_b16 a[154:155], v202 offset:3072
    v_mfma_f32_16x16x32_bf16 v[4:7], a[204:207], a[96:99], v[4:7]
    ds_read_b64_tr_b16 a[156:157], v203 offset:2048
    v_mfma_f32_16x16x32_bf16 v[4:7], a[196:199], a[32:35], v[4:7]
    ds_read_b64_tr_b16 a[158:159], v203 offset:3072
    v_mfma_f32_16x16x32_bf16 v[4:7], a[76:79], a[208:211], v[4:7]
    ds_read_b64_tr_b16 a[160:161], v234 offset:16384
    v_mfma_f32_16x16x32_bf16 v[4:7], a[68:71], a[80:83], v[4:7]
    ds_read_b64_tr_b16 a[162:163], v234 offset:17408
    v_mfma_f32_16x16x32_bf16 v[8:11], a[64:67], a[84:87], v[8:11]
    ds_read_b64_tr_b16 a[164:165], v235 offset:16384
    v_mfma_f32_16x16x32_bf16 v[8:11], a[72:75], a[212:215], v[8:11]
    ds_read_b64_tr_b16 a[166:167], v235 offset:17408
    v_mfma_f32_16x16x32_bf16 v[8:11], a[192:195], a[36:39], v[8:11]
    ds_read_b64_tr_b16 a[168:169], v234 offset:49152
    v_mfma_f32_16x16x32_bf16 v[8:11], a[200:203], a[100:103], v[8:11]
    ds_read_b64_tr_b16 a[170:171], v234 offset:50176
    v_mfma_f32_16x16x32_bf16 v[8:11], a[16:19], a[228:231], v[8:11]
    ds_read_b64_tr_b16 a[172:173], v235 offset:49152
    v_mfma_f32_16x16x32_bf16 v[8:11], a[24:27], a[52:55], v[8:11]
    ds_read_b64_tr_b16 a[174:175], v235 offset:50176
    v_mfma_f32_16x16x32_bf16 v[8:11], a[128:131], a[116:119], v[8:11]
    ds_read_b64_tr_b16 a[176:177], v202 offset:16384
    v_mfma_f32_16x16x32_bf16 v[8:11], a[136:139], a[244:247], v[8:11]
    v_cvt_pk_bf16_f32 v0, v0, v1
    v_cvt_pk_bf16_f32 v1, v2, v3
    v_mfma_f32_16x16x32_bf16 v[12:15], a[140:143], a[244:247], v[12:15]
    v_cvt_pk_bf16_f32 v2, v4, v5
    v_cvt_pk_bf16_f32 v3, v6, v7
    v_mfma_f32_16x16x32_bf16 v[12:15], a[132:135], a[116:119], v[12:15]
    s_xor_b32 s48, s8, 32768
    s_cmp_eq_u32 s45, 1
    s_cselect_b32 s30, 0, 51380224
    v_mfma_f32_16x16x32_bf16 v[12:15], a[28:31], a[52:55], v[12:15]
    buffer_store_dwordx4 v[0:3], v206, s[28:31], s48 offen sc1
    v_mfma_f32_16x16x32_bf16 v[12:15], a[20:23], a[228:231], v[12:15]
    ds_read_b64_tr_b16 a[178:179], v202 offset:17408
    v_mfma_f32_16x16x32_bf16 v[12:15], a[204:207], a[100:103], v[12:15]
    ds_read_b64_tr_b16 a[180:181], v203 offset:16384
    v_mfma_f32_16x16x32_bf16 v[12:15], a[196:199], a[36:39], v[12:15]
    ds_read_b64_tr_b16 a[182:183], v203 offset:17408
    v_mfma_f32_16x16x32_bf16 v[12:15], a[76:79], a[212:215], v[12:15]
    ds_read_b64_tr_b16 a[184:185], v234 offset:18432
    v_mfma_f32_16x16x32_bf16 v[12:15], a[68:71], a[84:87], v[12:15]
    ds_read_b64_tr_b16 a[186:187], v234 offset:19456
    v_mfma_f32_16x16x32_bf16 v[16:19], a[64:67], a[88:91], v[16:19]
    ds_read_b64_tr_b16 a[188:189], v235 offset:18432
    v_mfma_f32_16x16x32_bf16 v[16:19], a[72:75], a[216:219], v[16:19]
    ds_read_b64_tr_b16 a[190:191], v235 offset:19456
    v_mfma_f32_16x16x32_bf16 v[16:19], a[192:195], a[40:43], v[16:19]
    ds_read_b64_tr_b16 a[0:1], v234 offset:51200
    v_mfma_f32_16x16x32_bf16 v[16:19], a[200:203], a[104:107], v[16:19]
    ds_read_b64_tr_b16 a[2:3], v234 offset:52224
    v_mfma_f32_16x16x32_bf16 v[16:19], a[16:19], a[232:235], v[16:19]
    ds_read_b64_tr_b16 a[4:5], v235 offset:51200
    v_mfma_f32_16x16x32_bf16 v[16:19], a[24:27], a[56:59], v[16:19]
    ds_read_b64_tr_b16 a[6:7], v235 offset:52224
    v_mfma_f32_16x16x32_bf16 v[16:19], a[128:131], a[120:123], v[16:19]
    ds_read_b64_tr_b16 a[8:9], v202 offset:18432
    v_mfma_f32_16x16x32_bf16 v[16:19], a[136:139], a[248:251], v[16:19]
    v_cvt_pk_bf16_f32 v8, v8, v9
    v_cvt_pk_bf16_f32 v9, v10, v11
    v_mfma_f32_16x16x32_bf16 v[20:23], a[140:143], a[248:251], v[20:23]
    v_cvt_pk_bf16_f32 v10, v12, v13
    v_cvt_pk_bf16_f32 v11, v14, v15
    v_mfma_f32_16x16x32_bf16 v[20:23], a[132:135], a[120:123], v[20:23]
    s_xor_b32 s48, s8, 37888
    v_mfma_f32_16x16x32_bf16 v[20:23], a[28:31], a[56:59], v[20:23]
    buffer_store_dwordx4 v[8:11], v206, s[28:31], s48 offen sc1
    v_mfma_f32_16x16x32_bf16 v[20:23], a[20:23], a[232:235], v[20:23]
    ds_read_b64_tr_b16 a[10:11], v202 offset:19456
    v_mfma_f32_16x16x32_bf16 v[20:23], a[204:207], a[104:107], v[20:23]
    ds_read_b64_tr_b16 a[12:13], v203 offset:18432
    v_mfma_f32_16x16x32_bf16 v[20:23], a[196:199], a[40:43], v[20:23]
    ds_read_b64_tr_b16 a[14:15], v203 offset:19456
    v_mfma_f32_16x16x32_bf16 v[20:23], a[76:79], a[216:219], v[20:23]
    v_mfma_f32_16x16x32_bf16 v[20:23], a[68:71], a[88:91], v[20:23]
    v_mfma_f32_16x16x32_bf16 v[24:27], a[64:67], a[92:95], v[24:27]
    v_mfma_f32_16x16x32_bf16 v[24:27], a[72:75], a[220:223], v[24:27]
    v_mfma_f32_16x16x32_bf16 v[24:27], a[192:195], a[44:47], v[24:27]
    v_mfma_f32_16x16x32_bf16 v[24:27], a[200:203], a[108:111], v[24:27]
    v_mfma_f32_16x16x32_bf16 v[24:27], a[16:19], a[236:239], v[24:27]
    v_mfma_f32_16x16x32_bf16 v[24:27], a[24:27], a[60:63], v[24:27]
    v_mfma_f32_16x16x32_bf16 v[24:27], a[128:131], a[124:127], v[24:27]
    v_mfma_f32_16x16x32_bf16 v[24:27], a[136:139], a[252:255], v[24:27]
    v_cvt_pk_bf16_f32 v16, v16, v17
    v_cvt_pk_bf16_f32 v17, v18, v19
    v_mfma_f32_16x16x32_bf16 v[28:31], a[140:143], a[252:255], v[28:31]
    v_cvt_pk_bf16_f32 v18, v20, v21
    v_cvt_pk_bf16_f32 v19, v22, v23
    v_mfma_f32_16x16x32_bf16 v[28:31], a[132:135], a[124:127], v[28:31]
    s_xor_b32 s48, s8, 43008
    v_mfma_f32_16x16x32_bf16 v[28:31], a[28:31], a[60:63], v[28:31]
    buffer_store_dwordx4 v[16:19], v206, s[28:31], s48 offen sc1
    v_mfma_f32_16x16x32_bf16 v[28:31], a[20:23], a[236:239], v[28:31]
    v_mfma_f32_16x16x32_bf16 v[28:31], a[204:207], a[108:111], v[28:31]
    v_mfma_f32_16x16x32_bf16 v[28:31], a[196:199], a[44:47], v[28:31]
    v_mfma_f32_16x16x32_bf16 v[28:31], a[76:79], a[220:223], v[28:31]
    v_mfma_f32_16x16x32_bf16 v[28:31], a[68:71], a[92:95], v[28:31]
    s_waitcnt lgkmcnt(0)
    v_mfma_f32_16x16x32_bf16 v[32:35], a[144:147], a[80:83], v[32:35]
    v_mfma_f32_16x16x32_bf16 v[32:35], a[152:155], a[208:211], v[32:35]
    v_mfma_f32_16x16x32_bf16 v[32:35], a[160:163], a[32:35], v[32:35]
    v_mfma_f32_16x16x32_bf16 v[32:35], a[168:171], a[96:99], v[32:35]
    v_mfma_f32_16x16x32_bf16 v[32:35], a[176:179], a[224:227], v[32:35]
    v_mfma_f32_16x16x32_bf16 v[32:35], a[184:187], a[48:51], v[32:35]
    v_mfma_f32_16x16x32_bf16 v[32:35], a[0:3], a[112:115], v[32:35]
    v_mfma_f32_16x16x32_bf16 v[32:35], a[8:11], a[240:243], v[32:35]
    v_cvt_pk_bf16_f32 v24, v24, v25
    v_cvt_pk_bf16_f32 v25, v26, v27
    v_mfma_f32_16x16x32_bf16 v[36:39], a[12:15], a[240:243], v[36:39]
    v_cvt_pk_bf16_f32 v26, v28, v29
    v_cvt_pk_bf16_f32 v27, v30, v31
    v_mfma_f32_16x16x32_bf16 v[36:39], a[4:7], a[112:115], v[36:39]
    s_xor_b32 s48, s8, 48128
    v_mfma_f32_16x16x32_bf16 v[36:39], a[188:191], a[48:51], v[36:39]
    buffer_store_dwordx4 v[24:27], v206, s[28:31], s48 offen sc1
    v_mfma_f32_16x16x32_bf16 v[36:39], a[180:183], a[224:227], v[36:39]
    v_mfma_f32_16x16x32_bf16 v[36:39], a[172:175], a[96:99], v[36:39]
    v_mfma_f32_16x16x32_bf16 v[36:39], a[164:167], a[32:35], v[36:39]
    v_mfma_f32_16x16x32_bf16 v[36:39], a[156:159], a[208:211], v[36:39]
    buffer_load_dword v252, v251, s[12:15], s65 offen sc1
    v_mfma_f32_16x16x32_bf16 v[36:39], a[148:151], a[80:83], v[36:39]
    v_mfma_f32_16x16x32_bf16 v[40:43], a[144:147], a[84:87], v[40:43]
    v_mfma_f32_16x16x32_bf16 v[40:43], a[152:155], a[212:215], v[40:43]
    v_mfma_f32_16x16x32_bf16 v[40:43], a[160:163], a[36:39], v[40:43]
    v_mfma_f32_16x16x32_bf16 v[40:43], a[168:171], a[100:103], v[40:43]
    v_mfma_f32_16x16x32_bf16 v[40:43], a[176:179], a[228:231], v[40:43]
    v_mfma_f32_16x16x32_bf16 v[40:43], a[184:187], a[52:55], v[40:43]
    v_mfma_f32_16x16x32_bf16 v[40:43], a[0:3], a[116:119], v[40:43]
    v_mfma_f32_16x16x32_bf16 v[40:43], a[8:11], a[244:247], v[40:43]
    v_cvt_pk_bf16_f32 v32, v32, v33
    v_cvt_pk_bf16_f32 v33, v34, v35
    v_mfma_f32_16x16x32_bf16 v[44:47], a[12:15], a[244:247], v[44:47]
    v_cvt_pk_bf16_f32 v34, v36, v37
    v_cvt_pk_bf16_f32 v35, v38, v39
    v_mfma_f32_16x16x32_bf16 v[44:47], a[4:7], a[116:119], v[44:47]
    s_xor_b32 s48, s8, 49152
    v_mfma_f32_16x16x32_bf16 v[44:47], a[188:191], a[52:55], v[44:47]
    buffer_store_dwordx4 v[32:35], v206, s[28:31], s48 offen sc1
    v_mfma_f32_16x16x32_bf16 v[44:47], a[180:183], a[228:231], v[44:47]
    v_mfma_f32_16x16x32_bf16 v[44:47], a[172:175], a[100:103], v[44:47]
    v_mfma_f32_16x16x32_bf16 v[44:47], a[164:167], a[36:39], v[44:47]
    v_mfma_f32_16x16x32_bf16 v[44:47], a[156:159], a[212:215], v[44:47]
    v_mfma_f32_16x16x32_bf16 v[44:47], a[148:151], a[84:87], v[44:47]
    v_mfma_f32_16x16x32_bf16 v[48:51], a[144:147], a[88:91], v[48:51]
    v_mfma_f32_16x16x32_bf16 v[48:51], a[152:155], a[216:219], v[48:51]
    v_mfma_f32_16x16x32_bf16 v[48:51], a[160:163], a[40:43], v[48:51]
    v_mfma_f32_16x16x32_bf16 v[48:51], a[168:171], a[104:107], v[48:51]
    v_mfma_f32_16x16x32_bf16 v[48:51], a[176:179], a[232:235], v[48:51]
    v_mfma_f32_16x16x32_bf16 v[48:51], a[184:187], a[56:59], v[48:51]
    v_mfma_f32_16x16x32_bf16 v[48:51], a[0:3], a[120:123], v[48:51]
    v_mfma_f32_16x16x32_bf16 v[48:51], a[8:11], a[248:251], v[48:51]
    v_cvt_pk_bf16_f32 v40, v40, v41
    v_cvt_pk_bf16_f32 v41, v42, v43
    v_mfma_f32_16x16x32_bf16 v[52:55], a[12:15], a[248:251], v[52:55]
    v_cvt_pk_bf16_f32 v42, v44, v45
    v_cvt_pk_bf16_f32 v43, v46, v47
    v_mfma_f32_16x16x32_bf16 v[52:55], a[4:7], a[120:123], v[52:55]
    s_xor_b32 s48, s8, 54272
    v_mfma_f32_16x16x32_bf16 v[52:55], a[188:191], a[56:59], v[52:55]
    buffer_store_dwordx4 v[40:43], v206, s[28:31], s48 offen sc1
    v_mfma_f32_16x16x32_bf16 v[52:55], a[180:183], a[232:235], v[52:55]
    v_mfma_f32_16x16x32_bf16 v[52:55], a[172:175], a[104:107], v[52:55]
    v_mfma_f32_16x16x32_bf16 v[52:55], a[164:167], a[40:43], v[52:55]
    v_mfma_f32_16x16x32_bf16 v[52:55], a[156:159], a[216:219], v[52:55]
    v_mfma_f32_16x16x32_bf16 v[52:55], a[148:151], a[88:91], v[52:55]
    v_mfma_f32_16x16x32_bf16 v[56:59], a[144:147], a[92:95], v[56:59]
    v_mfma_f32_16x16x32_bf16 v[56:59], a[152:155], a[220:223], v[56:59]
    v_mfma_f32_16x16x32_bf16 v[56:59], a[160:163], a[44:47], v[56:59]
    v_mfma_f32_16x16x32_bf16 v[56:59], a[168:171], a[108:111], v[56:59]
    v_mfma_f32_16x16x32_bf16 v[56:59], a[176:179], a[236:239], v[56:59]
    v_mfma_f32_16x16x32_bf16 v[56:59], a[184:187], a[60:63], v[56:59]
    v_mfma_f32_16x16x32_bf16 v[56:59], a[0:3], a[124:127], v[56:59]
    v_mfma_f32_16x16x32_bf16 v[56:59], a[8:11], a[252:255], v[56:59]
    v_cvt_pk_bf16_f32 v48, v48, v49
    v_cvt_pk_bf16_f32 v49, v50, v51
    v_mfma_f32_16x16x32_bf16 v[60:63], a[12:15], a[252:255], v[60:63]
    v_cvt_pk_bf16_f32 v50, v52, v53
    v_cvt_pk_bf16_f32 v51, v54, v55
    v_mfma_f32_16x16x32_bf16 v[60:63], a[4:7], a[124:127], v[60:63]
    s_xor_b32 s48, s8, 59392
    v_mfma_f32_16x16x32_bf16 v[60:63], a[188:191], a[60:63], v[60:63]
    buffer_store_dwordx4 v[48:51], v206, s[28:31], s48 offen sc1
    v_mfma_f32_16x16x32_bf16 v[60:63], a[180:183], a[236:239], v[60:63]
    v_mfma_f32_16x16x32_bf16 v[60:63], a[172:175], a[108:111], v[60:63]
    v_mfma_f32_16x16x32_bf16 v[60:63], a[164:167], a[44:47], v[60:63]
    v_mfma_f32_16x16x32_bf16 v[60:63], a[156:159], a[220:223], v[60:63]
    v_mfma_f32_16x16x32_bf16 v[60:63], a[148:151], a[92:95], v[60:63]
    s_lshl_b32 s47, s33, 10
    s_add_u32 s47, s47, 98304
    v_add_u32 v253, s47, v206
    v_add_u32 v248, 98304, v206
    s_lshl_b32 s44, 1, s39
    s_andn2_b32 s44, 0xff, s44
    s_xor_b32 s48, s8, 64512
    s_nop 1
    v_cvt_pk_bf16_f32 v56, v56, v57
    v_cvt_pk_bf16_f32 v57, v58, v59
    v_cvt_pk_bf16_f32 v58, v60, v61
    v_cvt_pk_bf16_f32 v59, v62, v63
    buffer_store_dwordx4 v[56:59], v206, s[28:31], s48 offen sc1
    s_cmp_eq_u32 s45, 0
    s_cbranch_scc0 L_own0
    ds_write_b128 v248, v[64:67] offset:0
    ds_write_b128 v248, v[72:75] offset:1024
    ds_write_b128 v248, v[80:83] offset:2048
    ds_write_b128 v248, v[88:91] offset:3072
    ds_write_b128 v248, v[96:99] offset:4096
    ds_write_b128 v248, v[104:107] offset:5120
    ds_write_b128 v248, v[112:115] offset:6144
    ds_write_b128 v248, v[120:123] offset:7168
L_own0:
    s_cmp_eq_u32 s45, 1
    s_cbranch_scc0 L_own1
    ds_write_b128 v248, v[0:3] offset:0
    ds_write_b128 v248, v[8:11] offset:1024
    ds_write_b128 v248, v[16:19] offset:2048
    ds_write_b128 v248, v[24:27] offset:3072
    ds_write_b128 v248, v[32:35] offset:4096
    ds_write_b128 v248, v[40:43] offset:5120
    ds_write_b128 v248, v[48:51] offset:6144
    ds_write_b128 v248, v[56:59] offset:7168
L_own1:
    s_waitcnt vmcnt(4)
    v_cmp_le_u32 vcc, 1, v252
    s_nop 3
    s_and_b32 s38, vcc_lo, s44
    s_bitcmp1_b32 s38, 0
    s_cselect_b32 s30, 51380224, 0
    s_add_u32 s47, s9, 0
    buffer_load_dwordx4 v[144:147], v206, s[28:31], s47 offen sc1
    s_add_u32 s47, s9, 16384
    buffer_load_dwordx4 v[148:151], v206, s[28:31], s47 offen sc1
    s_bitcmp1_b32 s38, 1
    s_cselect_b32 s30, 51380224, 0
    s_add_u32 s47, s9, 65536
    buffer_load_dwordx4 v[152:155], v206, s[28:31], s47 offen sc1
    s_add_u32 s47, s9, 81920
    buffer_load_dwordx4 v[156:159], v206, s[28:31], s47 offen sc1
    s_waitcnt lgkmcnt(0)
    s_barrier
    ds_read_b128 v[112:115], v253 offset:0
    ds_read_b128 v[116:119], v253 offset:4096
    v_lshlrev_b32 v96, 16, v192
    v_and_b32 v97, 0xffff0000, v192
    v_lshlrev_b32 v98, 16, v193
    v_and_b32 v99, 0xffff0000, v193
    v_lshlrev_b32 v100, 16, v194
    v_and_b32 v101, 0xffff0000, v194
    v_lshlrev_b32 v102, 16, v195
    v_and_b32 v103, 0xffff0000, v195
    v_lshlrev_b32 v104, 16, v208
    v_and_b32 v105, 0xffff0000, v208
    v_lshlrev_b32 v106, 16, v209
    v_and_b32 v107, 0xffff0000, v209
    v_lshlrev_b32 v108, 16, v210
    v_and_b32 v109, 0xffff0000, v210
    v_lshlrev_b32 v110, 16, v211
    v_and_b32 v111, 0xffff0000, v211
    s_waitcnt lgkmcnt(0)
    v_lshlrev_b32 v64, 16, v112
    v_and_b32 v65, 0xffff0000, v112
    v_lshlrev_b32 v66, 16, v113
    v_and_b32 v67, 0xffff0000, v113
    v_lshlrev_b32 v68, 16, v114
    v_and_b32 v69, 0xffff0000, v114
    v_lshlrev_b32 v70, 16, v115
    v_and_b32 v71, 0xffff0000, v115
    v_lshlrev_b32 v72, 16, v116
    v_and_b32 v73, 0xffff0000, v116
    v_lshlrev_b32 v74, 16, v117
    v_and_b32 v75, 0xffff0000, v117
    v_lshlrev_b32 v76, 16, v118
    v_and_b32 v77, 0xffff0000, v118
    v_lshlrev_b32 v78, 16, v119
    v_and_b32 v79, 0xffff0000, v119
    s_waitcnt vmcnt(4)
    buffer_store_dword v246, v245, s[12:15], s1 offen sc1
    s_bitcmp1_b32 s38, 2
    s_cselect_b32 s30, 51380224, 0
    s_add_u32 s47, s9, 131072
    buffer_load_dwordx4 v[160:163], v206, s[28:31], s47 offen sc1
    s_add_u32 s47, s9, 147456
    buffer_load_dwordx4 v[164:167], v206, s[28:31], s47 offen sc1
    s_bitcmp1_b32 s38, 3
    s_cselect_b32 s30, 51380224, 0
    s_add_u32 s47, s9, 196608
    buffer_load_dwordx4 v[168:171], v206, s[28:31], s47 offen sc1
    s_add_u32 s47, s9, 212992
    buffer_load_dwordx4 v[172:175], v206, s[28:31], s47 offen sc1
    s_bitcmp1_b32 s38, 4
    s_cselect_b32 s30, 51380224, 0
    s_add_u32 s47, s9, 262144
    buffer_load_dwordx4 v[176:179], v206, s[28:31], s47 offen sc1
    s_add_u32 s47, s9, 278528
    buffer_load_dwordx4 v[180:183], v206, s[28:31], s47 offen sc1
    s_bitcmp1_b32 s38, 5
    s_cselect_b32 s30, 51380224, 0
    s_add_u32 s47, s9, 327680
    buffer_load_dwordx4 v[184:187], v206, s[28:31], s47 offen sc1
    s_add_u32 s47, s9, 344064
    buffer_load_dwordx4 v[188:191], v206, s[28:31], s47 offen sc1
    s_bitcmp1_b32 s38, 6
    s_cselect_b32 s30, 51380224, 0
    s_add_u32 s47, s9, 393216
    buffer_load_dwordx4 v[212:215], v206, s[28:31], s47 offen sc1
    s_add_u32 s47, s9, 409600
    buffer_load_dwordx4 v[216:219], v206, s[28:31], s47 offen sc1
    s_bitcmp1_b32 s38, 7
    s_cselect_b32 s30, 51380224, 0
    s_add_u32 s47, s9, 458752
    buffer_load_dwordx4 v[220:223], v206, s[28:31], s47 offen sc1
    s_add_u32 s47, s9, 475136
    buffer_load_dwordx4 v[224:227], v206, s[28:31], s47 offen sc1
    buffer_load_dword v252, v251, s[12:15], s65 offen sc1
    s_waitcnt vmcnt(16)
    v_lshlrev_b32 v80, 16, v144
    v_and_b32 v81, 0xffff0000, v144
    v_lshlrev_b32 v82, 16, v145
    v_and_b32 v83, 0xffff0000, v145
    v_lshlrev_b32 v84, 16, v146
    v_and_b32 v85, 0xffff0000, v146
    v_lshlrev_b32 v86, 16, v147
    v_and_b32 v87, 0xffff0000, v147
    v_lshlrev_b32 v88, 16, v148
    v_and_b32 v89, 0xffff0000, v148
    v_lshlrev_b32 v90, 16, v149
    v_and_b32 v91, 0xffff0000, v149
    v_lshlrev_b32 v92, 16, v150
    v_and_b32 v93, 0xffff0000, v150
    v_lshlrev_b32 v94, 16, v151
    v_and_b32 v95, 0xffff0000, v151
    v_pk_add_f32 v[64:65], v[64:65], v[80:81] op_sel:[0,0] op_sel_hi:[1,1]
    v_pk_add_f32 v[66:67], v[66:67], v[82:83] op_sel:[0,0] op_sel_hi:[1,1]
    v_pk_add_f32 v[68:69], v[68:69], v[84:85] op_sel:[0,0] op_sel_hi:[1,1]
    v_pk_add_f32 v[70:71], v[70:71], v[86:87] op_sel:[0,0] op_sel_hi:[1,1]
    v_pk_add_f32 v[72:73], v[72:73], v[88:89] op_sel:[0,0] op_sel_hi:[1,1]
    v_pk_add_f32 v[74:75], v[74:75], v[90:91] op_sel:[0,0] op_sel_hi:[1,1]
    v_pk_add_f32 v[76:77], v[76:77], v[92:93] op_sel:[0,0] op_sel_hi:[1,1]
    v_pk_add_f32 v[78:79], v[78:79], v[94:95] op_sel:[0,0] op_sel_hi:[1,1]
    s_waitcnt vmcnt(14)
    v_lshlrev_b32 v80, 16, v152
    v_and_b32 v81, 0xffff0000, v152
    v_lshlrev_b32 v82, 16, v153
    v_and_b32 v83, 0xffff0000, v153
    v_lshlrev_b32 v84, 16, v154
    v_and_b32 v85, 0xffff0000, v154
    v_lshlrev_b32 v86, 16, v155
    v_and_b32 v87, 0xffff0000, v155
    v_lshlrev_b32 v88, 16, v156
    v_and_b32 v89, 0xffff0000, v156
    v_lshlrev_b32 v90, 16, v157
    v_and_b32 v91, 0xffff0000, v157
    v_lshlrev_b32 v92, 16, v158
    v_and_b32 v93, 0xffff0000, v158
    v_lshlrev_b32_e64 v94, 16, v159
    v_and_b32 v95, 0xffff0000, v159
    v_pk_add_f32 v[64:65], v[64:65], v[80:81] op_sel:[0,0] op_sel_hi:[1,1]
    v_pk_add_f32 v[66:67], v[66:67], v[82:83] op_sel:[0,0] op_sel_hi:[1,1]
    v_pk_add_f32 v[68:69], v[68:69], v[84:85] op_sel:[0,0] op_sel_hi:[1,1]
    v_pk_add_f32 v[70:71], v[70:71], v[86:87] op_sel:[0,0] op_sel_hi:[1,1]
    v_pk_add_f32 v[72:73], v[72:73], v[88:89] op_sel:[0,0] op_sel_hi:[1,1]
    v_pk_add_f32 v[74:75], v[74:75], v[90:91] op_sel:[0,0] op_sel_hi:[1,1]
    v_pk_add_f32 v[76:77], v[76:77], v[92:93] op_sel:[0,0] op_sel_hi:[1,1]
    v_pk_add_f32 v[78:79], v[78:79], v[94:95] op_sel:[0,0] op_sel_hi:[1,1]
    s_waitcnt vmcnt(11)
    v_lshlrev_b32 v80, 16, v160
    v_and_b32 v81, 0xffff0000, v160
    v_lshlrev_b32 v82, 16, v161
    v_and_b32 v83, 0xffff0000, v161
    v_lshlrev_b32 v84, 16, v162
    v_and_b32 v85, 0xffff0000, v162
    v_lshlrev_b32 v86, 16, v163
    v_and_b32 v87, 0xffff0000, v163
    v_lshlrev_b32 v88, 16, v164
    v_and_b32 v89, 0xffff0000, v164
    v_lshlrev_b32 v90, 16, v165
    v_and_b32 v91, 0xffff0000, v165
    v_lshlrev_b32 v92, 16, v166
    v_and_b32 v93, 0xffff0000, v166
    v_lshlrev_b32_e64 v94, 16, v167
    v_and_b32 v95, 0xffff0000, v167
    v_pk_add_f32 v[64:65], v[64:65], v[80:81] op_sel:[0,0] op_sel_hi:[1,1]
    v_pk_add_f32 v[66:67], v[66:67], v[82:83] op_sel:[0,0] op_sel_hi:[1,1]
    v_pk_add_f32 v[68:69], v[68:69], v[84:85] op_sel:[0,0] op_sel_hi:[1,1]
    v_pk_add_f32 v[70:71], v[70:71], v[86:87] op_sel:[0,0] op_sel_hi:[1,1]
    v_pk_add_f32 v[72:73], v[72:73], v[88:89] op_sel:[0,0] op_sel_hi:[1,1]
    v_pk_add_f32 v[74:75], v[74:75], v[90:91] op_sel:[0,0] op_sel_hi:[1,1]
    v_pk_add_f32 v[76:77], v[76:77], v[92:93] op_sel:[0,0] op_sel_hi:[1,1]
    v_pk_add_f32 v[78:79], v[78:79], v[94:95] op_sel:[0,0] op_sel_hi:[1,1]
    s_waitcnt vmcnt(9)
    v_lshlrev_b32 v80, 16, v168
    v_and_b32 v81, 0xffff0000, v168
    v_lshlrev_b32 v82, 16, v169
    v_and_b32 v83, 0xffff0000, v169
    v_lshlrev_b32 v84, 16, v170
    v_and_b32 v85, 0xffff0000, v170
    v_lshlrev_b32 v86, 16, v171
    v_and_b32 v87, 0xffff0000, v171
    v_lshlrev_b32 v88, 16, v172
    v_and_b32 v89, 0xffff0000, v172
    v_lshlrev_b32 v90, 16, v173
    v_and_b32 v91, 0xffff0000, v173
    v_lshlrev_b32 v92, 16, v174
    v_and_b32 v93, 0xffff0000, v174
    v_lshlrev_b32_e64 v94, 16, v175
    v_and_b32 v95, 0xffff0000, v175
    v_pk_add_f32 v[64:65], v[64:65], v[80:81] op_sel:[0,0] op_sel_hi:[1,1]
    v_pk_add_f32 v[66:67], v[66:67], v[82:83] op_sel:[0,0] op_sel_hi:[1,1]
    v_pk_add_f32 v[68:69], v[68:69], v[84:85] op_sel:[0,0] op_sel_hi:[1,1]
    v_pk_add_f32 v[70:71], v[70:71], v[86:87] op_sel:[0,0] op_sel_hi:[1,1]
    v_pk_add_f32 v[72:73], v[72:73], v[88:89] op_sel:[0,0] op_sel_hi:[1,1]
    v_pk_add_f32 v[74:75], v[74:75], v[90:91] op_sel:[0,0] op_sel_hi:[1,1]
L_hop15:
    s_cbranch_execz L_ret3
    v_pk_add_f32 v[76:77], v[76:77], v[92:93] op_sel:[0,0] op_sel_hi:[1,1]
    v_pk_add_f32 v[78:79], v[78:79], v[94:95] op_sel:[0,0] op_sel_hi:[1,1]
    s_waitcnt vmcnt(7)
    v_lshlrev_b32 v80, 16, v176
    v_and_b32 v81, 0xffff0000, v176
    v_lshlrev_b32 v82, 16, v177
    v_and_b32 v83, 0xffff0000, v177
    v_lshlrev_b32 v84, 16, v178
    v_and_b32 v85, 0xffff0000, v178
    v_lshlrev_b32 v86, 16, v179
    v_and_b32 v87, 0xffff0000, v179
    v_lshlrev_b32 v88, 16, v180
    v_and_b32 v89, 0xffff0000, v180
    v_lshlrev_b32 v90, 16, v181
    v_and_b32 v91, 0xffff0000, v181
    v_lshlrev_b32 v92, 16, v182
    v_and_b32 v93, 0xffff0000, v182
    v_lshlrev_b32 v94, 16, v183
    v_and_b32 v95, 0xffff0000, v183
    v_pk_add_f32 v[64:65], v[64:65], v[80:81] op_sel:[0,0] op_sel_hi:[1,1]
    v_pk_add_f32 v[66:67], v[66:67], v[82:83] op_sel:[0,0] op_sel_hi:[1,1]
    v_pk_add_f32 v[68:69], v[68:69], v[84:85] op_sel:[0,0] op_sel_hi:[1,1]
    v_pk_add_f32 v[70:71], v[70:71], v[86:87] op_sel:[0,0] op_sel_hi:[1,1]
    v_pk_add_f32 v[72:73], v[72:73], v[88:89] op_sel:[0,0] op_sel_hi:[1,1]
    v_pk_add_f32 v[74:75], v[74:75], v[90:91] op_sel:[0,0] op_sel_hi:[1,1]
    v_pk_add_f32 v[76:77], v[76:77], v[92:93] op_sel:[0,0] op_sel_hi:[1,1]
    v_pk_add_f32 v[78:79], v[78:79], v[94:95] op_sel:[0,0] op_sel_hi:[1,1]
    s_waitcnt vmcnt(5)
    v_lshlrev_b32 v80, 16, v184
    v_and_b32 v81, 0xffff0000, v184
    v_lshlrev_b32 v82, 16, v185
    v_and_b32 v83, 0xffff0000, v185
    v_lshlrev_b32 v84, 16, v186
    v_and_b32 v85, 0xffff0000, v186
    v_lshlrev_b32 v86, 16, v187
    v_and_b32 v87, 0xffff0000, v187
    v_lshlrev_b32 v88, 16, v188
    v_and_b32 v89, 0xffff0000, v188
    v_lshlrev_b32 v90, 16, v189
    v_and_b32 v91, 0xffff0000, v189
    v_lshlrev_b32 v92, 16, v190
    v_and_b32 v93, 0xffff0000, v190
    v_lshlrev_b32_e64 v94, 16, v191
    v_and_b32 v95, 0xffff0000, v191
    v_pk_add_f32 v[64:65], v[64:65], v[80:81] op_sel:[0,0] op_sel_hi:[1,1]
    v_pk_add_f32 v[66:67], v[66:67], v[82:83] op_sel:[0,0] op_sel_hi:[1,1]
    v_pk_add_f32 v[68:69], v[68:69], v[84:85] op_sel:[0,0] op_sel_hi:[1,1]
    v_pk_add_f32 v[70:71], v[70:71], v[86:87] op_sel:[0,0] op_sel_hi:[1,1]
    v_pk_add_f32 v[72:73], v[72:73], v[88:89] op_sel:[0,0] op_sel_hi:[1,1]
    v_pk_add_f32 v[74:75], v[74:75], v[90:91] op_sel:[0,0] op_sel_hi:[1,1]
    v_pk_add_f32 v[76:77], v[76:77], v[92:93] op_sel:[0,0] op_sel_hi:[1,1]
    v_pk_add_f32 v[78:79], v[78:79], v[94:95] op_sel:[0,0] op_sel_hi:[1,1]
    s_waitcnt vmcnt(3)
    v_lshlrev_b32 v80, 16, v212
    v_and_b32 v81, 0xffff0000, v212
    v_lshlrev_b32 v82, 16, v213
    v_and_b32 v83, 0xffff0000, v213
    v_lshlrev_b32 v84, 16, v214
    v_and_b32 v85, 0xffff0000, v214
    v_lshlrev_b32 v86, 16, v215
    v_and_b32 v87, 0xffff0000, v215
    v_lshlrev_b32 v88, 16, v216
    v_and_b32 v89, 0xffff0000, v216
    v_lshlrev_b32 v90, 16, v217
    v_and_b32 v91, 0xffff0000, v217
    v_lshlrev_b32 v92, 16, v218
    v_and_b32 v93, 0xffff0000, v218
    v_lshlrev_b32_e64 v94, 16, v219
    v_and_b32 v95, 0xffff0000, v219
    v_pk_add_f32 v[64:65], v[64:65], v[80:81] op_sel:[0,0] op_sel_hi:[1,1]
    v_pk_add_f32 v[66:67], v[66:67], v[82:83] op_sel:[0,0] op_sel_hi:[1,1]
    v_pk_add_f32 v[68:69], v[68:69], v[84:85] op_sel:[0,0] op_sel_hi:[1,1]
    v_pk_add_f32 v[70:71], v[70:71], v[86:87] op_sel:[0,0] op_sel_hi:[1,1]
    v_pk_add_f32 v[72:73], v[72:73], v[88:89] op_sel:[0,0] op_sel_hi:[1,1]
    v_pk_add_f32 v[74:75], v[74:75], v[90:91] op_sel:[0,0] op_sel_hi:[1,1]
    v_pk_add_f32 v[76:77], v[76:77], v[92:93] op_sel:[0,0] op_sel_hi:[1,1]
    v_pk_add_f32 v[78:79], v[78:79], v[94:95] op_sel:[0,0] op_sel_hi:[1,1]
    s_waitcnt vmcnt(1)
    v_lshlrev_b32 v80, 16, v220
    v_and_b32 v81, 0xffff0000, v220
    v_lshlrev_b32 v82, 16, v221
    v_and_b32 v83, 0xffff0000, v221
    v_lshlrev_b32 v84, 16, v222
    v_and_b32 v85, 0xffff0000, v222
    v_lshlrev_b32 v86, 16, v223
    v_and_b32 v87, 0xffff0000, v223
    v_lshlrev_b32 v88, 16, v224
    v_and_b32 v89, 0xffff0000, v224
    v_lshlrev_b32 v90, 16, v225
    v_and_b32 v91, 0xffff0000, v225
    v_lshlrev_b32 v92, 16, v226
    v_and_b32 v93, 0xffff0000, v226
    v_lshlrev_b32_e64 v94, 16, v227
    v_and_b32 v95, 0xffff0000, v227
    v_pk_add_f32 v[64:65], v[64:65], v[80:81] op_sel:[0,0] op_sel_hi:[1,1]
    v_pk_add_f32 v[66:67], v[66:67], v[82:83] op_sel:[0,0] op_sel_hi:[1,1]
    v_pk_add_f32 v[68:69], v[68:69], v[84:85] op_sel:[0,0] op_sel_hi:[1,1]
    v_pk_add_f32 v[70:71], v[70:71], v[86:87] op_sel:[0,0] op_sel_hi:[1,1]
    v_pk_add_f32 v[72:73], v[72:73], v[88:89] op_sel:[0,0] op_sel_hi:[1,1]
    v_pk_add_f32 v[74:75], v[74:75], v[90:91] op_sel:[0,0] op_sel_hi:[1,1]
    v_pk_add_f32 v[76:77], v[76:77], v[92:93] op_sel:[0,0] op_sel_hi:[1,1]
    v_pk_add_f32 v[78:79], v[78:79], v[94:95] op_sel:[0,0] op_sel_hi:[1,1]
    s_mov_b32 s48, 0
    s_andn2_b32 s38, s44, s38
    s_cbranch_scc0 L_done3
    s_branch L_chk3
L_wait3:
    buffer_load_dword v252, v251, s[12:15], s65 offen sc1
    s_add_u32 s48, s48, 1
L_chk3:
    s_waitcnt vmcnt(0)
    v_cmp_le_u32 vcc, 1, v252
    s_nop 3
    s_and_b32 s44, vcc_lo, s38
    s_cbranch_scc0 L_next3
    s_bitcmp1_b32 s44, 0
    s_cbranch_scc0 L_ld3_0
    s_add_u32 s47, s9, 0
    buffer_load_dwordx4 v[144:147], v206, s[12:15], s47 offen sc1
    s_add_u32 s47, s9, 16384
    buffer_load_dwordx4 v[148:151], v206, s[12:15], s47 offen sc1
L_ld3_0:
    s_bitcmp1_b32 s44, 1
    s_cbranch_scc0 L_ld3_1
    s_add_u32 s47, s9, 65536
    buffer_load_dwordx4 v[152:155], v206, s[12:15], s47 offen sc1
    s_add_u32 s47, s9, 81920
    buffer_load_dwordx4 v[156:159], v206, s[12:15], s47 offen sc1
L_ld3_1:
    s_bitcmp1_b32 s44, 2
    s_cbranch_scc0 L_ld3_2
    s_add_u32 s47, s9, 131072
    buffer_load_dwordx4 v[160:163], v206, s[12:15], s47 offen sc1
    s_add_u32 s47, s9, 147456
    buffer_load_dwordx4 v[164:167], v206, s[12:15], s47 offen sc1
L_ld3_2:
    s_bitcmp1_b32 s44, 3
    s_cbranch_scc0 L_ld3_3
    s_add_u32 s47, s9, 196608
    buffer_load_dwordx4 v[168:171], v206, s[12:15], s47 offen sc1
    s_add_u32 s47, s9, 212992
    buffer_load_dwordx4 v[172:175], v206, s[12:15], s47 offen sc1
L_ld3_3:
    s_bitcmp1_b32 s44, 4
    s_cbranch_scc0 L_ld3_4
    s_add_u32 s47, s9, 262144
    buffer_load_dwordx4 v[176:179], v206, s[12:15], s47 offen sc1
    s_add_u32 s47, s9, 278528
    buffer_load_dwordx4 v[180:183], v206, s[12:15], s47 offen sc1
L_ld3_4:
    s_bitcmp1_b32 s44, 5
    s_cbranch_scc0 L_ld3_5
    s_add_u32 s47, s9, 327680
    buffer_load_dwordx4 v[184:187], v206, s[12:15], s47 offen sc1
    s_add_u32 s47, s9, 344064
    buffer_load_dwordx4 v[188:191], v206, s[12:15], s47 offen sc1
L_ld3_5:
    s_bitcmp1_b32 s44, 6
    s_cbranch_scc0 L_ld3_6
    s_add_u32 s47, s9, 393216
    buffer_load_dwordx4 v[212:215], v206, s[12:15], s47 offen sc1
    s_add_u32 s47, s9, 409600
    buffer_load_dwordx4 v[216:219], v206, s[12:15], s47 offen sc1
L_ld3_6:
    s_bitcmp1_b32 s44, 7
    s_cbranch_scc0 L_ld3_7
    s_add_u32 s47, s9, 458752
    buffer_load_dwordx4 v[220:223], v206, s[12:15], s47 offen sc1
    s_add_u32 s47, s9, 475136
    buffer_load_dwordx4 v[224:227], v206, s[12:15], s47 offen sc1
L_ld3_7:
    s_waitcnt vmcnt(0)
    s_bitcmp1_b32 s44, 0
    s_cbranch_scc0 L_ad3_0
    v_lshlrev_b32 v80, 16, v144
    v_and_b32 v81, 0xffff0000, v144
    v_lshlrev_b32 v82, 16, v145
    v_and_b32 v83, 0xffff0000, v145
    v_lshlrev_b32 v84, 16, v146
    v_and_b32 v85, 0xffff0000, v146
    v_lshlrev_b32 v86, 16, v147
    v_and_b32 v87, 0xffff0000, v147
    v_lshlrev_b32 v88, 16, v148
    v_and_b32 v89, 0xffff0000, v148
    v_lshlrev_b32 v90, 16, v149
    v_and_b32 v91, 0xffff0000, v149
    v_lshlrev_b32 v92, 16, v150
    v_and_b32 v93, 0xffff0000, v150
    v_lshlrev_b32 v94, 16, v151
    v_and_b32 v95, 0xffff0000, v151
    v_pk_add_f32 v[64:65], v[64:65], v[80:81] op_sel:[0,0] op_sel_hi:[1,1]
    v_pk_add_f32 v[66:67], v[66:67], v[82:83] op_sel:[0,0] op_sel_hi:[1,1]
    v_pk_add_f32 v[68:69], v[68:69], v[84:85] op_sel:[0,0] op_sel_hi:[1,1]
    v_pk_add_f32 v[70:71], v[70:71], v[86:87] op_sel:[0,0] op_sel_hi:[1,1]
    v_pk_add_f32 v[72:73], v[72:73], v[88:89] op_sel:[0,0] op_sel_hi:[1,1]
    v_pk_add_f32 v[74:75], v[74:75], v[90:91] op_sel:[0,0] op_sel_hi:[1,1]
    v_pk_add_f32 v[76:77], v[76:77], v[92:93] op_sel:[0,0] op_sel_hi:[1,1]
    v_pk_add_f32 v[78:79], v[78:79], v[94:95] op_sel:[0,0] op_sel_hi:[1,1]
L_ad3_0:
    s_bitcmp1_b32 s44, 1
    s_cbranch_scc0 L_ad3_1
    v_lshlrev_b32 v80, 16, v152
    v_and_b32 v81, 0xffff0000, v152
    v_lshlrev_b32 v82, 16, v153
    v_and_b32 v83, 0xffff0000, v153
    v_lshlrev_b32 v84, 16, v154
    v_and_b32 v85, 0xffff0000, v154
    v_lshlrev_b32 v86, 16, v155
    v_and_b32 v87, 0xffff0000, v155
    v_lshlrev_b32 v88, 16, v156
    v_and_b32 v89, 0xffff0000, v156
    v_lshlrev_b32 v90, 16, v157
    v_and_b32 v91, 0xffff0000, v157
    v_lshlrev_b32 v92, 16, v158
    v_and_b32 v93, 0xffff0000, v158
    v_lshlrev_b32 v94, 16, v159
    v_and_b32 v95, 0xffff0000, v159
    v_pk_add_f32 v[64:65], v[64:65], v[80:81] op_sel:[0,0] op_sel_hi:[1,1]
    v_pk_add_f32 v[66:67], v[66:67], v[82:83] op_sel:[0,0] op_sel_hi:[1,1]
    v_pk_add_f32 v[68:69], v[68:69], v[84:85] op_sel:[0,0] op_sel_hi:[1,1]
    v_pk_add_f32 v[70:71], v[70:71], v[86:87] op_sel:[0,0] op_sel_hi:[1,1]
    v_pk_add_f32 v[72:73], v[72:73], v[88:89] op_sel:[0,0] op_sel_hi:[1,1]
    v_pk_add_f32 v[74:75], v[74:75], v[90:91] op_sel:[0,0] op_sel_hi:[1,1]
    v_pk_add_f32 v[76:77], v[76:77], v[92:93] op_sel:[0,0] op_sel_hi:[1,1]
    v_pk_add_f32 v[78:79], v[78:79], v[94:95] op_sel:[0,0] op_sel_hi:[1,1]
L_ad3_1:
    s_bitcmp1_b32 s44, 2
    s_cbranch_scc0 L_ad3_2
    v_lshlrev_b32 v80, 16, v160
    v_and_b32 v81, 0xffff0000, v160
    v_lshlrev_b32 v82, 16, v161
    v_and_b32 v83, 0xffff0000, v161
    v_lshlrev_b32 v84, 16, v162
    v_and_b32 v85, 0xffff0000, v162
    v_lshlrev_b32 v86, 16, v163
    v_and_b32 v87, 0xffff0000, v163
    v_lshlrev_b32 v88, 16, v164
    v_and_b32 v89, 0xffff0000, v164
    v_lshlrev_b32 v90, 16, v165
    v_and_b32 v91, 0xffff0000, v165
    v_lshlrev_b32 v92, 16, v166
    v_and_b32 v93, 0xffff0000, v166
    v_lshlrev_b32 v94, 16, v167
    v_and_b32 v95, 0xffff0000, v167
    v_pk_add_f32 v[64:65], v[64:65], v[80:81] op_sel:[0,0] op_sel_hi:[1,1]
    v_pk_add_f32 v[66:67], v[66:67], v[82:83] op_sel:[0,0] op_sel_hi:[1,1]
    v_pk_add_f32 v[68:69], v[68:69], v[84:85] op_sel:[0,0] op_sel_hi:[1,1]
    v_pk_add_f32 v[70:71], v[70:71], v[86:87] op_sel:[0,0] op_sel_hi:[1,1]
    v_pk_add_f32 v[72:73], v[72:73], v[88:89] op_sel:[0,0] op_sel_hi:[1,1]
    v_pk_add_f32 v[74:75], v[74:75], v[90:91] op_sel:[0,0] op_sel_hi:[1,1]
    v_pk_add_f32 v[76:77], v[76:77], v[92:93] op_sel:[0,0] op_sel_hi:[1,1]
    v_pk_add_f32 v[78:79], v[78:79], v[94:95] op_sel:[0,0] op_sel_hi:[1,1]
L_ad3_2:
    s_bitcmp1_b32 s44, 3
    s_cbranch_scc0 L_ad3_3
    v_lshlrev_b32 v80, 16, v168
    v_and_b32 v81, 0xffff0000, v168
    v_lshlrev_b32 v82, 16, v169
    v_and_b32 v83, 0xffff0000, v169
    v_lshlrev_b32 v84, 16, v170
    v_and_b32 v85, 0xffff0000, v170
    v_lshlrev_b32 v86, 16, v171
    v_and_b32 v87, 0xffff0000, v171
    v_lshlrev_b32 v88, 16, v172
    v_and_b32 v89, 0xffff0000, v172
    v_lshlrev_b32 v90, 16, v173
    v_and_b32 v91, 0xffff0000, v173
    v_lshlrev_b32 v92, 16, v174
    v_and_b32 v93, 0xffff0000, v174
    v_lshlrev_b32 v94, 16, v175
    v_and_b32 v95, 0xffff0000, v175
    v_pk_add_f32 v[64:65], v[64:65], v[80:81] op_sel:[0,0] op_sel_hi:[1,1]
    v_pk_add_f32 v[66:67], v[66:67], v[82:83] op_sel:[0,0] op_sel_hi:[1,1]
    v_pk_add_f32 v[68:69], v[68:69], v[84:85] op_sel:[0,0] op_sel_hi:[1,1]
    v_pk_add_f32 v[70:71], v[70:71], v[86:87] op_sel:[0,0] op_sel_hi:[1,1]
    v_pk_add_f32 v[72:73], v[72:73], v[88:89] op_sel:[0,0] op_sel_hi:[1,1]
    v_pk_add_f32 v[74:75], v[74:75], v[90:91] op_sel:[0,0] op_sel_hi:[1,1]
    v_pk_add_f32 v[76:77], v[76:77], v[92:93] op_sel:[0,0] op_sel_hi:[1,1]
    v_pk_add_f32 v[78:79], v[78:79], v[94:95] op_sel:[0,0] op_sel_hi:[1,1]
L_ad3_3:
    s_bitcmp1_b32 s44, 4
    s_cbranch_scc0 L_ad3_4
    v_lshlrev_b32 v80, 16, v176
    v_and_b32 v81, 0xffff0000, v176
    v_lshlrev_b32 v82, 16, v177
    v_and_b32 v83, 0xffff0000, v177
    v_lshlrev_b32 v84, 16, v178
    v_and_b32 v85, 0xffff0000, v178
    v_lshlrev_b32 v86, 16, v179
    v_and_b32 v87, 0xffff0000, v179
    v_lshlrev_b32 v88, 16, v180
    v_and_b32 v89, 0xffff0000, v180
    v_lshlrev_b32 v90, 16, v181
    v_and_b32 v91, 0xffff0000, v181
    v_lshlrev_b32 v92, 16, v182
    v_and_b32 v93, 0xffff0000, v182
    v_lshlrev_b32 v94, 16, v183
    v_and_b32 v95, 0xffff0000, v183
    v_pk_add_f32 v[64:65], v[64:65], v[80:81] op_sel:[0,0] op_sel_hi:[1,1]
    v_pk_add_f32 v[66:67], v[66:67], v[82:83] op_sel:[0,0] op_sel_hi:[1,1]
    v_pk_add_f32 v[68:69], v[68:69], v[84:85] op_sel:[0,0] op_sel_hi:[1,1]
    v_pk_add_f32 v[70:71], v[70:71], v[86:87] op_sel:[0,0] op_sel_hi:[1,1]
    v_pk_add_f32 v[72:73], v[72:73], v[88:89] op_sel:[0,0] op_sel_hi:[1,1]
    v_pk_add_f32 v[74:75], v[74:75], v[90:91] op_sel:[0,0] op_sel_hi:[1,1]
    v_pk_add_f32 v[76:77], v[76:77], v[92:93] op_sel:[0,0] op_sel_hi:[1,1]
    v_pk_add_f32 v[78:79], v[78:79], v[94:95] op_sel:[0,0] op_sel_hi:[1,1]
L_ad3_4:
    s_bitcmp1_b32 s44, 5
    s_cbranch_scc0 L_ad3_5
    v_lshlrev_b32 v80, 16, v184
    v_and_b32 v81, 0xffff0000, v184
    v_lshlrev_b32 v82, 16, v185
    v_and_b32 v83, 0xffff0000, v185
    v_lshlrev_b32 v84, 16, v186
    v_and_b32 v85, 0xffff0000, v186
    v_lshlrev_b32 v86, 16, v187
    v_and_b32 v87, 0xffff0000, v187
    v_lshlrev_b32 v88, 16, v188
    v_and_b32 v89, 0xffff0000, v188
    v_lshlrev_b32 v90, 16, v189
    v_and_b32 v91, 0xffff0000, v189
    v_lshlrev_b32 v92, 16, v190
    v_and_b32 v93, 0xffff0000, v190
    v_lshlrev_b32 v94, 16, v191
    v_and_b32 v95, 0xffff0000, v191
    v_pk_add_f32 v[64:65], v[64:65], v[80:81] op_sel:[0,0] op_sel_hi:[1,1]
    v_pk_add_f32 v[66:67], v[66:67], v[82:83] op_sel:[0,0] op_sel_hi:[1,1]
    v_pk_add_f32 v[68:69], v[68:69], v[84:85] op_sel:[0,0] op_sel_hi:[1,1]
    v_pk_add_f32 v[70:71], v[70:71], v[86:87] op_sel:[0,0] op_sel_hi:[1,1]
    v_pk_add_f32 v[72:73], v[72:73], v[88:89] op_sel:[0,0] op_sel_hi:[1,1]
    v_pk_add_f32 v[74:75], v[74:75], v[90:91] op_sel:[0,0] op_sel_hi:[1,1]
    v_pk_add_f32 v[76:77], v[76:77], v[92:93] op_sel:[0,0] op_sel_hi:[1,1]
    v_pk_add_f32 v[78:79], v[78:79], v[94:95] op_sel:[0,0] op_sel_hi:[1,1]
L_ad3_5:
    s_bitcmp1_b32 s44, 6
    s_cbranch_scc0 L_ad3_6
    v_lshlrev_b32 v80, 16, v212
    v_and_b32 v81, 0xffff0000, v212
    v_lshlrev_b32 v82, 16, v213
    v_and_b32 v83, 0xffff0000, v213
    v_lshlrev_b32 v84, 16, v214
    v_and_b32 v85, 0xffff0000, v214
    v_lshlrev_b32 v86, 16, v215
    v_and_b32 v87, 0xffff0000, v215
    v_lshlrev_b32 v88, 16, v216
    v_and_b32 v89, 0xffff0000, v216
    v_lshlrev_b32 v90, 16, v217
    v_and_b32 v91, 0xffff0000, v217
    v_lshlrev_b32 v92, 16, v218
    v_and_b32 v93, 0xffff0000, v218
    v_lshlrev_b32 v94, 16, v219
    v_and_b32 v95, 0xffff0000, v219
    v_pk_add_f32 v[64:65], v[64:65], v[80:81] op_sel:[0,0] op_sel_hi:[1,1]
    v_pk_add_f32 v[66:67], v[66:67], v[82:83] op_sel:[0,0] op_sel_hi:[1,1]
    v_pk_add_f32 v[68:69], v[68:69], v[84:85] op_sel:[0,0] op_sel_hi:[1,1]
    v_pk_add_f32 v[70:71], v[70:71], v[86:87] op_sel:[0,0] op_sel_hi:[1,1]
    v_pk_add_f32 v[72:73], v[72:73], v[88:89] op_sel:[0,0] op_sel_hi:[1,1]
    v_pk_add_f32 v[74:75], v[74:75], v[90:91] op_sel:[0,0] op_sel_hi:[1,1]
    v_pk_add_f32 v[76:77], v[76:77], v[92:93] op_sel:[0,0] op_sel_hi:[1,1]
    v_pk_add_f32 v[78:79], v[78:79], v[94:95] op_sel:[0,0] op_sel_hi:[1,1]
L_ad3_6:
    s_bitcmp1_b32 s44, 7
    s_cbranch_scc0 L_ad3_7
    v_lshlrev_b32 v80, 16, v220
    v_and_b32 v81, 0xffff0000, v220
    v_lshlrev_b32 v82, 16, v221
    v_and_b32 v83, 0xffff0000, v221
    v_lshlrev_b32 v84, 16, v222
    v_and_b32 v85, 0xffff0000, v222
    v_lshlrev_b32 v86, 16, v223
    v_and_b32 v87, 0xffff0000, v223
    v_lshlrev_b32 v88, 16, v224
    v_and_b32 v89, 0xffff0000, v224
    v_lshlrev_b32 v90, 16, v225
    v_and_b32 v91, 0xffff0000, v225
    v_lshlrev_b32 v92, 16, v226
    v_and_b32 v93, 0xffff0000, v226
    v_lshlrev_b32 v94, 16, v227
    v_and_b32 v95, 0xffff0000, v227
    v_pk_add_f32 v[64:65], v[64:65], v[80:81] op_sel:[0,0] op_sel_hi:[1,1]
    v_pk_add_f32 v[66:67], v[66:67], v[82:83] op_sel:[0,0] op_sel_hi:[1,1]
    v_pk_add_f32 v[68:69], v[68:69], v[84:85] op_sel:[0,0] op_sel_hi:[1,1]
    v_pk_add_f32 v[70:71], v[70:71], v[86:87] op_sel:[0,0] op_sel_hi:[1,1]
    v_pk_add_f32 v[72:73], v[72:73], v[88:89] op_sel:[0,0] op_sel_hi:[1,1]
    v_pk_add_f32 v[74:75], v[74:75], v[90:91] op_sel:[0,0] op_sel_hi:[1,1]
    v_pk_add_f32 v[76:77], v[76:77], v[92:93] op_sel:[0,0] op_sel_hi:[1,1]
    v_pk_add_f32 v[78:79], v[78:79], v[94:95] op_sel:[0,0] op_sel_hi:[1,1]
L_ad3_7:
    s_andn2_b32 s38, s38, s44
    s_cbranch_scc0 L_done3
L_next3:
    s_cmp_lt_u32 s48, 200000
    s_cbranch_scc1 L_wait3
L_done3:
    s_nop 0
    v_pk_fma_f32 v[96:97], v[64:65], v[128:129], v[96:97] op_sel:[0,0,0] op_sel_hi:[1,1,1]
    v_pk_fma_f32 v[98:99], v[66:67], v[130:131], v[98:99] op_sel:[0,0,0] op_sel_hi:[1,1,1]
    v_pk_fma_f32 v[100:101], v[68:69], v[132:133], v[100:101] op_sel:[0,0,0] op_sel_hi:[1,1,1]
    v_pk_fma_f32 v[102:103], v[70:71], v[134:135], v[102:103] op_sel:[0,0,0] op_sel_hi:[1,1,1]
    v_pk_fma_f32 v[104:105], v[72:73], v[136:137], v[104:105] op_sel:[0,0,0] op_sel_hi:[1,1,1]
    v_pk_fma_f32 v[106:107], v[74:75], v[138:139], v[106:107] op_sel:[0,0,0] op_sel_hi:[1,1,1]
    v_pk_fma_f32 v[108:109], v[76:77], v[140:141], v[108:109] op_sel:[0,0,0] op_sel_hi:[1,1,1]
    v_pk_fma_f32 v[110:111], v[78:79], v[142:143], v[110:111] op_sel:[0,0,0] op_sel_hi:[1,1,1]
    v_cvt_pk_bf16_f32 v80, v96, v97
    v_cvt_pk_bf16_f32 v81, v98, v99
    v_cvt_pk_bf16_f32 v82, v100, v101
    v_cvt_pk_bf16_f32 v83, v102, v103
    v_cvt_pk_bf16_f32 v84, v104, v105
    v_cvt_pk_bf16_f32 v85, v106, v107
    v_cvt_pk_bf16_f32 v86, v108, v109
    v_cvt_pk_bf16_f32 v87, v110, v111
    global_store_dwordx2 v249, v[80:81], s[72:73] offset:0
    global_store_dwordx2 v249, v[82:83], s[72:73] offset:32
    global_store_dwordx2 v249, v[84:85], s[72:73] offset:64
    global_store_dwordx2 v249, v[86:87], s[72:73] offset:96
L_end:
    s_endpgm
L_wait0:
    s_mov_b32 s47, 0
L_wait0s:
    buffer_load_dword v243, v242, s[28:31], s50 offen sc1
    s_add_u32 s47, s47, 1
    s_waitcnt vmcnt(0)
    v_cmp_gt_u32 vcc, 32, v243
    s_cmp_gt_u32 s47, 200000
    s_cbranch_scc1 L_wait0s_x
    s_nop 3
    s_cbranch_vccnz L_wait0s
L_wait0s_x:
    s_branch L_go0
L_wait1:
    s_mov_b32 s47, 0
L_wait1s:
    buffer_load_dword v249, v248, s[28:31], 0 offen sc1
    s_add_u32 s47, s47, 1
    s_waitcnt vmcnt(0)
    v_cmp_gt_u32 vcc, 32, v249
    s_cmp_gt_u32 s47, 200000
    s_cbranch_scc1 L_wait1s_x
    s_nop 3
    s_cbranch_vccnz L_wait1s
L_wait1s_x:
    s_branch L_go1
L_wait2:
    s_mov_b32 s47, 0
L_wait2s:
    buffer_load_dword v252, v250, s[12:15], s64 offen sc1
    s_add_u32 s47, s47, 1
    s_waitcnt vmcnt(0)
    v_cmp_gt_u32 vcc, 1, v252
    s_cmp_gt_u32 s47, 200000
    s_cbranch_scc1 L_wait2s_x
    s_nop 3
    s_cbranch_vccnz L_wait2s
L_wait2s_x:
    s_branch L_go2
L_redo:
    s_mov_b32 s40, -1
    s_mov_b32 s22, 0
    v_subrev_u32 v204, 32768, v204
    s_nop 7
    v_mov_b32 v161, 0xff800000
    v_mov_b32 v165, 0xff800000
    v_mov_b32 v169, 0xff800000
    v_mov_b32 v173, 0xff800000
    s_mov_b32 s37, 0
L_maxloop:
    s_waitcnt vmcnt(0) lgkmcnt(0)
    s_barrier
    s_mov_b32 m0, s35
    s_nop 0
    buffer_load_dwordx4 v204, s[4:7], s37 offen offset:0 lds
    buffer_load_dwordx4 v204, s[4:7], s37 offen offset:1024 lds
    buffer_load_dwordx4 v204, s[4:7], s37 offen offset:2048 lds
    buffer_load_dwordx4 v204, s[4:7], s37 offen offset:3072 lds
    s_waitcnt vmcnt(0)
    s_barrier
    s_nop 0
    ds_read_b128 a[192:195], v192 offset:0
    ds_read_b128 a[196:199], v193 offset:0
    ds_read_b128 a[200:203], v194 offset:0
    ds_read_b128 a[204:207], v195 offset:0
    ds_read_b128 a[208:211], v192 offset:1024
    ds_read_b128 a[212:215], v193 offset:1024
    ds_read_b128 a[216:219], v194 offset:1024
    ds_read_b128 a[220:223], v195 offset:1024
    s_waitcnt lgkmcnt(0)
    v_mfma_f32_16x16x32_bf16 v[64:67], a[192:195], v[0:3], 0
    v_mfma_f32_16x16x32_bf16 v[64:67], a[196:199], v[16:19], v[64:67]
    v_mfma_f32_16x16x32_bf16 v[64:67], a[200:203], v[32:35], v[64:67]
    v_mfma_f32_16x16x32_bf16 v[64:67], a[204:207], v[48:51], v[64:67]
    v_mfma_f32_16x16x32_bf16 v[68:71], a[220:223], v[48:51], 0
    v_mfma_f32_16x16x32_bf16 v[68:71], a[216:219], v[32:35], v[68:71]
    v_mfma_f32_16x16x32_bf16 v[68:71], a[212:215], v[16:19], v[68:71]
    v_mfma_f32_16x16x32_bf16 v[68:71], a[208:211], v[0:3], v[68:71]
    v_mfma_f32_16x16x32_bf16 v[76:79], a[208:211], v[4:7], 0
    v_mfma_f32_16x16x32_bf16 v[76:79], a[212:215], v[20:23], v[76:79]
    v_mfma_f32_16x16x32_bf16 v[76:79], a[216:219], v[36:39], v[76:79]
    v_mfma_f32_16x16x32_bf16 v[76:79], a[220:223], v[52:55], v[76:79]
    v_mfma_f32_16x16x32_bf16 v[72:75], a[204:207], v[52:55], 0
    v_mfma_f32_16x16x32_bf16 v[72:75], a[200:203], v[36:39], v[72:75]
    v_mfma_f32_16x16x32_bf16 v[72:75], a[196:199], v[20:23], v[72:75]
    v_mfma_f32_16x16x32_bf16 v[72:75], a[192:195], v[4:7], v[72:75]
    v_mfma_f32_16x16x32_bf16 v[80:83], a[192:195], v[8:11], 0
    v_mfma_f32_16x16x32_bf16 v[80:83], a[196:199], v[24:27], v[80:83]
    v_mfma_f32_16x16x32_bf16 v[80:83], a[200:203], v[40:43], v[80:83]
    v_mfma_f32_16x16x32_bf16 v[80:83], a[204:207], v[56:59], v[80:83]
    v_mfma_f32_16x16x32_bf16 v[84:87], a[220:223], v[56:59], 0
    v_mfma_f32_16x16x32_bf16 v[84:87], a[216:219], v[40:43], v[84:87]
    v_mfma_f32_16x16x32_bf16 v[84:87], a[212:215], v[24:27], v[84:87]
    v_mfma_f32_16x16x32_bf16 v[84:87], a[208:211], v[8:11], v[84:87]
    v_mfma_f32_16x16x32_bf16 v[92:95], a[208:211], v[12:15], 0
    v_mfma_f32_16x16x32_bf16 v[92:95], a[212:215], v[28:31], v[92:95]
    v_mfma_f32_16x16x32_bf16 v[92:95], a[216:219], v[44:47], v[92:95]
    v_mfma_f32_16x16x32_bf16 v[92:95], a[220:223], v[60:63], v[92:95]
    v_mfma_f32_16x16x32_bf16 v[88:91], a[204:207], v[60:63], 0
    v_mfma_f32_16x16x32_bf16 v[88:91], a[200:203], v[44:47], v[88:91]
    v_mfma_f32_16x16x32_bf16 v[88:91], a[196:199], v[28:31], v[88:91]
    v_mfma_f32_16x16x32_bf16 v[88:91], a[192:195], v[12:15], v[88:91]
    s_nop 7
    v_max3_f32 v161, v161, v64, v65
    v_max3_f32 v161, v161, v66, v67
    v_max3_f32 v161, v161, v68, v69
    v_max3_f32 v161, v161, v70, v71
    v_max3_f32 v165, v165, v72, v73
    v_max3_f32 v165, v165, v74, v75
    v_max3_f32 v165, v165, v76, v77
    v_max3_f32 v165, v165, v78, v79
    v_max3_f32 v169, v169, v80, v81
    v_max3_f32 v169, v169, v82, v83
    v_max3_f32 v169, v169, v84, v85
    v_max3_f32 v169, v169, v86, v87
    v_max3_f32 v173, v173, v88, v89
    v_max3_f32 v173, v173, v90, v91
    v_max3_f32 v173, v173, v92, v93
    v_max3_f32 v173, v173, v94, v95
    ds_read_b128 a[192:195], v192 offset:2048
    ds_read_b128 a[196:199], v193 offset:2048
    ds_read_b128 a[200:203], v194 offset:2048
    ds_read_b128 a[204:207], v195 offset:2048
    ds_read_b128 a[208:211], v192 offset:3072
    ds_read_b128 a[212:215], v193 offset:3072
    ds_read_b128 a[216:219], v194 offset:3072
    ds_read_b128 a[220:223], v195 offset:3072
    s_waitcnt lgkmcnt(0)
    v_mfma_f32_16x16x32_bf16 v[64:67], a[192:195], v[0:3], 0
    v_mfma_f32_16x16x32_bf16 v[64:67], a[196:199], v[16:19], v[64:67]
    v_mfma_f32_16x16x32_bf16 v[64:67], a[200:203], v[32:35], v[64:67]
    v_mfma_f32_16x16x32_bf16 v[64:67], a[204:207], v[48:51], v[64:67]
    v_mfma_f32_16x16x32_bf16 v[68:71], a[220:223], v[48:51], 0
    v_mfma_f32_16x16x32_bf16 v[68:71], a[216:219], v[32:35], v[68:71]
    v_mfma_f32_16x16x32_bf16 v[68:71], a[212:215], v[16:19], v[68:71]
    v_mfma_f32_16x16x32_bf16 v[68:71], a[208:211], v[0:3], v[68:71]
    v_mfma_f32_16x16x32_bf16 v[76:79], a[208:211], v[4:7], 0
    v_mfma_f32_16x16x32_bf16 v[76:79], a[212:215], v[20:23], v[76:79]
    v_mfma_f32_16x16x32_bf16 v[76:79], a[216:219], v[36:39], v[76:79]
    v_mfma_f32_16x16x32_bf16 v[76:79], a[220:223], v[52:55], v[76:79]
    v_mfma_f32_16x16x32_bf16 v[72:75], a[204:207], v[52:55], 0
    v_mfma_f32_16x16x32_bf16 v[72:75], a[200:203], v[36:39], v[72:75]
    v_mfma_f32_16x16x32_bf16 v[72:75], a[196:199], v[20:23], v[72:75]
    v_mfma_f32_16x16x32_bf16 v[72:75], a[192:195], v[4:7], v[72:75]
    v_mfma_f32_16x16x32_bf16 v[80:83], a[192:195], v[8:11], 0
    v_mfma_f32_16x16x32_bf16 v[80:83], a[196:199], v[24:27], v[80:83]
    v_mfma_f32_16x16x32_bf16 v[80:83], a[200:203], v[40:43], v[80:83]
    v_mfma_f32_16x16x32_bf16 v[80:83], a[204:207], v[56:59], v[80:83]
    v_mfma_f32_16x16x32_bf16 v[84:87], a[220:223], v[56:59], 0
    v_mfma_f32_16x16x32_bf16 v[84:87], a[216:219], v[40:43], v[84:87]
    v_mfma_f32_16x16x32_bf16 v[84:87], a[212:215], v[24:27], v[84:87]
    v_mfma_f32_16x16x32_bf16 v[84:87], a[208:211], v[8:11], v[84:87]
    v_mfma_f32_16x16x32_bf16 v[92:95], a[208:211], v[12:15], 0
    v_mfma_f32_16x16x32_bf16 v[92:95], a[212:215], v[28:31], v[92:95]
    v_mfma_f32_16x16x32_bf16 v[92:95], a[216:219], v[44:47], v[92:95]
    v_mfma_f32_16x16x32_bf16 v[92:95], a[220:223], v[60:63], v[92:95]
    v_mfma_f32_16x16x32_bf16 v[88:91], a[204:207], v[60:63], 0
    v_mfma_f32_16x16x32_bf16 v[88:91], a[200:203], v[44:47], v[88:91]
    v_mfma_f32_16x16x32_bf16 v[88:91], a[196:199], v[28:31], v[88:91]
    v_mfma_f32_16x16x32_bf16 v[88:91], a[192:195], v[12:15], v[88:91]
    s_nop 7
    v_max3_f32 v161, v161, v64, v65
    v_max3_f32 v161, v161, v66, v67
    v_max3_f32 v161, v161, v68, v69
    v_max3_f32 v161, v161, v70, v71
    v_max3_f32 v165, v165, v72, v73
    v_max3_f32 v165, v165, v74, v75
    v_max3_f32 v165, v165, v76, v77
    v_max3_f32 v165, v165, v78, v79
    v_max3_f32 v169, v169, v80, v81
    v_max3_f32 v169, v169, v82, v83
    v_max3_f32 v169, v169, v84, v85
    v_max3_f32 v169, v169, v86, v87
    v_max3_f32 v173, v173, v88, v89
    v_max3_f32 v173, v173, v90, v91
    v_max3_f32 v173, v173, v92, v93
    v_max3_f32 v173, v173, v94, v95
    s_add_u32 s37, s37, 16384
    s_cmp_lt_u32 s37, 524288
    s_cbranch_scc1 L_maxloop
    v_mov_b32 v248, v161
    v_mov_b32 v249, v165
    v_mov_b32 v250, v169
    v_mov_b32 v251, v173
    v_permlane32_swap_b32 v161, v248
    v_permlane32_swap_b32 v165, v249
    v_permlane32_swap_b32 v169, v250
    v_permlane32_swap_b32 v173, v251
    v_max_f32 v161, v161, v248
    v_max_f32 v165, v165, v249
    v_max_f32 v169, v169, v250
    v_max_f32 v173, v173, v251
    v_mov_b32 v248, v161
    v_mov_b32 v249, v165
    v_mov_b32 v250, v169
    v_mov_b32 v251, v173
    v_permlane16_swap_b32 v161, v248
    v_permlane16_swap_b32 v165, v249
    v_permlane16_swap_b32 v169, v250
    v_permlane16_swap_b32 v173, v251
    v_max_f32 v161, v161, v248
    v_max_f32 v165, v165, v249
    v_max_f32 v169, v169, v250
    v_max_f32 v173, v173, v251
    v_sub_f32 v160, 0, v161
    v_sub_f32 v164, 0, v165
    v_sub_f32 v168, 0, v169
    v_sub_f32 v172, 0, v173
    s_barrier
    s_add_u32 m0, s35, 0
    s_mov_b32 s37, 0
    buffer_load_dwordx4 v204, s[4:7], s37 offen offset:0 lds
    buffer_load_dwordx4 v204, s[4:7], s37 offen offset:1024 lds
    buffer_load_dwordx4 v204, s[4:7], s37 offen offset:2048 lds
    buffer_load_dwordx4 v204, s[4:7], s37 offen offset:3072 lds
    s_add_u32 m0, s36, 0
    s_mov_b32 s37, 0
    buffer_load_dwordx4 v205, s[8:11], s37 offen offset:0 lds
    buffer_load_dwordx4 v205, s[8:11], s37 offen offset:1024 lds
    buffer_load_dwordx4 v205, s[8:11], s37 offen offset:2048 lds
    buffer_load_dwordx4 v205, s[8:11], s37 offen offset:3072 lds
    s_add_u32 m0, s35, 16384
    s_mov_b32 s37, 16384
    buffer_load_dwordx4 v204, s[4:7], s37 offen offset:0 lds
    buffer_load_dwordx4 v204, s[4:7], s37 offen offset:1024 lds
    buffer_load_dwordx4 v204, s[4:7], s37 offen offset:2048 lds
    buffer_load_dwordx4 v204, s[4:7], s37 offen offset:3072 lds
    s_add_u32 m0, s36, 16384
    s_mov_b32 s37, 16384
    buffer_load_dwordx4 v205, s[8:11], s37 offen offset:0 lds
    buffer_load_dwordx4 v205, s[8:11], s37 offen offset:1024 lds
    buffer_load_dwordx4 v205, s[8:11], s37 offen offset:2048 lds
    buffer_load_dwordx4 v205, s[8:11], s37 offen offset:3072 lds
    s_add_u32 m0, s35, 32768
    s_mov_b32 s37, 32768
    buffer_load_dwordx4 v204, s[4:7], s37 offen offset:0 lds
    buffer_load_dwordx4 v204, s[4:7], s37 offen offset:1024 lds
    buffer_load_dwordx4 v204, s[4:7], s37 offen offset:2048 lds
    buffer_load_dwordx4 v204, s[4:7], s37 offen offset:3072 lds
    s_add_u32 m0, s35, 49152
    s_mov_b32 s37, 49152
    buffer_load_dwordx4 v204, s[4:7], s37 offen offset:0 lds
    buffer_load_dwordx4 v204, s[4:7], s37 offen offset:1024 lds
    buffer_load_dwordx4 v204, s[4:7], s37 offen offset:2048 lds
    buffer_load_dwordx4 v204, s[4:7], s37 offen offset:3072 lds
    s_waitcnt vmcnt(0)
    s_barrier
    ds_read_b128 a[192:195], v192 offset:0
    ds_read_b128 a[196:199], v193 offset:0
    ds_read_b128 a[200:203], v194 offset:0
    ds_read_b128 a[204:207], v195 offset:0
    ds_read_b128 a[208:211], v192 offset:1024
    ds_read_b128 a[212:215], v193 offset:1024
    ds_read_b128 a[216:219], v194 offset:1024
    ds_read_b128 a[220:223], v195 offset:1024
    s_waitcnt lgkmcnt(0)
    v_mfma_f32_16x16x32_bf16 v[64:67], a[192:195], v[0:3], 0
    v_mfma_f32_16x16x32_bf16 v[64:67], a[196:199], v[16:19], v[64:67]
    v_mfma_f32_16x16x32_bf16 v[64:67], a[200:203], v[32:35], v[64:67]
    v_mfma_f32_16x16x32_bf16 v[64:67], a[204:207], v[48:51], v[64:67]
    v_mfma_f32_16x16x32_bf16 v[68:71], a[220:223], v[48:51], 0
    v_mfma_f32_16x16x32_bf16 v[68:71], a[216:219], v[32:35], v[68:71]
    v_mfma_f32_16x16x32_bf16 v[68:71], a[212:215], v[16:19], v[68:71]
    v_mfma_f32_16x16x32_bf16 v[68:71], a[208:211], v[0:3], v[68:71]
    v_mfma_f32_16x16x32_bf16 v[76:79], a[208:211], v[4:7], 0
    v_mfma_f32_16x16x32_bf16 v[76:79], a[212:215], v[20:23], v[76:79]
    v_mfma_f32_16x16x32_bf16 v[76:79], a[216:219], v[36:39], v[76:79]
    v_mfma_f32_16x16x32_bf16 v[76:79], a[220:223], v[52:55], v[76:79]
    v_mfma_f32_16x16x32_bf16 v[72:75], a[204:207], v[52:55], 0
    v_mfma_f32_16x16x32_bf16 v[72:75], a[200:203], v[36:39], v[72:75]
    v_mfma_f32_16x16x32_bf16 v[72:75], a[196:199], v[20:23], v[72:75]
    v_mfma_f32_16x16x32_bf16 v[72:75], a[192:195], v[4:7], v[72:75]
    v_mfma_f32_16x16x32_bf16 v[80:83], a[192:195], v[8:11], 0
    v_mfma_f32_16x16x32_bf16 v[80:83], a[196:199], v[24:27], v[80:83]
    v_mfma_f32_16x16x32_bf16 v[80:83], a[200:203], v[40:43], v[80:83]
    v_mfma_f32_16x16x32_bf16 v[80:83], a[204:207], v[56:59], v[80:83]
    v_mfma_f32_16x16x32_bf16 v[84:87], a[220:223], v[56:59], 0
    v_mfma_f32_16x16x32_bf16 v[84:87], a[216:219], v[40:43], v[84:87]
    v_mfma_f32_16x16x32_bf16 v[84:87], a[212:215], v[24:27], v[84:87]
    v_mfma_f32_16x16x32_bf16 v[84:87], a[208:211], v[8:11], v[84:87]
    v_mfma_f32_16x16x32_bf16 v[92:95], a[208:211], v[12:15], 0
    v_mfma_f32_16x16x32_bf16 v[92:95], a[212:215], v[28:31], v[92:95]
    v_mfma_f32_16x16x32_bf16 v[92:95], a[216:219], v[44:47], v[92:95]
    v_mfma_f32_16x16x32_bf16 v[92:95], a[220:223], v[60:63], v[92:95]
    v_mfma_f32_16x16x32_bf16 v[88:91], a[204:207], v[60:63], 0
    v_mfma_f32_16x16x32_bf16 v[88:91], a[200:203], v[44:47], v[88:91]
    v_mfma_f32_16x16x32_bf16 v[88:91], a[196:199], v[28:31], v[88:91]
    v_mfma_f32_16x16x32_bf16 v[88:91], a[192:195], v[12:15], v[88:91]
    s_nop 7
    ds_read_b128 a[192:195], v192 offset:2048
    ds_read_b128 a[196:199], v193 offset:2048
    ds_read_b128 a[200:203], v194 offset:2048
    ds_read_b128 a[204:207], v195 offset:2048
    ds_read_b128 a[208:211], v192 offset:3072
    ds_read_b128 a[212:215], v193 offset:3072
    ds_read_b128 a[216:219], v194 offset:3072
    ds_read_b128 a[220:223], v195 offset:3072
    s_nop 7
    s_branch L_attn
L_codeend:
.section .rodata,"a"
.p2align 6
.amdhsa_kernel recurrent_scan__mha_block_cached__mixer_channel_mlp__prompt_kernel
  .amdhsa_next_free_vgpr 512
  .amdhsa_next_free_sgpr 102
  .amdhsa_accum_offset 256
  .amdhsa_group_segment_fixed_size 0
  .amdhsa_kernarg_size 104
  .amdhsa_user_sgpr_count 2
  .amdhsa_user_sgpr_kernarg_segment_ptr 1
  .amdhsa_system_sgpr_workgroup_id_x 1
.end_amdhsa_kernel
```
